```python
import torch

def _softmax(x, axis=-1):
    return torch.softmax(x, dim=axis)
def _gelu(x):
    return torch.nn.functional.gelu(x, approximate="tanh")
def _silu(x):
    return torch.nn.functional.silu(x)
def _sigmoid(x):
    return torch.sigmoid(x)
def _layernorm(x, axis=-1, eps=1e-5):
    m = x.mean(dim=axis, keepdim=True)
    v = x.var(dim=axis, keepdim=True, unbiased=False)
    return (x - m) / torch.sqrt(v + eps)
def _scatter_add(tgt, idx, src, axis=0):
    return tgt.clone().index_add_(axis, idx, src)
def _segment_sum(src, seg, n):
    out = torch.zeros((n,) + src.shape[1:], dtype=src.dtype)
    return out.index_add_(0, seg, src)
def _pad(x, pw):
    flat = tuple(v for pair in reversed(pw) for v in pair)
    return torch.nn.functional.pad(x, flat)

kernel_name = 'recurrent_scan__mha_block_cached__dense_activation_relu__prompt'

def setup_inputs():

    _w = (lambda a: (lambda t: t.to(torch.bfloat16) if t.is_floating_point() else t)(torch.as_tensor(a)))
    def _A_setup():
        B, Sq, D = 1, 2048, 576
        H, Sk, Dh = 32, 2048, 128
        return {
            "x": _w((lambda *s: torch.randn(*s, dtype=torch.bfloat16) * 0.05)(B, Sq, D)),
            "k_cache": _w((lambda *s: torch.randn(*s, dtype=torch.bfloat16) * 0.8)(B, H, Sk, Dh)),
            "v_cache": _w((lambda *s: torch.randn(*s, dtype=torch.bfloat16) * 0.2)(B, H, Sk, Dh)),
            "wq": _w((lambda *s: torch.randn(*s, dtype=torch.bfloat16) * 0.8)(D, H * Dh) * (D ** -0.5)),
            "wo": _w((lambda *s: torch.randn(*s, dtype=torch.bfloat16) * 0.2)(H * Dh, D) * ((H * Dh) ** -0.5)),
        }
    _A_in = _A_setup()

    def _B_setup():
        B, S, D, Dff = 1, 2048, 576, 4608
        return {
            "x": _w((lambda *s: torch.randn(*s, dtype=torch.bfloat16) * 0.05)(B, S, D)),
            "w1": _w((lambda *s: torch.randn(*s, dtype=torch.bfloat16) * 0.1)(D, Dff)),
            "w2": _w((lambda *s: torch.randn(*s, dtype=torch.bfloat16) * 0.1)(Dff, D)),
        }
    _B_in = _B_setup()

    return {
        "A_x": _A_in["x"],
        "A_k_cache": _A_in["k_cache"],
        "A_v_cache": _A_in["v_cache"],
        "A_wq": _A_in["wq"],
        "A_wo": _A_in["wo"],
        "B_x": _B_in["x"],
        "B_w1": _B_in["w1"],
        "B_w2": _B_in["w2"],
    }

def reference(A_x, A_k_cache, A_v_cache, A_wq, A_wo, B_x, B_w1, B_w2):
    def _A_ref(x, k_cache, v_cache, wq, wo):
        B, Sq, D = x.shape
        H, Dh = 32, 128
        q = (lambda x, *d: x.permute(*d))((x @ wq).reshape(B, Sq, H, Dh), 0, 2, 1, 3)
        scores = torch.einsum("bhqd,bhkd->bhqk", q, k_cache) * (Dh ** -0.5)
        p = _softmax(scores, axis=-1)
        o = torch.einsum("bhqk,bhkd->bhqd", p, v_cache)
        return (lambda x, *d: x.permute(*d))(o, 0, 2, 1, 3).reshape(B, Sq, H * Dh) @ wo

    def _B_ref(x, w1, w2):
        h = torch.einsum("bsd,df->bsf", x, w1)
        zero = torch.zeros_like(h)
        h = torch.maximum(h, zero)
        return torch.einsum("bsf,fd->bsd", h, w2)

    x = A_x
    xn = _layernorm(x, axis=-1)
    s = _A_ref(xn, A_k_cache, A_v_cache, A_wq, A_wo)
    g = _silu(_B_ref(xn, B_w1, B_w2))
    return x + s * g
```

```asm
; @launch grid=(256,1,1) block=(256,1,1) lds=163840
.amdgcn_target "amdgcn-amd-amdhsa--gfx950"
.text
.globl recurrent_scan__mha_block_cached__dense_activation_relu__prompt_kernel
.p2align 8
.type recurrent_scan__mha_block_cached__dense_activation_relu__prompt_kernel,@function
recurrent_scan__mha_block_cached__dense_activation_relu__prompt_kernel:
    s_cmp_ge_u32 s2, 256
    s_cbranch_scc1 Lend
    s_load_dwordx16 s[4:19], s[0:1], 0
    s_load_dwordx4 s[20:23], s[0:1], 64
    s_load_dwordx2 s[24:25], s[0:1], 80
    s_getpc_b64 s[92:93]
Lpc:
    s_and_b32 s93, s93, 0xffff
    s_mov_b32 s94, Lcode_end-Lpc
    s_mov_b32 s95, 0x20000
    v_and_b32 v1, 63, v0
    v_lshrrev_b32 v80, 6, v0
    s_and_b32 s71, s2, 7
    s_lshr_b32 s72, s2, 6
    s_lshl2_add_u32 s68, s71, s72
    s_lshr_b32 s69, s2, 3
    s_and_b32 s69, s69, 7
    v_readfirstlane_b32 s70, v80
    s_lshl_b32 s88, s69, 5
    s_add_u32 s88, s88, s68
    s_lshl1_add_u32 s88, s88, s70
    s_lshl_b32 s88, s88, 2
    v_and_b32 v84, 3, v1
    v_add_u32 v84, s88, v84
    v_lshrrev_b32 v85, 2, v1
    v_mul_u32_u24 v86, 1152, v84
    v_lshl_add_u32 v86, v85, 4, v86
    v_cmp_gt_u32 s[96:97], 8, v85
    v_mov_b32 v88, 1879048192
    s_lshl_b32 s82, s70, 11
    s_lshl_b32 s83, s70, 12
    v_cndmask_b32 v87, v88, v86, s[96:97]
    s_lshl_b32 s90, s69, 7
    s_add_u32 s90, s90, 12288
    v_mov_b32 v91, 0
    s_lshl3_add_u32 s86, s71, s69
    v_cmp_eq_u32 vcc, 0, v0
    s_cmp_ge_u32 s70, 2
    s_nop 0
    v_cndmask_b32 v63, v88, 0, vcc
    s_waitcnt lgkmcnt(0)
    s_cbranch_scc1 Lst_touch
    s_add_u32 s44, s4, 0
    s_addc_u32 s45, s5, 0
    s_and_b32 s45, s45, 0xffff
    s_mov_b32 s46, 2359296
    s_mov_b32 s47, 0x20000
    buffer_load_dwordx4 v[112:115], v86, s[44:47], 0 offen offset:0 nt
    buffer_load_dwordx4 v[116:119], v86, s[44:47], 0 offen offset:256 nt
    buffer_load_dwordx4 v[120:123], v86, s[44:47], 0 offen offset:512 nt
    buffer_load_dwordx4 v[124:127], v86, s[44:47], 0 offen offset:768 nt
    buffer_load_dwordx4 v[128:131], v87, s[44:47], 0 offen offset:1024 nt
    s_add_u32 s56, s24, 41943040
    s_addc_u32 s57, s25, 0
    s_and_b32 s57, s57, 0xffff
    s_mov_b32 s58, 106496
    s_mov_b32 s59, 0x20000
    buffer_load_dword v91, v91, s[56:59], s90 offen sc1
    v_and_b32 v80, 15, v0
    s_mul_i32 s88, s71, 1152
    s_add_u32 s48, s16, s88
    s_addc_u32 s49, s17, 0
    s_sub_u32 s50, 5308416, s88
    s_lshl_b32 s88, s71, 10
    s_add_u32 s84, s10, s88
    s_addc_u32 s85, s11, 0
    s_sub_u32 s88, 4718592, s88
    s_bitcmp1_b32 s70, 0
    s_cselect_b32 s48, s48, s84
    s_cselect_b32 s49, s49, s85
    s_cselect_b32 s50, s50, s88
    s_mov_b32 s89, 8192
    s_cselect_b32 s89, 9216, s89
    s_cselect_b32 s88, 8, 7
    s_and_b32 s49, s49, 0xffff
    s_mov_b32 s51, 0x20000
    v_min_u32 v80, s88, v80
    s_lshr_b32 s88, s2, 3
    v_and_b32 v81, 32, v0
    v_add_u32 v81, s88, v81
    v_mul_u32_u24 v81, s89, v81
    v_lshl_add_u32 v79, v80, 7, v81
    s_lshl_b32 s84, s89, 6
    s_mov_b32 s23, 0
    s_mov_b32 s85, 262144
    v_mov_b32 v79, 1879048192
    s_add_u32 s28, s24, 0
    s_addc_u32 s29, s25, 0
    s_and_b32 s29, s29, 0xffff
    s_mov_b32 s30, 2359296
    s_mov_b32 s31, 0x20000
    v_lshrrev_b32 v80, 2, v85
    v_lshlrev_b32 v80, 17, v80
    v_and_b32 v81, 3, v85
    v_lshl_add_u32 v80, v81, 8, v80
    v_lshrrev_b32 v81, 4, v84
    v_lshl_add_u32 v80, v81, 10, v80
    v_and_b32 v81, 15, v84
    v_lshl_add_u32 v86, v81, 4, v80
    v_cndmask_b32 v87, v88, v86, s[96:97]
    s_lshl_b32 s88, s86, 5
    s_add_u32 s88, s88, s72
    s_lshl_b32 s88, s88, 2
    s_getreg_b32 s89, hwreg(HW_REG_XCC_ID, 0, 4)
    v_mov_b32 v90, s89
    v_cmp_eq_u32 vcc, 2, v0
    v_lshl_add_u32 v80, v0, 4, s88
    s_lshr_b32 s88, s2, 3
    v_cndmask_b32 v90, 0, v90, vcc
    s_lshl_b32 s88, s88, 5
    s_add_u32 s88, s88, s71
    s_lshl_b32 s88, s88, 2
    s_add_u32 s88, s88, 8000
    v_cmp_gt_u32 vcc, 6, v0
    v_lshl_add_u32 v81, v0, 5, s88
    s_nop 0
    v_cndmask_b32 v80, v81, v80, vcc
    v_cmp_gt_u32 vcc, 10, v0
    s_nop 1
    v_cndmask_b32 v80, v88, v80, vcc
    buffer_store_dword v90, v80, s[56:59], 0 offen sc1
    s_mov_b32 s88, 98304
    buffer_store_dword v90, v80, s[56:59], s88 offen sc1
    v_cmp_eq_u32 vcc, 0, v85
    v_lshlrev_b32 v89, 3, v84
    s_mov_b32 s26, 81920
    v_cndmask_b32 v89, v88, v89, vcc
    s_lshl_b32 s88, s70, 7
    v_add_u32 v80, s88, v1
    v_mul_u32_u24 v81, 3641, v80
    v_lshrrev_b32 v81, 16, v81
    v_mul_u32_u24 v82, 18, v81
    v_sub_u32 v82, v80, v82
    v_bfe_u32 v83, v81, 2, 2
    v_lshlrev_b32 v83, 3, v83
    v_and_b32 v64, 3, v81
    v_or_b32 v83, v83, v64
    v_bfe_u32 v64, v81, 4, 1
    v_lshl_or_b32 v83, v64, 2, v83
    v_mul_u32_u24 v83, 8192, v83
    v_lshl_add_u32 v64, v82, 4, v83
    v_cmp_le_u32 vcc, 16, v82
    v_mov_b32 v81, 1879048192
    s_nop 0
    v_cndmask_b32 v64, v64, v81, vcc
    v_mul_u32_u24 v81, 3641, v80
    v_lshrrev_b32 v81, 16, v81
    v_mul_u32_u24 v82, 18, v81
    v_sub_u32 v82, v80, v82
    v_bfe_u32 v83, v81, 2, 2
    v_lshlrev_b32 v83, 3, v83
    v_and_b32 v66, 3, v81
    v_or_b32 v83, v83, v66
    v_bfe_u32 v66, v81, 4, 1
    v_lshl_or_b32 v83, v66, 2, v83
    v_mul_u32_u24 v83, 9216, v83
    v_lshl_add_u32 v66, v82, 4, v83
    v_add_u32 v80, 64, v80
    v_mul_u32_u24 v81, 3641, v80
    v_lshrrev_b32 v81, 16, v81
    v_mul_u32_u24 v82, 18, v81
    v_sub_u32 v82, v80, v82
    v_bfe_u32 v83, v81, 2, 2
    v_lshlrev_b32 v83, 3, v83
    v_and_b32 v65, 3, v81
    v_or_b32 v83, v83, v65
    v_bfe_u32 v65, v81, 4, 1
    v_lshl_or_b32 v83, v65, 2, v83
    v_mul_u32_u24 v83, 8192, v83
    v_lshl_add_u32 v65, v82, 4, v83
    v_cmp_le_u32 vcc, 16, v82
    v_mov_b32 v81, 1879048192
    s_nop 0
    v_cndmask_b32 v65, v65, v81, vcc
    v_mul_u32_u24 v81, 3641, v80
    v_lshrrev_b32 v81, 16, v81
    v_mul_u32_u24 v82, 18, v81
    v_sub_u32 v82, v80, v82
    v_bfe_u32 v83, v81, 2, 2
    v_lshlrev_b32 v83, 3, v83
    v_and_b32 v67, 3, v81
    v_or_b32 v83, v83, v67
    v_bfe_u32 v67, v81, 4, 1
    v_lshl_or_b32 v83, v67, 2, v83
    v_mul_u32_u24 v83, 9216, v83
    v_lshl_add_u32 v67, v82, 4, v83
    s_bitcmp0_b32 s70, 0
    s_mov_b32 s88, 9216
    s_cselect_b32 s88, 8192, s88
    s_cselect_b32 s89, 16, 18
    s_mul_i32 s78, s70, 9216
    s_add_u32 s78, s78, 8192
    v_add_u32 v80, 512, v1
    v_mul_u32_u24 v81, 3641, v80
    v_lshrrev_b32 v81, 16, v81
    v_mul_u32_u24 v82, 18, v81
    v_sub_u32 v82, v80, v82
    v_bfe_u32 v83, v81, 2, 2
    v_lshlrev_b32 v83, 3, v83
    v_and_b32 v68, 3, v81
    v_or_b32 v83, v83, v68
    v_bfe_u32 v68, v81, 4, 1
    v_lshl_or_b32 v83, v68, 2, v83
    v_mul_u32_u24 v83, s88, v83
    v_lshl_add_u32 v68, v82, 4, v83
    v_cmp_le_u32 vcc, s89, v82
    v_mov_b32 v81, 1879048192
    s_nop 0
    v_cndmask_b32 v68, v68, v81, vcc
    s_lshl_b32 s77, s88, 6
    s_lshr_b32 s76, s70, 1
    s_mul_i32 s76, s76, s88
    s_lshl_b32 s76, s76, 5
    s_lshl_b32 s88, s68, 8
    s_add_u32 s32, s10, s88
    s_addc_u32 s33, s11, 0
    s_and_b32 s33, s33, 0xffff
    s_sub_u32 s34, 4718592, s88
    s_mov_b32 s35, 0x20000
    s_mul_i32 s88, s68, 288
    s_add_u32 s36, s16, s88
    s_addc_u32 s37, s17, 0
    s_and_b32 s37, s37, 0xffff
    s_sub_u32 s38, 5308416, s88
    s_mov_b32 s39, 0x20000
    s_bitcmp0_b32 s70, 0
    s_cselect_b32 s40, s32, s36
    s_cselect_b32 s41, s33, s37
    s_cselect_b32 s42, s34, s38
    s_mov_b32 s43, 0x20000
    s_mov_b32 s73, 0
    s_mov_b32 s74, 0
    s_mov_b32 s75, 0
    s_waitcnt vmcnt(7)
    v_lshlrev_b32 v144, 16, v112
    v_and_b32 v145, 0xffff0000, v112
    v_lshlrev_b32 v146, 16, v113
    v_and_b32 v147, 0xffff0000, v113
    v_lshlrev_b32 v148, 16, v114
    v_and_b32 v149, 0xffff0000, v114
    v_lshlrev_b32 v150, 16, v115
    v_and_b32 v151, 0xffff0000, v115
    s_waitcnt vmcnt(6)
    v_lshlrev_b32 v152, 16, v116
    v_and_b32 v153, 0xffff0000, v116
    v_lshlrev_b32 v154, 16, v117
    v_and_b32 v155, 0xffff0000, v117
    v_lshlrev_b32 v156, 16, v118
    v_and_b32 v157, 0xffff0000, v118
    v_lshlrev_b32 v158, 16, v119
    v_and_b32 v159, 0xffff0000, v119
    s_waitcnt vmcnt(5)
    v_lshlrev_b32 v160, 16, v120
    v_and_b32 v161, 0xffff0000, v120
    v_lshlrev_b32 v162, 16, v121
    v_and_b32 v163, 0xffff0000, v121
    v_lshlrev_b32 v164, 16, v122
    v_and_b32 v165, 0xffff0000, v122
    v_lshlrev_b32 v166, 16, v123
    v_and_b32 v167, 0xffff0000, v123
    s_waitcnt vmcnt(4)
    v_lshlrev_b32 v168, 16, v124
    v_and_b32 v169, 0xffff0000, v124
    v_lshlrev_b32 v170, 16, v125
    v_and_b32 v171, 0xffff0000, v125
    v_lshlrev_b32 v172, 16, v126
    v_and_b32 v173, 0xffff0000, v126
    v_lshlrev_b32 v174, 16, v127
    v_and_b32 v175, 0xffff0000, v127
    s_waitcnt vmcnt(3)
    v_lshlrev_b32 v176, 16, v128
    v_and_b32 v177, 0xffff0000, v128
    v_lshlrev_b32 v178, 16, v129
    v_and_b32 v179, 0xffff0000, v129
    v_lshlrev_b32 v180, 16, v130
    v_and_b32 v181, 0xffff0000, v130
    v_lshlrev_b32 v182, 16, v131
    v_and_b32 v183, 0xffff0000, v131
    v_pk_add_f32 v[92:93], v[144:145], v[146:147]
    v_pk_add_f32 v[94:95], v[148:149], v[150:151]
    v_pk_add_f32 v[92:93], v[92:93], v[152:153]
    v_pk_add_f32 v[94:95], v[94:95], v[154:155]
    v_pk_add_f32 v[92:93], v[92:93], v[156:157]
    v_pk_add_f32 v[94:95], v[94:95], v[158:159]
    v_pk_add_f32 v[92:93], v[92:93], v[160:161]
    v_pk_add_f32 v[94:95], v[94:95], v[162:163]
    v_pk_add_f32 v[92:93], v[92:93], v[164:165]
    v_pk_add_f32 v[94:95], v[94:95], v[166:167]
    v_pk_add_f32 v[92:93], v[92:93], v[168:169]
    v_pk_add_f32 v[94:95], v[94:95], v[170:171]
    v_pk_add_f32 v[92:93], v[92:93], v[172:173]
    v_pk_add_f32 v[94:95], v[94:95], v[174:175]
    v_pk_add_f32 v[92:93], v[92:93], v[176:177]
    v_pk_add_f32 v[94:95], v[94:95], v[178:179]
    v_pk_add_f32 v[92:93], v[92:93], v[180:181]
    v_pk_add_f32 v[94:95], v[94:95], v[182:183]
    v_pk_add_f32 v[92:93], v[92:93], v[94:95]
    v_add_f32 v92, v92, v93
    s_nop 1
    v_add_f32_dpp v92, v92, v92 row_ror:4 row_mask:0xf bank_mask:0xf
    s_nop 1
    v_add_f32_dpp v92, v92, v92 row_ror:8 row_mask:0xf bank_mask:0xf
    v_mov_b32 v96, v92
    s_nop 1
    v_permlane32_swap_b32 v92, v96
    s_nop 1
    v_add_f32 v92, v92, v96
    v_mov_b32 v96, v92
    s_nop 1
    v_permlane16_swap_b32 v92, v96
    s_nop 1
    v_add_f32 v92, v92, v96
    v_mul_f32 v92, 0xbae38e39, v92
    s_nop 0
    v_cndmask_b32 v93, 0, v92, s[96:97]
    v_pk_add_f32 v[144:145], v[144:145], v[92:93] op_sel:[0,0] op_sel_hi:[1,0]
    v_pk_add_f32 v[146:147], v[146:147], v[92:93] op_sel:[0,0] op_sel_hi:[1,0]
    v_pk_add_f32 v[148:149], v[148:149], v[92:93] op_sel:[0,0] op_sel_hi:[1,0]
    v_pk_add_f32 v[150:151], v[150:151], v[92:93] op_sel:[0,0] op_sel_hi:[1,0]
    v_pk_add_f32 v[152:153], v[152:153], v[92:93] op_sel:[0,0] op_sel_hi:[1,0]
    v_pk_add_f32 v[154:155], v[154:155], v[92:93] op_sel:[0,0] op_sel_hi:[1,0]
    v_pk_add_f32 v[156:157], v[156:157], v[92:93] op_sel:[0,0] op_sel_hi:[1,0]
    v_pk_add_f32 v[158:159], v[158:159], v[92:93] op_sel:[0,0] op_sel_hi:[1,0]
    v_pk_add_f32 v[160:161], v[160:161], v[92:93] op_sel:[0,0] op_sel_hi:[1,0]
    v_pk_add_f32 v[162:163], v[162:163], v[92:93] op_sel:[0,0] op_sel_hi:[1,0]
    v_pk_add_f32 v[164:165], v[164:165], v[92:93] op_sel:[0,0] op_sel_hi:[1,0]
    v_pk_add_f32 v[166:167], v[166:167], v[92:93] op_sel:[0,0] op_sel_hi:[1,0]
    v_pk_add_f32 v[168:169], v[168:169], v[92:93] op_sel:[0,0] op_sel_hi:[1,0]
    v_pk_add_f32 v[170:171], v[170:171], v[92:93] op_sel:[0,0] op_sel_hi:[1,0]
    v_pk_add_f32 v[172:173], v[172:173], v[92:93] op_sel:[0,0] op_sel_hi:[1,0]
    v_pk_add_f32 v[174:175], v[174:175], v[92:93] op_sel:[0,0] op_sel_hi:[1,0]
    v_pk_add_f32 v[176:177], v[176:177], v[92:93] op_sel:[0,1] op_sel_hi:[1,1]
    v_pk_add_f32 v[178:179], v[178:179], v[92:93] op_sel:[0,1] op_sel_hi:[1,1]
    v_pk_add_f32 v[180:181], v[180:181], v[92:93] op_sel:[0,1] op_sel_hi:[1,1]
    v_pk_add_f32 v[182:183], v[182:183], v[92:93] op_sel:[0,1] op_sel_hi:[1,1]
    s_waitcnt vmcnt(2)
    v_readfirstlane_b32 s22, v91
    s_nop 0
    s_mul_i32 s22, s22, 0x9e3779b1
    s_add_u32 s22, s22, 0x7f4a7c15
    s_or_b32 s22, s22, 1
    v_mov_b32 v91, s22
    v_pk_mul_f32 v[94:95], v[144:145], v[144:145]
    v_pk_mul_f32 v[98:99], v[146:147], v[146:147]
    v_pk_fma_f32 v[94:95], v[148:149], v[148:149], v[94:95]
    v_pk_fma_f32 v[98:99], v[150:151], v[150:151], v[98:99]
    v_pk_fma_f32 v[94:95], v[152:153], v[152:153], v[94:95]
    v_pk_fma_f32 v[98:99], v[154:155], v[154:155], v[98:99]
    v_pk_fma_f32 v[94:95], v[156:157], v[156:157], v[94:95]
    v_pk_fma_f32 v[98:99], v[158:159], v[158:159], v[98:99]
    v_pk_fma_f32 v[94:95], v[160:161], v[160:161], v[94:95]
    v_pk_fma_f32 v[98:99], v[162:163], v[162:163], v[98:99]
    v_pk_fma_f32 v[94:95], v[164:165], v[164:165], v[94:95]
    v_pk_fma_f32 v[98:99], v[166:167], v[166:167], v[98:99]
    v_pk_fma_f32 v[94:95], v[168:169], v[168:169], v[94:95]
    v_pk_fma_f32 v[98:99], v[170:171], v[170:171], v[98:99]
    v_pk_fma_f32 v[94:95], v[172:173], v[172:173], v[94:95]
    v_pk_fma_f32 v[98:99], v[174:175], v[174:175], v[98:99]
    v_pk_fma_f32 v[94:95], v[176:177], v[176:177], v[94:95]
    v_pk_fma_f32 v[98:99], v[178:179], v[178:179], v[98:99]
    v_pk_fma_f32 v[94:95], v[180:181], v[180:181], v[94:95]
    v_pk_fma_f32 v[98:99], v[182:183], v[182:183], v[98:99]
    v_pk_add_f32 v[94:95], v[94:95], v[98:99]
    v_add_f32 v94, v94, v95
    s_nop 1
    v_add_f32_dpp v94, v94, v94 row_ror:4 row_mask:0xf bank_mask:0xf
    s_nop 1
    v_add_f32_dpp v94, v94, v94 row_ror:8 row_mask:0xf bank_mask:0xf
    v_mov_b32 v96, v94
    s_nop 1
    v_permlane32_swap_b32 v94, v96
    s_nop 1
    v_add_f32 v94, v94, v96
    v_mov_b32 v96, v94
    s_nop 1
    v_permlane16_swap_b32 v94, v96
    s_nop 1
    v_add_f32 v94, v94, v96
    v_mul_f32 v94, 0x3ae38e39, v94
    v_cvt_pk_bf16_f32 v94, v94, v94
    v_lshlrev_b32 v94, 16, v94
    v_add_f32 v94, 0x3727c5ac, v94
    v_cvt_pk_bf16_f32 v94, v94, v94
    v_lshlrev_b32 v94, 16, v94
    v_sqrt_f32 v94, v94
    v_mov_b32 v93, v92
    v_cvt_pk_bf16_f32 v94, v94, v94
    v_lshlrev_b32 v94, 16, v94
    v_cvt_pk_bf16_f32 v93, v93, v93
    v_lshlrev_b32 v93, 16, v93
    v_lshrrev_b32 v90, 16, v94
    v_or_b32 v90, v90, v93
    buffer_store_dwordx2 v[90:91], v89, s[56:59], s26 offen sc1
    v_rcp_f32 v94, v94
    s_nop 0
    v_mul_f32 v94, 1040356334, v94
    v_sub_f32 v92, v93, v92
    v_mul_f32 v95, v92, v94
    v_pk_fma_f32 v[144:145], v[144:145], v[94:95], v[94:95] op_sel:[0,0,1] op_sel_hi:[1,0,1]
    v_pk_fma_f32 v[146:147], v[146:147], v[94:95], v[94:95] op_sel:[0,0,1] op_sel_hi:[1,0,1]
    v_pk_fma_f32 v[148:149], v[148:149], v[94:95], v[94:95] op_sel:[0,0,1] op_sel_hi:[1,0,1]
    v_pk_fma_f32 v[150:151], v[150:151], v[94:95], v[94:95] op_sel:[0,0,1] op_sel_hi:[1,0,1]
    v_cvt_pk_bf16_f32 v112, v144, v145
    v_cvt_pk_bf16_f32 v113, v146, v147
    v_cvt_pk_bf16_f32 v114, v148, v149
    v_cvt_pk_bf16_f32 v115, v150, v151
    s_mov_b32 s91, 0
    buffer_store_dwordx4 v[112:115], v86, s[28:31], s91 offen sc1
    v_pk_fma_f32 v[152:153], v[152:153], v[94:95], v[94:95] op_sel:[0,0,1] op_sel_hi:[1,0,1]
    v_pk_fma_f32 v[154:155], v[154:155], v[94:95], v[94:95] op_sel:[0,0,1] op_sel_hi:[1,0,1]
    v_pk_fma_f32 v[156:157], v[156:157], v[94:95], v[94:95] op_sel:[0,0,1] op_sel_hi:[1,0,1]
    v_pk_fma_f32 v[158:159], v[158:159], v[94:95], v[94:95] op_sel:[0,0,1] op_sel_hi:[1,0,1]
    v_cvt_pk_bf16_f32 v116, v152, v153
    v_cvt_pk_bf16_f32 v117, v154, v155
    v_cvt_pk_bf16_f32 v118, v156, v157
    v_cvt_pk_bf16_f32 v119, v158, v159
    s_mov_b32 s91, 524288
    buffer_store_dwordx4 v[116:119], v86, s[28:31], s91 offen sc1
    v_pk_fma_f32 v[160:161], v[160:161], v[94:95], v[94:95] op_sel:[0,0,1] op_sel_hi:[1,0,1]
    v_pk_fma_f32 v[162:163], v[162:163], v[94:95], v[94:95] op_sel:[0,0,1] op_sel_hi:[1,0,1]
    v_pk_fma_f32 v[164:165], v[164:165], v[94:95], v[94:95] op_sel:[0,0,1] op_sel_hi:[1,0,1]
    v_pk_fma_f32 v[166:167], v[166:167], v[94:95], v[94:95] op_sel:[0,0,1] op_sel_hi:[1,0,1]
    v_cvt_pk_bf16_f32 v120, v160, v161
    v_cvt_pk_bf16_f32 v121, v162, v163
    v_cvt_pk_bf16_f32 v122, v164, v165
    v_cvt_pk_bf16_f32 v123, v166, v167
    s_mov_b32 s91, 1048576
    buffer_store_dwordx4 v[120:123], v86, s[28:31], s91 offen sc1
    v_pk_fma_f32 v[168:169], v[168:169], v[94:95], v[94:95] op_sel:[0,0,1] op_sel_hi:[1,0,1]
    v_pk_fma_f32 v[170:171], v[170:171], v[94:95], v[94:95] op_sel:[0,0,1] op_sel_hi:[1,0,1]
    v_pk_fma_f32 v[172:173], v[172:173], v[94:95], v[94:95] op_sel:[0,0,1] op_sel_hi:[1,0,1]
    v_pk_fma_f32 v[174:175], v[174:175], v[94:95], v[94:95] op_sel:[0,0,1] op_sel_hi:[1,0,1]
    v_cvt_pk_bf16_f32 v124, v168, v169
    v_cvt_pk_bf16_f32 v125, v170, v171
    v_cvt_pk_bf16_f32 v126, v172, v173
    v_cvt_pk_bf16_f32 v127, v174, v175
    s_mov_b32 s91, 1572864
    buffer_store_dwordx4 v[124:127], v86, s[28:31], s91 offen sc1
    v_pk_fma_f32 v[176:177], v[176:177], v[94:95], v[94:95] op_sel:[0,0,1] op_sel_hi:[1,0,1]
    v_pk_fma_f32 v[178:179], v[178:179], v[94:95], v[94:95] op_sel:[0,0,1] op_sel_hi:[1,0,1]
    v_pk_fma_f32 v[180:181], v[180:181], v[94:95], v[94:95] op_sel:[0,0,1] op_sel_hi:[1,0,1]
    v_pk_fma_f32 v[182:183], v[182:183], v[94:95], v[94:95] op_sel:[0,0,1] op_sel_hi:[1,0,1]
    v_cvt_pk_bf16_f32 v128, v176, v177
    v_cvt_pk_bf16_f32 v129, v178, v179
    v_cvt_pk_bf16_f32 v130, v180, v181
    v_cvt_pk_bf16_f32 v131, v182, v183
    s_mov_b32 s91, 2097152
    buffer_store_dwordx4 v[128:131], v87, s[28:31], s91 offen sc1
    s_branch Lst_join
Lst_touch:
    s_add_u32 s56, s24, 41943040
    s_addc_u32 s57, s25, 0
    s_and_b32 s57, s57, 0xffff
    s_mov_b32 s58, 106496
    s_mov_b32 s59, 0x20000
    buffer_load_dword v91, v91, s[56:59], s90 offen sc1
    s_add_u32 s44, s4, 0
    s_addc_u32 s45, s5, 0
    s_and_b32 s45, s45, 0xffff
    s_mov_b32 s46, 2359296
    s_mov_b32 s47, 0x20000
    s_lshr_b32 s88, s2, 3
    s_lshl1_add_u32 s88, s88, s70
    s_sub_u32 s88, s88, 2
    s_lshl_b32 s88, s88, 11
    v_and_b32 v80, 15, v0
    v_lshl_add_u32 v82, v80, 7, s88
    s_lshl2_add_u32 s88, s69, s72
    s_lshl1_add_u32 s88, s88, s70
    s_sub_u32 s88, s88, 2
    s_mul_i32 s88, s88, 36864
    v_and_b32 v80, 31, v0
    v_mul_u32_u24 v83, 1152, v80
    buffer_load_dword v76, v83, s[44:47], s88 offen
    buffer_load_dword v76, v82, s[92:95], 0 offen
    v_and_b32 v80, 15, v0
    s_mul_i32 s88, s71, 1152
    s_add_u32 s48, s16, s88
    s_addc_u32 s49, s17, 0
    s_sub_u32 s50, 5308416, s88
    s_lshl_b32 s88, s71, 10
    s_add_u32 s84, s10, s88
    s_addc_u32 s85, s11, 0
    s_sub_u32 s88, 4718592, s88
    s_bitcmp1_b32 s70, 0
    s_cselect_b32 s48, s48, s84
    s_cselect_b32 s49, s49, s85
    s_cselect_b32 s50, s50, s88
    s_mov_b32 s89, 8192
    s_cselect_b32 s89, 9216, s89
    s_cselect_b32 s88, 8, 7
    s_and_b32 s49, s49, 0xffff
    s_mov_b32 s51, 0x20000
    v_min_u32 v80, s88, v80
    s_lshr_b32 s88, s2, 3
    v_and_b32 v81, 32, v0
    v_add_u32 v81, s88, v81
    v_mul_u32_u24 v81, s89, v81
    v_lshl_add_u32 v79, v80, 7, v81
    s_lshl_b32 s84, s89, 6
    s_mov_b32 s23, 0
    s_mov_b32 s85, 262144
    buffer_load_dword v76, v79, s[48:51], s23 offen sc1
    s_add_u32 s23, s23, s84
    buffer_load_dword v76, v79, s[48:51], s23 offen sc1
    s_add_u32 s23, s23, s84
    buffer_load_dword v76, v79, s[48:51], s23 offen sc1
    s_add_u32 s23, s23, s84
    buffer_load_dword v76, v79, s[48:51], s23 offen sc1
    s_add_u32 s23, s23, s84
    s_add_u32 s28, s24, 0
    s_addc_u32 s29, s25, 0
    s_and_b32 s29, s29, 0xffff
    s_mov_b32 s30, 2359296
    s_mov_b32 s31, 0x20000
    s_lshl_b32 s88, s70, 7
    v_add_u32 v80, s88, v1
    v_mul_u32_u24 v81, 3641, v80
    v_lshrrev_b32 v81, 16, v81
    v_mul_u32_u24 v82, 18, v81
    v_sub_u32 v82, v80, v82
    v_bfe_u32 v83, v81, 2, 2
    v_lshlrev_b32 v83, 3, v83
    v_and_b32 v64, 3, v81
    v_or_b32 v83, v83, v64
    v_bfe_u32 v64, v81, 4, 1
    v_lshl_or_b32 v83, v64, 2, v83
    v_mul_u32_u24 v83, 8192, v83
    v_lshl_add_u32 v64, v82, 4, v83
    v_cmp_le_u32 vcc, 16, v82
    v_mov_b32 v81, 1879048192
    s_nop 0
    v_cndmask_b32 v64, v64, v81, vcc
    v_mul_u32_u24 v81, 3641, v80
    v_lshrrev_b32 v81, 16, v81
    v_mul_u32_u24 v82, 18, v81
    v_sub_u32 v82, v80, v82
    v_bfe_u32 v83, v81, 2, 2
    v_lshlrev_b32 v83, 3, v83
    v_and_b32 v66, 3, v81
    v_or_b32 v83, v83, v66
    v_bfe_u32 v66, v81, 4, 1
    v_lshl_or_b32 v83, v66, 2, v83
    v_mul_u32_u24 v83, 9216, v83
    v_lshl_add_u32 v66, v82, 4, v83
    v_add_u32 v80, 64, v80
    v_mul_u32_u24 v81, 3641, v80
    v_lshrrev_b32 v81, 16, v81
    v_mul_u32_u24 v82, 18, v81
    v_sub_u32 v82, v80, v82
    v_bfe_u32 v83, v81, 2, 2
    v_lshlrev_b32 v83, 3, v83
    v_and_b32 v65, 3, v81
    v_or_b32 v83, v83, v65
    v_bfe_u32 v65, v81, 4, 1
    v_lshl_or_b32 v83, v65, 2, v83
    v_mul_u32_u24 v83, 8192, v83
    v_lshl_add_u32 v65, v82, 4, v83
    v_cmp_le_u32 vcc, 16, v82
    v_mov_b32 v81, 1879048192
    s_nop 0
    v_cndmask_b32 v65, v65, v81, vcc
    v_mul_u32_u24 v81, 3641, v80
    v_lshrrev_b32 v81, 16, v81
    v_mul_u32_u24 v82, 18, v81
    v_sub_u32 v82, v80, v82
    v_bfe_u32 v83, v81, 2, 2
    v_lshlrev_b32 v83, 3, v83
    v_and_b32 v67, 3, v81
    v_or_b32 v83, v83, v67
    v_bfe_u32 v67, v81, 4, 1
    v_lshl_or_b32 v83, v67, 2, v83
    v_mul_u32_u24 v83, 9216, v83
    v_lshl_add_u32 v67, v82, 4, v83
    s_bitcmp0_b32 s70, 0
    s_mov_b32 s88, 9216
    s_cselect_b32 s88, 8192, s88
    s_cselect_b32 s89, 16, 18
    s_mul_i32 s78, s70, 9216
    s_add_u32 s78, s78, 8192
    v_add_u32 v80, 512, v1
    v_mul_u32_u24 v81, 3641, v80
    v_lshrrev_b32 v81, 16, v81
    v_mul_u32_u24 v82, 18, v81
    v_sub_u32 v82, v80, v82
    v_bfe_u32 v83, v81, 2, 2
    v_lshlrev_b32 v83, 3, v83
    v_and_b32 v68, 3, v81
    v_or_b32 v83, v83, v68
    v_bfe_u32 v68, v81, 4, 1
    v_lshl_or_b32 v83, v68, 2, v83
    v_mul_u32_u24 v83, s88, v83
    v_lshl_add_u32 v68, v82, 4, v83
    v_cmp_le_u32 vcc, s89, v82
    v_mov_b32 v81, 1879048192
    s_nop 0
    v_cndmask_b32 v68, v68, v81, vcc
    s_lshl_b32 s77, s88, 6
    s_lshr_b32 s76, s70, 1
    s_mul_i32 s76, s76, s88
    s_lshl_b32 s76, s76, 5
    s_lshl_b32 s88, s68, 8
    s_add_u32 s32, s10, s88
    s_addc_u32 s33, s11, 0
    s_and_b32 s33, s33, 0xffff
    s_sub_u32 s34, 4718592, s88
    s_mov_b32 s35, 0x20000
    s_mul_i32 s88, s68, 288
    s_add_u32 s36, s16, s88
    s_addc_u32 s37, s17, 0
    s_and_b32 s37, s37, 0xffff
    s_sub_u32 s38, 5308416, s88
    s_mov_b32 s39, 0x20000
    s_bitcmp0_b32 s70, 0
    s_cselect_b32 s40, s32, s36
    s_cselect_b32 s41, s33, s37
    s_cselect_b32 s42, s34, s38
    s_mov_b32 s43, 0x20000
    s_mov_b32 s73, 0
    s_mov_b32 s74, 0
    s_mov_b32 s75, 0
Lst_join:
    s_lshl_b32 s88, s69, 14
    s_add_u32 s88, s88, s83
    v_lshl_add_u32 v2, v1, 4, s88
    v_lshrrev_b32 v80, 2, v1
    v_mul_u32_u24 v80, 288, v80
    v_and_b32 v81, 3, v1
    v_lshl_add_u32 v70, v81, 4, v80
    v_add_u32 v69, 73728, v70
    v_lshl_add_u32 v56, v81, 3, v80
    s_bitcmp1_b32 s68, 0
    s_mov_b32 s89, 9216
    s_cselect_b32 s89, 9248, s89
    s_mov_b32 s88, 9472
    s_cselect_b32 s88, 9216, s88
    v_add_u32 v72, s89, v56
    v_add_u32 v74, s88, v56
    v_add_u32 v71, 73728, v72
    v_add_u32 v73, 73728, v74
    s_lshr_b32 s88, s72, 1
    s_lshl_b32 s88, s88, 3
    s_add_u32 s88, s88, s69
    s_lshl_b32 s88, s88, 1
    s_and_b32 s89, s72, 1
    s_add_u32 s88, s88, s89
    s_lshl2_add_u32 s88, s88, s70
    s_lshl_b32 s88, s88, 11
    v_and_b32 v80, 15, v0
    v_lshl_add_u32 v77, v80, 7, s88
    s_lshl_b32 s14, s86, 7
    s_lshr_b32 s15, s2, 3
    s_lshl_b32 s15, s15, 7
    s_add_u32 s15, s15, 8192
    s_lshl_b32 s86, s69, 13
    s_add_u32 s86, s86, 16384
    v_lshlrev_b32 v24, 7, v1
    s_lshl2_add_u32 s88, s69, s70
    s_mul_i32 s89, s88, 73728
    v_lshrrev_b32 v80, 3, v1
    v_mul_u32_u24 v80, 1152, v80
    v_lshrrev_b32 v81, 4, v1
    v_xor_b32 v81, v81, v1
    v_and_b32 v81, 7, v81
    v_lshlrev_b32 v81, 4, v81
    v_add3_u32 v84, v80, v81, s89
    v_xor_b32 v81, 64, v81
    v_add3_u32 v85, v80, v81, s89
    s_lshl_b32 s88, s88, 9
    s_add_u32 s88, s88, 81920
    v_and_b32 v80, 15, v1
    v_lshl_add_u32 v86, v80, 3, s88
    v_bfe_u32 v81, v1, 1, 3
    v_lshrrev_b32 v82, 4, v1
    v_xor_b32 v81, v81, v82
    v_lshlrev_b32 v81, 4, v81
    v_lshl_add_u32 v81, v80, 7, v81
    s_lshl_b32 s91, s70, 13
    s_add_u32 s91, s91, 110592
    v_add_u32 v87, s91, v81
    v_xor_b32 v88, 64, v87
    s_lshl1_add_u32 s26, s68, s70
    s_lshl_b32 s26, s26, 7
    s_add_u32 s26, s26, s86
    v_cmp_eq_u32 vcc, 0, v1
    v_mov_b32 v89, 1879048192
    s_cmp_lt_u32 s70, 2
    s_cselect_b32 s26, s26, 1879048192
    v_cndmask_b32 v89, v89, 0, vcc
    s_cbranch_scc0 Lst_hop
    s_waitcnt vmcnt(0)
    buffer_store_dword v91, v89, s[56:59], s26 offen sc1
    s_branch Lwalk_done
Lst_hop:
    s_waitcnt vmcnt(3)
    v_readfirstlane_b32 s22, v91
    s_nop 0
    s_mul_i32 s22, s22, 0x9e3779b1
    s_add_u32 s22, s22, 0x7f4a7c15
    s_or_b32 s22, s22, 1
    v_mov_b32 v91, s22
    s_mov_b64 exec, 0
    s_cmp_eq_u32 s70, 2
    s_cbranch_scc1 Lpad0
    s_branch Lpad1
.p2align 12
Lwalk_done:
    s_mov_b64 exec, -1
    s_add_u32 m0, s91, 0
    s_mov_b32 s88, 0
    buffer_load_dwordx4 v84, s[44:47], s88 offen lds
    s_add_u32 m0, s91, 1024
    s_mov_b32 s88, 9216
    buffer_load_dwordx4 v85, s[44:47], s88 offen lds
    s_add_u32 m0, s91, 2048
    s_mov_b32 s88, 18432
    buffer_load_dwordx4 v84, s[44:47], s88 offen lds
    s_add_u32 m0, s91, 3072
    s_mov_b32 s88, 27648
    buffer_load_dwordx4 v85, s[44:47], s88 offen lds
    s_add_u32 m0, s91, 4096
    s_mov_b32 s88, 36864
    buffer_load_dwordx4 v84, s[44:47], s88 offen lds
    s_add_u32 m0, s91, 5120
    s_mov_b32 s88, 46080
    buffer_load_dwordx4 v85, s[44:47], s88 offen lds
    s_add_u32 m0, s91, 6144
    s_mov_b32 s88, 55296
    buffer_load_dwordx4 v84, s[44:47], s88 offen lds
    s_add_u32 m0, s91, 7168
    s_mov_b32 s88, 64512
    buffer_load_dwordx4 v85, s[44:47], s88 offen lds
    s_add_u32 m0, s78, 36864
    s_nop 0
    buffer_load_dwordx4 v68, s[40:43], s76 offen lds
    s_add_u32 s76, s76, s77
    s_add_u32 m0, s82, 46080
    s_nop 0
    buffer_load_dwordx4 v66, s[36:39], s75 offen lds
    s_add_u32 m0, s82, 47104
    s_nop 0
    buffer_load_dwordx4 v67, s[36:39], s75 offen lds
    s_add_u32 m0, s82, 36864
    s_nop 0
    buffer_load_dwordx4 v64, s[32:35], s74 offen lds
    s_add_u32 m0, s82, 37888
    s_nop 0
    buffer_load_dwordx4 v65, s[32:35], s74 offen lds
    s_add_u32 s74, s74, 262144
    s_add_u32 s75, s75, 294912
    s_add_u32 m0, s82, 64512
    s_nop 0
    buffer_load_dwordx4 v66, s[36:39], s75 offen lds
    s_add_u32 m0, s82, 65536
    s_nop 0
    buffer_load_dwordx4 v67, s[36:39], s75 offen lds
    s_add_u32 m0, s82, 55296
    s_nop 0
    buffer_load_dwordx4 v64, s[32:35], s74 offen lds
    s_add_u32 m0, s82, 56320
    s_nop 0
    buffer_load_dwordx4 v65, s[32:35], s74 offen lds
    s_add_u32 s74, s74, 262144
    s_add_u32 s75, s75, 294912
    buffer_load_dwordx2 v[184:185], v86, s[56:59], 0 offen offset:0 sc1
    buffer_load_dwordx2 v[186:187], v86, s[56:59], 0 offen offset:128 sc1
    buffer_load_dwordx2 v[188:189], v86, s[56:59], 0 offen offset:256 sc1
    buffer_load_dwordx2 v[190:191], v86, s[56:59], 0 offen offset:384 sc1
    s_waitcnt vmcnt(13)
    ds_read_b128 v[192:195], v87 offset:0
    ds_read_b128 v[196:199], v87 offset:2048
    ds_read_b128 v[200:203], v87 offset:4096
    ds_read_b128 v[204:207], v87 offset:6144
    ds_read_b128 v[208:211], v88 offset:0
    ds_read_b128 v[212:215], v88 offset:2048
    ds_read_b128 v[216:219], v88 offset:4096
    ds_read_b128 v[220:223], v88 offset:6144
    s_waitcnt lgkmcnt(7)
    v_lshlrev_b32 v112, 16, v192
    v_and_b32 v113, 0xffff0000, v192
    v_lshlrev_b32 v114, 16, v193
    v_and_b32 v115, 0xffff0000, v193
    v_lshlrev_b32 v116, 16, v194
    v_and_b32 v117, 0xffff0000, v194
    v_lshlrev_b32 v118, 16, v195
    v_and_b32 v119, 0xffff0000, v195
    s_waitcnt lgkmcnt(6)
    v_lshlrev_b32 v120, 16, v196
    v_and_b32 v121, 0xffff0000, v196
    v_lshlrev_b32 v122, 16, v197
    v_and_b32 v123, 0xffff0000, v197
    v_lshlrev_b32 v124, 16, v198
    v_and_b32 v125, 0xffff0000, v198
    v_lshlrev_b32 v126, 16, v199
    v_and_b32 v127, 0xffff0000, v199
    s_waitcnt lgkmcnt(5)
    v_lshlrev_b32 v128, 16, v200
    v_and_b32 v129, 0xffff0000, v200
    v_lshlrev_b32 v130, 16, v201
    v_and_b32 v131, 0xffff0000, v201
    v_lshlrev_b32 v132, 16, v202
    v_and_b32 v133, 0xffff0000, v202
    v_lshlrev_b32 v134, 16, v203
    v_and_b32 v135, 0xffff0000, v203
    s_waitcnt lgkmcnt(4)
    v_lshlrev_b32 v136, 16, v204
    v_and_b32 v137, 0xffff0000, v204
    v_lshlrev_b32 v138, 16, v205
    v_and_b32 v139, 0xffff0000, v205
    v_lshlrev_b32 v140, 16, v206
    v_and_b32 v141, 0xffff0000, v206
    v_lshlrev_b32 v142, 16, v207
    v_and_b32 v143, 0xffff0000, v207
    s_waitcnt lgkmcnt(3)
    v_lshlrev_b32 v144, 16, v208
    v_and_b32 v145, 0xffff0000, v208
    v_lshlrev_b32 v146, 16, v209
    v_and_b32 v147, 0xffff0000, v209
    v_lshlrev_b32 v148, 16, v210
    v_and_b32 v149, 0xffff0000, v210
    v_lshlrev_b32 v150, 16, v211
    v_and_b32 v151, 0xffff0000, v211
    s_waitcnt lgkmcnt(2)
    v_lshlrev_b32 v152, 16, v212
    v_and_b32 v153, 0xffff0000, v212
    v_lshlrev_b32 v154, 16, v213
    v_and_b32 v155, 0xffff0000, v213
    v_lshlrev_b32 v156, 16, v214
    v_and_b32 v157, 0xffff0000, v214
    v_lshlrev_b32 v158, 16, v215
    v_and_b32 v159, 0xffff0000, v215
    s_waitcnt lgkmcnt(1)
    v_lshlrev_b32 v160, 16, v216
    v_and_b32 v161, 0xffff0000, v216
    v_lshlrev_b32 v162, 16, v217
    v_and_b32 v163, 0xffff0000, v217
    v_lshlrev_b32 v164, 16, v218
    v_and_b32 v165, 0xffff0000, v218
    v_lshlrev_b32 v166, 16, v219
    v_and_b32 v167, 0xffff0000, v219
    s_waitcnt lgkmcnt(0)
    v_lshlrev_b32 v168, 16, v220
    v_and_b32 v169, 0xffff0000, v220
    v_lshlrev_b32 v170, 16, v221
    v_and_b32 v171, 0xffff0000, v221
    v_lshlrev_b32 v172, 16, v222
    v_and_b32 v173, 0xffff0000, v222
    v_lshlrev_b32 v174, 16, v223
    v_and_b32 v175, 0xffff0000, v223
    s_mov_b32 s88, 1048576
Lst_spin:
    s_waitcnt vmcnt(0)
    v_xor_b32 v80, s22, v185
    v_xor_b32 v81, s22, v187
    v_xor_b32 v82, s22, v189
    v_xor_b32 v83, s22, v191
    v_or3_b32 v80, v80, v81, v82
    v_or_b32 v80, v80, v83
    v_cmp_ne_u32 vcc, 0, v80
    s_sub_u32 s88, s88, 1
    s_cbranch_scc1 Lst_ok
    s_cbranch_vccz Lst_ok
    buffer_load_dwordx2 v[184:185], v86, s[56:59], 0 offen offset:0 sc1
    buffer_load_dwordx2 v[186:187], v86, s[56:59], 0 offen offset:128 sc1
    buffer_load_dwordx2 v[188:189], v86, s[56:59], 0 offen offset:256 sc1
    buffer_load_dwordx2 v[190:191], v86, s[56:59], 0 offen offset:384 sc1
    s_branch Lst_spin
Lst_ok:
    s_barrier
    s_mov_b32 s73, 262144
    s_mov_b32 s85, 524288
    ds_read_b64_tr_b16 v[32:33], v72 offset:36864
    ds_read_b64_tr_b16 v[34:35], v72 offset:41472
    ds_read_b64_tr_b16 v[36:37], v72 offset:55296
    ds_read_b64_tr_b16 v[38:39], v72 offset:59904
    ds_read_b64_tr_b16 v[40:41], v72 offset:36896
    ds_read_b64_tr_b16 v[42:43], v72 offset:41504
    ds_read_b64_tr_b16 v[44:45], v72 offset:55328
    ds_read_b64_tr_b16 v[46:47], v72 offset:59936
    v_lshlrev_b32 v185, 16, v184
    v_rcp_f32 v185, v185
    v_and_b32 v184, 0xffff0000, v184
    v_lshlrev_b32 v187, 16, v186
    v_rcp_f32 v187, v187
    v_and_b32 v186, 0xffff0000, v186
    v_lshlrev_b32 v189, 16, v188
    v_rcp_f32 v189, v189
    v_and_b32 v188, 0xffff0000, v188
    v_lshlrev_b32 v191, 16, v190
    v_rcp_f32 v191, v191
    v_and_b32 v190, 0xffff0000, v190
    v_mul_f32 v185, 1040356334, v185
    v_mul_f32 v184, v184, v185
    v_mul_f32 v187, 1040356334, v187
    v_mul_f32 v186, v186, v187
    v_mul_f32 v189, 1040356334, v189
    v_mul_f32 v188, v188, v189
    v_mul_f32 v191, 1040356334, v191
    v_mul_f32 v190, v190, v191
    v_pk_fma_f32 v[112:113], v[112:113], v[184:185], v[184:185] op_sel:[0,1,0] op_sel_hi:[1,1,0]
    v_pk_fma_f32 v[114:115], v[114:115], v[184:185], v[184:185] op_sel:[0,1,0] op_sel_hi:[1,1,0]
    v_pk_fma_f32 v[116:117], v[116:117], v[184:185], v[184:185] op_sel:[0,1,0] op_sel_hi:[1,1,0]
    v_pk_fma_f32 v[118:119], v[118:119], v[184:185], v[184:185] op_sel:[0,1,0] op_sel_hi:[1,1,0]
    v_cvt_pk_bf16_f32 v192, v112, v113
    v_cvt_pk_bf16_f32 v193, v114, v115
    v_cvt_pk_bf16_f32 v194, v116, v117
    v_cvt_pk_bf16_f32 v195, v118, v119
    v_accvgpr_write_b32 a208, v192
    v_accvgpr_write_b32 a209, v193
    v_accvgpr_write_b32 a210, v194
    v_accvgpr_write_b32 a211, v195
    v_pk_fma_f32 v[144:145], v[144:145], v[184:185], v[184:185] op_sel:[0,1,0] op_sel_hi:[1,1,0]
    v_pk_fma_f32 v[146:147], v[146:147], v[184:185], v[184:185] op_sel:[0,1,0] op_sel_hi:[1,1,0]
    v_pk_fma_f32 v[148:149], v[148:149], v[184:185], v[184:185] op_sel:[0,1,0] op_sel_hi:[1,1,0]
    v_pk_fma_f32 v[150:151], v[150:151], v[184:185], v[184:185] op_sel:[0,1,0] op_sel_hi:[1,1,0]
    v_cvt_pk_bf16_f32 v208, v144, v145
    v_cvt_pk_bf16_f32 v209, v146, v147
    v_cvt_pk_bf16_f32 v210, v148, v149
    v_cvt_pk_bf16_f32 v211, v150, v151
    v_accvgpr_write_b32 a224, v208
    v_accvgpr_write_b32 a225, v209
    v_accvgpr_write_b32 a226, v210
    v_accvgpr_write_b32 a227, v211
    v_pk_fma_f32 v[120:121], v[120:121], v[186:187], v[186:187] op_sel:[0,1,0] op_sel_hi:[1,1,0]
    v_pk_fma_f32 v[122:123], v[122:123], v[186:187], v[186:187] op_sel:[0,1,0] op_sel_hi:[1,1,0]
    v_pk_fma_f32 v[124:125], v[124:125], v[186:187], v[186:187] op_sel:[0,1,0] op_sel_hi:[1,1,0]
    v_pk_fma_f32 v[126:127], v[126:127], v[186:187], v[186:187] op_sel:[0,1,0] op_sel_hi:[1,1,0]
    v_cvt_pk_bf16_f32 v196, v120, v121
    v_cvt_pk_bf16_f32 v197, v122, v123
    v_cvt_pk_bf16_f32 v198, v124, v125
    v_cvt_pk_bf16_f32 v199, v126, v127
    v_accvgpr_write_b32 a212, v196
    v_accvgpr_write_b32 a213, v197
    v_accvgpr_write_b32 a214, v198
    v_accvgpr_write_b32 a215, v199
    v_pk_fma_f32 v[152:153], v[152:153], v[186:187], v[186:187] op_sel:[0,1,0] op_sel_hi:[1,1,0]
    v_pk_fma_f32 v[154:155], v[154:155], v[186:187], v[186:187] op_sel:[0,1,0] op_sel_hi:[1,1,0]
    v_pk_fma_f32 v[156:157], v[156:157], v[186:187], v[186:187] op_sel:[0,1,0] op_sel_hi:[1,1,0]
    v_pk_fma_f32 v[158:159], v[158:159], v[186:187], v[186:187] op_sel:[0,1,0] op_sel_hi:[1,1,0]
    v_cvt_pk_bf16_f32 v212, v152, v153
    v_cvt_pk_bf16_f32 v213, v154, v155
    v_cvt_pk_bf16_f32 v214, v156, v157
    v_cvt_pk_bf16_f32 v215, v158, v159
    v_accvgpr_write_b32 a228, v212
    v_accvgpr_write_b32 a229, v213
    v_accvgpr_write_b32 a230, v214
    v_accvgpr_write_b32 a231, v215
    v_pk_fma_f32 v[128:129], v[128:129], v[188:189], v[188:189] op_sel:[0,1,0] op_sel_hi:[1,1,0]
    v_pk_fma_f32 v[130:131], v[130:131], v[188:189], v[188:189] op_sel:[0,1,0] op_sel_hi:[1,1,0]
    v_pk_fma_f32 v[132:133], v[132:133], v[188:189], v[188:189] op_sel:[0,1,0] op_sel_hi:[1,1,0]
    v_pk_fma_f32 v[134:135], v[134:135], v[188:189], v[188:189] op_sel:[0,1,0] op_sel_hi:[1,1,0]
    v_cvt_pk_bf16_f32 v200, v128, v129
    v_cvt_pk_bf16_f32 v201, v130, v131
    v_cvt_pk_bf16_f32 v202, v132, v133
    v_cvt_pk_bf16_f32 v203, v134, v135
    v_accvgpr_write_b32 a216, v200
    v_accvgpr_write_b32 a217, v201
    v_accvgpr_write_b32 a218, v202
    v_accvgpr_write_b32 a219, v203
    v_pk_fma_f32 v[160:161], v[160:161], v[188:189], v[188:189] op_sel:[0,1,0] op_sel_hi:[1,1,0]
    v_pk_fma_f32 v[162:163], v[162:163], v[188:189], v[188:189] op_sel:[0,1,0] op_sel_hi:[1,1,0]
    v_pk_fma_f32 v[164:165], v[164:165], v[188:189], v[188:189] op_sel:[0,1,0] op_sel_hi:[1,1,0]
    v_pk_fma_f32 v[166:167], v[166:167], v[188:189], v[188:189] op_sel:[0,1,0] op_sel_hi:[1,1,0]
    v_cvt_pk_bf16_f32 v216, v160, v161
    v_cvt_pk_bf16_f32 v217, v162, v163
    v_cvt_pk_bf16_f32 v218, v164, v165
    v_cvt_pk_bf16_f32 v219, v166, v167
    v_accvgpr_write_b32 a232, v216
    v_accvgpr_write_b32 a233, v217
    v_accvgpr_write_b32 a234, v218
    v_accvgpr_write_b32 a235, v219
    v_pk_fma_f32 v[136:137], v[136:137], v[190:191], v[190:191] op_sel:[0,1,0] op_sel_hi:[1,1,0]
    v_pk_fma_f32 v[138:139], v[138:139], v[190:191], v[190:191] op_sel:[0,1,0] op_sel_hi:[1,1,0]
    v_pk_fma_f32 v[140:141], v[140:141], v[190:191], v[190:191] op_sel:[0,1,0] op_sel_hi:[1,1,0]
    v_pk_fma_f32 v[142:143], v[142:143], v[190:191], v[190:191] op_sel:[0,1,0] op_sel_hi:[1,1,0]
    v_cvt_pk_bf16_f32 v204, v136, v137
    v_cvt_pk_bf16_f32 v205, v138, v139
    v_cvt_pk_bf16_f32 v206, v140, v141
    v_cvt_pk_bf16_f32 v207, v142, v143
    v_accvgpr_write_b32 a220, v204
    v_accvgpr_write_b32 a221, v205
    v_accvgpr_write_b32 a222, v206
    v_accvgpr_write_b32 a223, v207
    v_pk_fma_f32 v[168:169], v[168:169], v[190:191], v[190:191] op_sel:[0,1,0] op_sel_hi:[1,1,0]
    v_pk_fma_f32 v[170:171], v[170:171], v[190:191], v[190:191] op_sel:[0,1,0] op_sel_hi:[1,1,0]
    v_pk_fma_f32 v[172:173], v[172:173], v[190:191], v[190:191] op_sel:[0,1,0] op_sel_hi:[1,1,0]
    v_pk_fma_f32 v[174:175], v[174:175], v[190:191], v[190:191] op_sel:[0,1,0] op_sel_hi:[1,1,0]
    v_cvt_pk_bf16_f32 v220, v168, v169
    v_cvt_pk_bf16_f32 v221, v170, v171
    v_cvt_pk_bf16_f32 v222, v172, v173
    v_cvt_pk_bf16_f32 v223, v174, v175
    v_accvgpr_write_b32 a236, v220
    v_accvgpr_write_b32 a237, v221
    v_accvgpr_write_b32 a238, v222
    v_accvgpr_write_b32 a239, v223
    s_nop 1
    s_waitcnt lgkmcnt(6)
    v_mfma_f32_16x16x32_bf16 v[112:115], v[32:35], a[208:211], 0
    s_waitcnt lgkmcnt(4)
    s_add_u32 m0, s78, 0
    ds_read_b64_tr_b16 v[48:49], v72 offset:36928
    ds_read_b64_tr_b16 v[50:51], v72 offset:41536
    v_mfma_f32_16x16x32_bf16 v[112:115], v[36:39], a[224:227], v[112:115]
    s_mul_i32 s88, s71, 663552
    buffer_load_dwordx4 v68, s[40:43], s76 offen lds
    v_mfma_f32_16x16x32_bf16 v[116:119], v[36:39], a[228:231], 0
    s_add_u32 s76, s76, s77
    ds_read_b64_tr_b16 v[52:53], v72 offset:55360
    ds_read_b64_tr_b16 v[54:55], v72 offset:59968
    v_mfma_f32_16x16x32_bf16 v[116:119], v[32:35], a[212:215], v[116:119]
    s_add_u32 m0, s82, 9216
    v_mfma_f32_16x16x32_bf16 v[120:123], v[32:35], a[216:219], 0
    buffer_load_dwordx4 v66, s[36:39], s75 offen lds
    v_mfma_f32_16x16x32_bf16 v[120:123], v[36:39], a[232:235], v[120:123]
    s_add_u32 s60, s18, s88
    s_addc_u32 s61, s19, 0
    v_mfma_f32_16x16x32_bf16 v[124:127], v[36:39], a[236:239], 0
    s_add_u32 m0, s82, 10240
    v_mfma_f32_16x16x32_bf16 v[124:127], v[32:35], a[220:223], v[124:127]
    s_waitcnt lgkmcnt(6)
    s_and_b32 s61, s61, 0xffff
    buffer_load_dwordx4 v67, s[36:39], s75 offen lds
    v_mfma_f32_16x16x32_bf16 v[128:131], v[40:43], a[208:211], 0
    s_waitcnt lgkmcnt(4)
    s_mov_b32 s62, 663552
    ds_read_b64_tr_b16 v[32:33], v72 offset:36960
    ds_read_b64_tr_b16 v[34:35], v72 offset:41568
    v_mfma_f32_16x16x32_bf16 v[128:131], v[44:47], a[224:227], v[128:131]
    s_add_u32 m0, s82, 0
    ds_read_b64_tr_b16 v[36:37], v72 offset:55392
    ds_read_b64_tr_b16 v[38:39], v72 offset:60000
    v_mfma_f32_16x16x32_bf16 v[132:135], v[44:47], a[228:231], 0
    s_mov_b32 s63, 0x20000
    buffer_load_dword v25, v24, s[56:59], s86 offen offset:0 sc1
    v_mfma_f32_16x16x32_bf16 v[132:135], v[40:43], a[212:215], v[132:135]
    s_lshl_b32 s88, s68, 19
    v_mfma_f32_16x16x32_bf16 v[136:139], v[40:43], a[216:219], 0
    s_add_u32 s44, s6, s88
    s_addc_u32 s45, s7, 0
    v_mfma_f32_16x16x32_bf16 v[136:139], v[44:47], a[232:235], v[136:139]
    s_and_b32 s45, s45, 0xffff
    buffer_load_dwordx4 v64, s[32:35], s74 offen lds
    v_mfma_f32_16x16x32_bf16 v[140:143], v[44:47], a[236:239], 0
    s_add_u32 m0, s82, 1024
    v_mfma_f32_16x16x32_bf16 v[140:143], v[40:43], a[220:223], v[140:143]
    s_waitcnt lgkmcnt(6)
    s_mov_b32 s46, 524288
    v_mfma_f32_16x16x32_bf16 v[144:147], v[48:51], a[208:211], 0
    s_waitcnt lgkmcnt(4)
    s_mov_b32 s47, 0x20000
    buffer_load_dwordx4 v65, s[32:35], s74 offen lds
    v_mfma_f32_16x16x32_bf16 v[144:147], v[52:55], a[224:227], v[144:147]
    s_add_u32 s74, s74, 262144
    ds_read_b64_tr_b16 v[40:41], v72 offset:36992
    ds_read_b64_tr_b16 v[42:43], v72 offset:41600
    v_mfma_f32_16x16x32_bf16 v[148:151], v[52:55], a[228:231], 0
    s_lshr_b32 s88, s2, 3
    ds_read_b64_tr_b16 v[44:45], v72 offset:55424
    ds_read_b64_tr_b16 v[46:47], v72 offset:60032
    v_mfma_f32_16x16x32_bf16 v[148:151], v[48:51], a[212:215], v[148:151]
    s_add_u32 s75, s75, 294912
    v_mfma_f32_16x16x32_bf16 v[152:155], v[48:51], a[216:219], 0
    s_lshl2_add_u32 s88, s88, s70
    v_mfma_f32_16x16x32_bf16 v[152:155], v[52:55], a[232:235], v[152:155]
    s_lshl_b32 s88, s88, 11
    v_and_b32 v75, 15, v0
    v_lshl_add_u32 v75, v75, 7, s88
    v_mfma_f32_16x16x32_bf16 v[156:159], v[52:55], a[236:239], 0
    s_add_u32 m0, s82, 27648
    v_and_b32 v78, 0xffff, v75
    v_lshrrev_b32 v19, 1, v2
    v_mfma_f32_16x16x32_bf16 v[156:159], v[48:51], a[220:223], v[156:159]
    s_waitcnt lgkmcnt(6)
    buffer_load_dwordx4 v66, s[36:39], s75 offen lds
    v_mfma_f32_16x16x32_bf16 v[160:163], v[32:35], a[208:211], 0
    s_waitcnt lgkmcnt(4)
    s_add_u32 m0, s82, 28672
    ds_read_b64_tr_b16 v[48:49], v72 offset:37024
    ds_read_b64_tr_b16 v[50:51], v72 offset:41632
    v_mfma_f32_16x16x32_bf16 v[160:163], v[36:39], a[224:227], v[160:163]
    ds_read_b64_tr_b16 v[52:53], v72 offset:55456
    ds_read_b64_tr_b16 v[54:55], v72 offset:60064
    v_mfma_f32_16x16x32_bf16 v[164:167], v[36:39], a[228:231], 0
    buffer_load_dwordx4 v67, s[36:39], s75 offen lds
    v_mfma_f32_16x16x32_bf16 v[164:167], v[32:35], a[212:215], v[164:167]
    s_add_u32 s52, s24, 4194304
    s_addc_u32 s53, s25, 0
    v_mfma_f32_16x16x32_bf16 v[168:171], v[32:35], a[216:219], 0
    s_add_u32 m0, s82, 18432
    v_mfma_f32_16x16x32_bf16 v[168:171], v[36:39], a[232:235], v[168:171]
    s_and_b32 s53, s53, 0xffff
    v_mfma_f32_16x16x32_bf16 v[172:175], v[36:39], a[236:239], 0
    s_mov_b32 s54, 35651584
    v_mfma_f32_16x16x32_bf16 v[172:175], v[32:35], a[220:223], v[172:175]
    s_waitcnt lgkmcnt(6)
    s_mov_b32 s55, 0x20000
    buffer_load_dwordx4 v64, s[32:35], s74 offen lds
    v_mfma_f32_16x16x32_bf16 v[176:179], v[40:43], a[208:211], 0
    s_waitcnt lgkmcnt(4)
    s_add_u32 m0, s82, 19456
    ds_read_b64_tr_b16 v[32:33], v72 offset:37056
    ds_read_b64_tr_b16 v[34:35], v72 offset:41664
    v_mfma_f32_16x16x32_bf16 v[176:179], v[44:47], a[224:227], v[176:179]
    ds_read_b64_tr_b16 v[36:37], v72 offset:55488
    ds_read_b64_tr_b16 v[38:39], v72 offset:60096
    v_mfma_f32_16x16x32_bf16 v[180:183], v[44:47], a[228:231], 0
    s_add_u32 s64, s24, 50331648
    s_addc_u32 s65, s25, 0
    v_mfma_f32_16x16x32_bf16 v[180:183], v[40:43], a[212:215], v[180:183]
    s_and_b32 s65, s65, 0xffff
    v_mfma_f32_16x16x32_bf16 v[184:187], v[40:43], a[216:219], 0
    s_mov_b32 s66, 37748736
    buffer_load_dwordx4 v65, s[32:35], s74 offen lds
    v_mfma_f32_16x16x32_bf16 v[184:187], v[44:47], a[232:235], v[184:187]
    s_add_u32 s74, s74, 262144
    v_mfma_f32_16x16x32_bf16 v[188:191], v[44:47], a[236:239], 0
    s_mov_b32 s67, 0x20000
    v_add_u32 v57, 55296, v56
    v_add_u32 v58, 110592, v56
    v_mfma_f32_16x16x32_bf16 v[188:191], v[40:43], a[220:223], v[188:191]
    s_waitcnt lgkmcnt(6)
    s_add_u32 s75, s75, 294912
    v_mfma_f32_16x16x32_bf16 v[192:195], v[48:51], a[208:211], 0
    s_waitcnt vmcnt(6)
    v_cmp_ne_u32 vcc, s22, v25
    s_nop 0
    s_cbranch_vccnz Lspin_ln
Lret_ln:
    s_waitcnt lgkmcnt(4)
    v_mfma_f32_16x16x32_bf16 v[192:195], v[52:55], a[224:227], v[192:195]
    s_mov_b32 s89, 524288
    buffer_load_dwordx4 a[128:131], v2, s[28:31], s73 offen offset:0 sc1
    v_mfma_f32_16x16x32_bf16 v[196:199], v[52:55], a[228:231], 0
    ds_read_b64_tr_b16 v[40:41], v72 offset:37088
    ds_read_b64_tr_b16 v[42:43], v72 offset:41696
    v_mfma_f32_16x16x32_bf16 v[196:199], v[48:51], a[212:215], v[196:199]
    ds_read_b64_tr_b16 v[44:45], v72 offset:55520
    ds_read_b64_tr_b16 v[46:47], v72 offset:60128
    v_mfma_f32_16x16x32_bf16 v[200:203], v[48:51], a[216:219], 0
    s_bitcmp1_b32 s68, 0
    s_cselect_b32 s89, -65536, s89
    v_mfma_f32_16x16x32_bf16 v[200:203], v[52:55], a[232:235], v[200:203]
    s_mul_i32 s91, s68, 9
    v_mfma_f32_16x16x32_bf16 v[204:207], v[52:55], a[236:239], 0
    s_add_u32 s91, s91, 1
    buffer_load_dwordx4 a[132:135], v2, s[28:31], s73 offen offset:1024 sc1
    v_mfma_f32_16x16x32_bf16 v[204:207], v[48:51], a[220:223], v[204:207]
    s_waitcnt lgkmcnt(6)
    s_lshr_b32 s91, s91, 1
    v_mfma_f32_16x16x32_bf16 v[208:211], v[32:35], a[208:211], 0
    s_waitcnt lgkmcnt(4)
    s_mul_i32 s3, s71, 18
    ds_read_b64_tr_b16 v[48:49], v74 offset:36864
    ds_read_b64_tr_b16 v[50:51], v74 offset:41472
    v_mfma_f32_16x16x32_bf16 v[208:211], v[36:39], a[224:227], v[208:211]
    s_lshl_b32 s91, s91, 17
    ds_read_b64_tr_b16 v[52:53], v74 offset:55296
    ds_read_b64_tr_b16 v[54:55], v74 offset:59904
    v_mfma_f32_16x16x32_bf16 v[212:215], v[36:39], a[228:231], 0
    s_add_u32 s26, s91, s89
    buffer_load_dwordx4 a[136:139], v2, s[28:31], s73 offen offset:2048 sc1
    v_mfma_f32_16x16x32_bf16 v[212:215], v[32:35], a[212:215], v[212:215]
    v_lshrrev_b32 v80, 4, v1
    v_and_b32 v81, 15, v1
    v_mfma_f32_16x16x32_bf16 v[216:219], v[32:35], a[216:219], 0
    v_xor_b32 v82, v80, v81
    v_lshlrev_b32 v82, 4, v82
    v_mfma_f32_16x16x32_bf16 v[216:219], v[36:39], a[232:235], v[216:219]
    v_lshl_add_u32 v83, v80, 8, v82
    v_add_u32 v14, s83, v83
    v_mfma_f32_16x16x32_bf16 v[220:223], v[36:39], a[236:239], 0
    v_xor_b32 v15, 64, v14
    v_xor_b32 v16, 128, v14
    v_mfma_f32_16x16x32_bf16 v[220:223], v[32:35], a[220:223], v[220:223]
    s_waitcnt lgkmcnt(6)
    buffer_load_dwordx4 a[140:143], v2, s[28:31], s73 offen offset:3072 sc1
    v_mfma_f32_16x16x32_bf16 v[224:227], v[40:43], a[208:211], 0
    s_waitcnt lgkmcnt(4)
    s_add_u32 s73, s73, 131072
    ds_read_b64_tr_b16 v[32:33], v70 offset:36864
    ds_read_b64_tr_b16 v[34:35], v70 offset:41472
    v_mfma_f32_16x16x32_bf16 v[224:227], v[44:47], a[224:227], v[224:227]
    ds_read_b64_tr_b16 v[36:37], v70 offset:55296
    ds_read_b64_tr_b16 v[38:39], v70 offset:59904
    v_mfma_f32_16x16x32_bf16 v[228:231], v[44:47], a[228:231], 0
    v_xor_b32 v17, 192, v14
    v_lshl_add_u32 v83, v81, 8, v82
    v_mfma_f32_16x16x32_bf16 v[228:231], v[40:43], a[212:215], v[228:231]
    buffer_load_dwordx4 a[240:243], v2, s[28:31], s73 offen offset:0 sc1
    v_mfma_f32_16x16x32_bf16 v[232:235], v[40:43], a[216:219], 0
    v_add_u32 v83, 4096, v83
    v_xor_b32 v23, 192, v83
    v_mfma_f32_16x16x32_bf16 v[232:235], v[44:47], a[232:235], v[232:235]
    v_lshlrev_b32 v82, 1, v80
    v_xor_b32 v82, v82, v81
    v_mfma_f32_16x16x32_bf16 v[236:239], v[44:47], a[236:239], 0
    v_lshlrev_b32 v82, 4, v82
    v_lshl_add_u32 v82, v80, 8, v82
    v_mfma_f32_16x16x32_bf16 v[236:239], v[40:43], a[220:223], v[236:239]
    s_waitcnt lgkmcnt(6)
    buffer_load_dwordx4 a[244:247], v2, s[28:31], s73 offen offset:1024 sc1
    v_mfma_f32_16x16x32_bf16 v[240:243], v[48:51], a[208:211], 0
    s_waitcnt lgkmcnt(4)
    ds_read_b64_tr_b16 v[40:41], v70 offset:36872
    ds_read_b64_tr_b16 v[42:43], v70 offset:41480
    v_mfma_f32_16x16x32_bf16 v[240:243], v[52:55], a[224:227], v[240:243]
    ds_read_b64_tr_b16 v[44:45], v70 offset:55304
    ds_read_b64_tr_b16 v[46:47], v70 offset:59912
    v_mfma_f32_16x16x32_bf16 v[244:247], v[52:55], a[228:231], 0
    v_add_u32 v18, s83, v82
    v_mfma_f32_16x16x32_bf16 v[244:247], v[48:51], a[212:215], v[244:247]
    s_mul_i32 s88, s72, 288
    v_add_u32 v80, 0, v1
    v_mul_u32_u24 v81, 3641, v80
    v_mfma_f32_16x16x32_bf16 v[248:251], v[48:51], a[216:219], 0
    buffer_load_dwordx4 a[248:251], v2, s[28:31], s73 offen offset:2048 sc1
    v_mfma_f32_16x16x32_bf16 v[248:251], v[52:55], a[232:235], v[248:251]
    v_lshrrev_b32 v81, 16, v81
    v_mul_u32_u24 v82, 18, v81
    v_mfma_f32_16x16x32_bf16 v[252:255], v[52:55], a[236:239], 0
    v_sub_u32 v82, v80, v82
    v_mul_u32_u24 v83, 1152, v81
    v_mfma_f32_16x16x32_bf16 v[252:255], v[48:51], a[220:223], v[252:255]
    s_waitcnt lgkmcnt(6)
    v_lshl_add_u32 v3, v82, 4, v83
    v_add_u32 v3, s88, v3
    v_mfma_f32_16x16x32_bf16 a[0:3], v[32:35], a[208:211], 0
    s_waitcnt lgkmcnt(4)
    buffer_load_dwordx4 a[252:255], v2, s[28:31], s73 offen offset:3072 sc1
    v_mfma_f32_16x16x32_bf16 a[0:3], v[36:39], a[224:227], a[0:3]
    s_add_u32 s73, s73, 131072
    ds_read_b64_tr_b16 v[48:49], v70 offset:36928
    ds_read_b64_tr_b16 v[50:51], v70 offset:41536
    v_mfma_f32_16x16x32_bf16 a[4:7], v[36:39], a[228:231], 0
    ds_read_b64_tr_b16 v[52:53], v70 offset:55360
    ds_read_b64_tr_b16 v[54:55], v70 offset:59968
    v_mfma_f32_16x16x32_bf16 a[4:7], v[32:35], a[212:215], a[4:7]
    v_add_u32 v80, 64, v1
    v_mul_u32_u24 v81, 3641, v80
    v_mfma_f32_16x16x32_bf16 a[8:11], v[32:35], a[216:219], 0
    v_lshrrev_b32 v81, 16, v81
    v_mul_u32_u24 v82, 18, v81
    v_mfma_f32_16x16x32_bf16 a[8:11], v[36:39], a[232:235], a[8:11]
    buffer_load_dword v76, v77, s[28:31], s85 offen sc1
    v_mfma_f32_16x16x32_bf16 a[12:15], v[36:39], a[236:239], 0
    s_add_u32 s85, s85, 262144
    v_sub_u32 v82, v80, v82
    v_mul_u32_u24 v83, 1152, v81
    v_mfma_f32_16x16x32_bf16 a[12:15], v[32:35], a[220:223], a[12:15]
    s_waitcnt lgkmcnt(6)
    v_lshl_add_u32 v4, v82, 4, v83
    v_add_u32 v4, s88, v4
    v_mfma_f32_16x16x32_bf16 a[16:19], v[40:43], a[208:211], 0
    s_waitcnt lgkmcnt(4)
    ds_read_b64_tr_b16 v[32:33], v70 offset:36936
    ds_read_b64_tr_b16 v[34:35], v70 offset:41544
    v_mfma_f32_16x16x32_bf16 a[16:19], v[44:47], a[224:227], a[16:19]
    ds_read_b64_tr_b16 v[36:37], v70 offset:55368
    ds_read_b64_tr_b16 v[38:39], v70 offset:59976
    v_mfma_f32_16x16x32_bf16 a[20:23], v[44:47], a[228:231], 0
    buffer_load_dword v76, v77, s[28:31], s85 offen sc1
    v_mfma_f32_16x16x32_bf16 a[20:23], v[40:43], a[212:215], a[20:23]
    s_add_u32 s85, s85, 262144
    v_add_u32 v80, 128, v1
    v_mul_u32_u24 v81, 3641, v80
    v_mfma_f32_16x16x32_bf16 a[24:27], v[40:43], a[216:219], 0
    v_lshrrev_b32 v81, 16, v81
    v_mul_u32_u24 v82, 18, v81
    v_mfma_f32_16x16x32_bf16 a[24:27], v[44:47], a[232:235], a[24:27]
    buffer_load_dword v76, v77, s[28:31], s85 offen sc1
    v_mfma_f32_16x16x32_bf16 a[28:31], v[44:47], a[236:239], 0
    s_add_u32 s85, s85, 262144
    v_sub_u32 v82, v80, v82
    v_mul_u32_u24 v83, 1152, v81
    v_mfma_f32_16x16x32_bf16 a[28:31], v[40:43], a[220:223], a[28:31]
    s_waitcnt lgkmcnt(6)
    s_add_u32 m0, s78, 73728
    v_lshl_add_u32 v5, v82, 4, v83
    v_add_u32 v5, s88, v5
    v_mfma_f32_16x16x32_bf16 a[32:35], v[48:51], a[208:211], 0
    s_waitcnt lgkmcnt(4)
    ds_read_b64_tr_b16 v[40:41], v70 offset:36992
    ds_read_b64_tr_b16 v[42:43], v70 offset:41600
    v_mfma_f32_16x16x32_bf16 a[32:35], v[52:55], a[224:227], a[32:35]
    ds_read_b64_tr_b16 v[44:45], v70 offset:55424
    ds_read_b64_tr_b16 v[46:47], v70 offset:60032
    v_mfma_f32_16x16x32_bf16 a[36:39], v[52:55], a[228:231], 0
    buffer_load_dwordx4 v68, s[40:43], s76 offen lds
    v_mfma_f32_16x16x32_bf16 a[36:39], v[48:51], a[212:215], a[36:39]
    s_add_u32 s76, s76, s77
    v_add_u32 v80, 192, v1
    v_mul_u32_u24 v81, 3641, v80
    v_mfma_f32_16x16x32_bf16 a[40:43], v[48:51], a[216:219], 0
    s_add_u32 m0, s82, 82944
    v_lshrrev_b32 v81, 16, v81
    v_mul_u32_u24 v82, 18, v81
    v_mfma_f32_16x16x32_bf16 a[40:43], v[52:55], a[232:235], a[40:43]
    v_sub_u32 v82, v80, v82
    v_mul_u32_u24 v83, 1152, v81
    v_mfma_f32_16x16x32_bf16 a[44:47], v[52:55], a[236:239], 0
    buffer_load_dwordx4 v66, s[36:39], s75 offen lds
    v_mfma_f32_16x16x32_bf16 a[44:47], v[48:51], a[220:223], a[44:47]
    s_waitcnt lgkmcnt(6)
    s_add_u32 m0, s82, 83968
    v_lshl_add_u32 v6, v82, 4, v83
    v_add_u32 v6, s88, v6
    v_mfma_f32_16x16x32_bf16 a[48:51], v[32:35], a[208:211], 0
Lpad0:
    s_cbranch_execz Lpad2
    s_waitcnt lgkmcnt(4)
    ds_read_b64_tr_b16 v[48:49], v70 offset:37000
    ds_read_b64_tr_b16 v[50:51], v70 offset:41608
    v_mfma_f32_16x16x32_bf16 a[48:51], v[36:39], a[224:227], a[48:51]
    ds_read_b64_tr_b16 v[52:53], v70 offset:55432
    ds_read_b64_tr_b16 v[54:55], v70 offset:60040
    v_mfma_f32_16x16x32_bf16 a[52:55], v[36:39], a[228:231], 0
    v_add_u32 v80, 256, v1
    v_mul_u32_u24 v81, 3641, v80
    v_mfma_f32_16x16x32_bf16 a[52:55], v[32:35], a[212:215], a[52:55]
    buffer_load_dwordx4 v67, s[36:39], s75 offen lds
    v_mfma_f32_16x16x32_bf16 a[56:59], v[32:35], a[216:219], 0
    s_add_u32 m0, s82, 73728
    v_lshrrev_b32 v81, 16, v81
    v_mul_u32_u24 v82, 18, v81
    v_mfma_f32_16x16x32_bf16 a[56:59], v[36:39], a[232:235], a[56:59]
    v_sub_u32 v82, v80, v82
    v_mul_u32_u24 v83, 1152, v81
    v_mfma_f32_16x16x32_bf16 a[60:63], v[36:39], a[236:239], 0
    v_lshl_add_u32 v7, v82, 4, v83
    v_add_u32 v7, s88, v7
    v_mfma_f32_16x16x32_bf16 a[60:63], v[32:35], a[220:223], a[60:63]
    s_waitcnt lgkmcnt(6)
    v_add_u32 v80, 320, v1
    v_mul_u32_u24 v81, 3641, v80
    v_mfma_f32_16x16x32_bf16 a[64:67], v[40:43], a[208:211], 0
    s_waitcnt lgkmcnt(4)
    ds_read_b64_tr_b16 v[32:33], v70 offset:37056
    ds_read_b64_tr_b16 v[34:35], v70 offset:41664
    v_mfma_f32_16x16x32_bf16 a[64:67], v[44:47], a[224:227], a[64:67]
    ds_read_b64_tr_b16 v[36:37], v70 offset:55488
    ds_read_b64_tr_b16 v[38:39], v70 offset:60096
    v_mfma_f32_16x16x32_bf16 a[68:71], v[44:47], a[228:231], 0
    buffer_load_dwordx4 v64, s[32:35], s74 offen lds
    v_mfma_f32_16x16x32_bf16 a[68:71], v[40:43], a[212:215], a[68:71]
    s_add_u32 m0, s82, 74752
    v_lshrrev_b32 v81, 16, v81
    v_mul_u32_u24 v82, 18, v81
    v_mfma_f32_16x16x32_bf16 a[72:75], v[40:43], a[216:219], 0
    v_sub_u32 v82, v80, v82
    v_mul_u32_u24 v83, 1152, v81
    v_mfma_f32_16x16x32_bf16 a[72:75], v[44:47], a[232:235], a[72:75]
    buffer_load_dwordx4 v65, s[32:35], s74 offen lds
    v_mfma_f32_16x16x32_bf16 a[76:79], v[44:47], a[236:239], 0
    s_add_u32 s74, s74, 262144
    v_lshl_add_u32 v8, v82, 4, v83
    v_add_u32 v8, s88, v8
    v_mfma_f32_16x16x32_bf16 a[76:79], v[40:43], a[220:223], a[76:79]
    s_waitcnt lgkmcnt(6)
    s_add_u32 s75, s75, 294912
    v_add_u32 v80, 384, v1
    v_mul_u32_u24 v81, 3641, v80
    v_mfma_f32_16x16x32_bf16 a[80:83], v[48:51], a[208:211], 0
    s_waitcnt lgkmcnt(4)
    s_add_u32 m0, s82, 101376
    ds_read_b64_tr_b16 v[40:41], v70 offset:37064
    ds_read_b64_tr_b16 v[42:43], v70 offset:41672
    v_mfma_f32_16x16x32_bf16 a[80:83], v[52:55], a[224:227], a[80:83]
    ds_read_b64_tr_b16 v[44:45], v70 offset:55496
    ds_read_b64_tr_b16 v[46:47], v70 offset:60104
    v_mfma_f32_16x16x32_bf16 a[84:87], v[52:55], a[228:231], 0
    buffer_load_dwordx4 v66, s[36:39], s75 offen lds
    v_mfma_f32_16x16x32_bf16 a[84:87], v[48:51], a[212:215], a[84:87]
    s_add_u32 m0, s82, 102400
    v_lshrrev_b32 v81, 16, v81
    v_mul_u32_u24 v82, 18, v81
    v_mfma_f32_16x16x32_bf16 a[88:91], v[48:51], a[216:219], 0
    v_sub_u32 v82, v80, v82
    v_mul_u32_u24 v83, 1152, v81
    v_mfma_f32_16x16x32_bf16 a[88:91], v[52:55], a[232:235], a[88:91]
    v_lshl_add_u32 v9, v82, 4, v83
    v_add_u32 v9, s88, v9
    v_mfma_f32_16x16x32_bf16 a[92:95], v[52:55], a[236:239], 0
    s_waitcnt vmcnt(17)
    v_add_u32 v80, 448, v1
    v_mul_u32_u24 v81, 3641, v80
    v_mfma_f32_16x16x32_bf16 a[92:95], v[48:51], a[220:223], a[92:95]
    s_barrier
    buffer_load_dwordx4 v67, s[36:39], s75 offen lds
    s_waitcnt lgkmcnt(6)
    v_mfma_f32_16x16x32_bf16 a[96:99], v[32:35], a[208:211], 0
    s_waitcnt lgkmcnt(4)
    s_add_u32 m0, s82, 92160
    ds_read_b64_tr_b16 v[48:49], v72 offset:0
    ds_read_b64_tr_b16 v[50:51], v72 offset:4608
    v_mfma_f32_16x16x32_bf16 a[96:99], v[36:39], a[224:227], a[96:99]
    ds_read_b64_tr_b16 v[52:53], v72 offset:18432
    ds_read_b64_tr_b16 v[54:55], v72 offset:23040
    v_mfma_f32_16x16x32_bf16 a[100:103], v[36:39], a[228:231], 0
    v_lshrrev_b32 v81, 16, v81
    v_mul_u32_u24 v82, 18, v81
    v_mfma_f32_16x16x32_bf16 a[100:103], v[32:35], a[212:215], a[100:103]
    v_sub_u32 v82, v80, v82
    v_mul_u32_u24 v83, 1152, v81
    v_mfma_f32_16x16x32_bf16 a[104:107], v[32:35], a[216:219], 0
    buffer_load_dwordx4 v64, s[32:35], s74 offen lds
    v_mfma_f32_16x16x32_bf16 a[104:107], v[36:39], a[232:235], a[104:107]
    s_add_u32 m0, s82, 93184
    v_lshl_add_u32 v10, v82, 4, v83
    v_add_u32 v10, s88, v10
    v_mfma_f32_16x16x32_bf16 a[108:111], v[36:39], a[236:239], 0
    v_add_u32 v80, 512, v1
    v_mul_u32_u24 v81, 3641, v80
    v_mfma_f32_16x16x32_bf16 a[108:111], v[32:35], a[220:223], a[108:111]
    s_waitcnt lgkmcnt(6)
    v_lshrrev_b32 v81, 16, v81
    v_mul_u32_u24 v82, 18, v81
    v_mfma_f32_16x16x32_bf16 a[112:115], v[40:43], a[208:211], 0
    s_waitcnt lgkmcnt(4)
    ds_read_b64_tr_b16 v[32:33], v72 offset:32
    ds_read_b64_tr_b16 v[34:35], v72 offset:4640
    v_mfma_f32_16x16x32_bf16 a[112:115], v[44:47], a[224:227], a[112:115]
    ds_read_b64_tr_b16 v[36:37], v72 offset:18464
    ds_read_b64_tr_b16 v[38:39], v72 offset:23072
    v_mfma_f32_16x16x32_bf16 a[116:119], v[44:47], a[228:231], 0
    buffer_load_dwordx4 v65, s[32:35], s74 offen lds
    v_mfma_f32_16x16x32_bf16 a[116:119], v[40:43], a[212:215], a[116:119]
    s_add_u32 s74, s74, 262144
    v_sub_u32 v82, v80, v82
    v_mul_u32_u24 v83, 1152, v81
    v_mfma_f32_16x16x32_bf16 a[120:123], v[40:43], a[216:219], 0
    s_add_u32 s75, s75, 294912
    v_lshl_add_u32 v11, v82, 4, v83
    v_add_u32 v11, s88, v11
    v_mfma_f32_16x16x32_bf16 a[120:123], v[44:47], a[232:235], a[120:123]
    s_lshr_b32 s88, s2, 3
    v_mfma_f32_16x16x32_bf16 a[124:127], v[44:47], a[236:239], 0
    s_lshl_b32 s88, s88, 3
    buffer_load_dwordx4 a[144:147], v2, s[28:31], s73 offen offset:0 sc1
    v_mfma_f32_16x16x32_bf16 a[124:127], v[40:43], a[220:223], a[124:127]
    s_waitcnt vmcnt(20) lgkmcnt(6)
    s_lshl1_add_u32 s89, s70, s88
    v_mfma_f32_16x16x32_bf16 v[112:115], v[48:51], a[128:131], v[112:115]
    s_waitcnt vmcnt(16) lgkmcnt(4)
    s_lshl3_add_u32 s89, s89, s71
    ds_read_b64_tr_b16 v[40:41], v72 offset:64
    ds_read_b64_tr_b16 v[42:43], v72 offset:4672
    v_mfma_f32_16x16x32_bf16 v[112:115], v[52:55], a[240:243], v[112:115]
    s_waitcnt vmcnt(15)
    s_mul_i32 s89, s89, 9216
    ds_read_b64_tr_b16 v[44:45], v72 offset:18496
    ds_read_b64_tr_b16 v[46:47], v72 offset:23104
    v_mfma_f32_16x16x32_bf16 v[116:119], v[52:55], a[244:247], v[116:119]
    buffer_load_dwordx4 a[148:151], v2, s[28:31], s73 offen offset:1024 sc1
    v_mfma_f32_16x16x32_bf16 v[116:119], v[48:51], a[132:135], v[116:119]
    v_lshl_add_u32 v59, v1, 4, s89
    v_mfma_f32_16x16x32_bf16 v[120:123], v[48:51], a[136:139], v[120:123]
    s_waitcnt vmcnt(15)
    s_add_u32 s88, s88, s71
    v_mfma_f32_16x16x32_bf16 v[120:123], v[52:55], a[248:251], v[120:123]
    s_waitcnt vmcnt(14)
    s_mul_i32 s88, s88, 73728
    v_lshl_add_u32 v60, v0, 4, s88
    v_mfma_f32_16x16x32_bf16 v[124:127], v[52:55], a[252:255], v[124:127]
    s_mov_b32 s89, 1879048192
    v_mfma_f32_16x16x32_bf16 v[124:127], v[48:51], a[140:143], v[124:127]
    s_waitcnt lgkmcnt(6)
    s_cmp_eq_u32 s70, 0
    s_cselect_b32 s89, 8192, s89
    s_nop 0
    v_mfma_f32_16x16x32_bf16 v[128:131], v[32:35], a[128:131], v[128:131]
    s_barrier
    ds_read_b64_tr_b16 v[48:49], v72 offset:96
    ds_read_b64_tr_b16 v[50:51], v72 offset:4704
    s_waitcnt lgkmcnt(6)
    v_mfma_f32_16x16x32_bf16 v[128:131], v[36:39], a[240:243], v[128:131]
    ds_read_b64_tr_b16 v[52:53], v72 offset:18528
    ds_read_b64_tr_b16 v[54:55], v72 offset:23136
    v_mfma_f32_16x16x32_bf16 v[132:135], v[36:39], a[244:247], v[132:135]
    buffer_load_dwordx4 a[152:155], v2, s[28:31], s73 offen offset:2048 sc1
    v_mfma_f32_16x16x32_bf16 v[132:135], v[32:35], a[132:135], v[132:135]
    v_add_u32 v61, 4096, v60
    v_add_u32 v62, s89, v60
    v_mfma_f32_16x16x32_bf16 v[136:139], v[32:35], a[136:139], v[136:139]
    v_and_b32 v100, 127, v0
    v_lshlrev_b32 v100, 7, v100
    v_mfma_f32_16x16x32_bf16 v[136:139], v[36:39], a[248:251], v[136:139]
    buffer_load_dwordx4 a[156:159], v2, s[28:31], s73 offen offset:3072 sc1
    v_mfma_f32_16x16x32_bf16 v[140:143], v[36:39], a[252:255], v[140:143]
    s_add_u32 s73, s73, 131072
    v_lshrrev_b32 v101, 7, v0
    v_lshl_add_u32 v100, v101, 17, v100
    v_mfma_f32_16x16x32_bf16 v[140:143], v[32:35], a[140:143], v[140:143]
    s_waitcnt lgkmcnt(6)
    s_lshl_b32 s88, s69, 14
    v_add_u32 v100, s88, v100
    v_mfma_f32_16x16x32_bf16 v[144:147], v[40:43], a[128:131], v[144:147]
    s_waitcnt lgkmcnt(4)
    s_mul_i32 s81, s70, 9216
    ds_read_b64_tr_b16 v[32:33], v72 offset:128
    ds_read_b64_tr_b16 v[34:35], v72 offset:4736
    v_mfma_f32_16x16x32_bf16 v[144:147], v[44:47], a[240:243], v[144:147]
    s_mov_b32 s87, 0
    ds_read_b64_tr_b16 v[36:37], v72 offset:18560
    ds_read_b64_tr_b16 v[38:39], v72 offset:23168
    v_mfma_f32_16x16x32_bf16 v[148:151], v[44:47], a[244:247], v[148:151]
    buffer_load_dwordx4 a[160:163], v2, s[28:31], s73 offen offset:0 sc1
    v_mfma_f32_16x16x32_bf16 v[148:151], v[40:43], a[132:135], v[148:151]
    v_and_b32 v1, 3, v1
    v_lshlrev_b32 v1, 2, v1
    v_mfma_f32_16x16x32_bf16 v[152:155], v[40:43], a[136:139], v[152:155]
    s_getreg_b32 s89, hwreg(HW_REG_XCC_ID, 0, 4)
    v_mfma_f32_16x16x32_bf16 v[152:155], v[44:47], a[248:251], v[152:155]
    buffer_load_dwordx4 a[164:167], v2, s[28:31], s73 offen offset:1024 sc1
    v_mfma_f32_16x16x32_bf16 v[156:159], v[44:47], a[252:255], v[156:159]
    v_mfma_f32_16x16x32_bf16 v[156:159], v[40:43], a[140:143], v[156:159]
    s_waitcnt lgkmcnt(6)
    v_mfma_f32_16x16x32_bf16 v[160:163], v[48:51], a[128:131], v[160:163]
    s_waitcnt lgkmcnt(4)
    ds_read_b64_tr_b16 v[40:41], v72 offset:160
    ds_read_b64_tr_b16 v[42:43], v72 offset:4768
    v_mfma_f32_16x16x32_bf16 v[160:163], v[52:55], a[240:243], v[160:163]
    ds_read_b64_tr_b16 v[44:45], v72 offset:18592
    ds_read_b64_tr_b16 v[46:47], v72 offset:23200
    v_mfma_f32_16x16x32_bf16 v[164:167], v[52:55], a[244:247], v[164:167]
    buffer_load_dwordx4 a[168:171], v2, s[28:31], s73 offen offset:2048 sc1
    v_mfma_f32_16x16x32_bf16 v[164:167], v[48:51], a[132:135], v[164:167]
    v_mfma_f32_16x16x32_bf16 v[168:171], v[48:51], a[136:139], v[168:171]
    v_mfma_f32_16x16x32_bf16 v[168:171], v[52:55], a[248:251], v[168:171]
    buffer_load_dwordx4 a[172:175], v2, s[28:31], s73 offen offset:3072 sc1
    v_mfma_f32_16x16x32_bf16 v[172:175], v[52:55], a[252:255], v[172:175]
    s_add_u32 s73, s73, 131072
    v_mfma_f32_16x16x32_bf16 v[172:175], v[48:51], a[140:143], v[172:175]
    s_waitcnt lgkmcnt(6)
    v_mfma_f32_16x16x32_bf16 v[176:179], v[32:35], a[128:131], v[176:179]
    s_waitcnt lgkmcnt(4)
    ds_read_b64_tr_b16 v[48:49], v72 offset:192
    ds_read_b64_tr_b16 v[50:51], v72 offset:4800
    v_mfma_f32_16x16x32_bf16 v[176:179], v[36:39], a[240:243], v[176:179]
    ds_read_b64_tr_b16 v[52:53], v72 offset:18624
    ds_read_b64_tr_b16 v[54:55], v72 offset:23232
    v_mfma_f32_16x16x32_bf16 v[180:183], v[36:39], a[244:247], v[180:183]
    buffer_load_dword v76, v77, s[28:31], s85 offen sc1
    v_mfma_f32_16x16x32_bf16 v[180:183], v[32:35], a[132:135], v[180:183]
    s_add_u32 s85, s85, 262144
    v_mfma_f32_16x16x32_bf16 v[184:187], v[32:35], a[136:139], v[184:187]
    s_add_u32 m0, s78, 110592
    v_mfma_f32_16x16x32_bf16 v[184:187], v[36:39], a[248:251], v[184:187]
    buffer_load_dwordx4 v68, s[40:43], s76 offen lds
    v_mfma_f32_16x16x32_bf16 v[188:191], v[36:39], a[252:255], v[188:191]
    s_add_u32 s76, s76, s77
    v_mfma_f32_16x16x32_bf16 v[188:191], v[32:35], a[140:143], v[188:191]
    s_waitcnt lgkmcnt(6)
    s_add_u32 m0, s82, 119808
    v_mfma_f32_16x16x32_bf16 v[192:195], v[40:43], a[128:131], v[192:195]
    s_waitcnt lgkmcnt(4)
    ds_read_b64_tr_b16 v[32:33], v72 offset:224
    ds_read_b64_tr_b16 v[34:35], v72 offset:4832
    v_mfma_f32_16x16x32_bf16 v[192:195], v[44:47], a[240:243], v[192:195]
    ds_read_b64_tr_b16 v[36:37], v72 offset:18656
    ds_read_b64_tr_b16 v[38:39], v72 offset:23264
    v_mfma_f32_16x16x32_bf16 v[196:199], v[44:47], a[244:247], v[196:199]
    buffer_load_dwordx4 v66, s[36:39], s75 offen lds
    v_mfma_f32_16x16x32_bf16 v[196:199], v[40:43], a[132:135], v[196:199]
    s_add_u32 m0, s82, 120832
    v_mfma_f32_16x16x32_bf16 v[200:203], v[40:43], a[136:139], v[200:203]
    v_mfma_f32_16x16x32_bf16 v[200:203], v[44:47], a[248:251], v[200:203]
    buffer_load_dword v81, v1, s[56:59], s14 offen offset:32 sc1
    v_mfma_f32_16x16x32_bf16 v[204:207], v[44:47], a[252:255], v[204:207]
    v_mfma_f32_16x16x32_bf16 v[204:207], v[40:43], a[140:143], v[204:207]
    s_waitcnt lgkmcnt(6)
    v_mfma_f32_16x16x32_bf16 v[208:211], v[48:51], a[128:131], v[208:211]
    s_waitcnt lgkmcnt(4)
    ds_read_b64_tr_b16 v[40:41], v74 offset:0
    ds_read_b64_tr_b16 v[42:43], v74 offset:4608
    v_mfma_f32_16x16x32_bf16 v[208:211], v[52:55], a[240:243], v[208:211]
    ds_read_b64_tr_b16 v[44:45], v74 offset:18432
    ds_read_b64_tr_b16 v[46:47], v74 offset:23040
    v_mfma_f32_16x16x32_bf16 v[212:215], v[52:55], a[244:247], v[212:215]
    buffer_load_dwordx4 v67, s[36:39], s75 offen lds
    v_mfma_f32_16x16x32_bf16 v[212:215], v[48:51], a[132:135], v[212:215]
    s_add_u32 m0, s82, 110592
    v_mfma_f32_16x16x32_bf16 v[216:219], v[48:51], a[136:139], v[216:219]
    v_mfma_f32_16x16x32_bf16 v[216:219], v[52:55], a[248:251], v[216:219]
    buffer_load_dwordx4 v64, s[32:35], s74 offen lds
    v_mfma_f32_16x16x32_bf16 v[220:223], v[52:55], a[252:255], v[220:223]
    s_add_u32 m0, s82, 111616
    v_mfma_f32_16x16x32_bf16 v[220:223], v[48:51], a[140:143], v[220:223]
    s_waitcnt lgkmcnt(6)
    v_mfma_f32_16x16x32_bf16 v[224:227], v[32:35], a[128:131], v[224:227]
    s_waitcnt lgkmcnt(4)
    ds_read_b64_tr_b16 v[48:49], v70 offset:0
    ds_read_b64_tr_b16 v[50:51], v70 offset:4608
    v_mfma_f32_16x16x32_bf16 v[224:227], v[36:39], a[240:243], v[224:227]
    ds_read_b64_tr_b16 v[52:53], v70 offset:18432
    ds_read_b64_tr_b16 v[54:55], v70 offset:23040
    v_mfma_f32_16x16x32_bf16 v[228:231], v[36:39], a[244:247], v[228:231]
    buffer_load_dwordx4 v65, s[32:35], s74 offen lds
    v_mfma_f32_16x16x32_bf16 v[228:231], v[32:35], a[132:135], v[228:231]
    s_add_u32 s74, s74, 262144
    v_mfma_f32_16x16x32_bf16 v[232:235], v[32:35], a[136:139], v[232:235]
    s_add_u32 s75, s75, 294912
    v_mfma_f32_16x16x32_bf16 v[232:235], v[36:39], a[248:251], v[232:235]
    s_add_u32 m0, s82, 138240
    v_mfma_f32_16x16x32_bf16 v[236:239], v[36:39], a[252:255], v[236:239]
    v_mfma_f32_16x16x32_bf16 v[236:239], v[32:35], a[140:143], v[236:239]
    s_waitcnt lgkmcnt(6)
    buffer_load_dwordx4 v66, s[36:39], s75 offen lds
    v_mfma_f32_16x16x32_bf16 v[240:243], v[40:43], a[128:131], v[240:243]
    s_waitcnt lgkmcnt(4)
    s_add_u32 m0, s82, 139264
    ds_read_b64_tr_b16 v[32:33], v70 offset:8
    ds_read_b64_tr_b16 v[34:35], v70 offset:4616
    v_mfma_f32_16x16x32_bf16 v[240:243], v[44:47], a[240:243], v[240:243]
    ds_read_b64_tr_b16 v[36:37], v70 offset:18440
    ds_read_b64_tr_b16 v[38:39], v70 offset:23048
    v_mfma_f32_16x16x32_bf16 v[244:247], v[44:47], a[244:247], v[244:247]
    v_mfma_f32_16x16x32_bf16 v[244:247], v[40:43], a[132:135], v[244:247]
    v_mfma_f32_16x16x32_bf16 v[248:251], v[40:43], a[136:139], v[248:251]
    buffer_load_dwordx4 v67, s[36:39], s75 offen lds
    v_mfma_f32_16x16x32_bf16 v[248:251], v[44:47], a[248:251], v[248:251]
    s_add_u32 m0, s82, 129024
    v_mfma_f32_16x16x32_bf16 v[252:255], v[44:47], a[252:255], v[252:255]
    v_mfma_f32_16x16x32_bf16 v[252:255], v[40:43], a[140:143], v[252:255]
    s_waitcnt lgkmcnt(6)
    v_mfma_f32_16x16x32_bf16 a[0:3], v[48:51], a[128:131], a[0:3]
    s_waitcnt lgkmcnt(4)
    ds_read_b64_tr_b16 v[40:41], v70 offset:64
    ds_read_b64_tr_b16 v[42:43], v70 offset:4672
    v_mfma_f32_16x16x32_bf16 a[0:3], v[52:55], a[240:243], a[0:3]
    ds_read_b64_tr_b16 v[44:45], v70 offset:18496
    ds_read_b64_tr_b16 v[46:47], v70 offset:23104
    v_mfma_f32_16x16x32_bf16 a[4:7], v[52:55], a[244:247], a[4:7]
    buffer_load_dwordx4 v64, s[32:35], s74 offen lds
    v_mfma_f32_16x16x32_bf16 a[4:7], v[48:51], a[132:135], a[4:7]
    s_add_u32 m0, s82, 130048
    v_mfma_f32_16x16x32_bf16 a[8:11], v[48:51], a[136:139], a[8:11]
    v_mfma_f32_16x16x32_bf16 a[8:11], v[52:55], a[248:251], a[8:11]
    v_mfma_f32_16x16x32_bf16 a[12:15], v[52:55], a[252:255], a[12:15]
    buffer_load_dwordx4 v65, s[32:35], s74 offen lds
    v_mfma_f32_16x16x32_bf16 a[12:15], v[48:51], a[140:143], a[12:15]
    s_waitcnt lgkmcnt(6)
    s_add_u32 s74, s74, 262144
    v_mfma_f32_16x16x32_bf16 a[16:19], v[32:35], a[128:131], a[16:19]
    s_waitcnt lgkmcnt(4)
    s_add_u32 s75, s75, 294912
    ds_read_b64_tr_b16 v[48:49], v70 offset:72
    ds_read_b64_tr_b16 v[50:51], v70 offset:4680
    v_mfma_f32_16x16x32_bf16 a[16:19], v[36:39], a[240:243], a[16:19]
    ds_read_b64_tr_b16 v[52:53], v70 offset:18504
    ds_read_b64_tr_b16 v[54:55], v70 offset:23112
    v_mfma_f32_16x16x32_bf16 a[20:23], v[36:39], a[244:247], a[20:23]
    v_mfma_f32_16x16x32_bf16 a[20:23], v[32:35], a[132:135], a[20:23]
    buffer_load_dwordx4 a[176:179], v2, s[28:31], s73 offen offset:0 sc1
    v_mfma_f32_16x16x32_bf16 a[24:27], v[32:35], a[136:139], a[24:27]
    v_mfma_f32_16x16x32_bf16 a[24:27], v[36:39], a[248:251], a[24:27]
    v_mfma_f32_16x16x32_bf16 a[28:31], v[36:39], a[252:255], a[28:31]
    v_mfma_f32_16x16x32_bf16 a[28:31], v[32:35], a[140:143], a[28:31]
    s_waitcnt lgkmcnt(6)
    buffer_load_dwordx4 a[180:183], v2, s[28:31], s73 offen offset:1024 sc1
    v_mfma_f32_16x16x32_bf16 a[32:35], v[40:43], a[128:131], a[32:35]
    s_waitcnt lgkmcnt(4)
    ds_read_b64_tr_b16 v[32:33], v70 offset:128
    ds_read_b64_tr_b16 v[34:35], v70 offset:4736
    v_mfma_f32_16x16x32_bf16 a[32:35], v[44:47], a[240:243], a[32:35]
    ds_read_b64_tr_b16 v[36:37], v70 offset:18560
    ds_read_b64_tr_b16 v[38:39], v70 offset:23168
    v_mfma_f32_16x16x32_bf16 a[36:39], v[44:47], a[244:247], a[36:39]
    v_mfma_f32_16x16x32_bf16 a[36:39], v[40:43], a[132:135], a[36:39]
    v_mfma_f32_16x16x32_bf16 a[40:43], v[40:43], a[136:139], a[40:43]
    buffer_load_dwordx4 a[184:187], v2, s[28:31], s73 offen offset:2048 sc1
    v_mfma_f32_16x16x32_bf16 a[40:43], v[44:47], a[248:251], a[40:43]
    v_mfma_f32_16x16x32_bf16 a[44:47], v[44:47], a[252:255], a[44:47]
    v_mfma_f32_16x16x32_bf16 a[44:47], v[40:43], a[140:143], a[44:47]
    s_waitcnt lgkmcnt(6)
    v_mfma_f32_16x16x32_bf16 a[48:51], v[48:51], a[128:131], a[48:51]
    s_waitcnt lgkmcnt(4)
    ds_read_b64_tr_b16 v[40:41], v70 offset:136
    ds_read_b64_tr_b16 v[42:43], v70 offset:4744
    v_mfma_f32_16x16x32_bf16 a[48:51], v[52:55], a[240:243], a[48:51]
    ds_read_b64_tr_b16 v[44:45], v70 offset:18568
    ds_read_b64_tr_b16 v[46:47], v70 offset:23176
    v_mfma_f32_16x16x32_bf16 a[52:55], v[52:55], a[244:247], a[52:55]
    buffer_load_dwordx4 a[188:191], v2, s[28:31], s73 offen offset:3072 sc1
    v_mfma_f32_16x16x32_bf16 a[52:55], v[48:51], a[132:135], a[52:55]
    s_add_u32 s73, s73, 131072
    v_mfma_f32_16x16x32_bf16 a[56:59], v[48:51], a[136:139], a[56:59]
    v_mfma_f32_16x16x32_bf16 a[56:59], v[52:55], a[248:251], a[56:59]
    buffer_load_dwordx4 a[192:195], v2, s[28:31], s73 offen offset:0 sc1
    v_mfma_f32_16x16x32_bf16 a[60:63], v[52:55], a[252:255], a[60:63]
    v_mfma_f32_16x16x32_bf16 a[60:63], v[48:51], a[140:143], a[60:63]
    s_waitcnt lgkmcnt(6)
    v_mfma_f32_16x16x32_bf16 a[64:67], v[32:35], a[128:131], a[64:67]
    s_waitcnt lgkmcnt(4)
    ds_read_b64_tr_b16 v[48:49], v70 offset:192
    ds_read_b64_tr_b16 v[50:51], v70 offset:4800
    v_mfma_f32_16x16x32_bf16 a[64:67], v[36:39], a[240:243], a[64:67]
    ds_read_b64_tr_b16 v[52:53], v70 offset:18624
    ds_read_b64_tr_b16 v[54:55], v70 offset:23232
    v_mfma_f32_16x16x32_bf16 a[68:71], v[36:39], a[244:247], a[68:71]
    buffer_load_dwordx4 a[196:199], v2, s[28:31], s73 offen offset:1024 sc1
    v_mfma_f32_16x16x32_bf16 a[68:71], v[32:35], a[132:135], a[68:71]
    v_mfma_f32_16x16x32_bf16 a[72:75], v[32:35], a[136:139], a[72:75]
    v_mfma_f32_16x16x32_bf16 a[72:75], v[36:39], a[248:251], a[72:75]
    buffer_load_dwordx4 a[200:203], v2, s[28:31], s73 offen offset:2048 sc1
    v_mfma_f32_16x16x32_bf16 a[76:79], v[36:39], a[252:255], a[76:79]
    v_mfma_f32_16x16x32_bf16 a[76:79], v[32:35], a[140:143], a[76:79]
    s_waitcnt lgkmcnt(6)
    v_mfma_f32_16x16x32_bf16 a[80:83], v[40:43], a[128:131], a[80:83]
    s_waitcnt lgkmcnt(4)
    ds_read_b64_tr_b16 v[32:33], v70 offset:200
    ds_read_b64_tr_b16 v[34:35], v70 offset:4808
    v_mfma_f32_16x16x32_bf16 a[80:83], v[44:47], a[240:243], a[80:83]
    ds_read_b64_tr_b16 v[36:37], v70 offset:18632
    ds_read_b64_tr_b16 v[38:39], v70 offset:23240
    v_mfma_f32_16x16x32_bf16 a[84:87], v[44:47], a[244:247], a[84:87]
    buffer_load_dwordx4 a[204:207], v2, s[28:31], s73 offen offset:3072 sc1
    v_mfma_f32_16x16x32_bf16 a[84:87], v[40:43], a[132:135], a[84:87]
    s_add_u32 s73, s73, 131072
    v_mfma_f32_16x16x32_bf16 a[88:91], v[40:43], a[136:139], a[88:91]
    s_mul_i32 s23, s84, 4
    v_mfma_f32_16x16x32_bf16 a[88:91], v[44:47], a[248:251], a[88:91]
    v_mfma_f32_16x16x32_bf16 a[92:95], v[44:47], a[252:255], a[92:95]
    s_waitcnt vmcnt(27)
    buffer_load_dword v76, v79, s[48:51], s23 offen sc1
    v_mfma_f32_16x16x32_bf16 a[92:95], v[40:43], a[140:143], a[92:95]
    s_barrier
    s_waitcnt lgkmcnt(6)
    v_mfma_f32_16x16x32_bf16 a[96:99], v[48:51], a[128:131], a[96:99]
    s_waitcnt lgkmcnt(4)
    s_add_u32 s23, s23, s84
    ds_read_b64_tr_b16 v[40:41], v71 offset:0
    ds_read_b64_tr_b16 v[42:43], v71 offset:4608
    v_mfma_f32_16x16x32_bf16 a[96:99], v[52:55], a[240:243], a[96:99]
    buffer_load_dword v76, v79, s[48:51], s23 offen sc1
    v_mfma_f32_16x16x32_bf16 a[100:103], v[52:55], a[244:247], a[100:103]
    s_add_u32 s23, s23, s84
    ds_read_b64_tr_b16 v[44:45], v71 offset:18432
    ds_read_b64_tr_b16 v[46:47], v71 offset:23040
    v_mfma_f32_16x16x32_bf16 a[100:103], v[48:51], a[132:135], a[100:103]
    v_mfma_f32_16x16x32_bf16 a[104:107], v[48:51], a[136:139], a[104:107]
    buffer_load_dword v76, v79, s[48:51], s23 offen sc1
    v_mfma_f32_16x16x32_bf16 a[104:107], v[52:55], a[248:251], a[104:107]
    s_add_u32 s23, s23, s84
    v_mfma_f32_16x16x32_bf16 a[108:111], v[52:55], a[252:255], a[108:111]
    v_mfma_f32_16x16x32_bf16 a[108:111], v[48:51], a[140:143], a[108:111]
    s_waitcnt lgkmcnt(6)
    buffer_load_dword v76, v79, s[48:51], s23 offen sc1
    v_mfma_f32_16x16x32_bf16 a[112:115], v[32:35], a[128:131], a[112:115]
    s_waitcnt lgkmcnt(4)
    s_add_u32 s23, s23, s84
    ds_read_b64_tr_b16 v[48:49], v71 offset:32
    ds_read_b64_tr_b16 v[50:51], v71 offset:4640
    v_mfma_f32_16x16x32_bf16 a[112:115], v[36:39], a[240:243], a[112:115]
    ds_read_b64_tr_b16 v[52:53], v71 offset:18464
    ds_read_b64_tr_b16 v[54:55], v71 offset:23072
    v_mfma_f32_16x16x32_bf16 a[116:119], v[36:39], a[244:247], a[116:119]
    buffer_load_dword v76, v79, s[48:51], s23 offen sc1
    v_mfma_f32_16x16x32_bf16 a[116:119], v[32:35], a[132:135], a[116:119]
    s_add_u32 s23, s23, s84
    v_mfma_f32_16x16x32_bf16 a[120:123], v[32:35], a[136:139], a[120:123]
    s_lshl_b32 s80, s68, 19
    v_mfma_f32_16x16x32_bf16 a[120:123], v[36:39], a[248:251], a[120:123]
    s_add_u32 s48, s8, s80
    s_addc_u32 s49, s9, 0
    v_mfma_f32_16x16x32_bf16 a[124:127], v[36:39], a[252:255], a[124:127]
    s_and_b32 s49, s49, 0xffff
    v_mfma_f32_16x16x32_bf16 a[124:127], v[32:35], a[140:143], a[124:127]
    s_waitcnt vmcnt(31) lgkmcnt(6)
    s_mov_b32 s50, 524288
    v_mfma_f32_16x16x32_bf16 v[112:115], v[40:43], a[144:147], v[112:115]
    s_waitcnt vmcnt(27) lgkmcnt(4)
    s_mov_b32 s51, 0x20000
    buffer_load_dword v76, v78, s[44:47], 0 offen sc1
    v_mfma_f32_16x16x32_bf16 v[112:115], v[44:47], a[160:163], v[112:115]
    s_waitcnt vmcnt(27)
    ds_read_b64_tr_b16 v[32:33], v71 offset:64
    ds_read_b64_tr_b16 v[34:35], v71 offset:4672
    v_mfma_f32_16x16x32_bf16 v[116:119], v[44:47], a[164:167], v[116:119]
    ds_read_b64_tr_b16 v[36:37], v71 offset:18496
    ds_read_b64_tr_b16 v[38:39], v71 offset:23104
    v_mfma_f32_16x16x32_bf16 v[116:119], v[40:43], a[148:151], v[116:119]
    buffer_load_dword v76, v78, s[48:51], 0 offen sc1
    v_mfma_f32_16x16x32_bf16 v[120:123], v[40:43], a[152:155], v[120:123]
    s_waitcnt vmcnt(27)
    v_mfma_f32_16x16x32_bf16 v[120:123], v[44:47], a[168:171], v[120:123]
    s_waitcnt vmcnt(26)
    v_mfma_f32_16x16x32_bf16 v[124:127], v[44:47], a[172:175], v[124:127]
    v_mfma_f32_16x16x32_bf16 v[124:127], v[40:43], a[156:159], v[124:127]
    s_waitcnt lgkmcnt(6)
    s_nop 0
    v_mfma_f32_16x16x32_bf16 v[128:131], v[48:51], a[144:147], v[128:131]
    s_barrier
    ds_read_b64_tr_b16 v[40:41], v71 offset:96
    ds_read_b64_tr_b16 v[42:43], v71 offset:4704
    s_waitcnt lgkmcnt(6)
    v_mfma_f32_16x16x32_bf16 v[128:131], v[52:55], a[160:163], v[128:131]
    ds_read_b64_tr_b16 v[44:45], v71 offset:18528
    ds_read_b64_tr_b16 v[46:47], v71 offset:23136
    v_mfma_f32_16x16x32_bf16 v[132:135], v[52:55], a[164:167], v[132:135]
    v_mfma_f32_16x16x32_bf16 v[132:135], v[48:51], a[148:151], v[132:135]
    v_mfma_f32_16x16x32_bf16 v[136:139], v[48:51], a[152:155], v[136:139]
    v_mfma_f32_16x16x32_bf16 v[136:139], v[52:55], a[168:171], v[136:139]
    v_mfma_f32_16x16x32_bf16 v[140:143], v[52:55], a[172:175], v[140:143]
    v_mfma_f32_16x16x32_bf16 v[140:143], v[48:51], a[156:159], v[140:143]
    s_waitcnt lgkmcnt(6)
    v_mfma_f32_16x16x32_bf16 v[144:147], v[32:35], a[144:147], v[144:147]
    s_waitcnt lgkmcnt(4)
    ds_read_b64_tr_b16 v[48:49], v71 offset:128
    ds_read_b64_tr_b16 v[50:51], v71 offset:4736
    v_mfma_f32_16x16x32_bf16 v[144:147], v[36:39], a[160:163], v[144:147]
    ds_read_b64_tr_b16 v[52:53], v71 offset:18560
    ds_read_b64_tr_b16 v[54:55], v71 offset:23168
    v_mfma_f32_16x16x32_bf16 v[148:151], v[36:39], a[164:167], v[148:151]
    v_mfma_f32_16x16x32_bf16 v[148:151], v[32:35], a[148:151], v[148:151]
    v_mfma_f32_16x16x32_bf16 v[152:155], v[32:35], a[152:155], v[152:155]
    v_mfma_f32_16x16x32_bf16 v[152:155], v[36:39], a[168:171], v[152:155]
    v_mfma_f32_16x16x32_bf16 v[156:159], v[36:39], a[172:175], v[156:159]
    v_mfma_f32_16x16x32_bf16 v[156:159], v[32:35], a[156:159], v[156:159]
    s_waitcnt lgkmcnt(6)
    v_mfma_f32_16x16x32_bf16 v[160:163], v[40:43], a[144:147], v[160:163]
    s_waitcnt lgkmcnt(4)
    ds_read_b64_tr_b16 v[32:33], v71 offset:160
    ds_read_b64_tr_b16 v[34:35], v71 offset:4768
    v_mfma_f32_16x16x32_bf16 v[160:163], v[44:47], a[160:163], v[160:163]
    ds_read_b64_tr_b16 v[36:37], v71 offset:18592
    ds_read_b64_tr_b16 v[38:39], v71 offset:23200
    v_mfma_f32_16x16x32_bf16 v[164:167], v[44:47], a[164:167], v[164:167]
    v_mfma_f32_16x16x32_bf16 v[164:167], v[40:43], a[148:151], v[164:167]
    v_mfma_f32_16x16x32_bf16 v[168:171], v[40:43], a[152:155], v[168:171]
    v_mfma_f32_16x16x32_bf16 v[168:171], v[44:47], a[168:171], v[168:171]
    v_mfma_f32_16x16x32_bf16 v[172:175], v[44:47], a[172:175], v[172:175]
    v_mfma_f32_16x16x32_bf16 v[172:175], v[40:43], a[156:159], v[172:175]
    s_waitcnt lgkmcnt(6)
    v_mfma_f32_16x16x32_bf16 v[176:179], v[48:51], a[144:147], v[176:179]
    s_waitcnt lgkmcnt(4)
    ds_read_b64_tr_b16 v[40:41], v71 offset:192
    ds_read_b64_tr_b16 v[42:43], v71 offset:4800
    v_mfma_f32_16x16x32_bf16 v[176:179], v[52:55], a[160:163], v[176:179]
    ds_read_b64_tr_b16 v[44:45], v71 offset:18624
    ds_read_b64_tr_b16 v[46:47], v71 offset:23232
    v_mfma_f32_16x16x32_bf16 v[180:183], v[52:55], a[164:167], v[180:183]
    v_mfma_f32_16x16x32_bf16 v[180:183], v[48:51], a[148:151], v[180:183]
    v_mfma_f32_16x16x32_bf16 v[184:187], v[48:51], a[152:155], v[184:187]
    v_mfma_f32_16x16x32_bf16 v[184:187], v[52:55], a[168:171], v[184:187]
    v_mfma_f32_16x16x32_bf16 v[188:191], v[52:55], a[172:175], v[188:191]
    v_mfma_f32_16x16x32_bf16 v[188:191], v[48:51], a[156:159], v[188:191]
    s_waitcnt lgkmcnt(6)
    v_mfma_f32_16x16x32_bf16 v[192:195], v[32:35], a[144:147], v[192:195]
    s_waitcnt lgkmcnt(4)
    ds_read_b64_tr_b16 v[48:49], v71 offset:224
    ds_read_b64_tr_b16 v[50:51], v71 offset:4832
    v_mfma_f32_16x16x32_bf16 v[192:195], v[36:39], a[160:163], v[192:195]
    ds_read_b64_tr_b16 v[52:53], v71 offset:18656
    ds_read_b64_tr_b16 v[54:55], v71 offset:23264
    v_mfma_f32_16x16x32_bf16 v[196:199], v[36:39], a[164:167], v[196:199]
    v_mfma_f32_16x16x32_bf16 v[196:199], v[32:35], a[148:151], v[196:199]
    v_mfma_f32_16x16x32_bf16 v[200:203], v[32:35], a[152:155], v[200:203]
    v_mfma_f32_16x16x32_bf16 v[200:203], v[36:39], a[168:171], v[200:203]
    v_mfma_f32_16x16x32_bf16 v[204:207], v[36:39], a[172:175], v[204:207]
    v_mfma_f32_16x16x32_bf16 v[204:207], v[32:35], a[156:159], v[204:207]
    s_waitcnt lgkmcnt(6)
    v_mfma_f32_16x16x32_bf16 v[208:211], v[40:43], a[144:147], v[208:211]
    s_waitcnt lgkmcnt(4)
    ds_read_b64_tr_b16 v[32:33], v73 offset:0
    ds_read_b64_tr_b16 v[34:35], v73 offset:4608
    v_mfma_f32_16x16x32_bf16 v[208:211], v[44:47], a[160:163], v[208:211]
    ds_read_b64_tr_b16 v[36:37], v73 offset:18432
    ds_read_b64_tr_b16 v[38:39], v73 offset:23040
    v_mfma_f32_16x16x32_bf16 v[212:215], v[44:47], a[164:167], v[212:215]
    v_mfma_f32_16x16x32_bf16 v[212:215], v[40:43], a[148:151], v[212:215]
    v_mfma_f32_16x16x32_bf16 v[216:219], v[40:43], a[152:155], v[216:219]
    v_mfma_f32_16x16x32_bf16 v[216:219], v[44:47], a[168:171], v[216:219]
    v_mfma_f32_16x16x32_bf16 v[220:223], v[44:47], a[172:175], v[220:223]
Lpad1:
    s_cbranch_execz Lpad3
    v_mfma_f32_16x16x32_bf16 v[220:223], v[40:43], a[156:159], v[220:223]
    s_waitcnt lgkmcnt(6)
    v_mfma_f32_16x16x32_bf16 v[224:227], v[48:51], a[144:147], v[224:227]
    s_waitcnt lgkmcnt(4)
    ds_read_b64_tr_b16 v[40:41], v69 offset:0
    ds_read_b64_tr_b16 v[42:43], v69 offset:4608
    v_mfma_f32_16x16x32_bf16 v[224:227], v[52:55], a[160:163], v[224:227]
    ds_read_b64_tr_b16 v[44:45], v69 offset:18432
    ds_read_b64_tr_b16 v[46:47], v69 offset:23040
    v_mfma_f32_16x16x32_bf16 v[228:231], v[52:55], a[164:167], v[228:231]
    v_mfma_f32_16x16x32_bf16 v[228:231], v[48:51], a[148:151], v[228:231]
    v_mfma_f32_16x16x32_bf16 v[232:235], v[48:51], a[152:155], v[232:235]
    v_mfma_f32_16x16x32_bf16 v[232:235], v[52:55], a[168:171], v[232:235]
    v_mfma_f32_16x16x32_bf16 v[236:239], v[52:55], a[172:175], v[236:239]
    v_mfma_f32_16x16x32_bf16 v[236:239], v[48:51], a[156:159], v[236:239]
    s_waitcnt lgkmcnt(6)
    v_mfma_f32_16x16x32_bf16 v[240:243], v[32:35], a[144:147], v[240:243]
    s_waitcnt lgkmcnt(4)
    ds_read_b64_tr_b16 v[48:49], v69 offset:8
    ds_read_b64_tr_b16 v[50:51], v69 offset:4616
    v_mfma_f32_16x16x32_bf16 v[240:243], v[36:39], a[160:163], v[240:243]
    ds_read_b64_tr_b16 v[52:53], v69 offset:18440
    ds_read_b64_tr_b16 v[54:55], v69 offset:23048
    v_mfma_f32_16x16x32_bf16 v[244:247], v[36:39], a[164:167], v[244:247]
    v_mfma_f32_16x16x32_bf16 v[244:247], v[32:35], a[148:151], v[244:247]
    v_mfma_f32_16x16x32_bf16 v[248:251], v[32:35], a[152:155], v[248:251]
    v_mfma_f32_16x16x32_bf16 v[248:251], v[36:39], a[168:171], v[248:251]
    v_mfma_f32_16x16x32_bf16 v[252:255], v[36:39], a[172:175], v[252:255]
    v_mfma_f32_16x16x32_bf16 v[252:255], v[32:35], a[156:159], v[252:255]
    s_waitcnt lgkmcnt(6)
    v_mfma_f32_16x16x32_bf16 a[0:3], v[40:43], a[144:147], a[0:3]
    s_waitcnt lgkmcnt(4)
    ds_read_b64_tr_b16 v[32:33], v69 offset:64
    ds_read_b64_tr_b16 v[34:35], v69 offset:4672
    v_mfma_f32_16x16x32_bf16 a[0:3], v[44:47], a[160:163], a[0:3]
    ds_read_b64_tr_b16 v[36:37], v69 offset:18496
    ds_read_b64_tr_b16 v[38:39], v69 offset:23104
    v_mfma_f32_16x16x32_bf16 a[4:7], v[44:47], a[164:167], a[4:7]
    v_mfma_f32_16x16x32_bf16 a[4:7], v[40:43], a[148:151], a[4:7]
    v_mfma_f32_16x16x32_bf16 a[8:11], v[40:43], a[152:155], a[8:11]
    v_mfma_f32_16x16x32_bf16 a[8:11], v[44:47], a[168:171], a[8:11]
    v_mfma_f32_16x16x32_bf16 a[12:15], v[44:47], a[172:175], a[12:15]
    v_mfma_f32_16x16x32_bf16 a[12:15], v[40:43], a[156:159], a[12:15]
    s_waitcnt lgkmcnt(6)
    v_mfma_f32_16x16x32_bf16 a[16:19], v[48:51], a[144:147], a[16:19]
    s_waitcnt lgkmcnt(4)
    ds_read_b64_tr_b16 v[40:41], v69 offset:72
    ds_read_b64_tr_b16 v[42:43], v69 offset:4680
    v_mfma_f32_16x16x32_bf16 a[16:19], v[52:55], a[160:163], a[16:19]
    ds_read_b64_tr_b16 v[44:45], v69 offset:18504
    ds_read_b64_tr_b16 v[46:47], v69 offset:23112
    v_mfma_f32_16x16x32_bf16 a[20:23], v[52:55], a[164:167], a[20:23]
    v_mfma_f32_16x16x32_bf16 a[20:23], v[48:51], a[148:151], a[20:23]
    v_mfma_f32_16x16x32_bf16 a[24:27], v[48:51], a[152:155], a[24:27]
    v_mfma_f32_16x16x32_bf16 a[24:27], v[52:55], a[168:171], a[24:27]
    v_mfma_f32_16x16x32_bf16 a[28:31], v[52:55], a[172:175], a[28:31]
    v_mfma_f32_16x16x32_bf16 a[28:31], v[48:51], a[156:159], a[28:31]
    s_waitcnt lgkmcnt(6)
    v_mfma_f32_16x16x32_bf16 a[32:35], v[32:35], a[144:147], a[32:35]
    s_waitcnt lgkmcnt(4)
    ds_read_b64_tr_b16 v[48:49], v69 offset:128
    ds_read_b64_tr_b16 v[50:51], v69 offset:4736
    v_mfma_f32_16x16x32_bf16 a[32:35], v[36:39], a[160:163], a[32:35]
    ds_read_b64_tr_b16 v[52:53], v69 offset:18560
    ds_read_b64_tr_b16 v[54:55], v69 offset:23168
    v_mfma_f32_16x16x32_bf16 a[36:39], v[36:39], a[164:167], a[36:39]
    v_mfma_f32_16x16x32_bf16 a[36:39], v[32:35], a[148:151], a[36:39]
    v_mfma_f32_16x16x32_bf16 a[40:43], v[32:35], a[152:155], a[40:43]
    v_mfma_f32_16x16x32_bf16 a[40:43], v[36:39], a[168:171], a[40:43]
    v_mfma_f32_16x16x32_bf16 a[44:47], v[36:39], a[172:175], a[44:47]
    v_mfma_f32_16x16x32_bf16 a[44:47], v[32:35], a[156:159], a[44:47]
    s_waitcnt lgkmcnt(6)
    v_mfma_f32_16x16x32_bf16 a[48:51], v[40:43], a[144:147], a[48:51]
    s_waitcnt lgkmcnt(4)
    ds_read_b64_tr_b16 v[32:33], v69 offset:136
    ds_read_b64_tr_b16 v[34:35], v69 offset:4744
    v_mfma_f32_16x16x32_bf16 a[48:51], v[44:47], a[160:163], a[48:51]
    ds_read_b64_tr_b16 v[36:37], v69 offset:18568
    ds_read_b64_tr_b16 v[38:39], v69 offset:23176
    v_mfma_f32_16x16x32_bf16 a[52:55], v[44:47], a[164:167], a[52:55]
    v_mfma_f32_16x16x32_bf16 a[52:55], v[40:43], a[148:151], a[52:55]
    v_mfma_f32_16x16x32_bf16 a[56:59], v[40:43], a[152:155], a[56:59]
    v_mfma_f32_16x16x32_bf16 a[56:59], v[44:47], a[168:171], a[56:59]
    v_mfma_f32_16x16x32_bf16 a[60:63], v[44:47], a[172:175], a[60:63]
    v_mfma_f32_16x16x32_bf16 a[60:63], v[40:43], a[156:159], a[60:63]
    s_waitcnt lgkmcnt(6)
    v_mfma_f32_16x16x32_bf16 a[64:67], v[48:51], a[144:147], a[64:67]
    s_waitcnt lgkmcnt(4)
    ds_read_b64_tr_b16 v[40:41], v69 offset:192
    ds_read_b64_tr_b16 v[42:43], v69 offset:4800
    v_mfma_f32_16x16x32_bf16 a[64:67], v[52:55], a[160:163], a[64:67]
    ds_read_b64_tr_b16 v[44:45], v69 offset:18624
    ds_read_b64_tr_b16 v[46:47], v69 offset:23232
    v_mfma_f32_16x16x32_bf16 a[68:71], v[52:55], a[164:167], a[68:71]
    v_mfma_f32_16x16x32_bf16 a[68:71], v[48:51], a[148:151], a[68:71]
    v_mfma_f32_16x16x32_bf16 a[72:75], v[48:51], a[152:155], a[72:75]
    buffer_load_dword v76, v77, s[28:31], s85 offen sc1
    v_mfma_f32_16x16x32_bf16 a[72:75], v[52:55], a[168:171], a[72:75]
    s_add_u32 s85, s85, 262144
    v_mfma_f32_16x16x32_bf16 a[76:79], v[52:55], a[172:175], a[76:79]
    s_add_u32 m0, s78, 36864
    v_mfma_f32_16x16x32_bf16 a[76:79], v[48:51], a[156:159], a[76:79]
    s_waitcnt lgkmcnt(6)
    buffer_load_dwordx4 v68, s[40:43], s76 offen lds
    v_mfma_f32_16x16x32_bf16 a[80:83], v[32:35], a[144:147], a[80:83]
    s_waitcnt lgkmcnt(4)
    s_add_u32 s76, s76, s77
    ds_read_b64_tr_b16 v[48:49], v69 offset:200
    ds_read_b64_tr_b16 v[50:51], v69 offset:4808
    v_mfma_f32_16x16x32_bf16 a[80:83], v[36:39], a[160:163], a[80:83]
    s_add_u32 m0, s82, 46080
    ds_read_b64_tr_b16 v[52:53], v69 offset:18632
    ds_read_b64_tr_b16 v[54:55], v69 offset:23240
    v_mfma_f32_16x16x32_bf16 a[84:87], v[36:39], a[164:167], a[84:87]
    buffer_load_dwordx4 v66, s[36:39], s75 offen lds
    v_mfma_f32_16x16x32_bf16 a[84:87], v[32:35], a[148:151], a[84:87]
    s_add_u32 m0, s82, 47104
    v_mfma_f32_16x16x32_bf16 a[88:91], v[32:35], a[152:155], a[88:91]
    v_mfma_f32_16x16x32_bf16 a[88:91], v[36:39], a[168:171], a[88:91]
    buffer_load_dwordx4 v67, s[36:39], s75 offen lds
    v_mfma_f32_16x16x32_bf16 a[92:95], v[36:39], a[172:175], a[92:95]
    s_waitcnt vmcnt(19)
    v_mfma_f32_16x16x32_bf16 a[92:95], v[32:35], a[156:159], a[92:95]
    s_barrier
    s_waitcnt lgkmcnt(6)
    v_mfma_f32_16x16x32_bf16 a[96:99], v[40:43], a[144:147], a[96:99]
    s_waitcnt lgkmcnt(4)
    s_add_u32 m0, s82, 36864
    ds_read_b64_tr_b16 v[32:33], v71 offset:36864
    ds_read_b64_tr_b16 v[34:35], v71 offset:41472
    v_mfma_f32_16x16x32_bf16 a[96:99], v[44:47], a[160:163], a[96:99]
    buffer_load_dwordx4 v64, s[32:35], s74 offen lds
    v_mfma_f32_16x16x32_bf16 a[100:103], v[44:47], a[164:167], a[100:103]
    s_add_u32 m0, s82, 37888
    ds_read_b64_tr_b16 v[36:37], v71 offset:55296
    ds_read_b64_tr_b16 v[38:39], v71 offset:59904
    v_mfma_f32_16x16x32_bf16 a[100:103], v[40:43], a[148:151], a[100:103]
    v_mfma_f32_16x16x32_bf16 a[104:107], v[40:43], a[152:155], a[104:107]
    v_mfma_f32_16x16x32_bf16 a[104:107], v[44:47], a[168:171], a[104:107]
    v_mfma_f32_16x16x32_bf16 a[108:111], v[44:47], a[172:175], a[108:111]
    buffer_load_dwordx4 v65, s[32:35], s74 offen lds
    v_mfma_f32_16x16x32_bf16 a[108:111], v[40:43], a[156:159], a[108:111]
    s_waitcnt lgkmcnt(6)
    s_add_u32 s74, s74, 262144
    v_mfma_f32_16x16x32_bf16 a[112:115], v[48:51], a[144:147], a[112:115]
    s_waitcnt lgkmcnt(4)
    s_add_u32 s75, s75, 294912
    ds_read_b64_tr_b16 v[40:41], v71 offset:36896
    ds_read_b64_tr_b16 v[42:43], v71 offset:41504
    v_mfma_f32_16x16x32_bf16 a[112:115], v[52:55], a[160:163], a[112:115]
    s_add_u32 m0, s82, 64512
    ds_read_b64_tr_b16 v[44:45], v71 offset:55328
    ds_read_b64_tr_b16 v[46:47], v71 offset:59936
    v_mfma_f32_16x16x32_bf16 a[116:119], v[52:55], a[164:167], a[116:119]
    v_mfma_f32_16x16x32_bf16 a[116:119], v[48:51], a[148:151], a[116:119]
    buffer_load_dwordx4 v66, s[36:39], s75 offen lds
    v_mfma_f32_16x16x32_bf16 a[120:123], v[48:51], a[152:155], a[120:123]
    s_add_u32 m0, s82, 65536
    v_mfma_f32_16x16x32_bf16 a[120:123], v[52:55], a[168:171], a[120:123]
    v_mfma_f32_16x16x32_bf16 a[124:127], v[52:55], a[172:175], a[124:127]
    v_mfma_f32_16x16x32_bf16 a[124:127], v[48:51], a[156:159], a[124:127]
    s_waitcnt vmcnt(21) lgkmcnt(6)
    v_mfma_f32_16x16x32_bf16 v[112:115], v[32:35], a[176:179], v[112:115]
    s_waitcnt vmcnt(17) lgkmcnt(4)
    buffer_load_dwordx4 v67, s[36:39], s75 offen lds
    v_mfma_f32_16x16x32_bf16 v[112:115], v[36:39], a[192:195], v[112:115]
    s_waitcnt vmcnt(17)
    s_add_u32 m0, s82, 55296
    ds_read_b64_tr_b16 v[48:49], v71 offset:36928
    ds_read_b64_tr_b16 v[50:51], v71 offset:41536
    v_mfma_f32_16x16x32_bf16 v[116:119], v[36:39], a[196:199], v[116:119]
    ds_read_b64_tr_b16 v[52:53], v71 offset:55360
    ds_read_b64_tr_b16 v[54:55], v71 offset:59968
    v_mfma_f32_16x16x32_bf16 v[116:119], v[32:35], a[180:183], v[116:119]
    v_mfma_f32_16x16x32_bf16 v[120:123], v[32:35], a[184:187], v[120:123]
    s_waitcnt vmcnt(16)
    v_mfma_f32_16x16x32_bf16 v[120:123], v[36:39], a[200:203], v[120:123]
    s_waitcnt vmcnt(15)
    buffer_load_dwordx4 v64, s[32:35], s74 offen lds
    v_mfma_f32_16x16x32_bf16 v[124:127], v[36:39], a[204:207], v[124:127]
    s_add_u32 m0, s82, 56320
    v_mfma_f32_16x16x32_bf16 v[124:127], v[32:35], a[188:191], v[124:127]
    s_waitcnt lgkmcnt(6)
    s_nop 0
    v_mfma_f32_16x16x32_bf16 v[128:131], v[40:43], a[176:179], v[128:131]
    s_barrier
    ds_read_b64_tr_b16 v[32:33], v71 offset:36960
    ds_read_b64_tr_b16 v[34:35], v71 offset:41568
    s_waitcnt lgkmcnt(6)
    v_mfma_f32_16x16x32_bf16 v[128:131], v[44:47], a[192:195], v[128:131]
    ds_read_b64_tr_b16 v[36:37], v71 offset:55392
    ds_read_b64_tr_b16 v[38:39], v71 offset:60000
    v_mfma_f32_16x16x32_bf16 v[132:135], v[44:47], a[196:199], v[132:135]
    buffer_load_dwordx4 v65, s[32:35], s74 offen lds
    v_mfma_f32_16x16x32_bf16 v[132:135], v[40:43], a[180:183], v[132:135]
    s_add_u32 s74, s74, 262144
    v_mfma_f32_16x16x32_bf16 v[136:139], v[40:43], a[184:187], v[136:139]
    v_cmp_ne_u32 vcc, s89, v81
    s_nop 0
    s_cmp_lg_u64 vcc, 0
    s_cselect_b32 s27, 1, 0
    v_mfma_f32_16x16x32_bf16 v[136:139], v[44:47], a[200:203], v[136:139]
    s_add_u32 s75, s75, 294912
    v_mfma_f32_16x16x32_bf16 v[140:143], v[44:47], a[204:207], v[140:143]
    v_mfma_f32_16x16x32_bf16 v[140:143], v[40:43], a[188:191], v[140:143]
    s_waitcnt lgkmcnt(6)
    buffer_load_dwordx4 a[208:211], v2, s[28:31], s73 offen offset:0 sc1
    v_mfma_f32_16x16x32_bf16 v[144:147], v[48:51], a[176:179], v[144:147]
    s_waitcnt lgkmcnt(4)
    ds_read_b64_tr_b16 v[40:41], v71 offset:36992
    ds_read_b64_tr_b16 v[42:43], v71 offset:41600
    v_mfma_f32_16x16x32_bf16 v[144:147], v[52:55], a[192:195], v[144:147]
    ds_read_b64_tr_b16 v[44:45], v71 offset:55424
    ds_read_b64_tr_b16 v[46:47], v71 offset:60032
    v_mfma_f32_16x16x32_bf16 v[148:151], v[52:55], a[196:199], v[148:151]
    v_mfma_f32_16x16x32_bf16 v[148:151], v[48:51], a[180:183], v[148:151]
    v_mfma_f32_16x16x32_bf16 v[152:155], v[48:51], a[184:187], v[152:155]
    buffer_load_dwordx4 a[212:215], v2, s[28:31], s73 offen offset:1024 sc1
    v_mfma_f32_16x16x32_bf16 v[152:155], v[52:55], a[200:203], v[152:155]
    v_mfma_f32_16x16x32_bf16 v[156:159], v[52:55], a[204:207], v[156:159]
    v_mfma_f32_16x16x32_bf16 v[156:159], v[48:51], a[188:191], v[156:159]
    s_waitcnt lgkmcnt(6)
    v_mfma_f32_16x16x32_bf16 v[160:163], v[32:35], a[176:179], v[160:163]
    s_waitcnt lgkmcnt(4)
    buffer_load_dwordx4 a[216:219], v2, s[28:31], s73 offen offset:2048 sc1
    v_mfma_f32_16x16x32_bf16 v[160:163], v[36:39], a[192:195], v[160:163]
    ds_read_b64_tr_b16 v[48:49], v71 offset:37024
    ds_read_b64_tr_b16 v[50:51], v71 offset:41632
    v_mfma_f32_16x16x32_bf16 v[164:167], v[36:39], a[196:199], v[164:167]
    ds_read_b64_tr_b16 v[52:53], v71 offset:55456
    ds_read_b64_tr_b16 v[54:55], v71 offset:60064
    v_mfma_f32_16x16x32_bf16 v[164:167], v[32:35], a[180:183], v[164:167]
    v_mfma_f32_16x16x32_bf16 v[168:171], v[32:35], a[184:187], v[168:171]
    v_mfma_f32_16x16x32_bf16 v[168:171], v[36:39], a[200:203], v[168:171]
    buffer_load_dwordx4 a[220:223], v2, s[28:31], s73 offen offset:3072 sc1
    v_mfma_f32_16x16x32_bf16 v[172:175], v[36:39], a[204:207], v[172:175]
    s_add_u32 s73, s73, 131072
    v_mfma_f32_16x16x32_bf16 v[172:175], v[32:35], a[188:191], v[172:175]
    s_waitcnt lgkmcnt(6)
    v_mfma_f32_16x16x32_bf16 v[176:179], v[40:43], a[176:179], v[176:179]
    s_waitcnt lgkmcnt(4)
    ds_read_b64_tr_b16 v[32:33], v71 offset:37056
    ds_read_b64_tr_b16 v[34:35], v71 offset:41664
    v_mfma_f32_16x16x32_bf16 v[176:179], v[44:47], a[192:195], v[176:179]
    buffer_load_dwordx4 a[224:227], v2, s[28:31], s73 offen offset:0 sc1
    v_mfma_f32_16x16x32_bf16 v[180:183], v[44:47], a[196:199], v[180:183]
    ds_read_b64_tr_b16 v[36:37], v71 offset:55488
    ds_read_b64_tr_b16 v[38:39], v71 offset:60096
    v_mfma_f32_16x16x32_bf16 v[180:183], v[40:43], a[180:183], v[180:183]
    v_mfma_f32_16x16x32_bf16 v[184:187], v[40:43], a[184:187], v[184:187]
    v_mfma_f32_16x16x32_bf16 v[184:187], v[44:47], a[200:203], v[184:187]
    buffer_load_dwordx4 a[228:231], v2, s[28:31], s73 offen offset:1024 sc1
    v_mfma_f32_16x16x32_bf16 v[188:191], v[44:47], a[204:207], v[188:191]
    v_mfma_f32_16x16x32_bf16 v[188:191], v[40:43], a[188:191], v[188:191]
    s_waitcnt lgkmcnt(6)
    v_mfma_f32_16x16x32_bf16 v[192:195], v[48:51], a[176:179], v[192:195]
    s_waitcnt lgkmcnt(4)
    ds_read_b64_tr_b16 v[40:41], v71 offset:37088
    ds_read_b64_tr_b16 v[42:43], v71 offset:41696
    v_mfma_f32_16x16x32_bf16 v[192:195], v[52:55], a[192:195], v[192:195]
    ds_read_b64_tr_b16 v[44:45], v71 offset:55520
    ds_read_b64_tr_b16 v[46:47], v71 offset:60128
    v_mfma_f32_16x16x32_bf16 v[196:199], v[52:55], a[196:199], v[196:199]
    buffer_load_dwordx4 a[232:235], v2, s[28:31], s73 offen offset:2048 sc1
    v_mfma_f32_16x16x32_bf16 v[196:199], v[48:51], a[180:183], v[196:199]
    v_mfma_f32_16x16x32_bf16 v[200:203], v[48:51], a[184:187], v[200:203]
    v_mfma_f32_16x16x32_bf16 v[200:203], v[52:55], a[200:203], v[200:203]
    v_mfma_f32_16x16x32_bf16 v[204:207], v[52:55], a[204:207], v[204:207]
    buffer_load_dwordx4 a[236:239], v2, s[28:31], s73 offen offset:3072 sc1
    v_mfma_f32_16x16x32_bf16 v[204:207], v[48:51], a[188:191], v[204:207]
    s_waitcnt lgkmcnt(6)
    s_add_u32 s73, s73, 131072
    v_mfma_f32_16x16x32_bf16 v[208:211], v[32:35], a[176:179], v[208:211]
    s_waitcnt lgkmcnt(4)
    ds_read_b64_tr_b16 v[48:49], v73 offset:36864
    ds_read_b64_tr_b16 v[50:51], v73 offset:41472
    v_mfma_f32_16x16x32_bf16 v[208:211], v[36:39], a[192:195], v[208:211]
    ds_read_b64_tr_b16 v[52:53], v73 offset:55296
    ds_read_b64_tr_b16 v[54:55], v73 offset:59904
    v_mfma_f32_16x16x32_bf16 v[212:215], v[36:39], a[196:199], v[212:215]
    v_mfma_f32_16x16x32_bf16 v[212:215], v[32:35], a[180:183], v[212:215]
    buffer_load_dword v76, v77, s[28:31], s85 offen sc1
    v_mfma_f32_16x16x32_bf16 v[216:219], v[32:35], a[184:187], v[216:219]
    s_add_u32 s85, s85, 262144
    v_mfma_f32_16x16x32_bf16 v[216:219], v[36:39], a[200:203], v[216:219]
    s_add_u32 m0, s78, 0
    v_mfma_f32_16x16x32_bf16 v[220:223], v[36:39], a[204:207], v[220:223]
    v_mfma_f32_16x16x32_bf16 v[220:223], v[32:35], a[188:191], v[220:223]
    s_waitcnt lgkmcnt(6)
    buffer_load_dwordx4 v68, s[40:43], s76 offen lds
    v_mfma_f32_16x16x32_bf16 v[224:227], v[40:43], a[176:179], v[224:227]
    s_waitcnt lgkmcnt(4)
    s_add_u32 s76, s76, s77
    ds_read_b64_tr_b16 v[32:33], v69 offset:36864
    ds_read_b64_tr_b16 v[34:35], v69 offset:41472
    v_mfma_f32_16x16x32_bf16 v[224:227], v[44:47], a[192:195], v[224:227]
    s_add_u32 m0, s82, 9216
    ds_read_b64_tr_b16 v[36:37], v69 offset:55296
    ds_read_b64_tr_b16 v[38:39], v69 offset:59904
    v_mfma_f32_16x16x32_bf16 v[228:231], v[44:47], a[196:199], v[228:231]
    v_mfma_f32_16x16x32_bf16 v[228:231], v[40:43], a[180:183], v[228:231]
    v_mfma_f32_16x16x32_bf16 v[232:235], v[40:43], a[184:187], v[232:235]
    buffer_load_dwordx4 v66, s[36:39], s75 offen lds
    v_mfma_f32_16x16x32_bf16 v[232:235], v[44:47], a[200:203], v[232:235]
    s_add_u32 m0, s82, 10240
    v_mfma_f32_16x16x32_bf16 v[236:239], v[44:47], a[204:207], v[236:239]
    v_mfma_f32_16x16x32_bf16 v[236:239], v[40:43], a[188:191], v[236:239]
    s_waitcnt lgkmcnt(6)
    v_mfma_f32_16x16x32_bf16 v[240:243], v[48:51], a[176:179], v[240:243]
    s_waitcnt lgkmcnt(4)
    ds_read_b64_tr_b16 v[40:41], v69 offset:36872
    ds_read_b64_tr_b16 v[42:43], v69 offset:41480
    v_mfma_f32_16x16x32_bf16 v[240:243], v[52:55], a[192:195], v[240:243]
    buffer_load_dwordx4 v67, s[36:39], s75 offen lds
    v_mfma_f32_16x16x32_bf16 v[244:247], v[52:55], a[196:199], v[244:247]
    s_add_u32 m0, s82, 0
    ds_read_b64_tr_b16 v[44:45], v69 offset:55304
    ds_read_b64_tr_b16 v[46:47], v69 offset:59912
    v_mfma_f32_16x16x32_bf16 v[244:247], v[48:51], a[180:183], v[244:247]
    v_mfma_f32_16x16x32_bf16 v[248:251], v[48:51], a[184:187], v[248:251]
    v_mfma_f32_16x16x32_bf16 v[248:251], v[52:55], a[200:203], v[248:251]
    v_mfma_f32_16x16x32_bf16 v[252:255], v[52:55], a[204:207], v[252:255]
    buffer_load_dwordx4 v64, s[32:35], s74 offen lds
    v_mfma_f32_16x16x32_bf16 v[252:255], v[48:51], a[188:191], v[252:255]
    s_waitcnt lgkmcnt(6)
    s_add_u32 m0, s82, 1024
    v_mfma_f32_16x16x32_bf16 a[0:3], v[32:35], a[176:179], a[0:3]
    s_waitcnt lgkmcnt(4)
    ds_read_b64_tr_b16 v[48:49], v69 offset:36928
    ds_read_b64_tr_b16 v[50:51], v69 offset:41536
    v_mfma_f32_16x16x32_bf16 a[0:3], v[36:39], a[192:195], a[0:3]
    ds_read_b64_tr_b16 v[52:53], v69 offset:55360
    ds_read_b64_tr_b16 v[54:55], v69 offset:59968
    v_mfma_f32_16x16x32_bf16 a[4:7], v[36:39], a[196:199], a[4:7]
    v_mfma_f32_16x16x32_bf16 a[4:7], v[32:35], a[180:183], a[4:7]
    buffer_load_dwordx4 v65, s[32:35], s74 offen lds
    v_mfma_f32_16x16x32_bf16 a[8:11], v[32:35], a[184:187], a[8:11]
    s_add_u32 s74, s74, 262144
    v_mfma_f32_16x16x32_bf16 a[8:11], v[36:39], a[200:203], a[8:11]
    s_add_u32 s75, s75, 294912
    v_mfma_f32_16x16x32_bf16 a[12:15], v[36:39], a[204:207], a[12:15]
    s_add_u32 m0, s82, 27648
    v_mfma_f32_16x16x32_bf16 a[12:15], v[32:35], a[188:191], a[12:15]
    s_waitcnt lgkmcnt(6)
    v_mfma_f32_16x16x32_bf16 a[16:19], v[40:43], a[176:179], a[16:19]
    s_waitcnt lgkmcnt(4)
    buffer_load_dwordx4 v66, s[36:39], s75 offen lds
    v_mfma_f32_16x16x32_bf16 a[16:19], v[44:47], a[192:195], a[16:19]
    s_add_u32 m0, s82, 28672
    ds_read_b64_tr_b16 v[32:33], v69 offset:36936
    ds_read_b64_tr_b16 v[34:35], v69 offset:41544
    v_mfma_f32_16x16x32_bf16 a[20:23], v[44:47], a[196:199], a[20:23]
    ds_read_b64_tr_b16 v[36:37], v69 offset:55368
    ds_read_b64_tr_b16 v[38:39], v69 offset:59976
    v_mfma_f32_16x16x32_bf16 a[20:23], v[40:43], a[180:183], a[20:23]
    v_mfma_f32_16x16x32_bf16 a[24:27], v[40:43], a[184:187], a[24:27]
    v_mfma_f32_16x16x32_bf16 a[24:27], v[44:47], a[200:203], a[24:27]
    buffer_load_dwordx4 v67, s[36:39], s75 offen lds
    v_mfma_f32_16x16x32_bf16 a[28:31], v[44:47], a[204:207], a[28:31]
    s_add_u32 m0, s82, 18432
    v_mfma_f32_16x16x32_bf16 a[28:31], v[40:43], a[188:191], a[28:31]
    s_waitcnt lgkmcnt(6)
    v_mfma_f32_16x16x32_bf16 a[32:35], v[48:51], a[176:179], a[32:35]
    s_waitcnt lgkmcnt(4)
    ds_read_b64_tr_b16 v[40:41], v69 offset:36992
    ds_read_b64_tr_b16 v[42:43], v69 offset:41600
    v_mfma_f32_16x16x32_bf16 a[32:35], v[52:55], a[192:195], a[32:35]
    ds_read_b64_tr_b16 v[44:45], v69 offset:55424
    ds_read_b64_tr_b16 v[46:47], v69 offset:60032
    v_mfma_f32_16x16x32_bf16 a[36:39], v[52:55], a[196:199], a[36:39]
    buffer_load_dwordx4 v64, s[32:35], s74 offen lds
    v_mfma_f32_16x16x32_bf16 a[36:39], v[48:51], a[180:183], a[36:39]
    s_add_u32 m0, s82, 19456
    v_mfma_f32_16x16x32_bf16 a[40:43], v[48:51], a[184:187], a[40:43]
    v_mfma_f32_16x16x32_bf16 a[40:43], v[52:55], a[200:203], a[40:43]
    v_mfma_f32_16x16x32_bf16 a[44:47], v[52:55], a[204:207], a[44:47]
    v_mfma_f32_16x16x32_bf16 a[44:47], v[48:51], a[188:191], a[44:47]
    s_waitcnt lgkmcnt(6)
    buffer_load_dwordx4 v65, s[32:35], s74 offen lds
    v_mfma_f32_16x16x32_bf16 a[48:51], v[32:35], a[176:179], a[48:51]
    s_waitcnt lgkmcnt(4)
    s_add_u32 s74, s74, 262144
    ds_read_b64_tr_b16 v[48:49], v69 offset:37000
    ds_read_b64_tr_b16 v[50:51], v69 offset:41608
    v_mfma_f32_16x16x32_bf16 a[48:51], v[36:39], a[192:195], a[48:51]
    s_add_u32 s75, s75, 294912
    ds_read_b64_tr_b16 v[52:53], v69 offset:55432
    ds_read_b64_tr_b16 v[54:55], v69 offset:60040
    v_mfma_f32_16x16x32_bf16 a[52:55], v[36:39], a[196:199], a[52:55]
    v_mfma_f32_16x16x32_bf16 a[52:55], v[32:35], a[180:183], a[52:55]
    v_mfma_f32_16x16x32_bf16 a[56:59], v[32:35], a[184:187], a[56:59]
    buffer_load_dwordx4 a[128:131], v2, s[28:31], s73 offen offset:0 sc1
    v_mfma_f32_16x16x32_bf16 a[56:59], v[36:39], a[200:203], a[56:59]
    v_mfma_f32_16x16x32_bf16 a[60:63], v[36:39], a[204:207], a[60:63]
    v_mfma_f32_16x16x32_bf16 a[60:63], v[32:35], a[188:191], a[60:63]
    s_waitcnt lgkmcnt(6)
    v_mfma_f32_16x16x32_bf16 a[64:67], v[40:43], a[176:179], a[64:67]
    s_waitcnt lgkmcnt(4)
    buffer_load_dwordx4 a[132:135], v2, s[28:31], s73 offen offset:1024 sc1
    v_mfma_f32_16x16x32_bf16 a[64:67], v[44:47], a[192:195], a[64:67]
    ds_read_b64_tr_b16 v[32:33], v69 offset:37056
    ds_read_b64_tr_b16 v[34:35], v69 offset:41664
    v_mfma_f32_16x16x32_bf16 a[68:71], v[44:47], a[196:199], a[68:71]
    ds_read_b64_tr_b16 v[36:37], v69 offset:55488
    ds_read_b64_tr_b16 v[38:39], v69 offset:60096
    v_mfma_f32_16x16x32_bf16 a[68:71], v[40:43], a[180:183], a[68:71]
    v_mfma_f32_16x16x32_bf16 a[72:75], v[40:43], a[184:187], a[72:75]
    buffer_load_dwordx4 a[136:139], v2, s[28:31], s73 offen offset:2048 sc1
    v_mfma_f32_16x16x32_bf16 a[72:75], v[44:47], a[200:203], a[72:75]
    v_mfma_f32_16x16x32_bf16 a[76:79], v[44:47], a[204:207], a[76:79]
    v_mfma_f32_16x16x32_bf16 a[76:79], v[40:43], a[188:191], a[76:79]
    s_waitcnt lgkmcnt(6)
    v_mfma_f32_16x16x32_bf16 a[80:83], v[48:51], a[176:179], a[80:83]
    s_waitcnt lgkmcnt(4)
    ds_read_b64_tr_b16 v[40:41], v69 offset:37064
    ds_read_b64_tr_b16 v[42:43], v69 offset:41672
    v_mfma_f32_16x16x32_bf16 a[80:83], v[52:55], a[192:195], a[80:83]
    buffer_load_dwordx4 a[140:143], v2, s[28:31], s73 offen offset:3072 sc1
    v_mfma_f32_16x16x32_bf16 a[84:87], v[52:55], a[196:199], a[84:87]
    s_add_u32 s73, s73, 131072
    ds_read_b64_tr_b16 v[44:45], v69 offset:55496
    ds_read_b64_tr_b16 v[46:47], v69 offset:60104
    v_mfma_f32_16x16x32_bf16 a[84:87], v[48:51], a[180:183], a[84:87]
    v_mfma_f32_16x16x32_bf16 a[88:91], v[48:51], a[184:187], a[88:91]
    v_mfma_f32_16x16x32_bf16 a[88:91], v[52:55], a[200:203], a[88:91]
    buffer_load_dwordx4 a[240:243], v2, s[28:31], s73 offen offset:0 sc1
    v_mfma_f32_16x16x32_bf16 a[92:95], v[52:55], a[204:207], a[92:95]
    s_waitcnt vmcnt(23)
    v_mfma_f32_16x16x32_bf16 a[92:95], v[48:51], a[188:191], a[92:95]
    s_barrier
    s_waitcnt lgkmcnt(6)
    v_mfma_f32_16x16x32_bf16 a[96:99], v[32:35], a[176:179], a[96:99]
    s_waitcnt lgkmcnt(4)
    ds_read_b64_tr_b16 v[48:49], v72 offset:36864
    ds_read_b64_tr_b16 v[50:51], v72 offset:41472
    v_mfma_f32_16x16x32_bf16 a[96:99], v[36:39], a[192:195], a[96:99]
    ds_read_b64_tr_b16 v[52:53], v72 offset:55296
    ds_read_b64_tr_b16 v[54:55], v72 offset:59904
    v_mfma_f32_16x16x32_bf16 a[100:103], v[36:39], a[196:199], a[100:103]
    buffer_load_dwordx4 a[244:247], v2, s[28:31], s73 offen offset:1024 sc1
    v_mfma_f32_16x16x32_bf16 a[100:103], v[32:35], a[180:183], a[100:103]
    v_mfma_f32_16x16x32_bf16 a[104:107], v[32:35], a[184:187], a[104:107]
    v_mfma_f32_16x16x32_bf16 a[104:107], v[36:39], a[200:203], a[104:107]
    v_mfma_f32_16x16x32_bf16 a[108:111], v[36:39], a[204:207], a[108:111]
    buffer_load_dwordx4 a[248:251], v2, s[28:31], s73 offen offset:2048 sc1
    v_mfma_f32_16x16x32_bf16 a[108:111], v[32:35], a[188:191], a[108:111]
    s_waitcnt lgkmcnt(6)
    v_mfma_f32_16x16x32_bf16 a[112:115], v[40:43], a[176:179], a[112:115]
    s_waitcnt lgkmcnt(4)
    ds_read_b64_tr_b16 v[32:33], v72 offset:36896
    ds_read_b64_tr_b16 v[34:35], v72 offset:41504
    v_mfma_f32_16x16x32_bf16 a[112:115], v[44:47], a[192:195], a[112:115]
    ds_read_b64_tr_b16 v[36:37], v72 offset:55328
    ds_read_b64_tr_b16 v[38:39], v72 offset:59936
    v_mfma_f32_16x16x32_bf16 a[116:119], v[44:47], a[196:199], a[116:119]
    buffer_load_dwordx4 a[252:255], v2, s[28:31], s73 offen offset:3072 sc1
    v_mfma_f32_16x16x32_bf16 a[116:119], v[40:43], a[180:183], a[116:119]
    s_add_u32 s73, s73, 131072
    v_mfma_f32_16x16x32_bf16 a[120:123], v[40:43], a[184:187], a[120:123]
    v_mfma_f32_16x16x32_bf16 a[120:123], v[44:47], a[200:203], a[120:123]
    v_mfma_f32_16x16x32_bf16 a[124:127], v[44:47], a[204:207], a[124:127]
    v_mfma_f32_16x16x32_bf16 a[124:127], v[40:43], a[188:191], a[124:127]
    s_waitcnt vmcnt(25) lgkmcnt(6)
    buffer_load_dword v76, v77, s[28:31], s85 offen sc1
    v_mfma_f32_16x16x32_bf16 v[112:115], v[48:51], a[208:211], v[112:115]
    s_waitcnt vmcnt(22) lgkmcnt(4)
    s_add_u32 s85, s85, 262144
    ds_read_b64_tr_b16 v[40:41], v72 offset:36928
    ds_read_b64_tr_b16 v[42:43], v72 offset:41536
    v_mfma_f32_16x16x32_bf16 v[112:115], v[52:55], a[224:227], v[112:115]
    s_waitcnt vmcnt(21)
    s_add_u32 m0, s78, 73728
    ds_read_b64_tr_b16 v[44:45], v72 offset:55360
    ds_read_b64_tr_b16 v[46:47], v72 offset:59968
    v_mfma_f32_16x16x32_bf16 v[116:119], v[52:55], a[228:231], v[116:119]
    v_mfma_f32_16x16x32_bf16 v[116:119], v[48:51], a[212:215], v[116:119]
    buffer_load_dwordx4 v68, s[40:43], s76 offen lds
    v_mfma_f32_16x16x32_bf16 v[120:123], v[48:51], a[216:219], v[120:123]
    s_waitcnt vmcnt(21)
    s_add_u32 s76, s76, s77
    v_mfma_f32_16x16x32_bf16 v[120:123], v[52:55], a[232:235], v[120:123]
    s_waitcnt vmcnt(20)
    s_add_u32 m0, s82, 82944
    v_mfma_f32_16x16x32_bf16 v[124:127], v[52:55], a[236:239], v[124:127]
    v_mfma_f32_16x16x32_bf16 v[124:127], v[48:51], a[220:223], v[124:127]
    s_waitcnt lgkmcnt(6)
    s_nop 0
    v_mfma_f32_16x16x32_bf16 v[128:131], v[32:35], a[208:211], v[128:131]
    s_barrier
    buffer_load_dwordx4 v66, s[36:39], s75 offen lds
    s_waitcnt lgkmcnt(4)
    v_mfma_f32_16x16x32_bf16 v[128:131], v[36:39], a[224:227], v[128:131]
    s_add_u32 m0, s82, 83968
    ds_read_b64_tr_b16 v[48:49], v72 offset:36960
    ds_read_b64_tr_b16 v[50:51], v72 offset:41568
    v_mfma_f32_16x16x32_bf16 v[132:135], v[36:39], a[228:231], v[132:135]
    ds_read_b64_tr_b16 v[52:53], v72 offset:55392
    ds_read_b64_tr_b16 v[54:55], v72 offset:60000
    v_mfma_f32_16x16x32_bf16 v[132:135], v[32:35], a[212:215], v[132:135]
    v_mfma_f32_16x16x32_bf16 v[136:139], v[32:35], a[216:219], v[136:139]
    v_mfma_f32_16x16x32_bf16 v[136:139], v[36:39], a[232:235], v[136:139]
    buffer_load_dwordx4 v67, s[36:39], s75 offen lds
    v_mfma_f32_16x16x32_bf16 v[140:143], v[36:39], a[236:239], v[140:143]
    s_add_u32 m0, s82, 73728
    v_mfma_f32_16x16x32_bf16 v[140:143], v[32:35], a[220:223], v[140:143]
    s_waitcnt lgkmcnt(6)
    v_mfma_f32_16x16x32_bf16 v[144:147], v[40:43], a[208:211], v[144:147]
    s_waitcnt lgkmcnt(4)
    ds_read_b64_tr_b16 v[32:33], v72 offset:36992
    ds_read_b64_tr_b16 v[34:35], v72 offset:41600
    v_mfma_f32_16x16x32_bf16 v[144:147], v[44:47], a[224:227], v[144:147]
    ds_read_b64_tr_b16 v[36:37], v72 offset:55424
    ds_read_b64_tr_b16 v[38:39], v72 offset:60032
    v_mfma_f32_16x16x32_bf16 v[148:151], v[44:47], a[228:231], v[148:151]
    buffer_load_dwordx4 v64, s[32:35], s74 offen lds
    v_mfma_f32_16x16x32_bf16 v[148:151], v[40:43], a[212:215], v[148:151]
    s_add_u32 m0, s82, 74752
    v_mfma_f32_16x16x32_bf16 v[152:155], v[40:43], a[216:219], v[152:155]
    v_mfma_f32_16x16x32_bf16 v[152:155], v[44:47], a[232:235], v[152:155]
    v_mfma_f32_16x16x32_bf16 v[156:159], v[44:47], a[236:239], v[156:159]
    v_mfma_f32_16x16x32_bf16 v[156:159], v[40:43], a[220:223], v[156:159]
    s_waitcnt lgkmcnt(6)
    buffer_load_dwordx4 v65, s[32:35], s74 offen lds
    v_mfma_f32_16x16x32_bf16 v[160:163], v[48:51], a[208:211], v[160:163]
    s_waitcnt lgkmcnt(4)
    s_add_u32 s74, s74, 262144
    ds_read_b64_tr_b16 v[40:41], v72 offset:37024
    ds_read_b64_tr_b16 v[42:43], v72 offset:41632
    v_mfma_f32_16x16x32_bf16 v[160:163], v[52:55], a[224:227], v[160:163]
    s_add_u32 s75, s75, 294912
    ds_read_b64_tr_b16 v[44:45], v72 offset:55456
    ds_read_b64_tr_b16 v[46:47], v72 offset:60064
    v_mfma_f32_16x16x32_bf16 v[164:167], v[52:55], a[228:231], v[164:167]
    s_add_u32 m0, s82, 101376
    v_mfma_f32_16x16x32_bf16 v[164:167], v[48:51], a[212:215], v[164:167]
    v_mfma_f32_16x16x32_bf16 v[168:171], v[48:51], a[216:219], v[168:171]
    buffer_load_dwordx4 v66, s[36:39], s75 offen lds
    v_mfma_f32_16x16x32_bf16 v[168:171], v[52:55], a[232:235], v[168:171]
    s_add_u32 m0, s82, 102400
    v_mfma_f32_16x16x32_bf16 v[172:175], v[52:55], a[236:239], v[172:175]
    v_mfma_f32_16x16x32_bf16 v[172:175], v[48:51], a[220:223], v[172:175]
    s_waitcnt lgkmcnt(6)
    v_mfma_f32_16x16x32_bf16 v[176:179], v[32:35], a[208:211], v[176:179]
    s_waitcnt lgkmcnt(4)
    ds_read_b64_tr_b16 v[48:49], v72 offset:37056
    ds_read_b64_tr_b16 v[50:51], v72 offset:41664
    v_mfma_f32_16x16x32_bf16 v[176:179], v[36:39], a[224:227], v[176:179]
    buffer_load_dwordx4 v67, s[36:39], s75 offen lds
    v_mfma_f32_16x16x32_bf16 v[180:183], v[36:39], a[228:231], v[180:183]
    s_add_u32 m0, s82, 92160
    ds_read_b64_tr_b16 v[52:53], v72 offset:55488
    ds_read_b64_tr_b16 v[54:55], v72 offset:60096
    v_mfma_f32_16x16x32_bf16 v[180:183], v[32:35], a[212:215], v[180:183]
    v_mfma_f32_16x16x32_bf16 v[184:187], v[32:35], a[216:219], v[184:187]
    v_mfma_f32_16x16x32_bf16 v[184:187], v[36:39], a[232:235], v[184:187]
Lpad2:
    s_cbranch_execz Lpad4
    v_mfma_f32_16x16x32_bf16 v[188:191], v[36:39], a[236:239], v[188:191]
    buffer_load_dwordx4 v64, s[32:35], s74 offen lds
    v_mfma_f32_16x16x32_bf16 v[188:191], v[32:35], a[220:223], v[188:191]
    s_waitcnt lgkmcnt(6)
    s_add_u32 m0, s82, 93184
    v_mfma_f32_16x16x32_bf16 v[192:195], v[40:43], a[208:211], v[192:195]
    s_waitcnt lgkmcnt(4)
    ds_read_b64_tr_b16 v[32:33], v72 offset:37088
    ds_read_b64_tr_b16 v[34:35], v72 offset:41696
    v_mfma_f32_16x16x32_bf16 v[192:195], v[44:47], a[224:227], v[192:195]
    ds_read_b64_tr_b16 v[36:37], v72 offset:55520
    ds_read_b64_tr_b16 v[38:39], v72 offset:60128
    v_mfma_f32_16x16x32_bf16 v[196:199], v[44:47], a[228:231], v[196:199]
    v_mfma_f32_16x16x32_bf16 v[196:199], v[40:43], a[212:215], v[196:199]
    buffer_load_dwordx4 v65, s[32:35], s74 offen lds
    v_mfma_f32_16x16x32_bf16 v[200:203], v[40:43], a[216:219], v[200:203]
    s_add_u32 s74, s74, 262144
    v_mfma_f32_16x16x32_bf16 v[200:203], v[44:47], a[232:235], v[200:203]
    s_add_u32 s75, s75, 294912
    v_mfma_f32_16x16x32_bf16 v[204:207], v[44:47], a[236:239], v[204:207]
    v_mfma_f32_16x16x32_bf16 v[204:207], v[40:43], a[220:223], v[204:207]
    s_waitcnt lgkmcnt(6)
    v_mfma_f32_16x16x32_bf16 v[208:211], v[48:51], a[208:211], v[208:211]
    s_waitcnt lgkmcnt(4)
    buffer_load_dwordx4 a[144:147], v2, s[28:31], s73 offen offset:0 sc1
    v_mfma_f32_16x16x32_bf16 v[208:211], v[52:55], a[224:227], v[208:211]
    ds_read_b64_tr_b16 v[40:41], v74 offset:36864
    ds_read_b64_tr_b16 v[42:43], v74 offset:41472
    v_mfma_f32_16x16x32_bf16 v[212:215], v[52:55], a[228:231], v[212:215]
    ds_read_b64_tr_b16 v[44:45], v74 offset:55296
    ds_read_b64_tr_b16 v[46:47], v74 offset:59904
    v_mfma_f32_16x16x32_bf16 v[212:215], v[48:51], a[212:215], v[212:215]
    v_mfma_f32_16x16x32_bf16 v[216:219], v[48:51], a[216:219], v[216:219]
    buffer_load_dwordx4 a[148:151], v2, s[28:31], s73 offen offset:1024 sc1
    v_mfma_f32_16x16x32_bf16 v[216:219], v[52:55], a[232:235], v[216:219]
    v_mfma_f32_16x16x32_bf16 v[220:223], v[52:55], a[236:239], v[220:223]
    v_mfma_f32_16x16x32_bf16 v[220:223], v[48:51], a[220:223], v[220:223]
    s_waitcnt lgkmcnt(6)
    v_mfma_f32_16x16x32_bf16 v[224:227], v[32:35], a[208:211], v[224:227]
    s_waitcnt lgkmcnt(4)
    ds_read_b64_tr_b16 v[48:49], v70 offset:36864
    ds_read_b64_tr_b16 v[50:51], v70 offset:41472
    v_mfma_f32_16x16x32_bf16 v[224:227], v[36:39], a[224:227], v[224:227]
    buffer_load_dwordx4 a[152:155], v2, s[28:31], s73 offen offset:2048 sc1
    v_mfma_f32_16x16x32_bf16 v[228:231], v[36:39], a[228:231], v[228:231]
    ds_read_b64_tr_b16 v[52:53], v70 offset:55296
    ds_read_b64_tr_b16 v[54:55], v70 offset:59904
    v_mfma_f32_16x16x32_bf16 v[228:231], v[32:35], a[212:215], v[228:231]
    v_mfma_f32_16x16x32_bf16 v[232:235], v[32:35], a[216:219], v[232:235]
    v_mfma_f32_16x16x32_bf16 v[232:235], v[36:39], a[232:235], v[232:235]
    buffer_load_dwordx4 a[156:159], v2, s[28:31], s73 offen offset:3072 sc1
    v_mfma_f32_16x16x32_bf16 v[236:239], v[36:39], a[236:239], v[236:239]
    s_add_u32 s73, s73, 131072
    v_mfma_f32_16x16x32_bf16 v[236:239], v[32:35], a[220:223], v[236:239]
    s_waitcnt lgkmcnt(6)
    v_mfma_f32_16x16x32_bf16 v[240:243], v[40:43], a[208:211], v[240:243]
    s_waitcnt lgkmcnt(4)
    ds_read_b64_tr_b16 v[32:33], v70 offset:36872
    ds_read_b64_tr_b16 v[34:35], v70 offset:41480
    v_mfma_f32_16x16x32_bf16 v[240:243], v[44:47], a[224:227], v[240:243]
    buffer_load_dwordx4 a[160:163], v2, s[28:31], s73 offen offset:0 sc1
    v_mfma_f32_16x16x32_bf16 v[244:247], v[44:47], a[228:231], v[244:247]
    ds_read_b64_tr_b16 v[36:37], v70 offset:55304
    ds_read_b64_tr_b16 v[38:39], v70 offset:59912
    v_mfma_f32_16x16x32_bf16 v[244:247], v[40:43], a[212:215], v[244:247]
    v_mfma_f32_16x16x32_bf16 v[248:251], v[40:43], a[216:219], v[248:251]
    v_mfma_f32_16x16x32_bf16 v[248:251], v[44:47], a[232:235], v[248:251]
    v_mfma_f32_16x16x32_bf16 v[252:255], v[44:47], a[236:239], v[252:255]
    buffer_load_dwordx4 a[164:167], v2, s[28:31], s73 offen offset:1024 sc1
    v_mfma_f32_16x16x32_bf16 v[252:255], v[40:43], a[220:223], v[252:255]
    s_waitcnt lgkmcnt(6)
    v_mfma_f32_16x16x32_bf16 a[0:3], v[48:51], a[208:211], a[0:3]
    s_waitcnt lgkmcnt(4)
    ds_read_b64_tr_b16 v[40:41], v70 offset:36928
    ds_read_b64_tr_b16 v[42:43], v70 offset:41536
    v_mfma_f32_16x16x32_bf16 a[0:3], v[52:55], a[224:227], a[0:3]
    ds_read_b64_tr_b16 v[44:45], v70 offset:55360
    ds_read_b64_tr_b16 v[46:47], v70 offset:59968
    v_mfma_f32_16x16x32_bf16 a[4:7], v[52:55], a[228:231], a[4:7]
    buffer_load_dwordx4 a[168:171], v2, s[28:31], s73 offen offset:2048 sc1
    v_mfma_f32_16x16x32_bf16 a[4:7], v[48:51], a[212:215], a[4:7]
    v_mfma_f32_16x16x32_bf16 a[8:11], v[48:51], a[216:219], a[8:11]
    v_mfma_f32_16x16x32_bf16 a[8:11], v[52:55], a[232:235], a[8:11]
    v_mfma_f32_16x16x32_bf16 a[12:15], v[52:55], a[236:239], a[12:15]
    v_mfma_f32_16x16x32_bf16 a[12:15], v[48:51], a[220:223], a[12:15]
    s_waitcnt lgkmcnt(6)
    buffer_load_dwordx4 a[172:175], v2, s[28:31], s73 offen offset:3072 sc1
    v_mfma_f32_16x16x32_bf16 a[16:19], v[32:35], a[208:211], a[16:19]
    s_waitcnt lgkmcnt(4)
    s_add_u32 s73, s73, 131072
    ds_read_b64_tr_b16 v[48:49], v70 offset:36936
    ds_read_b64_tr_b16 v[50:51], v70 offset:41544
    v_mfma_f32_16x16x32_bf16 a[16:19], v[36:39], a[224:227], a[16:19]
    s_add_u32 m0, s78, 110592
    ds_read_b64_tr_b16 v[52:53], v70 offset:55368
    ds_read_b64_tr_b16 v[54:55], v70 offset:59976
    v_mfma_f32_16x16x32_bf16 a[20:23], v[36:39], a[228:231], a[20:23]
    v_mfma_f32_16x16x32_bf16 a[20:23], v[32:35], a[212:215], a[20:23]
    buffer_load_dwordx4 v68, s[40:43], s76 offen lds
    v_mfma_f32_16x16x32_bf16 a[24:27], v[32:35], a[216:219], a[24:27]
    s_add_u32 s76, s76, s77
    v_mfma_f32_16x16x32_bf16 a[24:27], v[36:39], a[232:235], a[24:27]
    s_add_u32 m0, s82, 119808
    v_mfma_f32_16x16x32_bf16 a[28:31], v[36:39], a[236:239], a[28:31]
    v_mfma_f32_16x16x32_bf16 a[28:31], v[32:35], a[220:223], a[28:31]
    s_waitcnt lgkmcnt(6)
    v_mfma_f32_16x16x32_bf16 a[32:35], v[40:43], a[208:211], a[32:35]
    s_waitcnt lgkmcnt(4)
    buffer_load_dwordx4 v66, s[36:39], s75 offen lds
    v_mfma_f32_16x16x32_bf16 a[32:35], v[44:47], a[224:227], a[32:35]
    s_add_u32 m0, s82, 120832
    ds_read_b64_tr_b16 v[32:33], v70 offset:36992
    ds_read_b64_tr_b16 v[34:35], v70 offset:41600
    v_mfma_f32_16x16x32_bf16 a[36:39], v[44:47], a[228:231], a[36:39]
    ds_read_b64_tr_b16 v[36:37], v70 offset:55424
    ds_read_b64_tr_b16 v[38:39], v70 offset:60032
    v_mfma_f32_16x16x32_bf16 a[36:39], v[40:43], a[212:215], a[36:39]
    v_mfma_f32_16x16x32_bf16 a[40:43], v[40:43], a[216:219], a[40:43]
    v_mfma_f32_16x16x32_bf16 a[40:43], v[44:47], a[232:235], a[40:43]
    buffer_load_dwordx4 v67, s[36:39], s75 offen lds
    v_mfma_f32_16x16x32_bf16 a[44:47], v[44:47], a[236:239], a[44:47]
    s_add_u32 m0, s82, 110592
    v_mfma_f32_16x16x32_bf16 a[44:47], v[40:43], a[220:223], a[44:47]
    s_waitcnt lgkmcnt(6)
    v_mfma_f32_16x16x32_bf16 a[48:51], v[48:51], a[208:211], a[48:51]
    s_waitcnt lgkmcnt(4)
    ds_read_b64_tr_b16 v[40:41], v70 offset:37000
    ds_read_b64_tr_b16 v[42:43], v70 offset:41608
    v_mfma_f32_16x16x32_bf16 a[48:51], v[52:55], a[224:227], a[48:51]
    ds_read_b64_tr_b16 v[44:45], v70 offset:55432
    ds_read_b64_tr_b16 v[46:47], v70 offset:60040
    v_mfma_f32_16x16x32_bf16 a[52:55], v[52:55], a[228:231], a[52:55]
    buffer_load_dwordx4 v64, s[32:35], s74 offen lds
    v_mfma_f32_16x16x32_bf16 a[52:55], v[48:51], a[212:215], a[52:55]
    s_add_u32 m0, s82, 111616
    v_mfma_f32_16x16x32_bf16 a[56:59], v[48:51], a[216:219], a[56:59]
    v_mfma_f32_16x16x32_bf16 a[56:59], v[52:55], a[232:235], a[56:59]
    v_mfma_f32_16x16x32_bf16 a[60:63], v[52:55], a[236:239], a[60:63]
    v_mfma_f32_16x16x32_bf16 a[60:63], v[48:51], a[220:223], a[60:63]
    s_waitcnt lgkmcnt(6)
    buffer_load_dwordx4 v65, s[32:35], s74 offen lds
    v_mfma_f32_16x16x32_bf16 a[64:67], v[32:35], a[208:211], a[64:67]
    s_waitcnt lgkmcnt(4)
    s_add_u32 s74, s74, 262144
    ds_read_b64_tr_b16 v[48:49], v70 offset:37056
    ds_read_b64_tr_b16 v[50:51], v70 offset:41664
    v_mfma_f32_16x16x32_bf16 a[64:67], v[36:39], a[224:227], a[64:67]
    s_add_u32 s75, s75, 294912
    ds_read_b64_tr_b16 v[52:53], v70 offset:55488
    ds_read_b64_tr_b16 v[54:55], v70 offset:60096
    v_mfma_f32_16x16x32_bf16 a[68:71], v[36:39], a[228:231], a[68:71]
    s_add_u32 m0, s82, 138240
    v_mfma_f32_16x16x32_bf16 a[68:71], v[32:35], a[212:215], a[68:71]
    v_mfma_f32_16x16x32_bf16 a[72:75], v[32:35], a[216:219], a[72:75]
    buffer_load_dwordx4 v66, s[36:39], s75 offen lds
    v_mfma_f32_16x16x32_bf16 a[72:75], v[36:39], a[232:235], a[72:75]
    s_add_u32 m0, s82, 139264
    v_mfma_f32_16x16x32_bf16 a[76:79], v[36:39], a[236:239], a[76:79]
    v_mfma_f32_16x16x32_bf16 a[76:79], v[32:35], a[220:223], a[76:79]
    s_waitcnt lgkmcnt(6)
    v_mfma_f32_16x16x32_bf16 a[80:83], v[40:43], a[208:211], a[80:83]
    s_waitcnt lgkmcnt(4)
    ds_read_b64_tr_b16 v[32:33], v70 offset:37064
    ds_read_b64_tr_b16 v[34:35], v70 offset:41672
    v_mfma_f32_16x16x32_bf16 a[80:83], v[44:47], a[224:227], a[80:83]
    buffer_load_dwordx4 v67, s[36:39], s75 offen lds
    v_mfma_f32_16x16x32_bf16 a[84:87], v[44:47], a[228:231], a[84:87]
    s_add_u32 m0, s82, 129024
    ds_read_b64_tr_b16 v[36:37], v70 offset:55496
    ds_read_b64_tr_b16 v[38:39], v70 offset:60104
    v_mfma_f32_16x16x32_bf16 a[84:87], v[40:43], a[212:215], a[84:87]
    v_mfma_f32_16x16x32_bf16 a[88:91], v[40:43], a[216:219], a[88:91]
    v_mfma_f32_16x16x32_bf16 a[88:91], v[44:47], a[232:235], a[88:91]
    v_mfma_f32_16x16x32_bf16 a[92:95], v[44:47], a[236:239], a[92:95]
    s_waitcnt vmcnt(33)
    buffer_load_dwordx4 v64, s[32:35], s74 offen lds
    v_mfma_f32_16x16x32_bf16 a[92:95], v[40:43], a[220:223], a[92:95]
    s_barrier
    s_waitcnt lgkmcnt(6)
    v_mfma_f32_16x16x32_bf16 a[96:99], v[48:51], a[208:211], a[96:99]
    s_waitcnt lgkmcnt(4)
    s_add_u32 m0, s82, 130048
    ds_read_b64_tr_b16 v[40:41], v72 offset:0
    ds_read_b64_tr_b16 v[42:43], v72 offset:4608
    v_mfma_f32_16x16x32_bf16 a[96:99], v[52:55], a[224:227], a[96:99]
    ds_read_b64_tr_b16 v[44:45], v72 offset:18432
    ds_read_b64_tr_b16 v[46:47], v72 offset:23040
    v_mfma_f32_16x16x32_bf16 a[100:103], v[52:55], a[228:231], a[100:103]
    v_mfma_f32_16x16x32_bf16 a[100:103], v[48:51], a[212:215], a[100:103]
    buffer_load_dwordx4 v65, s[32:35], s74 offen lds
    v_mfma_f32_16x16x32_bf16 a[104:107], v[48:51], a[216:219], a[104:107]
    s_add_u32 s74, s74, 262144
    v_mfma_f32_16x16x32_bf16 a[104:107], v[52:55], a[232:235], a[104:107]
    s_add_u32 s75, s75, 294912
    v_mfma_f32_16x16x32_bf16 a[108:111], v[52:55], a[236:239], a[108:111]
    v_mfma_f32_16x16x32_bf16 a[108:111], v[48:51], a[220:223], a[108:111]
    s_waitcnt lgkmcnt(6)
    v_mfma_f32_16x16x32_bf16 a[112:115], v[32:35], a[208:211], a[112:115]
    s_waitcnt lgkmcnt(4)
    buffer_load_dwordx4 a[176:179], v2, s[28:31], s73 offen offset:0 sc1
    v_mfma_f32_16x16x32_bf16 a[112:115], v[36:39], a[224:227], a[112:115]
    ds_read_b64_tr_b16 v[48:49], v72 offset:32
    ds_read_b64_tr_b16 v[50:51], v72 offset:4640
    v_mfma_f32_16x16x32_bf16 a[116:119], v[36:39], a[228:231], a[116:119]
    ds_read_b64_tr_b16 v[52:53], v72 offset:18464
    ds_read_b64_tr_b16 v[54:55], v72 offset:23072
    v_mfma_f32_16x16x32_bf16 a[116:119], v[32:35], a[212:215], a[116:119]
    v_mfma_f32_16x16x32_bf16 a[120:123], v[32:35], a[216:219], a[120:123]
    buffer_load_dwordx4 a[180:183], v2, s[28:31], s73 offen offset:1024 sc1
    v_mfma_f32_16x16x32_bf16 a[120:123], v[36:39], a[232:235], a[120:123]
    v_mfma_f32_16x16x32_bf16 a[124:127], v[36:39], a[236:239], a[124:127]
    v_mfma_f32_16x16x32_bf16 a[124:127], v[32:35], a[220:223], a[124:127]
    s_waitcnt vmcnt(36) lgkmcnt(6)
    v_mfma_f32_16x16x32_bf16 v[112:115], v[40:43], a[128:131], v[112:115]
    s_waitcnt vmcnt(32) lgkmcnt(4)
    ds_read_b64_tr_b16 v[32:33], v72 offset:64
    ds_read_b64_tr_b16 v[34:35], v72 offset:4672
    v_mfma_f32_16x16x32_bf16 v[112:115], v[44:47], a[240:243], v[112:115]
    s_waitcnt vmcnt(31)
    buffer_load_dwordx4 a[184:187], v2, s[28:31], s73 offen offset:2048 sc1
    v_mfma_f32_16x16x32_bf16 v[116:119], v[44:47], a[244:247], v[116:119]
    ds_read_b64_tr_b16 v[36:37], v72 offset:18496
    ds_read_b64_tr_b16 v[38:39], v72 offset:23104
    v_mfma_f32_16x16x32_bf16 v[116:119], v[40:43], a[132:135], v[116:119]
    v_mfma_f32_16x16x32_bf16 v[120:123], v[40:43], a[136:139], v[120:123]
    s_waitcnt vmcnt(31)
    v_mfma_f32_16x16x32_bf16 v[120:123], v[44:47], a[248:251], v[120:123]
    s_waitcnt vmcnt(30)
    buffer_load_dwordx4 a[188:191], v2, s[28:31], s73 offen offset:3072 sc1
    v_mfma_f32_16x16x32_bf16 v[124:127], v[44:47], a[252:255], v[124:127]
    s_add_u32 s73, s73, 131072
    v_mfma_f32_16x16x32_bf16 v[124:127], v[40:43], a[140:143], v[124:127]
    s_waitcnt lgkmcnt(6)
    s_nop 0
    v_mfma_f32_16x16x32_bf16 v[128:131], v[48:51], a[128:131], v[128:131]
    s_barrier
    ds_read_b64_tr_b16 v[40:41], v72 offset:96
    ds_read_b64_tr_b16 v[42:43], v72 offset:4704
    s_waitcnt lgkmcnt(6)
    v_mfma_f32_16x16x32_bf16 v[128:131], v[52:55], a[240:243], v[128:131]
    ds_read_b64_tr_b16 v[44:45], v72 offset:18528
    ds_read_b64_tr_b16 v[46:47], v72 offset:23136
    v_mfma_f32_16x16x32_bf16 v[132:135], v[52:55], a[244:247], v[132:135]
    buffer_load_dwordx4 a[192:195], v2, s[28:31], s73 offen offset:0 sc1
    v_mfma_f32_16x16x32_bf16 v[132:135], v[48:51], a[132:135], v[132:135]
    v_mfma_f32_16x16x32_bf16 v[136:139], v[48:51], a[136:139], v[136:139]
    v_mfma_f32_16x16x32_bf16 v[136:139], v[52:55], a[248:251], v[136:139]
    v_mfma_f32_16x16x32_bf16 v[140:143], v[52:55], a[252:255], v[140:143]
    buffer_load_dwordx4 a[196:199], v2, s[28:31], s73 offen offset:1024 sc1
    v_mfma_f32_16x16x32_bf16 v[140:143], v[48:51], a[140:143], v[140:143]
    s_waitcnt lgkmcnt(6)
    v_mfma_f32_16x16x32_bf16 v[144:147], v[32:35], a[128:131], v[144:147]
    s_waitcnt lgkmcnt(4)
    ds_read_b64_tr_b16 v[48:49], v72 offset:128
    ds_read_b64_tr_b16 v[50:51], v72 offset:4736
    v_mfma_f32_16x16x32_bf16 v[144:147], v[36:39], a[240:243], v[144:147]
    ds_read_b64_tr_b16 v[52:53], v72 offset:18560
    ds_read_b64_tr_b16 v[54:55], v72 offset:23168
    v_mfma_f32_16x16x32_bf16 v[148:151], v[36:39], a[244:247], v[148:151]
    buffer_load_dwordx4 a[200:203], v2, s[28:31], s73 offen offset:2048 sc1
    v_mfma_f32_16x16x32_bf16 v[148:151], v[32:35], a[132:135], v[148:151]
    v_mfma_f32_16x16x32_bf16 v[152:155], v[32:35], a[136:139], v[152:155]
    v_mfma_f32_16x16x32_bf16 v[152:155], v[36:39], a[248:251], v[152:155]
    v_mfma_f32_16x16x32_bf16 v[156:159], v[36:39], a[252:255], v[156:159]
    v_mfma_f32_16x16x32_bf16 v[156:159], v[32:35], a[140:143], v[156:159]
    s_waitcnt lgkmcnt(6)
    buffer_load_dwordx4 a[204:207], v2, s[28:31], s73 offen offset:3072 sc1
    v_mfma_f32_16x16x32_bf16 v[160:163], v[40:43], a[128:131], v[160:163]
    s_waitcnt lgkmcnt(4)
    s_add_u32 s73, s73, 131072
    ds_read_b64_tr_b16 v[32:33], v72 offset:160
    ds_read_b64_tr_b16 v[34:35], v72 offset:4768
    v_mfma_f32_16x16x32_bf16 v[160:163], v[44:47], a[240:243], v[160:163]
    s_add_u32 m0, s78, 36864
    ds_read_b64_tr_b16 v[36:37], v72 offset:18592
    ds_read_b64_tr_b16 v[38:39], v72 offset:23200
    v_mfma_f32_16x16x32_bf16 v[164:167], v[44:47], a[244:247], v[164:167]
    v_mfma_f32_16x16x32_bf16 v[164:167], v[40:43], a[132:135], v[164:167]
    buffer_load_dwordx4 v68, s[40:43], s76 offen lds
    v_mfma_f32_16x16x32_bf16 v[168:171], v[40:43], a[136:139], v[168:171]
    s_add_u32 s76, s76, s77
    v_mfma_f32_16x16x32_bf16 v[168:171], v[44:47], a[248:251], v[168:171]
    s_add_u32 m0, s82, 46080
    v_mfma_f32_16x16x32_bf16 v[172:175], v[44:47], a[252:255], v[172:175]
    v_mfma_f32_16x16x32_bf16 v[172:175], v[40:43], a[140:143], v[172:175]
    s_waitcnt lgkmcnt(6)
    v_mfma_f32_16x16x32_bf16 v[176:179], v[48:51], a[128:131], v[176:179]
    s_waitcnt lgkmcnt(4)
    ds_read_b64_tr_b16 v[40:41], v72 offset:192
    ds_read_b64_tr_b16 v[42:43], v72 offset:4800
    v_mfma_f32_16x16x32_bf16 v[176:179], v[52:55], a[240:243], v[176:179]
    buffer_load_dwordx4 v66, s[36:39], s75 offen lds
    v_mfma_f32_16x16x32_bf16 v[180:183], v[52:55], a[244:247], v[180:183]
    s_add_u32 m0, s82, 47104
    ds_read_b64_tr_b16 v[44:45], v72 offset:18624
    ds_read_b64_tr_b16 v[46:47], v72 offset:23232
    v_mfma_f32_16x16x32_bf16 v[180:183], v[48:51], a[132:135], v[180:183]
    v_mfma_f32_16x16x32_bf16 v[184:187], v[48:51], a[136:139], v[184:187]
    v_mfma_f32_16x16x32_bf16 v[184:187], v[52:55], a[248:251], v[184:187]
    buffer_load_dwordx4 v67, s[36:39], s75 offen lds
    v_mfma_f32_16x16x32_bf16 v[188:191], v[52:55], a[252:255], v[188:191]
    s_add_u32 m0, s82, 36864
    v_mfma_f32_16x16x32_bf16 v[188:191], v[48:51], a[140:143], v[188:191]
    s_waitcnt lgkmcnt(6)
    v_mfma_f32_16x16x32_bf16 v[192:195], v[32:35], a[128:131], v[192:195]
    s_waitcnt lgkmcnt(4)
    ds_read_b64_tr_b16 v[48:49], v72 offset:224
    ds_read_b64_tr_b16 v[50:51], v72 offset:4832
    v_mfma_f32_16x16x32_bf16 v[192:195], v[36:39], a[240:243], v[192:195]
    ds_read_b64_tr_b16 v[52:53], v72 offset:18656
    ds_read_b64_tr_b16 v[54:55], v72 offset:23264
    v_mfma_f32_16x16x32_bf16 v[196:199], v[36:39], a[244:247], v[196:199]
    buffer_load_dwordx4 v64, s[32:35], s74 offen lds
    v_mfma_f32_16x16x32_bf16 v[196:199], v[32:35], a[132:135], v[196:199]
    s_add_u32 m0, s82, 37888
    v_mfma_f32_16x16x32_bf16 v[200:203], v[32:35], a[136:139], v[200:203]
    v_mfma_f32_16x16x32_bf16 v[200:203], v[36:39], a[248:251], v[200:203]
    v_mfma_f32_16x16x32_bf16 v[204:207], v[36:39], a[252:255], v[204:207]
    v_mfma_f32_16x16x32_bf16 v[204:207], v[32:35], a[140:143], v[204:207]
    s_waitcnt lgkmcnt(6)
    buffer_load_dwordx4 v65, s[32:35], s74 offen lds
    v_mfma_f32_16x16x32_bf16 v[208:211], v[40:43], a[128:131], v[208:211]
    s_waitcnt lgkmcnt(4)
    s_add_u32 s74, s74, 262144
    ds_read_b64_tr_b16 v[32:33], v74 offset:0
    ds_read_b64_tr_b16 v[34:35], v74 offset:4608
    v_mfma_f32_16x16x32_bf16 v[208:211], v[44:47], a[240:243], v[208:211]
    s_add_u32 s75, s75, 294912
    ds_read_b64_tr_b16 v[36:37], v74 offset:18432
    ds_read_b64_tr_b16 v[38:39], v74 offset:23040
    v_mfma_f32_16x16x32_bf16 v[212:215], v[44:47], a[244:247], v[212:215]
    s_add_u32 m0, s82, 64512
    v_mfma_f32_16x16x32_bf16 v[212:215], v[40:43], a[132:135], v[212:215]
    v_mfma_f32_16x16x32_bf16 v[216:219], v[40:43], a[136:139], v[216:219]
    buffer_load_dwordx4 v66, s[36:39], s75 offen lds
    v_mfma_f32_16x16x32_bf16 v[216:219], v[44:47], a[248:251], v[216:219]
    s_add_u32 m0, s82, 65536
    v_mfma_f32_16x16x32_bf16 v[220:223], v[44:47], a[252:255], v[220:223]
    v_mfma_f32_16x16x32_bf16 v[220:223], v[40:43], a[140:143], v[220:223]
    s_waitcnt lgkmcnt(6)
    v_mfma_f32_16x16x32_bf16 v[224:227], v[48:51], a[128:131], v[224:227]
    s_waitcnt lgkmcnt(4)
    ds_read_b64_tr_b16 v[40:41], v70 offset:0
    ds_read_b64_tr_b16 v[42:43], v70 offset:4608
    v_mfma_f32_16x16x32_bf16 v[224:227], v[52:55], a[240:243], v[224:227]
    ds_read_b64_tr_b16 v[44:45], v70 offset:18432
    ds_read_b64_tr_b16 v[46:47], v70 offset:23040
    v_mfma_f32_16x16x32_bf16 v[228:231], v[52:55], a[244:247], v[228:231]
    buffer_load_dwordx4 v67, s[36:39], s75 offen lds
    v_mfma_f32_16x16x32_bf16 v[228:231], v[48:51], a[132:135], v[228:231]
    s_add_u32 m0, s82, 55296
    v_mfma_f32_16x16x32_bf16 v[232:235], v[48:51], a[136:139], v[232:235]
    v_mfma_f32_16x16x32_bf16 v[232:235], v[52:55], a[248:251], v[232:235]
    v_mfma_f32_16x16x32_bf16 v[236:239], v[52:55], a[252:255], v[236:239]
    buffer_load_dwordx4 v64, s[32:35], s74 offen lds
    v_mfma_f32_16x16x32_bf16 v[236:239], v[48:51], a[140:143], v[236:239]
    s_waitcnt lgkmcnt(6)
    s_add_u32 m0, s82, 56320
    v_mfma_f32_16x16x32_bf16 v[240:243], v[32:35], a[128:131], v[240:243]
    s_waitcnt lgkmcnt(4)
    ds_read_b64_tr_b16 v[48:49], v70 offset:8
    ds_read_b64_tr_b16 v[50:51], v70 offset:4616
    v_mfma_f32_16x16x32_bf16 v[240:243], v[36:39], a[240:243], v[240:243]
    ds_read_b64_tr_b16 v[52:53], v70 offset:18440
    ds_read_b64_tr_b16 v[54:55], v70 offset:23048
    v_mfma_f32_16x16x32_bf16 v[244:247], v[36:39], a[244:247], v[244:247]
    v_mfma_f32_16x16x32_bf16 v[244:247], v[32:35], a[132:135], v[244:247]
    buffer_load_dwordx4 v65, s[32:35], s74 offen lds
    v_mfma_f32_16x16x32_bf16 v[248:251], v[32:35], a[136:139], v[248:251]
    s_add_u32 s74, s74, 262144
    v_mfma_f32_16x16x32_bf16 v[248:251], v[36:39], a[248:251], v[248:251]
    s_add_u32 s75, s75, 294912
    v_mfma_f32_16x16x32_bf16 v[252:255], v[36:39], a[252:255], v[252:255]
    v_mfma_f32_16x16x32_bf16 v[252:255], v[32:35], a[140:143], v[252:255]
    s_waitcnt lgkmcnt(6)
    v_mfma_f32_16x16x32_bf16 a[0:3], v[40:43], a[128:131], a[0:3]
    s_waitcnt lgkmcnt(4)
    ds_read_b64_tr_b16 v[32:33], v70 offset:64
    ds_read_b64_tr_b16 v[34:35], v70 offset:4672
    v_mfma_f32_16x16x32_bf16 a[0:3], v[44:47], a[240:243], a[0:3]
    ds_read_b64_tr_b16 v[36:37], v70 offset:18496
    ds_read_b64_tr_b16 v[38:39], v70 offset:23104
    v_mfma_f32_16x16x32_bf16 a[4:7], v[44:47], a[244:247], a[4:7]
    buffer_load_dwordx4 a[208:211], v2, s[28:31], s73 offen offset:0 sc1
    v_mfma_f32_16x16x32_bf16 a[4:7], v[40:43], a[132:135], a[4:7]
    v_mfma_f32_16x16x32_bf16 a[8:11], v[40:43], a[136:139], a[8:11]
    v_mfma_f32_16x16x32_bf16 a[8:11], v[44:47], a[248:251], a[8:11]
    buffer_load_dwordx4 a[212:215], v2, s[28:31], s73 offen offset:1024 sc1
    v_mfma_f32_16x16x32_bf16 a[12:15], v[44:47], a[252:255], a[12:15]
    v_mfma_f32_16x16x32_bf16 a[12:15], v[40:43], a[140:143], a[12:15]
    s_waitcnt lgkmcnt(6)
    v_mfma_f32_16x16x32_bf16 a[16:19], v[48:51], a[128:131], a[16:19]
    s_waitcnt lgkmcnt(4)
    ds_read_b64_tr_b16 v[40:41], v70 offset:72
    ds_read_b64_tr_b16 v[42:43], v70 offset:4680
    v_mfma_f32_16x16x32_bf16 a[16:19], v[52:55], a[240:243], a[16:19]
    ds_read_b64_tr_b16 v[44:45], v70 offset:18504
    ds_read_b64_tr_b16 v[46:47], v70 offset:23112
    v_mfma_f32_16x16x32_bf16 a[20:23], v[52:55], a[244:247], a[20:23]
    buffer_load_dwordx4 a[216:219], v2, s[28:31], s73 offen offset:2048 sc1
    v_mfma_f32_16x16x32_bf16 a[20:23], v[48:51], a[132:135], a[20:23]
    v_mfma_f32_16x16x32_bf16 a[24:27], v[48:51], a[136:139], a[24:27]
    v_mfma_f32_16x16x32_bf16 a[24:27], v[52:55], a[248:251], a[24:27]
    buffer_load_dwordx4 a[220:223], v2, s[28:31], s73 offen offset:3072 sc1
    v_mfma_f32_16x16x32_bf16 a[28:31], v[52:55], a[252:255], a[28:31]
    s_add_u32 s73, s73, 131072
    v_mfma_f32_16x16x32_bf16 a[28:31], v[48:51], a[140:143], a[28:31]
    s_waitcnt lgkmcnt(6)
    v_mfma_f32_16x16x32_bf16 a[32:35], v[32:35], a[128:131], a[32:35]
    s_waitcnt lgkmcnt(4)
    ds_read_b64_tr_b16 v[48:49], v70 offset:128
    ds_read_b64_tr_b16 v[50:51], v70 offset:4736
    v_mfma_f32_16x16x32_bf16 a[32:35], v[36:39], a[240:243], a[32:35]
    ds_read_b64_tr_b16 v[52:53], v70 offset:18560
    ds_read_b64_tr_b16 v[54:55], v70 offset:23168
    v_mfma_f32_16x16x32_bf16 a[36:39], v[36:39], a[244:247], a[36:39]
    buffer_load_dwordx4 a[224:227], v2, s[28:31], s73 offen offset:0 sc1
    v_mfma_f32_16x16x32_bf16 a[36:39], v[32:35], a[132:135], a[36:39]
    v_mfma_f32_16x16x32_bf16 a[40:43], v[32:35], a[136:139], a[40:43]
    v_mfma_f32_16x16x32_bf16 a[40:43], v[36:39], a[248:251], a[40:43]
    v_mfma_f32_16x16x32_bf16 a[44:47], v[36:39], a[252:255], a[44:47]
    buffer_load_dwordx4 a[228:231], v2, s[28:31], s73 offen offset:1024 sc1
    v_mfma_f32_16x16x32_bf16 a[44:47], v[32:35], a[140:143], a[44:47]
    s_waitcnt lgkmcnt(6)
    v_mfma_f32_16x16x32_bf16 a[48:51], v[40:43], a[128:131], a[48:51]
    s_waitcnt lgkmcnt(4)
    ds_read_b64_tr_b16 v[32:33], v70 offset:136
    ds_read_b64_tr_b16 v[34:35], v70 offset:4744
    v_mfma_f32_16x16x32_bf16 a[48:51], v[44:47], a[240:243], a[48:51]
    ds_read_b64_tr_b16 v[36:37], v70 offset:18568
    ds_read_b64_tr_b16 v[38:39], v70 offset:23176
    v_mfma_f32_16x16x32_bf16 a[52:55], v[44:47], a[244:247], a[52:55]
    v_mfma_f32_16x16x32_bf16 a[52:55], v[40:43], a[132:135], a[52:55]
    buffer_load_dwordx4 a[232:235], v2, s[28:31], s73 offen offset:2048 sc1
    v_mfma_f32_16x16x32_bf16 a[56:59], v[40:43], a[136:139], a[56:59]
    v_mfma_f32_16x16x32_bf16 a[56:59], v[44:47], a[248:251], a[56:59]
    v_mfma_f32_16x16x32_bf16 a[60:63], v[44:47], a[252:255], a[60:63]
    v_mfma_f32_16x16x32_bf16 a[60:63], v[40:43], a[140:143], a[60:63]
    s_waitcnt lgkmcnt(6)
    buffer_load_dwordx4 a[236:239], v2, s[28:31], s73 offen offset:3072 sc1
    v_mfma_f32_16x16x32_bf16 a[64:67], v[48:51], a[128:131], a[64:67]
    s_waitcnt lgkmcnt(4)
    s_add_u32 s73, s73, 131072
    ds_read_b64_tr_b16 v[40:41], v70 offset:192
    ds_read_b64_tr_b16 v[42:43], v70 offset:4800
    v_mfma_f32_16x16x32_bf16 a[64:67], v[52:55], a[240:243], a[64:67]
    s_add_u32 s79, s14, 98304
    ds_read_b64_tr_b16 v[44:45], v70 offset:18624
    ds_read_b64_tr_b16 v[46:47], v70 offset:23232
    v_mfma_f32_16x16x32_bf16 a[68:71], v[52:55], a[244:247], a[68:71]
    buffer_load_dword v76, v1, s[56:59], s79 offen sc1
    v_mfma_f32_16x16x32_bf16 a[68:71], v[48:51], a[132:135], a[68:71]
    s_mov_b32 s80, 0
    v_mfma_f32_16x16x32_bf16 a[72:75], v[48:51], a[136:139], a[72:75]
    v_mfma_f32_16x16x32_bf16 a[72:75], v[52:55], a[248:251], a[72:75]
    buffer_load_dword v76, v75, s[60:63], s80 offen sc1
    v_mfma_f32_16x16x32_bf16 a[76:79], v[52:55], a[252:255], a[76:79]
    s_mov_b32 s80, 262144
    v_mfma_f32_16x16x32_bf16 a[76:79], v[48:51], a[140:143], a[76:79]
    s_waitcnt lgkmcnt(6)
    v_mfma_f32_16x16x32_bf16 a[80:83], v[32:35], a[128:131], a[80:83]
    s_waitcnt lgkmcnt(4)
    buffer_load_dword v76, v75, s[60:63], s80 offen sc1
    v_mfma_f32_16x16x32_bf16 a[80:83], v[36:39], a[240:243], a[80:83]
    s_mov_b32 s80, 524288
    ds_read_b64_tr_b16 v[48:49], v70 offset:200
    ds_read_b64_tr_b16 v[50:51], v70 offset:4808
    v_mfma_f32_16x16x32_bf16 a[84:87], v[36:39], a[244:247], a[84:87]
    ds_read_b64_tr_b16 v[52:53], v70 offset:18632
    ds_read_b64_tr_b16 v[54:55], v70 offset:23240
    v_mfma_f32_16x16x32_bf16 a[84:87], v[32:35], a[132:135], a[84:87]
    buffer_load_dword v76, v75, s[60:63], s80 offen sc1
    v_mfma_f32_16x16x32_bf16 a[88:91], v[32:35], a[136:139], a[88:91]
    v_mfma_f32_16x16x32_bf16 a[88:91], v[36:39], a[248:251], a[88:91]
    v_mfma_f32_16x16x32_bf16 a[92:95], v[36:39], a[252:255], a[92:95]
    s_waitcnt vmcnt(46)
    v_mfma_f32_16x16x32_bf16 a[92:95], v[32:35], a[140:143], a[92:95]
    s_barrier
    s_waitcnt lgkmcnt(6)
    v_mfma_f32_16x16x32_bf16 a[96:99], v[40:43], a[128:131], a[96:99]
    s_waitcnt lgkmcnt(4)
    ds_read_b64_tr_b16 v[32:33], v71 offset:0
    ds_read_b64_tr_b16 v[34:35], v71 offset:4608
    v_mfma_f32_16x16x32_bf16 a[96:99], v[44:47], a[240:243], a[96:99]
    ds_read_b64_tr_b16 v[36:37], v71 offset:18432
    ds_read_b64_tr_b16 v[38:39], v71 offset:23040
    v_mfma_f32_16x16x32_bf16 a[100:103], v[44:47], a[244:247], a[100:103]
    v_mfma_f32_16x16x32_bf16 a[100:103], v[40:43], a[132:135], a[100:103]
    v_mfma_f32_16x16x32_bf16 a[104:107], v[40:43], a[136:139], a[104:107]
    v_mfma_f32_16x16x32_bf16 a[104:107], v[44:47], a[248:251], a[104:107]
    v_mfma_f32_16x16x32_bf16 a[108:111], v[44:47], a[252:255], a[108:111]
    v_mfma_f32_16x16x32_bf16 a[108:111], v[40:43], a[140:143], a[108:111]
    s_waitcnt lgkmcnt(6)
    v_mfma_f32_16x16x32_bf16 a[112:115], v[48:51], a[128:131], a[112:115]
    s_waitcnt lgkmcnt(4)
    ds_read_b64_tr_b16 v[40:41], v71 offset:32
    ds_read_b64_tr_b16 v[42:43], v71 offset:4640
    v_mfma_f32_16x16x32_bf16 a[112:115], v[52:55], a[240:243], a[112:115]
    ds_read_b64_tr_b16 v[44:45], v71 offset:18464
    ds_read_b64_tr_b16 v[46:47], v71 offset:23072
    v_mfma_f32_16x16x32_bf16 a[116:119], v[52:55], a[244:247], a[116:119]
    v_mfma_f32_16x16x32_bf16 a[116:119], v[48:51], a[132:135], a[116:119]
    v_mfma_f32_16x16x32_bf16 a[120:123], v[48:51], a[136:139], a[120:123]
    v_mfma_f32_16x16x32_bf16 a[120:123], v[52:55], a[248:251], a[120:123]
    v_mfma_f32_16x16x32_bf16 a[124:127], v[52:55], a[252:255], a[124:127]
    v_mfma_f32_16x16x32_bf16 a[124:127], v[48:51], a[140:143], a[124:127]
    s_waitcnt vmcnt(45) lgkmcnt(6)
    v_mfma_f32_16x16x32_bf16 v[112:115], v[32:35], a[144:147], v[112:115]
    s_waitcnt vmcnt(41) lgkmcnt(4)
    ds_read_b64_tr_b16 v[48:49], v71 offset:64
    ds_read_b64_tr_b16 v[50:51], v71 offset:4672
    v_mfma_f32_16x16x32_bf16 v[112:115], v[36:39], a[160:163], v[112:115]
    s_waitcnt vmcnt(40)
    ds_read_b64_tr_b16 v[52:53], v71 offset:18496
    ds_read_b64_tr_b16 v[54:55], v71 offset:23104
    v_mfma_f32_16x16x32_bf16 v[116:119], v[36:39], a[164:167], v[116:119]
    v_mov_b32 v20, s22
    v_mfma_f32_16x16x32_bf16 v[116:119], v[32:35], a[148:151], v[116:119]
    v_mfma_f32_16x16x32_bf16 v[120:123], v[32:35], a[152:155], v[120:123]
    s_waitcnt vmcnt(39)
    v_mfma_f32_16x16x32_bf16 v[120:123], v[36:39], a[168:171], v[120:123]
    s_waitcnt vmcnt(38)
    v_mfma_f32_16x16x32_bf16 v[124:127], v[36:39], a[172:175], v[124:127]
    v_mfma_f32_16x16x32_bf16 v[124:127], v[32:35], a[156:159], v[124:127]
    s_waitcnt lgkmcnt(6)
    s_nop 0
    v_mfma_f32_16x16x32_bf16 v[128:131], v[40:43], a[144:147], v[128:131]
    s_barrier
    ds_read_b64_tr_b16 v[32:33], v71 offset:96
    ds_read_b64_tr_b16 v[34:35], v71 offset:4704
    s_waitcnt lgkmcnt(6)
    v_mfma_f32_16x16x32_bf16 v[128:131], v[44:47], a[160:163], v[128:131]
    ds_read_b64_tr_b16 v[36:37], v71 offset:18528
    ds_read_b64_tr_b16 v[38:39], v71 offset:23136
    v_mfma_f32_16x16x32_bf16 v[132:135], v[44:47], a[164:167], v[132:135]
    v_mfma_f32_16x16x32_bf16 v[132:135], v[40:43], a[148:151], v[132:135]
    v_mfma_f32_16x16x32_bf16 v[136:139], v[40:43], a[152:155], v[136:139]
    v_mfma_f32_16x16x32_bf16 v[136:139], v[44:47], a[168:171], v[136:139]
    v_mfma_f32_16x16x32_bf16 v[140:143], v[44:47], a[172:175], v[140:143]
    v_mfma_f32_16x16x32_bf16 v[140:143], v[40:43], a[156:159], v[140:143]
    s_waitcnt lgkmcnt(6)
    v_mfma_f32_16x16x32_bf16 v[144:147], v[48:51], a[144:147], v[144:147]
    s_waitcnt lgkmcnt(4)
    ds_read_b64_tr_b16 v[40:41], v71 offset:128
    ds_read_b64_tr_b16 v[42:43], v71 offset:4736
    v_mfma_f32_16x16x32_bf16 v[144:147], v[52:55], a[160:163], v[144:147]
    ds_read_b64_tr_b16 v[44:45], v71 offset:18560
    ds_read_b64_tr_b16 v[46:47], v71 offset:23168
    v_mfma_f32_16x16x32_bf16 v[148:151], v[52:55], a[164:167], v[148:151]
    v_mfma_f32_16x16x32_bf16 v[148:151], v[48:51], a[148:151], v[148:151]
    v_mfma_f32_16x16x32_bf16 v[152:155], v[48:51], a[152:155], v[152:155]
    v_mfma_f32_16x16x32_bf16 v[152:155], v[52:55], a[168:171], v[152:155]
    v_mfma_f32_16x16x32_bf16 v[156:159], v[52:55], a[172:175], v[156:159]
Lpad3:
    s_cbranch_execz Lpad5
    v_mfma_f32_16x16x32_bf16 v[156:159], v[48:51], a[156:159], v[156:159]
    s_waitcnt lgkmcnt(6)
    v_mfma_f32_16x16x32_bf16 v[160:163], v[32:35], a[144:147], v[160:163]
    s_waitcnt lgkmcnt(4)
    ds_read_b64_tr_b16 v[48:49], v71 offset:160
    ds_read_b64_tr_b16 v[50:51], v71 offset:4768
    v_mfma_f32_16x16x32_bf16 v[160:163], v[36:39], a[160:163], v[160:163]
    ds_read_b64_tr_b16 v[52:53], v71 offset:18592
    ds_read_b64_tr_b16 v[54:55], v71 offset:23200
    v_mfma_f32_16x16x32_bf16 v[164:167], v[36:39], a[164:167], v[164:167]
    v_mfma_f32_16x16x32_bf16 v[164:167], v[32:35], a[148:151], v[164:167]
    v_mfma_f32_16x16x32_bf16 v[168:171], v[32:35], a[152:155], v[168:171]
    v_mfma_f32_16x16x32_bf16 v[168:171], v[36:39], a[168:171], v[168:171]
    v_mfma_f32_16x16x32_bf16 v[172:175], v[36:39], a[172:175], v[172:175]
    v_mfma_f32_16x16x32_bf16 v[172:175], v[32:35], a[156:159], v[172:175]
    s_waitcnt lgkmcnt(6)
    v_mfma_f32_16x16x32_bf16 v[176:179], v[40:43], a[144:147], v[176:179]
    s_waitcnt lgkmcnt(4)
    ds_read_b64_tr_b16 v[32:33], v71 offset:192
    ds_read_b64_tr_b16 v[34:35], v71 offset:4800
    v_mfma_f32_16x16x32_bf16 v[176:179], v[44:47], a[160:163], v[176:179]
    ds_read_b64_tr_b16 v[36:37], v71 offset:18624
    ds_read_b64_tr_b16 v[38:39], v71 offset:23232
    v_mfma_f32_16x16x32_bf16 v[180:183], v[44:47], a[164:167], v[180:183]
    v_mfma_f32_16x16x32_bf16 v[180:183], v[40:43], a[148:151], v[180:183]
    v_mfma_f32_16x16x32_bf16 v[184:187], v[40:43], a[152:155], v[184:187]
    v_mfma_f32_16x16x32_bf16 v[184:187], v[44:47], a[168:171], v[184:187]
    v_mfma_f32_16x16x32_bf16 v[188:191], v[44:47], a[172:175], v[188:191]
    v_mfma_f32_16x16x32_bf16 v[188:191], v[40:43], a[156:159], v[188:191]
    s_waitcnt lgkmcnt(6)
    v_mfma_f32_16x16x32_bf16 v[192:195], v[48:51], a[144:147], v[192:195]
    s_waitcnt lgkmcnt(4)
    ds_read_b64_tr_b16 v[40:41], v71 offset:224
    ds_read_b64_tr_b16 v[42:43], v71 offset:4832
    v_mfma_f32_16x16x32_bf16 v[192:195], v[52:55], a[160:163], v[192:195]
    ds_read_b64_tr_b16 v[44:45], v71 offset:18656
    ds_read_b64_tr_b16 v[46:47], v71 offset:23264
    v_mfma_f32_16x16x32_bf16 v[196:199], v[52:55], a[164:167], v[196:199]
    v_mfma_f32_16x16x32_bf16 v[196:199], v[48:51], a[148:151], v[196:199]
    v_mfma_f32_16x16x32_bf16 v[200:203], v[48:51], a[152:155], v[200:203]
    v_mfma_f32_16x16x32_bf16 v[200:203], v[52:55], a[168:171], v[200:203]
    v_mfma_f32_16x16x32_bf16 v[204:207], v[52:55], a[172:175], v[204:207]
    v_mfma_f32_16x16x32_bf16 v[204:207], v[48:51], a[156:159], v[204:207]
    s_waitcnt lgkmcnt(6)
    v_mfma_f32_16x16x32_bf16 v[208:211], v[32:35], a[144:147], v[208:211]
    s_waitcnt lgkmcnt(4)
    ds_read_b64_tr_b16 v[48:49], v73 offset:0
    ds_read_b64_tr_b16 v[50:51], v73 offset:4608
    v_mfma_f32_16x16x32_bf16 v[208:211], v[36:39], a[160:163], v[208:211]
    ds_read_b64_tr_b16 v[52:53], v73 offset:18432
    ds_read_b64_tr_b16 v[54:55], v73 offset:23040
    v_mfma_f32_16x16x32_bf16 v[212:215], v[36:39], a[164:167], v[212:215]
    v_mfma_f32_16x16x32_bf16 v[212:215], v[32:35], a[148:151], v[212:215]
    v_mfma_f32_16x16x32_bf16 v[216:219], v[32:35], a[152:155], v[216:219]
    v_mfma_f32_16x16x32_bf16 v[216:219], v[36:39], a[168:171], v[216:219]
    v_mfma_f32_16x16x32_bf16 v[220:223], v[36:39], a[172:175], v[220:223]
    s_waitcnt vmcnt(12)
    v_mfma_f32_16x16x32_bf16 v[220:223], v[32:35], a[156:159], v[220:223]
    s_barrier
    s_waitcnt lgkmcnt(6)
    v_mfma_f32_16x16x32_bf16 v[224:227], v[40:43], a[144:147], v[224:227]
    s_waitcnt lgkmcnt(4)
    ds_read_b64_tr_b16 v[32:33], v71 offset:36864
    ds_read_b64_tr_b16 v[34:35], v71 offset:41472
    v_mfma_f32_16x16x32_bf16 v[224:227], v[44:47], a[160:163], v[224:227]
    ds_read_b64_tr_b16 v[36:37], v71 offset:55296
    ds_read_b64_tr_b16 v[38:39], v71 offset:59904
    v_mfma_f32_16x16x32_bf16 v[228:231], v[44:47], a[164:167], v[228:231]
    v_mfma_f32_16x16x32_bf16 v[228:231], v[40:43], a[148:151], v[228:231]
    v_mfma_f32_16x16x32_bf16 v[232:235], v[40:43], a[152:155], v[232:235]
    v_mfma_f32_16x16x32_bf16 v[232:235], v[44:47], a[168:171], v[232:235]
    v_mfma_f32_16x16x32_bf16 v[236:239], v[44:47], a[172:175], v[236:239]
    v_mfma_f32_16x16x32_bf16 v[236:239], v[40:43], a[156:159], v[236:239]
    s_waitcnt lgkmcnt(6)
    v_mfma_f32_16x16x32_bf16 v[240:243], v[48:51], a[144:147], v[240:243]
    s_waitcnt lgkmcnt(4)
    ds_read_b64_tr_b16 v[40:41], v72 offset:36864
    ds_read_b64_tr_b16 v[42:43], v72 offset:41472
    v_mfma_f32_16x16x32_bf16 v[240:243], v[52:55], a[160:163], v[240:243]
    ds_read_b64_tr_b16 v[44:45], v72 offset:55296
    ds_read_b64_tr_b16 v[46:47], v72 offset:59904
    v_mfma_f32_16x16x32_bf16 v[244:247], v[52:55], a[164:167], v[244:247]
    v_mfma_f32_16x16x32_bf16 v[244:247], v[48:51], a[148:151], v[244:247]
    v_mfma_f32_16x16x32_bf16 v[248:251], v[48:51], a[152:155], v[248:251]
    v_mfma_f32_16x16x32_bf16 v[248:251], v[52:55], a[168:171], v[248:251]
    v_mfma_f32_16x16x32_bf16 v[252:255], v[52:55], a[172:175], v[252:255]
    v_mfma_f32_16x16x32_bf16 v[252:255], v[48:51], a[156:159], v[252:255]
    s_waitcnt lgkmcnt(6)
    v_mfma_f32_16x16x32_bf16 v[112:115], v[32:35], a[176:179], v[112:115]
    s_waitcnt lgkmcnt(4)
    ds_read_b64_tr_b16 v[48:49], v71 offset:36896
    ds_read_b64_tr_b16 v[50:51], v71 offset:41504
    v_mfma_f32_16x16x32_bf16 v[112:115], v[36:39], a[192:195], v[112:115]
    ds_read_b64_tr_b16 v[52:53], v71 offset:55328
    ds_read_b64_tr_b16 v[54:55], v71 offset:59936
    v_mfma_f32_16x16x32_bf16 v[116:119], v[36:39], a[196:199], v[116:119]
    v_mfma_f32_16x16x32_bf16 v[116:119], v[32:35], a[180:183], v[116:119]
    v_mfma_f32_16x16x32_bf16 v[120:123], v[32:35], a[184:187], v[120:123]
    v_mfma_f32_16x16x32_bf16 v[120:123], v[36:39], a[200:203], v[120:123]
    v_mfma_f32_16x16x32_bf16 v[124:127], v[36:39], a[204:207], v[124:127]
    v_mfma_f32_16x16x32_bf16 v[124:127], v[32:35], a[188:191], v[124:127]
    s_waitcnt vmcnt(11) lgkmcnt(6)
    v_mfma_f32_16x16x32_bf16 v[112:115], v[40:43], a[208:211], v[112:115]
    s_waitcnt vmcnt(7) lgkmcnt(4)
    ds_read_b64_tr_b16 v[32:33], v72 offset:36896
    ds_read_b64_tr_b16 v[34:35], v72 offset:41504
    v_mfma_f32_16x16x32_bf16 v[112:115], v[44:47], a[224:227], v[112:115]
    s_waitcnt vmcnt(6)
    ds_read_b64_tr_b16 v[36:37], v72 offset:55328
    ds_read_b64_tr_b16 v[38:39], v72 offset:59936
    v_mfma_f32_16x16x32_bf16 v[116:119], v[44:47], a[228:231], v[116:119]
    s_lshl2_add_u32 s73, s72, s14
    v_mfma_f32_16x16x32_bf16 v[116:119], v[40:43], a[212:215], v[116:119]
    s_add_u32 s86, s73, 98304
    v_mfma_f32_16x16x32_bf16 v[120:123], v[40:43], a[216:219], v[120:123]
    s_waitcnt vmcnt(5)
    s_cmp_eq_u32 s27, 0
    s_cselect_b32 s79, s79, s14
    v_mfma_f32_16x16x32_bf16 v[120:123], v[44:47], a[232:235], v[120:123]
    s_waitcnt vmcnt(4)
    s_mul_i32 s88, s71, 589824
    v_mfma_f32_16x16x32_bf16 v[124:127], v[44:47], a[236:239], v[124:127]
    s_add_u32 s28, s12, s88
    s_addc_u32 s29, s13, 0
    v_mfma_f32_16x16x32_bf16 v[124:127], v[40:43], a[220:223], v[124:127]
    s_waitcnt lgkmcnt(6)
    s_and_b32 s29, s29, 0xffff
    v_mfma_f32_16x16x32_bf16 v[128:131], v[48:51], a[176:179], v[128:131]
    s_waitcnt lgkmcnt(4)
    s_mov_b32 s30, 589824
    ds_read_b64_tr_b16 v[40:41], v71 offset:36928
    ds_read_b64_tr_b16 v[42:43], v71 offset:41536
    v_mfma_f32_16x16x32_bf16 v[128:131], v[52:55], a[192:195], v[128:131]
    s_mov_b32 s31, 0x20000
    ds_read_b64_tr_b16 v[44:45], v71 offset:55360
    ds_read_b64_tr_b16 v[46:47], v71 offset:59968
    v_mfma_f32_16x16x32_bf16 v[132:135], v[52:55], a[196:199], v[132:135]
    s_add_u32 s32, s4, 0
    s_addc_u32 s33, s5, 0
    v_mfma_f32_16x16x32_bf16 v[132:135], v[48:51], a[180:183], v[132:135]
    s_and_b32 s33, s33, 0xffff
    v_mfma_f32_16x16x32_bf16 v[136:139], v[48:51], a[184:187], v[136:139]
    s_mov_b32 s34, 2359296
    v_mfma_f32_16x16x32_bf16 v[136:139], v[52:55], a[200:203], v[136:139]
    s_mov_b32 s35, 0x20000
    v_mfma_f32_16x16x32_bf16 v[140:143], v[52:55], a[204:207], v[140:143]
    s_add_u32 s36, s20, 0
    s_addc_u32 s37, s21, 0
    v_mfma_f32_16x16x32_bf16 v[140:143], v[48:51], a[188:191], v[140:143]
    s_waitcnt lgkmcnt(6)
    s_and_b32 s37, s37, 0xffff
    v_mfma_f32_16x16x32_bf16 v[128:131], v[32:35], a[208:211], v[128:131]
    s_waitcnt lgkmcnt(4)
    s_mov_b32 s38, 2359296
    ds_read_b64_tr_b16 v[48:49], v72 offset:36928
    ds_read_b64_tr_b16 v[50:51], v72 offset:41536
    v_mfma_f32_16x16x32_bf16 v[128:131], v[36:39], a[224:227], v[128:131]
    s_mov_b32 s39, 0x20000
    ds_read_b64_tr_b16 v[52:53], v72 offset:55360
    ds_read_b64_tr_b16 v[54:55], v72 offset:59968
    v_mfma_f32_16x16x32_bf16 v[132:135], v[36:39], a[228:231], v[132:135]
    v_mfma_f32_16x16x32_bf16 v[132:135], v[32:35], a[212:215], v[132:135]
    v_mfma_f32_16x16x32_bf16 v[136:139], v[32:35], a[216:219], v[136:139]
    v_mfma_f32_16x16x32_bf16 v[136:139], v[36:39], a[232:235], v[136:139]
    v_mfma_f32_16x16x32_bf16 v[140:143], v[36:39], a[236:239], v[140:143]
    v_mfma_f32_16x16x32_bf16 v[140:143], v[32:35], a[220:223], v[140:143]
    s_waitcnt lgkmcnt(6)
    v_mfma_f32_16x16x32_bf16 v[144:147], v[40:43], a[176:179], v[144:147]
    s_waitcnt lgkmcnt(4)
    ds_read_b64_tr_b16 v[32:33], v71 offset:36960
    ds_read_b64_tr_b16 v[34:35], v71 offset:41568
    v_mfma_f32_16x16x32_bf16 v[144:147], v[44:47], a[192:195], v[144:147]
    ds_read_b64_tr_b16 v[36:37], v71 offset:55392
    ds_read_b64_tr_b16 v[38:39], v71 offset:60000
    v_mfma_f32_16x16x32_bf16 v[148:151], v[44:47], a[196:199], v[148:151]
    v_mfma_f32_16x16x32_bf16 v[148:151], v[40:43], a[180:183], v[148:151]
    v_cvt_pk_bf16_f32 v112, v112, v113
    v_cvt_pk_bf16_f32 v113, v114, v115
    v_mfma_f32_16x16x32_bf16 v[152:155], v[40:43], a[184:187], v[152:155]
    v_cvt_pk_bf16_f32 v114, v128, v129
    v_cvt_pk_bf16_f32 v115, v130, v131
    v_mfma_f32_16x16x32_bf16 v[152:155], v[44:47], a[200:203], v[152:155]
    v_pk_max_i16 v112, v112, 0
    v_pk_max_i16 v113, v113, 0
    v_mfma_f32_16x16x32_bf16 v[156:159], v[44:47], a[204:207], v[156:159]
    v_pk_max_i16 v114, v114, 0
    v_pk_max_i16 v115, v115, 0
    v_mfma_f32_16x16x32_bf16 v[156:159], v[40:43], a[188:191], v[156:159]
    s_waitcnt lgkmcnt(6)
    buffer_store_dwordx4 v[112:115], v2, s[52:55], s91 offen offset:0 sc1
    v_mfma_f32_16x16x32_bf16 v[144:147], v[48:51], a[208:211], v[144:147]
    s_waitcnt lgkmcnt(4)
    ds_read_b64_tr_b16 v[40:41], v72 offset:36960
    ds_read_b64_tr_b16 v[42:43], v72 offset:41568
    v_mfma_f32_16x16x32_bf16 v[144:147], v[52:55], a[224:227], v[144:147]
    ds_read_b64_tr_b16 v[44:45], v72 offset:55392
    ds_read_b64_tr_b16 v[46:47], v72 offset:60000
    v_mfma_f32_16x16x32_bf16 v[148:151], v[52:55], a[228:231], v[148:151]
    v_cvt_pk_bf16_f32 v116, v116, v117
    v_cvt_pk_bf16_f32 v117, v118, v119
    v_mfma_f32_16x16x32_bf16 v[148:151], v[48:51], a[212:215], v[148:151]
    v_cvt_pk_bf16_f32 v118, v132, v133
    v_cvt_pk_bf16_f32 v119, v134, v135
    v_mfma_f32_16x16x32_bf16 v[152:155], v[48:51], a[216:219], v[152:155]
    v_pk_max_i16 v116, v116, 0
    v_pk_max_i16 v117, v117, 0
    v_mfma_f32_16x16x32_bf16 v[152:155], v[52:55], a[232:235], v[152:155]
    v_pk_max_i16 v118, v118, 0
    v_pk_max_i16 v119, v119, 0
    v_mfma_f32_16x16x32_bf16 v[156:159], v[52:55], a[236:239], v[156:159]
    v_cvt_pk_bf16_f32 v120, v120, v121
    v_cvt_pk_bf16_f32 v121, v122, v123
    v_mfma_f32_16x16x32_bf16 v[156:159], v[48:51], a[220:223], v[156:159]
    s_waitcnt lgkmcnt(6)
    buffer_store_dwordx4 v[116:119], v2, s[52:55], s91 offen offset:1024 sc1
    v_mfma_f32_16x16x32_bf16 v[160:163], v[32:35], a[176:179], v[160:163]
    s_waitcnt lgkmcnt(4)
    ds_read_b64_tr_b16 v[48:49], v71 offset:36992
    ds_read_b64_tr_b16 v[50:51], v71 offset:41600
    v_mfma_f32_16x16x32_bf16 v[160:163], v[36:39], a[192:195], v[160:163]
    ds_read_b64_tr_b16 v[52:53], v71 offset:55424
    ds_read_b64_tr_b16 v[54:55], v71 offset:60032
    v_mfma_f32_16x16x32_bf16 v[164:167], v[36:39], a[196:199], v[164:167]
    v_cvt_pk_bf16_f32 v122, v136, v137
    v_cvt_pk_bf16_f32 v123, v138, v139
    v_mfma_f32_16x16x32_bf16 v[164:167], v[32:35], a[180:183], v[164:167]
    v_pk_max_i16 v120, v120, 0
    v_pk_max_i16 v121, v121, 0
    v_mfma_f32_16x16x32_bf16 v[168:171], v[32:35], a[184:187], v[168:171]
    v_pk_max_i16 v122, v122, 0
    v_pk_max_i16 v123, v123, 0
    v_mfma_f32_16x16x32_bf16 v[168:171], v[36:39], a[200:203], v[168:171]
    v_cvt_pk_bf16_f32 v124, v124, v125
    v_cvt_pk_bf16_f32 v125, v126, v127
    v_mfma_f32_16x16x32_bf16 v[172:175], v[36:39], a[204:207], v[172:175]
    v_cvt_pk_bf16_f32 v126, v140, v141
    v_cvt_pk_bf16_f32 v127, v142, v143
    v_mfma_f32_16x16x32_bf16 v[172:175], v[32:35], a[188:191], v[172:175]
    s_waitcnt lgkmcnt(6)
    v_pk_max_i16 v124, v124, 0
    v_pk_max_i16 v125, v125, 0
    v_mfma_f32_16x16x32_bf16 v[160:163], v[40:43], a[208:211], v[160:163]
    s_waitcnt lgkmcnt(4)
    ds_read_b64_tr_b16 v[32:33], v72 offset:36992
    ds_read_b64_tr_b16 v[34:35], v72 offset:41600
    v_mfma_f32_16x16x32_bf16 v[160:163], v[44:47], a[224:227], v[160:163]
    v_pk_max_i16 v126, v126, 0
    v_pk_max_i16 v127, v127, 0
    v_mfma_f32_16x16x32_bf16 v[164:167], v[44:47], a[228:231], v[164:167]
    ds_read_b64_tr_b16 v[36:37], v72 offset:55424
    ds_read_b64_tr_b16 v[38:39], v72 offset:60032
    v_mfma_f32_16x16x32_bf16 v[164:167], v[40:43], a[212:215], v[164:167]
    v_mfma_f32_16x16x32_bf16 v[168:171], v[40:43], a[216:219], v[168:171]
    v_mfma_f32_16x16x32_bf16 v[168:171], v[44:47], a[232:235], v[168:171]
    buffer_store_dwordx4 v[120:123], v2, s[52:55], s91 offen offset:2048 sc1
    v_mfma_f32_16x16x32_bf16 v[172:175], v[44:47], a[236:239], v[172:175]
    v_mfma_f32_16x16x32_bf16 v[172:175], v[40:43], a[220:223], v[172:175]
    s_waitcnt lgkmcnt(6)
    v_mfma_f32_16x16x32_bf16 v[176:179], v[48:51], a[176:179], v[176:179]
    s_waitcnt lgkmcnt(4)
    ds_read_b64_tr_b16 v[40:41], v71 offset:37024
    ds_read_b64_tr_b16 v[42:43], v71 offset:41632
    v_mfma_f32_16x16x32_bf16 v[176:179], v[52:55], a[192:195], v[176:179]
    ds_read_b64_tr_b16 v[44:45], v71 offset:55456
    ds_read_b64_tr_b16 v[46:47], v71 offset:60064
    v_mfma_f32_16x16x32_bf16 v[180:183], v[52:55], a[196:199], v[180:183]
    v_mfma_f32_16x16x32_bf16 v[180:183], v[48:51], a[180:183], v[180:183]
    v_cvt_pk_bf16_f32 v144, v144, v145
    v_cvt_pk_bf16_f32 v145, v146, v147
    v_mfma_f32_16x16x32_bf16 v[184:187], v[48:51], a[184:187], v[184:187]
    v_cvt_pk_bf16_f32 v146, v160, v161
    v_cvt_pk_bf16_f32 v147, v162, v163
    v_mfma_f32_16x16x32_bf16 v[184:187], v[52:55], a[200:203], v[184:187]
    v_pk_max_i16 v144, v144, 0
    v_pk_max_i16 v145, v145, 0
    v_mfma_f32_16x16x32_bf16 v[188:191], v[52:55], a[204:207], v[188:191]
    v_pk_max_i16 v146, v146, 0
    v_pk_max_i16 v147, v147, 0
    v_mfma_f32_16x16x32_bf16 v[188:191], v[48:51], a[188:191], v[188:191]
    s_waitcnt lgkmcnt(6)
    v_cvt_pk_bf16_f32 v148, v148, v149
    v_cvt_pk_bf16_f32 v149, v150, v151
    v_mfma_f32_16x16x32_bf16 v[176:179], v[32:35], a[208:211], v[176:179]
    s_waitcnt lgkmcnt(4)
    ds_read_b64_tr_b16 v[48:49], v72 offset:37024
    ds_read_b64_tr_b16 v[50:51], v72 offset:41632
    v_mfma_f32_16x16x32_bf16 v[176:179], v[36:39], a[224:227], v[176:179]
    ds_read_b64_tr_b16 v[52:53], v72 offset:55456
    ds_read_b64_tr_b16 v[54:55], v72 offset:60064
    v_mfma_f32_16x16x32_bf16 v[180:183], v[36:39], a[228:231], v[180:183]
    v_cvt_pk_bf16_f32 v150, v164, v165
    v_cvt_pk_bf16_f32 v151, v166, v167
    v_mfma_f32_16x16x32_bf16 v[180:183], v[32:35], a[212:215], v[180:183]
    buffer_store_dwordx4 v[124:127], v2, s[52:55], s91 offen offset:3072 sc1
    v_mfma_f32_16x16x32_bf16 v[184:187], v[32:35], a[216:219], v[184:187]
    s_add_u32 s91, s91, 131072
    v_pk_max_i16 v148, v148, 0
    v_pk_max_i16 v149, v149, 0
    v_mfma_f32_16x16x32_bf16 v[184:187], v[36:39], a[232:235], v[184:187]
    v_pk_max_i16 v150, v150, 0
    v_pk_max_i16 v151, v151, 0
    v_mfma_f32_16x16x32_bf16 v[188:191], v[36:39], a[236:239], v[188:191]
    v_cvt_pk_bf16_f32 v152, v152, v153
    v_cvt_pk_bf16_f32 v153, v154, v155
    v_mfma_f32_16x16x32_bf16 v[188:191], v[32:35], a[220:223], v[188:191]
    s_waitcnt lgkmcnt(6)
    v_cvt_pk_bf16_f32 v154, v168, v169
    v_cvt_pk_bf16_f32 v155, v170, v171
    v_mfma_f32_16x16x32_bf16 v[192:195], v[40:43], a[176:179], v[192:195]
    s_waitcnt lgkmcnt(4)
    ds_read_b64_tr_b16 v[32:33], v71 offset:37056
    ds_read_b64_tr_b16 v[34:35], v71 offset:41664
    v_mfma_f32_16x16x32_bf16 v[192:195], v[44:47], a[192:195], v[192:195]
    ds_read_b64_tr_b16 v[36:37], v71 offset:55488
    ds_read_b64_tr_b16 v[38:39], v71 offset:60096
    v_mfma_f32_16x16x32_bf16 v[196:199], v[44:47], a[196:199], v[196:199]
    v_pk_max_i16 v152, v152, 0
    v_pk_max_i16 v153, v153, 0
    v_mfma_f32_16x16x32_bf16 v[196:199], v[40:43], a[180:183], v[196:199]
    v_pk_max_i16 v154, v154, 0
    v_pk_max_i16 v155, v155, 0
    v_mfma_f32_16x16x32_bf16 v[200:203], v[40:43], a[184:187], v[200:203]
    v_cvt_pk_bf16_f32 v156, v156, v157
    v_cvt_pk_bf16_f32 v157, v158, v159
    v_mfma_f32_16x16x32_bf16 v[200:203], v[44:47], a[200:203], v[200:203]
    v_cvt_pk_bf16_f32 v158, v172, v173
    v_cvt_pk_bf16_f32 v159, v174, v175
    v_mfma_f32_16x16x32_bf16 v[204:207], v[44:47], a[204:207], v[204:207]
    v_pk_max_i16 v156, v156, 0
    v_pk_max_i16 v157, v157, 0
    v_mfma_f32_16x16x32_bf16 v[204:207], v[40:43], a[188:191], v[204:207]
    s_waitcnt lgkmcnt(6)
    v_pk_max_i16 v158, v158, 0
    v_pk_max_i16 v159, v159, 0
    v_mfma_f32_16x16x32_bf16 v[192:195], v[48:51], a[208:211], v[192:195]
    s_waitcnt lgkmcnt(4)
    ds_read_b64_tr_b16 v[40:41], v72 offset:37056
    ds_read_b64_tr_b16 v[42:43], v72 offset:41664
    v_mfma_f32_16x16x32_bf16 v[192:195], v[52:55], a[224:227], v[192:195]
    buffer_store_dwordx4 v[144:147], v2, s[52:55], s91 offen offset:0 sc1
    v_mfma_f32_16x16x32_bf16 v[196:199], v[52:55], a[228:231], v[196:199]
    ds_read_b64_tr_b16 v[44:45], v72 offset:55488
    ds_read_b64_tr_b16 v[46:47], v72 offset:60096
    v_mfma_f32_16x16x32_bf16 v[196:199], v[48:51], a[212:215], v[196:199]
    v_mfma_f32_16x16x32_bf16 v[200:203], v[48:51], a[216:219], v[200:203]
    v_mfma_f32_16x16x32_bf16 v[200:203], v[52:55], a[232:235], v[200:203]
    v_mfma_f32_16x16x32_bf16 v[204:207], v[52:55], a[236:239], v[204:207]
    v_mfma_f32_16x16x32_bf16 v[204:207], v[48:51], a[220:223], v[204:207]
    s_waitcnt lgkmcnt(6)
    v_mfma_f32_16x16x32_bf16 v[208:211], v[32:35], a[176:179], v[208:211]
    s_waitcnt lgkmcnt(4)
    ds_read_b64_tr_b16 v[48:49], v71 offset:37088
    ds_read_b64_tr_b16 v[50:51], v71 offset:41696
    v_mfma_f32_16x16x32_bf16 v[208:211], v[36:39], a[192:195], v[208:211]
    ds_read_b64_tr_b16 v[52:53], v71 offset:55520
    ds_read_b64_tr_b16 v[54:55], v71 offset:60128
    v_mfma_f32_16x16x32_bf16 v[212:215], v[36:39], a[196:199], v[212:215]
    v_mfma_f32_16x16x32_bf16 v[212:215], v[32:35], a[180:183], v[212:215]
    v_cvt_pk_bf16_f32 v176, v176, v177
    v_cvt_pk_bf16_f32 v177, v178, v179
    v_mfma_f32_16x16x32_bf16 v[216:219], v[32:35], a[184:187], v[216:219]
    v_cvt_pk_bf16_f32 v178, v192, v193
    v_cvt_pk_bf16_f32 v179, v194, v195
    v_mfma_f32_16x16x32_bf16 v[216:219], v[36:39], a[200:203], v[216:219]
    v_pk_max_i16 v176, v176, 0
    v_pk_max_i16 v177, v177, 0
    v_mfma_f32_16x16x32_bf16 v[220:223], v[36:39], a[204:207], v[220:223]
    v_pk_max_i16 v178, v178, 0
    v_pk_max_i16 v179, v179, 0
    v_mfma_f32_16x16x32_bf16 v[220:223], v[32:35], a[188:191], v[220:223]
    s_waitcnt lgkmcnt(6)
    buffer_store_dwordx4 v[148:151], v2, s[52:55], s91 offen offset:1024 sc1
    v_mfma_f32_16x16x32_bf16 v[208:211], v[40:43], a[208:211], v[208:211]
    s_waitcnt lgkmcnt(4)
    ds_read_b64_tr_b16 v[32:33], v72 offset:37088
    ds_read_b64_tr_b16 v[34:35], v72 offset:41696
    v_mfma_f32_16x16x32_bf16 v[208:211], v[44:47], a[224:227], v[208:211]
    ds_read_b64_tr_b16 v[36:37], v72 offset:55520
    ds_read_b64_tr_b16 v[38:39], v72 offset:60128
    v_mfma_f32_16x16x32_bf16 v[212:215], v[44:47], a[228:231], v[212:215]
    v_cvt_pk_bf16_f32 v180, v180, v181
    v_cvt_pk_bf16_f32 v181, v182, v183
    v_mfma_f32_16x16x32_bf16 v[212:215], v[40:43], a[212:215], v[212:215]
    v_cvt_pk_bf16_f32 v182, v196, v197
    v_cvt_pk_bf16_f32 v183, v198, v199
    v_mfma_f32_16x16x32_bf16 v[216:219], v[40:43], a[216:219], v[216:219]
    v_pk_max_i16 v180, v180, 0
    v_pk_max_i16 v181, v181, 0
    v_mfma_f32_16x16x32_bf16 v[216:219], v[44:47], a[232:235], v[216:219]
    v_pk_max_i16 v182, v182, 0
    v_pk_max_i16 v183, v183, 0
    v_mfma_f32_16x16x32_bf16 v[220:223], v[44:47], a[236:239], v[220:223]
    v_cvt_pk_bf16_f32 v184, v184, v185
    v_cvt_pk_bf16_f32 v185, v186, v187
    v_mfma_f32_16x16x32_bf16 v[220:223], v[40:43], a[220:223], v[220:223]
    s_waitcnt lgkmcnt(6)
    v_cvt_pk_bf16_f32 v186, v200, v201
    v_cvt_pk_bf16_f32 v187, v202, v203
    v_mfma_f32_16x16x32_bf16 v[224:227], v[48:51], a[176:179], v[224:227]
    s_waitcnt lgkmcnt(4)
    ds_read_b64_tr_b16 v[40:41], v73 offset:36864
    ds_read_b64_tr_b16 v[42:43], v73 offset:41472
    v_mfma_f32_16x16x32_bf16 v[224:227], v[52:55], a[192:195], v[224:227]
    ds_read_b64_tr_b16 v[44:45], v73 offset:55296
    ds_read_b64_tr_b16 v[46:47], v73 offset:59904
    v_mfma_f32_16x16x32_bf16 v[228:231], v[52:55], a[196:199], v[228:231]
    v_pk_max_i16 v184, v184, 0
    v_pk_max_i16 v185, v185, 0
    v_mfma_f32_16x16x32_bf16 v[228:231], v[48:51], a[180:183], v[228:231]
    v_pk_max_i16 v186, v186, 0
    v_pk_max_i16 v187, v187, 0
    v_mfma_f32_16x16x32_bf16 v[232:235], v[48:51], a[184:187], v[232:235]
    v_cvt_pk_bf16_f32 v188, v188, v189
    v_cvt_pk_bf16_f32 v189, v190, v191
    v_mfma_f32_16x16x32_bf16 v[232:235], v[52:55], a[200:203], v[232:235]
    buffer_store_dwordx4 v[152:155], v2, s[52:55], s91 offen offset:2048 sc1
    v_mfma_f32_16x16x32_bf16 v[236:239], v[52:55], a[204:207], v[236:239]
    v_cvt_pk_bf16_f32 v190, v204, v205
    v_cvt_pk_bf16_f32 v191, v206, v207
    v_mfma_f32_16x16x32_bf16 v[236:239], v[48:51], a[188:191], v[236:239]
    s_waitcnt lgkmcnt(6)
    v_pk_max_i16 v188, v188, 0
    v_pk_max_i16 v189, v189, 0
    v_mfma_f32_16x16x32_bf16 v[224:227], v[32:35], a[208:211], v[224:227]
    s_waitcnt lgkmcnt(4)
    ds_read_b64_tr_b16 v[48:49], v74 offset:36864
    ds_read_b64_tr_b16 v[50:51], v74 offset:41472
    v_mfma_f32_16x16x32_bf16 v[224:227], v[36:39], a[224:227], v[224:227]
    v_pk_max_i16 v190, v190, 0
    v_pk_max_i16 v191, v191, 0
    v_mfma_f32_16x16x32_bf16 v[228:231], v[36:39], a[228:231], v[228:231]
    ds_read_b64_tr_b16 v[52:53], v74 offset:55296
    ds_read_b64_tr_b16 v[54:55], v74 offset:59904
    v_mfma_f32_16x16x32_bf16 v[228:231], v[32:35], a[212:215], v[228:231]
    v_mfma_f32_16x16x32_bf16 v[232:235], v[32:35], a[216:219], v[232:235]
    v_mfma_f32_16x16x32_bf16 v[232:235], v[36:39], a[232:235], v[232:235]
    v_mfma_f32_16x16x32_bf16 v[236:239], v[36:39], a[236:239], v[236:239]
    v_mfma_f32_16x16x32_bf16 v[236:239], v[32:35], a[220:223], v[236:239]
    s_waitcnt lgkmcnt(6)
    v_mfma_f32_16x16x32_bf16 v[240:243], v[40:43], a[176:179], v[240:243]
    s_waitcnt lgkmcnt(4)
    ds_read_b64_tr_b16 v[32:33], v69 offset:0
    ds_read_b64_tr_b16 v[34:35], v69 offset:4608
    v_mfma_f32_16x16x32_bf16 v[240:243], v[44:47], a[192:195], v[240:243]
    ds_read_b64_tr_b16 v[36:37], v69 offset:18432
    ds_read_b64_tr_b16 v[38:39], v69 offset:23040
    v_mfma_f32_16x16x32_bf16 v[244:247], v[44:47], a[196:199], v[244:247]
    v_mfma_f32_16x16x32_bf16 v[244:247], v[40:43], a[180:183], v[244:247]
    buffer_store_dwordx4 v[156:159], v2, s[52:55], s91 offen offset:3072 sc1
    v_mfma_f32_16x16x32_bf16 v[248:251], v[40:43], a[184:187], v[248:251]
    s_add_u32 s91, s91, 131072
    v_cvt_pk_bf16_f32 v208, v208, v209
    v_cvt_pk_bf16_f32 v209, v210, v211
    v_mfma_f32_16x16x32_bf16 v[248:251], v[44:47], a[200:203], v[248:251]
    v_cvt_pk_bf16_f32 v210, v224, v225
    v_cvt_pk_bf16_f32 v211, v226, v227
    v_mfma_f32_16x16x32_bf16 v[252:255], v[44:47], a[204:207], v[252:255]
    v_pk_max_i16 v208, v208, 0
    v_pk_max_i16 v209, v209, 0
    v_mfma_f32_16x16x32_bf16 v[252:255], v[40:43], a[188:191], v[252:255]
    s_waitcnt lgkmcnt(6)
    v_pk_max_i16 v210, v210, 0
    v_pk_max_i16 v211, v211, 0
    v_mfma_f32_16x16x32_bf16 v[240:243], v[48:51], a[208:211], v[240:243]
    s_waitcnt lgkmcnt(4)
    ds_read_b64_tr_b16 v[40:41], v69 offset:8
    ds_read_b64_tr_b16 v[42:43], v69 offset:4616
    v_mfma_f32_16x16x32_bf16 v[240:243], v[52:55], a[224:227], v[240:243]
    ds_read_b64_tr_b16 v[44:45], v69 offset:18440
    ds_read_b64_tr_b16 v[46:47], v69 offset:23048
    v_mfma_f32_16x16x32_bf16 v[244:247], v[52:55], a[228:231], v[244:247]
    v_cvt_pk_bf16_f32 v212, v212, v213
    v_cvt_pk_bf16_f32 v213, v214, v215
    v_mfma_f32_16x16x32_bf16 v[244:247], v[48:51], a[212:215], v[244:247]
    v_cvt_pk_bf16_f32 v214, v228, v229
    v_cvt_pk_bf16_f32 v215, v230, v231
    v_mfma_f32_16x16x32_bf16 v[248:251], v[48:51], a[216:219], v[248:251]
    v_pk_max_i16 v212, v212, 0
    v_pk_max_i16 v213, v213, 0
    v_mfma_f32_16x16x32_bf16 v[248:251], v[52:55], a[232:235], v[248:251]
    v_pk_max_i16 v214, v214, 0
    v_pk_max_i16 v215, v215, 0
    v_mfma_f32_16x16x32_bf16 v[252:255], v[52:55], a[236:239], v[252:255]
    v_cvt_pk_bf16_f32 v216, v216, v217
    v_cvt_pk_bf16_f32 v217, v218, v219
    v_mfma_f32_16x16x32_bf16 v[252:255], v[48:51], a[220:223], v[252:255]
    s_waitcnt lgkmcnt(6)
    v_cvt_pk_bf16_f32 v218, v232, v233
    v_cvt_pk_bf16_f32 v219, v234, v235
    v_mfma_f32_16x16x32_bf16 a[0:3], v[32:35], a[144:147], a[0:3]
    s_waitcnt lgkmcnt(4)
    ds_read_b64_tr_b16 v[48:49], v69 offset:64
    ds_read_b64_tr_b16 v[50:51], v69 offset:4672
    v_mfma_f32_16x16x32_bf16 a[0:3], v[36:39], a[160:163], a[0:3]
    buffer_store_dwordx4 v[176:179], v2, s[52:55], s91 offen offset:0 sc1
    v_mfma_f32_16x16x32_bf16 a[4:7], v[36:39], a[164:167], a[4:7]
    ds_read_b64_tr_b16 v[52:53], v69 offset:18496
    ds_read_b64_tr_b16 v[54:55], v69 offset:23104
    v_mfma_f32_16x16x32_bf16 a[4:7], v[32:35], a[148:151], a[4:7]
    v_pk_max_i16 v216, v216, 0
    v_pk_max_i16 v217, v217, 0
    v_mfma_f32_16x16x32_bf16 a[8:11], v[32:35], a[152:155], a[8:11]
    v_pk_max_i16 v218, v218, 0
    v_pk_max_i16 v219, v219, 0
    v_mfma_f32_16x16x32_bf16 a[8:11], v[36:39], a[168:171], a[8:11]
    v_cvt_pk_bf16_f32 v220, v220, v221
    v_cvt_pk_bf16_f32 v221, v222, v223
    v_mfma_f32_16x16x32_bf16 a[12:15], v[36:39], a[172:175], a[12:15]
    v_cvt_pk_bf16_f32 v222, v236, v237
    v_cvt_pk_bf16_f32 v223, v238, v239
    v_mfma_f32_16x16x32_bf16 a[12:15], v[32:35], a[156:159], a[12:15]
    s_waitcnt lgkmcnt(6)
    v_pk_max_i16 v220, v220, 0
    v_pk_max_i16 v221, v221, 0
    v_mfma_f32_16x16x32_bf16 a[16:19], v[40:43], a[144:147], a[16:19]
    s_waitcnt lgkmcnt(4)
    ds_read_b64_tr_b16 v[32:33], v69 offset:72
    ds_read_b64_tr_b16 v[34:35], v69 offset:4680
    v_mfma_f32_16x16x32_bf16 a[16:19], v[44:47], a[160:163], a[16:19]
    v_pk_max_i16 v222, v222, 0
    v_pk_max_i16 v223, v223, 0
    v_mfma_f32_16x16x32_bf16 a[20:23], v[44:47], a[164:167], a[20:23]
    ds_read_b64_tr_b16 v[36:37], v69 offset:18504
    ds_read_b64_tr_b16 v[38:39], v69 offset:23112
    v_mfma_f32_16x16x32_bf16 a[20:23], v[40:43], a[148:151], a[20:23]
    v_cvt_pk_bf16_f32 v24, v240, v241
    v_cvt_pk_bf16_f32 v25, v242, v243
    v_mfma_f32_16x16x32_bf16 a[24:27], v[40:43], a[152:155], a[24:27]
    v_pk_max_i16 v24, v24, 0
    v_pk_max_i16 v25, v25, 0
    v_mfma_f32_16x16x32_bf16 a[24:27], v[44:47], a[168:171], a[24:27]
    v_cvt_pk_bf16_f32 v26, v244, v245
    v_cvt_pk_bf16_f32 v27, v246, v247
    v_mfma_f32_16x16x32_bf16 a[28:31], v[44:47], a[172:175], a[28:31]
    v_pk_max_i16 v26, v26, 0
    v_pk_max_i16 v27, v27, 0
    v_mfma_f32_16x16x32_bf16 a[28:31], v[40:43], a[156:159], a[28:31]
    s_waitcnt lgkmcnt(6)
    buffer_store_dwordx4 v[180:183], v2, s[52:55], s91 offen offset:1024 sc1
    v_mfma_f32_16x16x32_bf16 a[32:35], v[48:51], a[144:147], a[32:35]
    s_waitcnt lgkmcnt(4)
    ds_read_b64_tr_b16 v[40:41], v69 offset:128
    ds_read_b64_tr_b16 v[42:43], v69 offset:4736
    v_mfma_f32_16x16x32_bf16 a[32:35], v[52:55], a[160:163], a[32:35]
    ds_read_b64_tr_b16 v[44:45], v69 offset:18560
    ds_read_b64_tr_b16 v[46:47], v69 offset:23168
    v_mfma_f32_16x16x32_bf16 a[36:39], v[52:55], a[164:167], a[36:39]
Lpad4:
    s_cbranch_execz Lpad6
    v_cvt_pk_bf16_f32 v28, v248, v249
    v_cvt_pk_bf16_f32 v29, v250, v251
    v_mfma_f32_16x16x32_bf16 a[36:39], v[48:51], a[148:151], a[36:39]
    v_pk_max_i16 v28, v28, 0
    v_pk_max_i16 v29, v29, 0
    v_mfma_f32_16x16x32_bf16 a[40:43], v[48:51], a[152:155], a[40:43]
    v_cvt_pk_bf16_f32 v30, v252, v253
    v_cvt_pk_bf16_f32 v31, v254, v255
    v_mfma_f32_16x16x32_bf16 a[40:43], v[52:55], a[168:171], a[40:43]
    v_pk_max_i16 v30, v30, 0
    v_pk_max_i16 v31, v31, 0
    v_mfma_f32_16x16x32_bf16 a[44:47], v[52:55], a[172:175], a[44:47]
    v_mfma_f32_16x16x32_bf16 a[44:47], v[48:51], a[156:159], a[44:47]
    s_waitcnt lgkmcnt(6)
    v_mfma_f32_16x16x32_bf16 a[48:51], v[32:35], a[144:147], a[48:51]
    s_waitcnt lgkmcnt(4)
    ds_read_b64_tr_b16 v[48:49], v69 offset:136
    ds_read_b64_tr_b16 v[50:51], v69 offset:4744
    v_mfma_f32_16x16x32_bf16 a[48:51], v[36:39], a[160:163], a[48:51]
    ds_read_b64_tr_b16 v[52:53], v69 offset:18568
    ds_read_b64_tr_b16 v[54:55], v69 offset:23176
    v_mfma_f32_16x16x32_bf16 a[52:55], v[36:39], a[164:167], a[52:55]
    v_mfma_f32_16x16x32_bf16 a[52:55], v[32:35], a[148:151], a[52:55]
    v_mfma_f32_16x16x32_bf16 a[56:59], v[32:35], a[152:155], a[56:59]
    v_mfma_f32_16x16x32_bf16 a[56:59], v[36:39], a[168:171], a[56:59]
    buffer_store_dwordx4 v[184:187], v2, s[52:55], s91 offen offset:2048 sc1
    v_mfma_f32_16x16x32_bf16 a[60:63], v[36:39], a[172:175], a[60:63]
    v_mfma_f32_16x16x32_bf16 a[60:63], v[32:35], a[156:159], a[60:63]
    s_waitcnt lgkmcnt(6)
    v_mfma_f32_16x16x32_bf16 a[64:67], v[40:43], a[144:147], a[64:67]
    s_waitcnt lgkmcnt(4)
    ds_read_b64_tr_b16 v[32:33], v69 offset:192
    ds_read_b64_tr_b16 v[34:35], v69 offset:4800
    v_mfma_f32_16x16x32_bf16 a[64:67], v[44:47], a[160:163], a[64:67]
    ds_read_b64_tr_b16 v[36:37], v69 offset:18624
    ds_read_b64_tr_b16 v[38:39], v69 offset:23232
    v_mfma_f32_16x16x32_bf16 a[68:71], v[44:47], a[164:167], a[68:71]
    v_mfma_f32_16x16x32_bf16 a[68:71], v[40:43], a[148:151], a[68:71]
    v_mfma_f32_16x16x32_bf16 a[72:75], v[40:43], a[152:155], a[72:75]
    v_mfma_f32_16x16x32_bf16 a[72:75], v[44:47], a[168:171], a[72:75]
    v_mfma_f32_16x16x32_bf16 a[76:79], v[44:47], a[172:175], a[76:79]
    v_mfma_f32_16x16x32_bf16 a[76:79], v[40:43], a[156:159], a[76:79]
    s_waitcnt lgkmcnt(6)
    v_mfma_f32_16x16x32_bf16 a[80:83], v[48:51], a[144:147], a[80:83]
    s_waitcnt lgkmcnt(4)
    ds_read_b64_tr_b16 v[40:41], v69 offset:200
    ds_read_b64_tr_b16 v[42:43], v69 offset:4808
    v_mfma_f32_16x16x32_bf16 a[80:83], v[52:55], a[160:163], a[80:83]
    ds_read_b64_tr_b16 v[44:45], v69 offset:18632
    ds_read_b64_tr_b16 v[46:47], v69 offset:23240
    v_mfma_f32_16x16x32_bf16 a[84:87], v[52:55], a[164:167], a[84:87]
    v_mfma_f32_16x16x32_bf16 a[84:87], v[48:51], a[148:151], a[84:87]
    buffer_store_dwordx4 v[188:191], v2, s[52:55], s91 offen offset:3072 sc1
    v_mfma_f32_16x16x32_bf16 a[88:91], v[48:51], a[152:155], a[88:91]
    s_add_u32 s41, s72, 0
    v_mfma_f32_16x16x32_bf16 a[88:91], v[52:55], a[168:171], a[88:91]
    s_and_b32 s41, s41, 3
    v_mfma_f32_16x16x32_bf16 a[92:95], v[52:55], a[172:175], a[92:95]
    s_mul_i32 s41, s41, 9
    v_mfma_f32_16x16x32_bf16 a[92:95], v[48:51], a[156:159], a[92:95]
    s_waitcnt lgkmcnt(6)
    s_add_u32 s41, s41, 1
    v_mfma_f32_16x16x32_bf16 a[96:99], v[32:35], a[144:147], a[96:99]
    s_waitcnt lgkmcnt(4)
    s_lshr_b32 s41, s41, 1
    ds_read_b64_tr_b16 v[48:49], v69 offset:36864
    ds_read_b64_tr_b16 v[50:51], v69 offset:41472
    v_mfma_f32_16x16x32_bf16 a[96:99], v[36:39], a[160:163], a[96:99]
    s_add_u32 s41, s41, s70
    ds_read_b64_tr_b16 v[52:53], v69 offset:55296
    ds_read_b64_tr_b16 v[54:55], v69 offset:59904
    v_mfma_f32_16x16x32_bf16 a[100:103], v[36:39], a[164:167], a[100:103]
    s_mul_i32 s41, s41, 36864
    v_mfma_f32_16x16x32_bf16 a[100:103], v[32:35], a[148:151], a[100:103]
    s_add_u32 s40, s81, 0
    v_mfma_f32_16x16x32_bf16 a[104:107], v[32:35], a[152:155], a[104:107]
    s_add_u32 m0, s40, 0
    v_mfma_f32_16x16x32_bf16 a[104:107], v[36:39], a[168:171], a[104:107]
    v_mfma_f32_16x16x32_bf16 a[108:111], v[36:39], a[172:175], a[108:111]
    v_mfma_f32_16x16x32_bf16 a[108:111], v[32:35], a[156:159], a[108:111]
    s_waitcnt lgkmcnt(6)
    v_mfma_f32_16x16x32_bf16 a[112:115], v[40:43], a[144:147], a[112:115]
    s_waitcnt lgkmcnt(4)
    ds_read_b64_tr_b16 v[32:33], v69 offset:36872
    ds_read_b64_tr_b16 v[34:35], v69 offset:41480
    v_mfma_f32_16x16x32_bf16 a[112:115], v[44:47], a[160:163], a[112:115]
    buffer_load_dwordx4 v3, s[60:63], s41 offen lds
    v_mfma_f32_16x16x32_bf16 a[116:119], v[44:47], a[164:167], a[116:119]
    s_add_u32 m0, s40, 1024
    ds_read_b64_tr_b16 v[36:37], v69 offset:55304
    ds_read_b64_tr_b16 v[38:39], v69 offset:59912
    v_mfma_f32_16x16x32_bf16 a[116:119], v[40:43], a[148:151], a[116:119]
    v_mfma_f32_16x16x32_bf16 a[120:123], v[40:43], a[152:155], a[120:123]
    v_mfma_f32_16x16x32_bf16 a[120:123], v[44:47], a[168:171], a[120:123]
    v_mfma_f32_16x16x32_bf16 a[124:127], v[44:47], a[172:175], a[124:127]
    buffer_load_dwordx4 v4, s[60:63], s41 offen lds
    v_mfma_f32_16x16x32_bf16 a[124:127], v[40:43], a[156:159], a[124:127]
    s_waitcnt lgkmcnt(6)
    s_add_u32 m0, s40, 2048
    v_mfma_f32_16x16x32_bf16 a[0:3], v[48:51], a[176:179], a[0:3]
    s_waitcnt lgkmcnt(4)
    ds_read_b64_tr_b16 v[40:41], v69 offset:36928
    ds_read_b64_tr_b16 v[42:43], v69 offset:41536
    v_mfma_f32_16x16x32_bf16 a[0:3], v[52:55], a[192:195], a[0:3]
    ds_read_b64_tr_b16 v[44:45], v69 offset:55360
    ds_read_b64_tr_b16 v[46:47], v69 offset:59968
    v_mfma_f32_16x16x32_bf16 a[4:7], v[52:55], a[196:199], a[4:7]
    v_mfma_f32_16x16x32_bf16 a[4:7], v[48:51], a[180:183], a[4:7]
    buffer_load_dwordx4 v5, s[60:63], s41 offen lds
    v_mfma_f32_16x16x32_bf16 a[8:11], v[48:51], a[184:187], a[8:11]
    s_add_u32 m0, s40, 3072
    v_mfma_f32_16x16x32_bf16 a[8:11], v[52:55], a[200:203], a[8:11]
    v_mfma_f32_16x16x32_bf16 a[12:15], v[52:55], a[204:207], a[12:15]
    v_mfma_f32_16x16x32_bf16 a[12:15], v[48:51], a[188:191], a[12:15]
    s_waitcnt lgkmcnt(6)
    v_mfma_f32_16x16x32_bf16 a[16:19], v[32:35], a[176:179], a[16:19]
    s_waitcnt lgkmcnt(4)
    buffer_load_dwordx4 v6, s[60:63], s41 offen lds
    v_mfma_f32_16x16x32_bf16 a[16:19], v[36:39], a[192:195], a[16:19]
    s_waitcnt vmcnt(8)
    ds_read_b64_tr_b16 v[48:49], v69 offset:36936
    ds_read_b64_tr_b16 v[50:51], v69 offset:41544
    v_mfma_f32_16x16x32_bf16 a[20:23], v[36:39], a[196:199], a[20:23]
    s_barrier
    ds_read_b64_tr_b16 v[52:53], v69 offset:55368
    ds_read_b64_tr_b16 v[54:55], v69 offset:59976
    v_mfma_f32_16x16x32_bf16 a[20:23], v[32:35], a[180:183], a[20:23]
    s_add_u32 m0, s40, 4096
    buffer_store_dword v20, v63, s[56:59], s86 offen
    v_mfma_f32_16x16x32_bf16 a[24:27], v[32:35], a[184:187], a[24:27]
    v_mfma_f32_16x16x32_bf16 a[24:27], v[36:39], a[200:203], a[24:27]
    v_mfma_f32_16x16x32_bf16 a[28:31], v[36:39], a[204:207], a[28:31]
    buffer_store_dword v20, v63, s[56:59], s73 offen sc1
    v_mfma_f32_16x16x32_bf16 a[28:31], v[32:35], a[188:191], a[28:31]
    s_waitcnt lgkmcnt(6)
    v_mfma_f32_16x16x32_bf16 a[32:35], v[40:43], a[176:179], a[32:35]
    s_waitcnt lgkmcnt(4)
    ds_read_b64_tr_b16 v[32:33], v69 offset:36992
    ds_read_b64_tr_b16 v[34:35], v69 offset:41600
    v_mfma_f32_16x16x32_bf16 a[32:35], v[44:47], a[192:195], a[32:35]
    buffer_load_dwordx4 v7, s[60:63], s41 offen lds
    v_mfma_f32_16x16x32_bf16 a[36:39], v[44:47], a[196:199], a[36:39]
    s_add_u32 m0, s40, 5120
    ds_read_b64_tr_b16 v[36:37], v69 offset:55424
    ds_read_b64_tr_b16 v[38:39], v69 offset:60032
    v_mfma_f32_16x16x32_bf16 a[36:39], v[40:43], a[180:183], a[36:39]
    v_mfma_f32_16x16x32_bf16 a[40:43], v[40:43], a[184:187], a[40:43]
    buffer_load_dwordx4 v8, s[60:63], s41 offen lds
    v_mfma_f32_16x16x32_bf16 a[40:43], v[44:47], a[200:203], a[40:43]
    s_add_u32 m0, s40, 6144
    v_mfma_f32_16x16x32_bf16 a[44:47], v[44:47], a[204:207], a[44:47]
    v_mfma_f32_16x16x32_bf16 a[44:47], v[40:43], a[188:191], a[44:47]
    s_waitcnt lgkmcnt(6)
    v_mfma_f32_16x16x32_bf16 a[48:51], v[48:51], a[176:179], a[48:51]
    s_waitcnt lgkmcnt(4)
    ds_read_b64_tr_b16 v[40:41], v69 offset:37000
    ds_read_b64_tr_b16 v[42:43], v69 offset:41608
    v_mfma_f32_16x16x32_bf16 a[48:51], v[52:55], a[192:195], a[48:51]
    buffer_load_dwordx4 v9, s[60:63], s41 offen lds
    v_mfma_f32_16x16x32_bf16 a[52:55], v[52:55], a[196:199], a[52:55]
    s_add_u32 m0, s40, 7168
    ds_read_b64_tr_b16 v[44:45], v69 offset:55432
    ds_read_b64_tr_b16 v[46:47], v69 offset:60040
    v_mfma_f32_16x16x32_bf16 a[52:55], v[48:51], a[180:183], a[52:55]
    v_mfma_f32_16x16x32_bf16 a[56:59], v[48:51], a[184:187], a[56:59]
    v_mfma_f32_16x16x32_bf16 a[56:59], v[52:55], a[200:203], a[56:59]
    v_mfma_f32_16x16x32_bf16 a[60:63], v[52:55], a[204:207], a[60:63]
    buffer_load_dwordx4 v10, s[60:63], s41 offen lds
    v_mfma_f32_16x16x32_bf16 a[60:63], v[48:51], a[188:191], a[60:63]
    s_waitcnt lgkmcnt(6)
    s_add_u32 m0, s40, 8192
    v_mfma_f32_16x16x32_bf16 a[64:67], v[32:35], a[176:179], a[64:67]
    s_waitcnt lgkmcnt(4)
    ds_read_b64_tr_b16 v[48:49], v69 offset:37056
    ds_read_b64_tr_b16 v[50:51], v69 offset:41664
    v_mfma_f32_16x16x32_bf16 a[64:67], v[36:39], a[192:195], a[64:67]
    ds_read_b64_tr_b16 v[52:53], v69 offset:55488
    ds_read_b64_tr_b16 v[54:55], v69 offset:60096
    v_mfma_f32_16x16x32_bf16 a[68:71], v[36:39], a[196:199], a[68:71]
    v_mfma_f32_16x16x32_bf16 a[68:71], v[32:35], a[180:183], a[68:71]
    buffer_load_dwordx4 v11, s[60:63], s41 offen lds
    v_mfma_f32_16x16x32_bf16 a[72:75], v[32:35], a[184:187], a[72:75]
    s_lshr_b32 s40, s70, 1
    v_mfma_f32_16x16x32_bf16 a[72:75], v[36:39], a[200:203], a[72:75]
    s_add_u32 s40, s40, 1
    v_mfma_f32_16x16x32_bf16 a[76:79], v[36:39], a[204:207], a[76:79]
    s_add_u32 s41, s72, s40
    v_mfma_f32_16x16x32_bf16 a[76:79], v[32:35], a[188:191], a[76:79]
    s_waitcnt lgkmcnt(6)
    s_and_b32 s41, s41, 3
    v_mfma_f32_16x16x32_bf16 a[80:83], v[40:43], a[176:179], a[80:83]
    s_waitcnt lgkmcnt(4)
    s_mul_i32 s41, s41, 9
    ds_read_b64_tr_b16 v[32:33], v69 offset:37064
    ds_read_b64_tr_b16 v[34:35], v69 offset:41672
    v_mfma_f32_16x16x32_bf16 a[80:83], v[44:47], a[192:195], a[80:83]
    s_add_u32 s41, s41, 1
    ds_read_b64_tr_b16 v[36:37], v69 offset:55496
    ds_read_b64_tr_b16 v[38:39], v69 offset:60104
    v_mfma_f32_16x16x32_bf16 a[84:87], v[44:47], a[196:199], a[84:87]
    s_lshr_b32 s41, s41, 1
    v_mfma_f32_16x16x32_bf16 a[84:87], v[40:43], a[180:183], a[84:87]
    s_and_b32 s40, s70, 1
    v_mfma_f32_16x16x32_bf16 a[88:91], v[40:43], a[184:187], a[88:91]
    s_add_u32 s41, s41, s40
    v_mfma_f32_16x16x32_bf16 a[88:91], v[44:47], a[200:203], a[88:91]
    s_mul_i32 s41, s41, 36864
    v_mfma_f32_16x16x32_bf16 a[92:95], v[44:47], a[204:207], a[92:95]
    s_add_u32 s40, s81, 73728
    v_mfma_f32_16x16x32_bf16 a[92:95], v[40:43], a[188:191], a[92:95]
    s_waitcnt lgkmcnt(6)
    s_add_u32 m0, s40, 0
    v_mfma_f32_16x16x32_bf16 a[96:99], v[48:51], a[176:179], a[96:99]
    s_waitcnt lgkmcnt(4)
    buffer_load_dwordx4 v3, s[60:63], s41 offen lds
    v_mfma_f32_16x16x32_bf16 a[96:99], v[52:55], a[192:195], a[96:99]
    s_add_u32 m0, s40, 1024
    ds_read_b64_tr_b16 v[40:41], v70 offset:36864
    ds_read_b64_tr_b16 v[42:43], v70 offset:41472
    v_mfma_f32_16x16x32_bf16 a[100:103], v[52:55], a[196:199], a[100:103]
    ds_read_b64_tr_b16 v[44:45], v70 offset:55296
    ds_read_b64_tr_b16 v[46:47], v70 offset:59904
    v_mfma_f32_16x16x32_bf16 a[100:103], v[48:51], a[180:183], a[100:103]
    buffer_load_dwordx4 v4, s[60:63], s41 offen lds
    v_mfma_f32_16x16x32_bf16 a[104:107], v[48:51], a[184:187], a[104:107]
    s_add_u32 m0, s40, 2048
    v_mfma_f32_16x16x32_bf16 a[104:107], v[52:55], a[200:203], a[104:107]
    v_mfma_f32_16x16x32_bf16 a[108:111], v[52:55], a[204:207], a[108:111]
    buffer_load_dwordx4 v5, s[60:63], s41 offen lds
    v_mfma_f32_16x16x32_bf16 a[108:111], v[48:51], a[188:191], a[108:111]
    s_waitcnt lgkmcnt(6)
    s_add_u32 m0, s40, 3072
    v_mfma_f32_16x16x32_bf16 a[112:115], v[32:35], a[176:179], a[112:115]
    s_waitcnt lgkmcnt(4)
    ds_read_b64_tr_b16 v[48:49], v70 offset:36872
    ds_read_b64_tr_b16 v[50:51], v70 offset:41480
    v_mfma_f32_16x16x32_bf16 a[112:115], v[36:39], a[192:195], a[112:115]
    buffer_load_dwordx4 v6, s[60:63], s41 offen lds
    v_mfma_f32_16x16x32_bf16 a[116:119], v[36:39], a[196:199], a[116:119]
    s_add_u32 m0, s40, 4096
    ds_read_b64_tr_b16 v[52:53], v70 offset:55304
    ds_read_b64_tr_b16 v[54:55], v70 offset:59912
    v_mfma_f32_16x16x32_bf16 a[116:119], v[32:35], a[180:183], a[116:119]
    v_mfma_f32_16x16x32_bf16 a[120:123], v[32:35], a[184:187], a[120:123]
    v_mfma_f32_16x16x32_bf16 a[120:123], v[36:39], a[200:203], a[120:123]
    v_mfma_f32_16x16x32_bf16 a[124:127], v[36:39], a[204:207], a[124:127]
    buffer_load_dwordx4 v7, s[60:63], s41 offen lds
    v_mfma_f32_16x16x32_bf16 a[124:127], v[32:35], a[188:191], a[124:127]
    s_waitcnt lgkmcnt(6)
    s_add_u32 m0, s40, 5120
    v_mfma_f32_16x16x32_bf16 a[0:3], v[40:43], a[208:211], a[0:3]
    s_waitcnt lgkmcnt(4)
    ds_read_b64_tr_b16 v[32:33], v70 offset:36928
    ds_read_b64_tr_b16 v[34:35], v70 offset:41536
    v_mfma_f32_16x16x32_bf16 a[0:3], v[44:47], a[224:227], a[0:3]
    buffer_load_dword v21, v1, s[56:59], s79 offen offset:0 sc1
    v_mfma_f32_16x16x32_bf16 a[4:7], v[44:47], a[228:231], a[4:7]
    ds_read_b64_tr_b16 v[36:37], v70 offset:55360
    ds_read_b64_tr_b16 v[38:39], v70 offset:59968
    v_mfma_f32_16x16x32_bf16 a[4:7], v[40:43], a[212:215], a[4:7]
    v_mfma_f32_16x16x32_bf16 a[8:11], v[40:43], a[216:219], a[8:11]
    buffer_load_dwordx4 v8, s[60:63], s41 offen lds
    v_mfma_f32_16x16x32_bf16 a[8:11], v[44:47], a[232:235], a[8:11]
    s_add_u32 m0, s40, 6144
    v_mfma_f32_16x16x32_bf16 a[12:15], v[44:47], a[236:239], a[12:15]
    v_mfma_f32_16x16x32_bf16 a[12:15], v[40:43], a[220:223], a[12:15]
    s_waitcnt lgkmcnt(6)
    v_mfma_f32_16x16x32_bf16 a[16:19], v[48:51], a[208:211], a[16:19]
    s_waitcnt lgkmcnt(4)
    ds_read_b64_tr_b16 v[40:41], v70 offset:36936
    ds_read_b64_tr_b16 v[42:43], v70 offset:41544
    v_mfma_f32_16x16x32_bf16 a[16:19], v[52:55], a[224:227], a[16:19]
    buffer_load_dwordx4 v9, s[60:63], s41 offen lds
    v_mfma_f32_16x16x32_bf16 a[20:23], v[52:55], a[228:231], a[20:23]
    s_add_u32 m0, s40, 7168
    ds_read_b64_tr_b16 v[44:45], v70 offset:55368
    ds_read_b64_tr_b16 v[46:47], v70 offset:59976
    v_mfma_f32_16x16x32_bf16 a[20:23], v[48:51], a[212:215], a[20:23]
    v_mfma_f32_16x16x32_bf16 a[24:27], v[48:51], a[216:219], a[24:27]
    v_mfma_f32_16x16x32_bf16 a[24:27], v[52:55], a[232:235], a[24:27]
    v_mfma_f32_16x16x32_bf16 a[28:31], v[52:55], a[236:239], a[28:31]
    buffer_load_dwordx4 v10, s[60:63], s41 offen lds
    v_mfma_f32_16x16x32_bf16 a[28:31], v[48:51], a[220:223], a[28:31]
    s_waitcnt lgkmcnt(6)
    s_add_u32 m0, s40, 8192
    v_mfma_f32_16x16x32_bf16 a[32:35], v[32:35], a[208:211], a[32:35]
    s_waitcnt lgkmcnt(4)
    ds_read_b64_tr_b16 v[48:49], v70 offset:36992
    ds_read_b64_tr_b16 v[50:51], v70 offset:41600
    v_mfma_f32_16x16x32_bf16 a[32:35], v[36:39], a[224:227], a[32:35]
    ds_read_b64_tr_b16 v[52:53], v70 offset:55424
    ds_read_b64_tr_b16 v[54:55], v70 offset:60032
    v_mfma_f32_16x16x32_bf16 a[36:39], v[36:39], a[228:231], a[36:39]
    v_mfma_f32_16x16x32_bf16 a[36:39], v[32:35], a[212:215], a[36:39]
    buffer_load_dwordx4 v11, s[60:63], s41 offen lds
    v_mfma_f32_16x16x32_bf16 a[40:43], v[32:35], a[216:219], a[40:43]
    v_mfma_f32_16x16x32_bf16 a[40:43], v[36:39], a[232:235], a[40:43]
    v_mfma_f32_16x16x32_bf16 a[44:47], v[36:39], a[236:239], a[44:47]
    s_waitcnt vmcnt(4)
    v_cmp_ne_u32 vcc, s22, v21
    s_nop 0
    s_cbranch_vccnz Lspin_ha
Lret_ha:
    v_mfma_f32_16x16x32_bf16 a[44:47], v[32:35], a[220:223], a[44:47]
    s_waitcnt lgkmcnt(6)
    s_add_u32 s42, s72, 1
    v_mfma_f32_16x16x32_bf16 a[48:51], v[40:43], a[208:211], a[48:51]
    s_waitcnt lgkmcnt(4)
    s_and_b32 s42, s42, 3
    ds_read_b64_tr_b16 v[32:33], v70 offset:37000
    ds_read_b64_tr_b16 v[34:35], v70 offset:41608
    v_mfma_f32_16x16x32_bf16 a[48:51], v[44:47], a[224:227], a[48:51]
    s_mul_i32 s42, s42, 9
    ds_read_b64_tr_b16 v[36:37], v70 offset:55432
    ds_read_b64_tr_b16 v[38:39], v70 offset:60040
    v_mfma_f32_16x16x32_bf16 a[52:55], v[44:47], a[228:231], a[52:55]
    s_add_u32 s42, s42, 1
    v_mfma_f32_16x16x32_bf16 a[52:55], v[40:43], a[212:215], a[52:55]
    s_lshr_b32 s42, s42, 1
    v_mfma_f32_16x16x32_bf16 a[56:59], v[40:43], a[216:219], a[56:59]
    s_add_u32 s42, s42, s3
    v_mfma_f32_16x16x32_bf16 a[56:59], v[44:47], a[232:235], a[56:59]
    s_lshl_b32 s42, s42, 17
    buffer_load_dwordx4 a[144:147], v2, s[52:55], s42 offen offset:0 sc1
    v_mfma_f32_16x16x32_bf16 a[60:63], v[44:47], a[236:239], a[60:63]
    v_mfma_f32_16x16x32_bf16 a[60:63], v[40:43], a[220:223], a[60:63]
    s_waitcnt lgkmcnt(6)
    v_mfma_f32_16x16x32_bf16 a[64:67], v[48:51], a[208:211], a[64:67]
    s_waitcnt lgkmcnt(4)
    buffer_load_dwordx4 a[148:151], v2, s[52:55], s42 offen offset:1024 sc1
    v_mfma_f32_16x16x32_bf16 a[64:67], v[52:55], a[224:227], a[64:67]
    ds_read_b64_tr_b16 v[40:41], v70 offset:37056
    ds_read_b64_tr_b16 v[42:43], v70 offset:41664
    v_mfma_f32_16x16x32_bf16 a[68:71], v[52:55], a[228:231], a[68:71]
    ds_read_b64_tr_b16 v[44:45], v70 offset:55488
    ds_read_b64_tr_b16 v[46:47], v70 offset:60096
    v_mfma_f32_16x16x32_bf16 a[68:71], v[48:51], a[212:215], a[68:71]
    buffer_load_dwordx4 a[152:155], v2, s[52:55], s42 offen offset:2048 sc1
    v_mfma_f32_16x16x32_bf16 a[72:75], v[48:51], a[216:219], a[72:75]
    v_mfma_f32_16x16x32_bf16 a[72:75], v[52:55], a[232:235], a[72:75]
    v_mfma_f32_16x16x32_bf16 a[76:79], v[52:55], a[236:239], a[76:79]
    buffer_load_dwordx4 a[156:159], v2, s[52:55], s42 offen offset:3072 sc1
    v_mfma_f32_16x16x32_bf16 a[76:79], v[48:51], a[220:223], a[76:79]
    s_waitcnt lgkmcnt(6)
    s_add_u32 s42, s42, 131072
    v_mfma_f32_16x16x32_bf16 a[80:83], v[32:35], a[208:211], a[80:83]
    s_waitcnt lgkmcnt(4)
    ds_read_b64_tr_b16 v[48:49], v70 offset:37064
    ds_read_b64_tr_b16 v[50:51], v70 offset:41672
    v_mfma_f32_16x16x32_bf16 a[80:83], v[36:39], a[224:227], a[80:83]
    ds_read_b64_tr_b16 v[52:53], v70 offset:55496
    ds_read_b64_tr_b16 v[54:55], v70 offset:60104
    v_mfma_f32_16x16x32_bf16 a[84:87], v[36:39], a[228:231], a[84:87]
    buffer_load_dwordx4 a[160:163], v2, s[52:55], s42 offen offset:0 sc1
    v_mfma_f32_16x16x32_bf16 a[84:87], v[32:35], a[212:215], a[84:87]
    v_mfma_f32_16x16x32_bf16 a[88:91], v[32:35], a[216:219], a[88:91]
    v_mfma_f32_16x16x32_bf16 a[88:91], v[36:39], a[232:235], a[88:91]
    v_mfma_f32_16x16x32_bf16 a[92:95], v[36:39], a[236:239], a[92:95]
    s_waitcnt vmcnt(15)
    v_mfma_f32_16x16x32_bf16 a[92:95], v[32:35], a[220:223], a[92:95]
    s_barrier
    buffer_load_dwordx4 a[164:167], v2, s[52:55], s42 offen offset:1024 sc1
    s_waitcnt lgkmcnt(6)
    v_mfma_f32_16x16x32_bf16 a[96:99], v[40:43], a[208:211], a[96:99]
    s_waitcnt lgkmcnt(4)
    ds_read_b64_tr_b16 v[32:33], v56 offset:0
    ds_read_b64_tr_b16 v[34:35], v56 offset:4608
    v_mfma_f32_16x16x32_bf16 a[96:99], v[44:47], a[224:227], a[96:99]
    ds_read_b64_tr_b16 v[36:37], v56 offset:9216
    ds_read_b64_tr_b16 v[38:39], v56 offset:13824
    v_mfma_f32_16x16x32_bf16 a[100:103], v[44:47], a[228:231], a[100:103]
    v_mfma_f32_16x16x32_bf16 a[100:103], v[40:43], a[212:215], a[100:103]
    buffer_load_dwordx4 a[168:171], v2, s[52:55], s42 offen offset:2048 sc1
    v_mfma_f32_16x16x32_bf16 a[104:107], v[40:43], a[216:219], a[104:107]
    v_mfma_f32_16x16x32_bf16 a[104:107], v[44:47], a[232:235], a[104:107]
    v_mfma_f32_16x16x32_bf16 a[108:111], v[44:47], a[236:239], a[108:111]
    v_mfma_f32_16x16x32_bf16 a[108:111], v[40:43], a[220:223], a[108:111]
    s_waitcnt lgkmcnt(6)
    buffer_load_dwordx4 a[172:175], v2, s[52:55], s42 offen offset:3072 sc1
    v_mfma_f32_16x16x32_bf16 a[112:115], v[48:51], a[208:211], a[112:115]
    s_waitcnt lgkmcnt(4)
    s_add_u32 s91, s91, 131072
    ds_read_b64_tr_b16 v[40:41], v56 offset:32
    ds_read_b64_tr_b16 v[42:43], v56 offset:4640
    v_mfma_f32_16x16x32_bf16 a[112:115], v[52:55], a[224:227], a[112:115]
    ds_read_b64_tr_b16 v[44:45], v56 offset:9248
    ds_read_b64_tr_b16 v[46:47], v56 offset:13856
    v_mfma_f32_16x16x32_bf16 a[116:119], v[52:55], a[228:231], a[116:119]
    v_mfma_f32_16x16x32_bf16 a[116:119], v[48:51], a[212:215], a[116:119]
    v_mfma_f32_16x16x32_bf16 a[120:123], v[48:51], a[216:219], a[120:123]
    buffer_store_dwordx4 v[208:211], v2, s[52:55], s91 offen offset:0 sc1
    v_mfma_f32_16x16x32_bf16 a[120:123], v[52:55], a[232:235], a[120:123]
    v_mfma_f32_16x16x32_bf16 a[124:127], v[52:55], a[236:239], a[124:127]
    v_mfma_f32_16x16x32_bf16 a[124:127], v[48:51], a[220:223], a[124:127]
    s_waitcnt lgkmcnt(6)
    v_mfma_f32_16x16x32_bf16 v[64:67], v[32:35], v[112:115], 0
    s_waitcnt lgkmcnt(4)
    ds_read_b64_tr_b16 v[48:49], v56 offset:64
    ds_read_b64_tr_b16 v[50:51], v56 offset:4672
    v_mfma_f32_16x16x32_bf16 v[64:67], v[36:39], v[144:147], v[64:67]
    ds_read_b64_tr_b16 v[52:53], v56 offset:9280
    ds_read_b64_tr_b16 v[54:55], v56 offset:13888
    v_mfma_f32_16x16x32_bf16 v[68:71], v[36:39], v[148:151], 0
    v_mfma_f32_16x16x32_bf16 v[68:71], v[32:35], v[116:119], v[68:71]
    v_mfma_f32_16x16x32_bf16 v[72:75], v[32:35], v[120:123], 0
    v_mfma_f32_16x16x32_bf16 v[72:75], v[36:39], v[152:155], v[72:75]
    v_mfma_f32_16x16x32_bf16 v[76:79], v[36:39], v[156:159], 0
    v_mfma_f32_16x16x32_bf16 v[76:79], v[32:35], v[124:127], v[76:79]
    s_waitcnt lgkmcnt(6)
    v_mfma_f32_16x16x32_bf16 a[128:131], v[40:43], v[112:115], 0
    s_waitcnt lgkmcnt(4)
    ds_read_b64_tr_b16 v[32:33], v56 offset:96
    ds_read_b64_tr_b16 v[34:35], v56 offset:4704
    v_mfma_f32_16x16x32_bf16 a[128:131], v[44:47], v[144:147], a[128:131]
    ds_read_b64_tr_b16 v[36:37], v56 offset:9312
    ds_read_b64_tr_b16 v[38:39], v56 offset:13920
    v_mfma_f32_16x16x32_bf16 a[132:135], v[44:47], v[148:151], 0
    buffer_store_dwordx4 v[212:215], v2, s[52:55], s91 offen offset:1024 sc1
    v_mfma_f32_16x16x32_bf16 a[132:135], v[40:43], v[116:119], a[132:135]
    v_mfma_f32_16x16x32_bf16 a[136:139], v[40:43], v[120:123], 0
    v_mfma_f32_16x16x32_bf16 a[136:139], v[44:47], v[152:155], a[136:139]
    v_mfma_f32_16x16x32_bf16 a[140:143], v[44:47], v[156:159], 0
    v_mfma_f32_16x16x32_bf16 a[140:143], v[40:43], v[124:127], a[140:143]
    s_waitcnt lgkmcnt(6)
    v_mfma_f32_16x16x32_bf16 v[80:83], v[48:51], v[112:115], 0
    s_waitcnt lgkmcnt(4)
    ds_read_b64_tr_b16 v[40:41], v56 offset:128
    ds_read_b64_tr_b16 v[42:43], v56 offset:4736
    v_mfma_f32_16x16x32_bf16 v[80:83], v[52:55], v[144:147], v[80:83]
    ds_read_b64_tr_b16 v[44:45], v56 offset:9344
    ds_read_b64_tr_b16 v[46:47], v56 offset:13952
    v_mfma_f32_16x16x32_bf16 v[84:87], v[52:55], v[148:151], 0
    v_mfma_f32_16x16x32_bf16 v[84:87], v[48:51], v[116:119], v[84:87]
    v_mfma_f32_16x16x32_bf16 v[88:91], v[48:51], v[120:123], 0
    v_mfma_f32_16x16x32_bf16 v[88:91], v[52:55], v[152:155], v[88:91]
    v_mfma_f32_16x16x32_bf16 v[92:95], v[52:55], v[156:159], 0
    v_mfma_f32_16x16x32_bf16 v[92:95], v[48:51], v[124:127], v[92:95]
    s_waitcnt lgkmcnt(6)
    v_mfma_f32_16x16x32_bf16 v[96:99], v[32:35], v[112:115], 0
    s_waitcnt lgkmcnt(4)
    buffer_store_dwordx4 v[216:219], v2, s[52:55], s91 offen offset:2048 sc1
    v_mfma_f32_16x16x32_bf16 v[96:99], v[36:39], v[144:147], v[96:99]
    ds_read_b64_tr_b16 v[48:49], v56 offset:160
    ds_read_b64_tr_b16 v[50:51], v56 offset:4768
    v_mfma_f32_16x16x32_bf16 v[100:103], v[36:39], v[148:151], 0
    ds_read_b64_tr_b16 v[52:53], v56 offset:9376
    ds_read_b64_tr_b16 v[54:55], v56 offset:13984
    v_mfma_f32_16x16x32_bf16 v[100:103], v[32:35], v[116:119], v[100:103]
    v_mfma_f32_16x16x32_bf16 v[104:107], v[32:35], v[120:123], 0
    v_mfma_f32_16x16x32_bf16 v[104:107], v[36:39], v[152:155], v[104:107]
    v_mfma_f32_16x16x32_bf16 v[108:111], v[36:39], v[156:159], 0
    v_mfma_f32_16x16x32_bf16 v[108:111], v[32:35], v[124:127], v[108:111]
    s_waitcnt lgkmcnt(6)
    v_mfma_f32_16x16x32_bf16 v[128:131], v[40:43], v[112:115], 0
    s_waitcnt lgkmcnt(4)
    ds_read_b64_tr_b16 v[32:33], v56 offset:192
    ds_read_b64_tr_b16 v[34:35], v56 offset:4800
    v_mfma_f32_16x16x32_bf16 v[128:131], v[44:47], v[144:147], v[128:131]
    ds_read_b64_tr_b16 v[36:37], v56 offset:9408
    ds_read_b64_tr_b16 v[38:39], v56 offset:14016
    v_mfma_f32_16x16x32_bf16 v[132:135], v[44:47], v[148:151], 0
    v_mfma_f32_16x16x32_bf16 v[132:135], v[40:43], v[116:119], v[132:135]
    v_mfma_f32_16x16x32_bf16 v[136:139], v[40:43], v[120:123], 0
    v_mfma_f32_16x16x32_bf16 v[136:139], v[44:47], v[152:155], v[136:139]
    v_mfma_f32_16x16x32_bf16 v[140:143], v[44:47], v[156:159], 0
    buffer_store_dwordx4 v[220:223], v2, s[52:55], s91 offen offset:3072 sc1
    v_mfma_f32_16x16x32_bf16 v[140:143], v[40:43], v[124:127], v[140:143]
    s_waitcnt lgkmcnt(6)
    v_mfma_f32_16x16x32_bf16 v[160:163], v[48:51], v[112:115], 0
    s_waitcnt lgkmcnt(4)
    ds_read_b64_tr_b16 v[40:41], v56 offset:224
    ds_read_b64_tr_b16 v[42:43], v56 offset:4832
    v_mfma_f32_16x16x32_bf16 v[160:163], v[52:55], v[144:147], v[160:163]
    ds_read_b64_tr_b16 v[44:45], v56 offset:9440
    ds_read_b64_tr_b16 v[46:47], v56 offset:14048
    v_mfma_f32_16x16x32_bf16 v[164:167], v[52:55], v[148:151], 0
    v_mfma_f32_16x16x32_bf16 v[164:167], v[48:51], v[116:119], v[164:167]
    v_mfma_f32_16x16x32_bf16 v[168:171], v[48:51], v[120:123], 0
    v_mfma_f32_16x16x32_bf16 v[168:171], v[52:55], v[152:155], v[168:171]
    v_mfma_f32_16x16x32_bf16 v[172:175], v[52:55], v[156:159], 0
    v_mfma_f32_16x16x32_bf16 v[172:175], v[48:51], v[124:127], v[172:175]
    s_waitcnt lgkmcnt(6)
    v_mfma_f32_16x16x32_bf16 v[192:195], v[32:35], v[112:115], 0
    s_waitcnt lgkmcnt(4)
    ds_read_b64_tr_b16 v[48:49], v56 offset:256
    ds_read_b64_tr_b16 v[50:51], v56 offset:4864
    v_mfma_f32_16x16x32_bf16 v[192:195], v[36:39], v[144:147], v[192:195]
    ds_read_b64_tr_b16 v[52:53], v56 offset:9472
    ds_read_b64_tr_b16 v[54:55], v56 offset:14080
    v_mfma_f32_16x16x32_bf16 v[196:199], v[36:39], v[148:151], 0
    v_mfma_f32_16x16x32_bf16 v[196:199], v[32:35], v[116:119], v[196:199]
    v_mfma_f32_16x16x32_bf16 v[200:203], v[32:35], v[120:123], 0
    buffer_store_dwordx2 v[24:25], v19, s[52:55], s26 offen offset:0 sc1
    v_mfma_f32_16x16x32_bf16 v[200:203], v[36:39], v[152:155], v[200:203]
    v_mfma_f32_16x16x32_bf16 v[204:207], v[36:39], v[156:159], 0
    v_mfma_f32_16x16x32_bf16 v[204:207], v[32:35], v[124:127], v[204:207]
    s_waitcnt lgkmcnt(6)
    v_mfma_f32_16x16x32_bf16 v[224:227], v[40:43], v[112:115], 0
    s_waitcnt lgkmcnt(4)
    ds_read_b64_tr_b16 v[32:33], v56 offset:18432
    ds_read_b64_tr_b16 v[34:35], v56 offset:23040
    v_mfma_f32_16x16x32_bf16 v[224:227], v[44:47], v[144:147], v[224:227]
    ds_read_b64_tr_b16 v[36:37], v56 offset:27648
    ds_read_b64_tr_b16 v[38:39], v56 offset:32256
    v_mfma_f32_16x16x32_bf16 v[228:231], v[44:47], v[148:151], 0
    v_mfma_f32_16x16x32_bf16 v[228:231], v[40:43], v[116:119], v[228:231]
    v_mfma_f32_16x16x32_bf16 v[232:235], v[40:43], v[120:123], 0
    v_mfma_f32_16x16x32_bf16 v[232:235], v[44:47], v[152:155], v[232:235]
    v_mfma_f32_16x16x32_bf16 v[236:239], v[44:47], v[156:159], 0
    buffer_store_dwordx2 v[26:27], v19, s[52:55], s26 offen offset:512 sc1
    v_mfma_f32_16x16x32_bf16 v[236:239], v[40:43], v[124:127], v[236:239]
    s_waitcnt lgkmcnt(6)
    v_mfma_f32_16x16x32_bf16 v[240:243], v[48:51], v[112:115], 0
    s_waitcnt lgkmcnt(4)
    ds_read_b64_tr_b16 v[40:41], v56 offset:18464
    ds_read_b64_tr_b16 v[42:43], v56 offset:23072
    v_mfma_f32_16x16x32_bf16 v[240:243], v[52:55], v[144:147], v[240:243]
    ds_read_b64_tr_b16 v[44:45], v56 offset:27680
    ds_read_b64_tr_b16 v[46:47], v56 offset:32288
    v_mfma_f32_16x16x32_bf16 v[244:247], v[52:55], v[148:151], 0
    v_mfma_f32_16x16x32_bf16 v[244:247], v[48:51], v[116:119], v[244:247]
    v_mfma_f32_16x16x32_bf16 v[248:251], v[48:51], v[120:123], 0
    v_mfma_f32_16x16x32_bf16 v[248:251], v[52:55], v[152:155], v[248:251]
    v_mfma_f32_16x16x32_bf16 v[252:255], v[52:55], v[156:159], 0
    v_mfma_f32_16x16x32_bf16 v[252:255], v[48:51], v[124:127], v[252:255]
    s_waitcnt lgkmcnt(6)
    buffer_store_dwordx2 v[28:29], v19, s[52:55], s26 offen offset:1024 sc1
    v_mfma_f32_16x16x32_bf16 v[64:67], v[32:35], v[176:179], v[64:67]
    s_waitcnt lgkmcnt(4)
    ds_read_b64_tr_b16 v[48:49], v56 offset:18496
    ds_read_b64_tr_b16 v[50:51], v56 offset:23104
    v_mfma_f32_16x16x32_bf16 v[64:67], v[36:39], v[208:211], v[64:67]
    ds_read_b64_tr_b16 v[52:53], v56 offset:27712
    ds_read_b64_tr_b16 v[54:55], v56 offset:32320
    v_mfma_f32_16x16x32_bf16 v[68:71], v[36:39], v[212:215], v[68:71]
    v_mfma_f32_16x16x32_bf16 v[68:71], v[32:35], v[180:183], v[68:71]
    v_mfma_f32_16x16x32_bf16 v[72:75], v[32:35], v[184:187], v[72:75]
    v_mfma_f32_16x16x32_bf16 v[72:75], v[36:39], v[216:219], v[72:75]
    v_mfma_f32_16x16x32_bf16 v[76:79], v[36:39], v[220:223], v[76:79]
    v_mfma_f32_16x16x32_bf16 v[76:79], v[32:35], v[188:191], v[76:79]
    s_waitcnt lgkmcnt(6)
    v_mfma_f32_16x16x32_bf16 a[128:131], v[40:43], v[176:179], a[128:131]
    s_waitcnt lgkmcnt(4)
    ds_read_b64_tr_b16 v[32:33], v56 offset:18528
    ds_read_b64_tr_b16 v[34:35], v56 offset:23136
    v_mfma_f32_16x16x32_bf16 a[128:131], v[44:47], v[208:211], a[128:131]
    buffer_store_dwordx2 v[30:31], v19, s[52:55], s26 offen offset:1536 sc1
    v_mfma_f32_16x16x32_bf16 a[132:135], v[44:47], v[212:215], a[132:135]
    s_add_u32 s42, s72, 2
    ds_read_b64_tr_b16 v[36:37], v56 offset:27744
    ds_read_b64_tr_b16 v[38:39], v56 offset:32352
    v_mfma_f32_16x16x32_bf16 a[132:135], v[40:43], v[180:183], a[132:135]
    s_and_b32 s42, s42, 3
    v_mfma_f32_16x16x32_bf16 a[136:139], v[40:43], v[184:187], a[136:139]
    s_mul_i32 s42, s42, 9
    v_mfma_f32_16x16x32_bf16 a[136:139], v[44:47], v[216:219], a[136:139]
    s_add_u32 s42, s42, 1
    v_mfma_f32_16x16x32_bf16 a[140:143], v[44:47], v[220:223], a[140:143]
    s_lshr_b32 s42, s42, 1
    v_mfma_f32_16x16x32_bf16 a[140:143], v[40:43], v[188:191], a[140:143]
    s_waitcnt lgkmcnt(6)
    s_add_u32 s42, s42, s3
    v_mfma_f32_16x16x32_bf16 v[80:83], v[48:51], v[176:179], v[80:83]
    s_waitcnt lgkmcnt(4)
    s_lshl_b32 s42, s42, 17
    ds_read_b64_tr_b16 v[40:41], v56 offset:18560
    ds_read_b64_tr_b16 v[42:43], v56 offset:23168
    v_mfma_f32_16x16x32_bf16 v[80:83], v[52:55], v[208:211], v[80:83]
Lpad5:
    s_cbranch_execz Lpad7
    ds_read_b64_tr_b16 v[44:45], v56 offset:27776
    ds_read_b64_tr_b16 v[46:47], v56 offset:32384
    v_mfma_f32_16x16x32_bf16 v[84:87], v[52:55], v[212:215], v[84:87]
    v_mfma_f32_16x16x32_bf16 v[84:87], v[48:51], v[180:183], v[84:87]
    buffer_load_dwordx4 a[176:179], v2, s[52:55], s42 offen offset:0 sc1
    v_mfma_f32_16x16x32_bf16 v[88:91], v[48:51], v[184:187], v[88:91]
    v_mfma_f32_16x16x32_bf16 v[88:91], v[52:55], v[216:219], v[88:91]
    v_mfma_f32_16x16x32_bf16 v[92:95], v[52:55], v[220:223], v[92:95]
    v_mfma_f32_16x16x32_bf16 v[92:95], v[48:51], v[188:191], v[92:95]
    s_waitcnt lgkmcnt(6)
    buffer_load_dwordx4 a[180:183], v2, s[52:55], s42 offen offset:1024 sc1
    v_mfma_f32_16x16x32_bf16 v[96:99], v[32:35], v[176:179], v[96:99]
    s_waitcnt lgkmcnt(4)
    ds_read_b64_tr_b16 v[48:49], v56 offset:18592
    ds_read_b64_tr_b16 v[50:51], v56 offset:23200
    v_mfma_f32_16x16x32_bf16 v[96:99], v[36:39], v[208:211], v[96:99]
    ds_read_b64_tr_b16 v[52:53], v56 offset:27808
    ds_read_b64_tr_b16 v[54:55], v56 offset:32416
    v_mfma_f32_16x16x32_bf16 v[100:103], v[36:39], v[212:215], v[100:103]
    v_mfma_f32_16x16x32_bf16 v[100:103], v[32:35], v[180:183], v[100:103]
    v_mfma_f32_16x16x32_bf16 v[104:107], v[32:35], v[184:187], v[104:107]
    buffer_load_dwordx4 a[184:187], v2, s[52:55], s42 offen offset:2048 sc1
    v_mfma_f32_16x16x32_bf16 v[104:107], v[36:39], v[216:219], v[104:107]
    v_mfma_f32_16x16x32_bf16 v[108:111], v[36:39], v[220:223], v[108:111]
    v_mfma_f32_16x16x32_bf16 v[108:111], v[32:35], v[188:191], v[108:111]
    s_waitcnt lgkmcnt(6)
    v_mfma_f32_16x16x32_bf16 v[128:131], v[40:43], v[176:179], v[128:131]
    s_waitcnt lgkmcnt(4)
    ds_read_b64_tr_b16 v[32:33], v56 offset:18624
    ds_read_b64_tr_b16 v[34:35], v56 offset:23232
    v_mfma_f32_16x16x32_bf16 v[128:131], v[44:47], v[208:211], v[128:131]
    ds_read_b64_tr_b16 v[36:37], v56 offset:27840
    ds_read_b64_tr_b16 v[38:39], v56 offset:32448
    v_mfma_f32_16x16x32_bf16 v[132:135], v[44:47], v[212:215], v[132:135]
    buffer_load_dwordx4 a[188:191], v2, s[52:55], s42 offen offset:3072 sc1
    v_mfma_f32_16x16x32_bf16 v[132:135], v[40:43], v[180:183], v[132:135]
    s_add_u32 s42, s42, 131072
    v_mfma_f32_16x16x32_bf16 v[136:139], v[40:43], v[184:187], v[136:139]
    v_mfma_f32_16x16x32_bf16 v[136:139], v[44:47], v[216:219], v[136:139]
    buffer_load_dwordx4 a[192:195], v2, s[52:55], s42 offen offset:0 sc1
    v_mfma_f32_16x16x32_bf16 v[140:143], v[44:47], v[220:223], v[140:143]
    v_mfma_f32_16x16x32_bf16 v[140:143], v[40:43], v[188:191], v[140:143]
    s_waitcnt lgkmcnt(6)
    v_mfma_f32_16x16x32_bf16 v[160:163], v[48:51], v[176:179], v[160:163]
    s_waitcnt lgkmcnt(4)
    ds_read_b64_tr_b16 v[40:41], v56 offset:18656
    ds_read_b64_tr_b16 v[42:43], v56 offset:23264
    v_mfma_f32_16x16x32_bf16 v[160:163], v[52:55], v[208:211], v[160:163]
    ds_read_b64_tr_b16 v[44:45], v56 offset:27872
    ds_read_b64_tr_b16 v[46:47], v56 offset:32480
    v_mfma_f32_16x16x32_bf16 v[164:167], v[52:55], v[212:215], v[164:167]
    buffer_load_dwordx4 a[196:199], v2, s[52:55], s42 offen offset:1024 sc1
    v_mfma_f32_16x16x32_bf16 v[164:167], v[48:51], v[180:183], v[164:167]
    v_mfma_f32_16x16x32_bf16 v[168:171], v[48:51], v[184:187], v[168:171]
    v_mfma_f32_16x16x32_bf16 v[168:171], v[52:55], v[216:219], v[168:171]
    buffer_load_dwordx4 a[200:203], v2, s[52:55], s42 offen offset:2048 sc1
    v_mfma_f32_16x16x32_bf16 v[172:175], v[52:55], v[220:223], v[172:175]
    v_mfma_f32_16x16x32_bf16 v[172:175], v[48:51], v[188:191], v[172:175]
    s_waitcnt lgkmcnt(6)
    v_mfma_f32_16x16x32_bf16 v[192:195], v[32:35], v[176:179], v[192:195]
    s_waitcnt lgkmcnt(4)
    ds_read_b64_tr_b16 v[48:49], v56 offset:18688
    ds_read_b64_tr_b16 v[50:51], v56 offset:23296
    v_mfma_f32_16x16x32_bf16 v[192:195], v[36:39], v[208:211], v[192:195]
    ds_read_b64_tr_b16 v[52:53], v56 offset:27904
    ds_read_b64_tr_b16 v[54:55], v56 offset:32512
    v_mfma_f32_16x16x32_bf16 v[196:199], v[36:39], v[212:215], v[196:199]
    buffer_load_dwordx4 a[204:207], v2, s[52:55], s42 offen offset:3072 sc1
    v_mfma_f32_16x16x32_bf16 v[196:199], v[32:35], v[180:183], v[196:199]
    s_add_u32 s42, s72, 3
    v_mfma_f32_16x16x32_bf16 v[200:203], v[32:35], v[184:187], v[200:203]
    s_and_b32 s42, s42, 3
    v_mfma_f32_16x16x32_bf16 v[200:203], v[36:39], v[216:219], v[200:203]
    s_mul_i32 s42, s42, 9
    v_mfma_f32_16x16x32_bf16 v[204:207], v[36:39], v[220:223], v[204:207]
    s_waitcnt vmcnt(24)
    v_mfma_f32_16x16x32_bf16 v[204:207], v[32:35], v[188:191], v[204:207]
    s_barrier
    s_waitcnt lgkmcnt(6)
    v_mfma_f32_16x16x32_bf16 v[224:227], v[40:43], v[176:179], v[224:227]
    s_waitcnt lgkmcnt(4)
    s_add_u32 s42, s42, 1
    ds_read_b64_tr_b16 v[32:33], v57 offset:18432
    ds_read_b64_tr_b16 v[34:35], v57 offset:23040
    v_mfma_f32_16x16x32_bf16 v[224:227], v[44:47], v[208:211], v[224:227]
    s_lshr_b32 s42, s42, 1
    ds_read_b64_tr_b16 v[36:37], v57 offset:27648
    ds_read_b64_tr_b16 v[38:39], v57 offset:32256
    v_mfma_f32_16x16x32_bf16 v[228:231], v[44:47], v[212:215], v[228:231]
    s_add_u32 s42, s42, s3
    v_mfma_f32_16x16x32_bf16 v[228:231], v[40:43], v[180:183], v[228:231]
    s_lshl_b32 s42, s42, 17
    buffer_load_dwordx4 a[208:211], v2, s[52:55], s42 offen offset:0 sc1
    v_mfma_f32_16x16x32_bf16 v[232:235], v[40:43], v[184:187], v[232:235]
    v_mfma_f32_16x16x32_bf16 v[232:235], v[44:47], v[216:219], v[232:235]
    v_mfma_f32_16x16x32_bf16 v[236:239], v[44:47], v[220:223], v[236:239]
    buffer_load_dwordx4 a[212:215], v2, s[52:55], s42 offen offset:1024 sc1
    v_mfma_f32_16x16x32_bf16 v[236:239], v[40:43], v[188:191], v[236:239]
    s_waitcnt lgkmcnt(6)
    v_mfma_f32_16x16x32_bf16 v[240:243], v[48:51], v[176:179], v[240:243]
    s_waitcnt lgkmcnt(4)
    ds_read_b64_tr_b16 v[40:41], v57 offset:18464
    ds_read_b64_tr_b16 v[42:43], v57 offset:23072
    v_mfma_f32_16x16x32_bf16 v[240:243], v[52:55], v[208:211], v[240:243]
    buffer_load_dwordx4 a[216:219], v2, s[52:55], s42 offen offset:2048 sc1
    v_mfma_f32_16x16x32_bf16 v[244:247], v[52:55], v[212:215], v[244:247]
    ds_read_b64_tr_b16 v[44:45], v57 offset:27680
    ds_read_b64_tr_b16 v[46:47], v57 offset:32288
    v_mfma_f32_16x16x32_bf16 v[244:247], v[48:51], v[180:183], v[244:247]
    s_waitcnt vmcnt(11)
    v_mfma_f32_16x16x32_bf16 v[248:251], v[48:51], v[184:187], v[248:251]
    s_barrier
    buffer_load_dwordx4 a[220:223], v2, s[52:55], s42 offen offset:3072 sc1
    v_mfma_f32_16x16x32_bf16 v[248:251], v[52:55], v[216:219], v[248:251]
    s_add_u32 s42, s42, 131072
    v_accvgpr_read_b32 v112, a0
    v_accvgpr_read_b32 v113, a1
    v_mfma_f32_16x16x32_bf16 v[252:255], v[52:55], v[220:223], v[252:255]
    v_cvt_pk_bf16_f32 v112, v112, v113
    v_accvgpr_read_b32 v113, a2
    v_mfma_f32_16x16x32_bf16 v[252:255], v[48:51], v[188:191], v[252:255]
    s_waitcnt lgkmcnt(6)
    buffer_store_dword v20, v63, s[56:59], s86 offen offset:64
    v_mfma_f32_16x16x32_bf16 v[64:67], v[32:35], a[144:147], v[64:67]
    s_waitcnt lgkmcnt(4)
    v_accvgpr_read_b32 v114, a3
    v_cvt_pk_bf16_f32 v113, v113, v114
    v_mfma_f32_16x16x32_bf16 v[64:67], v[36:39], a[160:163], v[64:67]
    v_accvgpr_read_b32 v114, a16
    v_accvgpr_read_b32 v115, a17
    v_mfma_f32_16x16x32_bf16 v[68:71], v[36:39], a[164:167], v[68:71]
    buffer_load_dwordx4 a[224:227], v2, s[52:55], s42 offen offset:0 sc1
    v_mfma_f32_16x16x32_bf16 v[68:71], v[32:35], a[148:151], v[68:71]
    ds_read_b64_tr_b16 v[48:49], v57 offset:18496
    v_cvt_pk_bf16_f32 v114, v114, v115
    v_mfma_f32_16x16x32_bf16 v[72:75], v[32:35], a[152:155], v[72:75]
    ds_read_b64_tr_b16 v[50:51], v57 offset:23104
    v_accvgpr_read_b32 v115, a18
    v_mfma_f32_16x16x32_bf16 v[72:75], v[36:39], a[168:171], v[72:75]
    buffer_load_dwordx4 a[228:231], v2, s[52:55], s42 offen offset:1024 sc1
    v_mfma_f32_16x16x32_bf16 v[76:79], v[36:39], a[172:175], v[76:79]
    ds_read_b64_tr_b16 v[52:53], v57 offset:27712
    ds_read_b64_tr_b16 v[54:55], v57 offset:32320
    v_mfma_f32_16x16x32_bf16 v[76:79], v[32:35], a[156:159], v[76:79]
    s_waitcnt lgkmcnt(6)
    v_accvgpr_read_b32 v22, a19
    v_cvt_pk_bf16_f32 v115, v115, v22
    v_mfma_f32_16x16x32_bf16 a[128:131], v[40:43], a[144:147], a[128:131]
    s_waitcnt lgkmcnt(4)
    buffer_store_dword v20, v63, s[56:59], s73 offen offset:64 sc1
    v_mfma_f32_16x16x32_bf16 a[128:131], v[44:47], a[160:163], a[128:131]
    v_accvgpr_read_b32 v116, a4
    v_accvgpr_read_b32 v117, a5
    v_mfma_f32_16x16x32_bf16 a[132:135], v[44:47], a[164:167], a[132:135]
    v_cvt_pk_bf16_f32 v116, v116, v117
    v_accvgpr_read_b32 v117, a6
    v_mfma_f32_16x16x32_bf16 a[132:135], v[40:43], a[148:151], a[132:135]
    buffer_load_dwordx4 a[232:235], v2, s[52:55], s42 offen offset:2048 sc1
    v_mfma_f32_16x16x32_bf16 a[136:139], v[40:43], a[152:155], a[136:139]
    v_accvgpr_read_b32 v118, a7
    v_cvt_pk_bf16_f32 v117, v117, v118
    v_mfma_f32_16x16x32_bf16 a[136:139], v[44:47], a[168:171], a[136:139]
    ds_read_b64_tr_b16 v[32:33], v57 offset:18528
    ds_read_b64_tr_b16 v[34:35], v57 offset:23136
    v_mfma_f32_16x16x32_bf16 a[140:143], v[44:47], a[172:175], a[140:143]
    ds_read_b64_tr_b16 v[36:37], v57 offset:27744
    v_accvgpr_read_b32 v118, a20
    v_mfma_f32_16x16x32_bf16 a[140:143], v[40:43], a[156:159], a[140:143]
    s_waitcnt lgkmcnt(5)
    buffer_load_dwordx4 a[236:239], v2, s[52:55], s42 offen offset:3072 sc1
    v_mfma_f32_16x16x32_bf16 v[80:83], v[48:51], a[144:147], v[80:83]
    s_waitcnt lgkmcnt(3)
    s_cmp_ge_u32 s70, 2
    s_cselect_b32 s40, 1, 3
    ds_read_b64_tr_b16 v[38:39], v57 offset:32352
    v_mfma_f32_16x16x32_bf16 v[80:83], v[52:55], a[160:163], v[80:83]
    s_add_u32 s41, s72, s40
    v_accvgpr_read_b32 v119, a21
    v_cvt_pk_bf16_f32 v118, v118, v119
    v_mfma_f32_16x16x32_bf16 v[84:87], v[52:55], a[164:167], v[84:87]
    s_and_b32 s41, s41, 3
    v_accvgpr_read_b32 v119, a22
    v_accvgpr_read_b32 v22, a23
    v_mfma_f32_16x16x32_bf16 v[84:87], v[48:51], a[148:151], v[84:87]
    s_mul_i32 s41, s41, 9
    v_cvt_pk_bf16_f32 v119, v119, v22
    v_accvgpr_read_b32 v120, a8
    v_mfma_f32_16x16x32_bf16 v[88:91], v[48:51], a[152:155], v[88:91]
    s_add_u32 s41, s41, 1
    v_accvgpr_read_b32 v121, a9
    v_cvt_pk_bf16_f32 v120, v120, v121
    v_mfma_f32_16x16x32_bf16 v[88:91], v[52:55], a[168:171], v[88:91]
    s_lshr_b32 s41, s41, 1
    ds_read_b64_tr_b16 v[40:41], v57 offset:18560
    ds_read_b64_tr_b16 v[42:43], v57 offset:23168
    v_mfma_f32_16x16x32_bf16 v[92:95], v[52:55], a[172:175], v[92:95]
    s_add_u32 s41, s41, s70
    ds_read_b64_tr_b16 v[44:45], v57 offset:27776
    v_accvgpr_read_b32 v121, a10
    v_mfma_f32_16x16x32_bf16 v[92:95], v[48:51], a[156:159], v[92:95]
    s_waitcnt lgkmcnt(5)
    s_mul_i32 s41, s41, 36864
    ds_read_b64_tr_b16 v[46:47], v57 offset:32384
    v_accvgpr_read_b32 v122, a11
    v_mfma_f32_16x16x32_bf16 v[96:99], v[32:35], a[144:147], v[96:99]
    s_waitcnt lgkmcnt(4)
    s_add_u32 s40, s81, 110592
    v_cvt_pk_bf16_f32 v121, v121, v122
    v_accvgpr_read_b32 v122, a24
    v_mfma_f32_16x16x32_bf16 v[96:99], v[36:39], a[160:163], v[96:99]
    s_add_u32 m0, s40, 0
    v_accvgpr_read_b32 v123, a25
    v_cvt_pk_bf16_f32 v122, v122, v123
    v_mfma_f32_16x16x32_bf16 v[100:103], v[36:39], a[164:167], v[100:103]
    buffer_load_dwordx4 v3, s[60:63], s41 offen lds
    v_mfma_f32_16x16x32_bf16 v[100:103], v[32:35], a[148:151], v[100:103]
    s_add_u32 m0, s40, 1024
    v_accvgpr_read_b32 v123, a26
    v_accvgpr_read_b32 v22, a27
    v_mfma_f32_16x16x32_bf16 v[104:107], v[32:35], a[152:155], v[104:107]
    ds_read_b64_tr_b16 v[48:49], v57 offset:18592
    ds_read_b64_tr_b16 v[50:51], v57 offset:23200
    v_mfma_f32_16x16x32_bf16 v[104:107], v[36:39], a[168:171], v[104:107]
    buffer_load_dwordx4 v4, s[60:63], s41 offen lds
    v_mfma_f32_16x16x32_bf16 v[108:111], v[36:39], a[172:175], v[108:111]
    s_add_u32 m0, s40, 2048
    v_cvt_pk_bf16_f32 v123, v123, v22
    v_accvgpr_read_b32 v124, a12
    v_mfma_f32_16x16x32_bf16 v[108:111], v[32:35], a[156:159], v[108:111]
    s_waitcnt lgkmcnt(4)
    ds_read_b64_tr_b16 v[52:53], v57 offset:27808
    ds_read_b64_tr_b16 v[54:55], v57 offset:32416
    v_mfma_f32_16x16x32_bf16 v[128:131], v[40:43], a[144:147], v[128:131]
    s_waitcnt lgkmcnt(4)
    buffer_load_dwordx4 v5, s[60:63], s41 offen lds
    v_mfma_f32_16x16x32_bf16 v[128:131], v[44:47], a[160:163], v[128:131]
    s_add_u32 m0, s40, 3072
    v_accvgpr_read_b32 v125, a13
    v_cvt_pk_bf16_f32 v124, v124, v125
    v_mfma_f32_16x16x32_bf16 v[132:135], v[44:47], a[164:167], v[132:135]
    v_accvgpr_read_b32 v125, a14
    v_accvgpr_read_b32 v126, a15
    v_mfma_f32_16x16x32_bf16 v[132:135], v[40:43], a[148:151], v[132:135]
    buffer_load_dwordx4 v6, s[60:63], s41 offen lds
    v_mfma_f32_16x16x32_bf16 v[136:139], v[40:43], a[152:155], v[136:139]
    s_add_u32 m0, s40, 4096
    v_cvt_pk_bf16_f32 v125, v125, v126
    v_accvgpr_read_b32 v126, a28
    v_mfma_f32_16x16x32_bf16 v[136:139], v[44:47], a[168:171], v[136:139]
    ds_read_b64_tr_b16 v[32:33], v57 offset:18624
    v_accvgpr_read_b32 v127, a29
    v_mfma_f32_16x16x32_bf16 v[140:143], v[44:47], a[172:175], v[140:143]
    ds_read_b64_tr_b16 v[34:35], v57 offset:23232
    v_cvt_pk_bf16_f32 v126, v126, v127
    v_mfma_f32_16x16x32_bf16 v[140:143], v[40:43], a[156:159], v[140:143]
    s_waitcnt lgkmcnt(4)
    ds_read_b64_tr_b16 v[36:37], v57 offset:27840
    ds_read_b64_tr_b16 v[38:39], v57 offset:32448
    v_mfma_f32_16x16x32_bf16 v[160:163], v[48:51], a[144:147], v[160:163]
    s_waitcnt lgkmcnt(4)
    buffer_load_dwordx4 v7, s[60:63], s41 offen lds
    v_mfma_f32_16x16x32_bf16 v[160:163], v[52:55], a[160:163], v[160:163]
    s_add_u32 m0, s40, 5120
    v_accvgpr_read_b32 v127, a30
    v_accvgpr_read_b32 v22, a31
    v_mfma_f32_16x16x32_bf16 v[164:167], v[52:55], a[164:167], v[164:167]
    v_cvt_pk_bf16_f32 v127, v127, v22
    v_accvgpr_read_b32 v144, a32
    v_mfma_f32_16x16x32_bf16 v[164:167], v[48:51], a[148:151], v[164:167]
    v_accvgpr_read_b32 v145, a33
    v_cvt_pk_bf16_f32 v144, v144, v145
    v_mfma_f32_16x16x32_bf16 v[168:171], v[48:51], a[152:155], v[168:171]
    v_accvgpr_read_b32 v145, a34
    v_accvgpr_read_b32 v146, a35
    v_mfma_f32_16x16x32_bf16 v[168:171], v[52:55], a[168:171], v[168:171]
    ds_read_b64_tr_b16 v[40:41], v57 offset:18656
    ds_read_b64_tr_b16 v[42:43], v57 offset:23264
    v_mfma_f32_16x16x32_bf16 v[172:175], v[52:55], a[172:175], v[172:175]
    buffer_load_dwordx4 v8, s[60:63], s41 offen lds
    v_mfma_f32_16x16x32_bf16 v[172:175], v[48:51], a[156:159], v[172:175]
    s_waitcnt lgkmcnt(4)
    s_add_u32 m0, s40, 6144
    ds_read_b64_tr_b16 v[44:45], v57 offset:27872
    v_cvt_pk_bf16_f32 v145, v145, v146
    v_mfma_f32_16x16x32_bf16 v[192:195], v[32:35], a[144:147], v[192:195]
    s_waitcnt lgkmcnt(3)
    ds_read_b64_tr_b16 v[46:47], v57 offset:32480
    v_accvgpr_read_b32 v146, a48
    v_mfma_f32_16x16x32_bf16 v[192:195], v[36:39], a[160:163], v[192:195]
    v_accvgpr_read_b32 v147, a49
    v_cvt_pk_bf16_f32 v146, v146, v147
    v_mfma_f32_16x16x32_bf16 v[196:199], v[36:39], a[164:167], v[196:199]
    buffer_load_dwordx4 v9, s[60:63], s41 offen lds
    v_mfma_f32_16x16x32_bf16 v[196:199], v[32:35], a[148:151], v[196:199]
    s_add_u32 m0, s40, 7168
    v_accvgpr_read_b32 v147, a50
    v_accvgpr_read_b32 v22, a51
    v_mfma_f32_16x16x32_bf16 v[200:203], v[32:35], a[152:155], v[200:203]
    v_cvt_pk_bf16_f32 v147, v147, v22
    v_accvgpr_read_b32 v148, a36
    v_mfma_f32_16x16x32_bf16 v[200:203], v[36:39], a[168:171], v[200:203]
    ds_read_b64_tr_b16 v[48:49], v57 offset:18688
    v_accvgpr_read_b32 v149, a37
    v_mfma_f32_16x16x32_bf16 v[204:207], v[36:39], a[172:175], v[204:207]
    ds_read_b64_tr_b16 v[50:51], v57 offset:23296
    v_cvt_pk_bf16_f32 v148, v148, v149
    v_mfma_f32_16x16x32_bf16 v[204:207], v[32:35], a[156:159], v[204:207]
    s_waitcnt lgkmcnt(4)
    ds_read_b64_tr_b16 v[52:53], v57 offset:27904
    ds_read_b64_tr_b16 v[54:55], v57 offset:32512
    v_mfma_f32_16x16x32_bf16 v[224:227], v[40:43], a[144:147], v[224:227]
    s_waitcnt lgkmcnt(4)
    buffer_load_dwordx4 v10, s[60:63], s41 offen lds
    v_mfma_f32_16x16x32_bf16 v[224:227], v[44:47], a[160:163], v[224:227]
    s_add_u32 m0, s40, 8192
    v_accvgpr_read_b32 v149, a38
    v_accvgpr_read_b32 v150, a39
    v_mfma_f32_16x16x32_bf16 v[228:231], v[44:47], a[164:167], v[228:231]
    v_cvt_pk_bf16_f32 v149, v149, v150
    v_accvgpr_read_b32 v150, a52
    v_mfma_f32_16x16x32_bf16 v[228:231], v[40:43], a[148:151], v[228:231]
    v_accvgpr_read_b32 v151, a53
    v_cvt_pk_bf16_f32 v150, v150, v151
    v_mfma_f32_16x16x32_bf16 v[232:235], v[40:43], a[152:155], v[232:235]
    buffer_load_dwordx4 v11, s[60:63], s41 offen lds
    v_mfma_f32_16x16x32_bf16 v[232:235], v[44:47], a[168:171], v[232:235]
    s_lshr_b32 s40, s70, 1
    ds_read_b64_tr_b16 v[32:33], v57 offset:36864
    v_accvgpr_read_b32 v151, a54
    v_mfma_f32_16x16x32_bf16 v[236:239], v[44:47], a[172:175], v[236:239]
    s_add_u32 s40, s40, 2
    ds_read_b64_tr_b16 v[34:35], v57 offset:41472
    v_accvgpr_read_b32 v22, a55
    v_mfma_f32_16x16x32_bf16 v[236:239], v[40:43], a[156:159], v[236:239]
    s_waitcnt lgkmcnt(4)
    s_add_u32 s41, s72, s40
    ds_read_b64_tr_b16 v[36:37], v57 offset:46080
    ds_read_b64_tr_b16 v[38:39], v57 offset:50688
    v_mfma_f32_16x16x32_bf16 v[240:243], v[48:51], a[144:147], v[240:243]
    s_waitcnt lgkmcnt(4)
    s_and_b32 s41, s41, 3
    buffer_load_dword v21, v1, s[56:59], s79 offen offset:64 sc1
    v_mfma_f32_16x16x32_bf16 v[240:243], v[52:55], a[160:163], v[240:243]
    s_mul_i32 s41, s41, 9
    v_cvt_pk_bf16_f32 v151, v151, v22
    v_accvgpr_read_b32 v152, a40
    v_mfma_f32_16x16x32_bf16 v[244:247], v[52:55], a[164:167], v[244:247]
    s_add_u32 s41, s41, 1
    v_accvgpr_read_b32 v153, a41
    v_cvt_pk_bf16_f32 v152, v152, v153
    v_mfma_f32_16x16x32_bf16 v[244:247], v[48:51], a[148:151], v[244:247]
    s_lshr_b32 s41, s41, 1
    v_accvgpr_read_b32 v153, a42
    v_accvgpr_read_b32 v154, a43
    v_mfma_f32_16x16x32_bf16 v[248:251], v[48:51], a[152:155], v[248:251]
    s_and_b32 s40, s70, 1
    v_cvt_pk_bf16_f32 v153, v153, v154
    v_accvgpr_read_b32 v154, a56
    v_mfma_f32_16x16x32_bf16 v[248:251], v[52:55], a[168:171], v[248:251]
    s_add_u32 s41, s41, s40
    ds_read_b64_tr_b16 v[40:41], v57 offset:36896
    ds_read_b64_tr_b16 v[42:43], v57 offset:41504
    v_mfma_f32_16x16x32_bf16 v[252:255], v[52:55], a[172:175], v[252:255]
    s_add_u32 s41, s41, 2
    ds_read_b64_tr_b16 v[44:45], v57 offset:46112
    v_accvgpr_read_b32 v155, a57
    v_mfma_f32_16x16x32_bf16 v[252:255], v[48:51], a[156:159], v[252:255]
    s_waitcnt vmcnt(27) lgkmcnt(5)
    s_mul_i32 s41, s41, 36864
    ds_read_b64_tr_b16 v[46:47], v57 offset:50720
    v_cvt_pk_bf16_f32 v154, v154, v155
    v_mfma_f32_16x16x32_bf16 v[64:67], v[32:35], a[176:179], v[64:67]
    s_waitcnt vmcnt(23) lgkmcnt(4)
    s_add_u32 s40, s81, 27648
    v_accvgpr_read_b32 v155, a58
    v_accvgpr_read_b32 v22, a59
    v_mfma_f32_16x16x32_bf16 v[64:67], v[36:39], a[192:195], v[64:67]
    s_waitcnt vmcnt(22)
    s_cmp_eq_u32 s70, 0
    s_cselect_b32 s40, 147456, s40
    v_cvt_pk_bf16_f32 v155, v155, v22
    v_mfma_f32_16x16x32_bf16 v[68:71], v[36:39], a[196:199], v[68:71]
    s_add_u32 m0, s40, 0
    v_accvgpr_read_b32 v156, a44
    v_accvgpr_read_b32 v157, a45
    v_mfma_f32_16x16x32_bf16 v[68:71], v[32:35], a[180:183], v[68:71]
    buffer_load_dwordx4 v3, s[60:63], s41 offen lds
    v_mfma_f32_16x16x32_bf16 v[72:75], v[32:35], a[184:187], v[72:75]
    s_waitcnt vmcnt(22)
    s_add_u32 m0, s40, 1024
    v_cvt_pk_bf16_f32 v156, v156, v157
    v_accvgpr_read_b32 v157, a46
    v_mfma_f32_16x16x32_bf16 v[72:75], v[36:39], a[200:203], v[72:75]
    s_waitcnt vmcnt(21)
    ds_read_b64_tr_b16 v[48:49], v57 offset:36928
    ds_read_b64_tr_b16 v[50:51], v57 offset:41536
    v_mfma_f32_16x16x32_bf16 v[76:79], v[36:39], a[204:207], v[76:79]
    buffer_load_dwordx4 v4, s[60:63], s41 offen lds
    v_mfma_f32_16x16x32_bf16 v[76:79], v[32:35], a[188:191], v[76:79]
    s_waitcnt lgkmcnt(4)
    s_add_u32 m0, s40, 2048
    ds_read_b64_tr_b16 v[52:53], v57 offset:46144
    v_accvgpr_read_b32 v158, a47
    v_mfma_f32_16x16x32_bf16 a[128:131], v[40:43], a[176:179], a[128:131]
    s_waitcnt lgkmcnt(3)
    ds_read_b64_tr_b16 v[54:55], v57 offset:50752
    v_cvt_pk_bf16_f32 v157, v157, v158
    v_mfma_f32_16x16x32_bf16 a[128:131], v[44:47], a[192:195], a[128:131]
    buffer_load_dwordx4 v5, s[60:63], s41 offen lds
    v_mfma_f32_16x16x32_bf16 a[132:135], v[44:47], a[196:199], a[132:135]
    s_add_u32 m0, s40, 3072
    v_accvgpr_read_b32 v158, a60
    v_accvgpr_read_b32 v159, a61
    v_mfma_f32_16x16x32_bf16 a[132:135], v[40:43], a[180:183], a[132:135]
    v_cvt_pk_bf16_f32 v158, v158, v159
    v_accvgpr_read_b32 v159, a62
    v_mfma_f32_16x16x32_bf16 a[136:139], v[40:43], a[184:187], a[136:139]
    buffer_load_dwordx4 v6, s[60:63], s41 offen lds
    v_mfma_f32_16x16x32_bf16 a[136:139], v[44:47], a[200:203], a[136:139]
    s_add_u32 m0, s40, 4096
    ds_read_b64_tr_b16 v[32:33], v57 offset:36960
    v_accvgpr_read_b32 v22, a63
    v_mfma_f32_16x16x32_bf16 a[140:143], v[44:47], a[204:207], a[140:143]
    ds_read_b64_tr_b16 v[34:35], v57 offset:41568
    v_cvt_pk_bf16_f32 v159, v159, v22
    v_mfma_f32_16x16x32_bf16 a[140:143], v[40:43], a[188:191], a[140:143]
    s_waitcnt lgkmcnt(4)
    ds_read_b64_tr_b16 v[36:37], v57 offset:46176
    v_accvgpr_read_b32 v176, a64
    v_mfma_f32_16x16x32_bf16 v[80:83], v[48:51], a[176:179], v[80:83]
    s_waitcnt lgkmcnt(3)
    ds_read_b64_tr_b16 v[38:39], v57 offset:50784
    v_accvgpr_read_b32 v177, a65
    v_mfma_f32_16x16x32_bf16 v[80:83], v[52:55], a[192:195], v[80:83]
    buffer_load_dwordx4 v7, s[60:63], s41 offen lds
    v_mfma_f32_16x16x32_bf16 v[84:87], v[52:55], a[196:199], v[84:87]
    s_add_u32 m0, s40, 5120
    v_cvt_pk_bf16_f32 v176, v176, v177
    v_accvgpr_read_b32 v177, a66
    v_mfma_f32_16x16x32_bf16 v[84:87], v[48:51], a[180:183], v[84:87]
    v_accvgpr_read_b32 v178, a67
    v_cvt_pk_bf16_f32 v177, v177, v178
    v_mfma_f32_16x16x32_bf16 v[88:91], v[48:51], a[184:187], v[88:91]
    v_accvgpr_read_b32 v178, a80
    v_accvgpr_read_b32 v179, a81
    v_mfma_f32_16x16x32_bf16 v[88:91], v[52:55], a[200:203], v[88:91]
    ds_read_b64_tr_b16 v[40:41], v57 offset:36992
    v_cvt_pk_bf16_f32 v178, v178, v179
    v_mfma_f32_16x16x32_bf16 v[92:95], v[52:55], a[204:207], v[92:95]
    ds_read_b64_tr_b16 v[42:43], v57 offset:41600
    v_accvgpr_read_b32 v179, a82
    v_mfma_f32_16x16x32_bf16 v[92:95], v[48:51], a[188:191], v[92:95]
    s_waitcnt lgkmcnt(4)
    ds_read_b64_tr_b16 v[44:45], v57 offset:46208
    ds_read_b64_tr_b16 v[46:47], v57 offset:50816
    v_mfma_f32_16x16x32_bf16 v[96:99], v[32:35], a[176:179], v[96:99]
    s_waitcnt lgkmcnt(4)
    buffer_load_dwordx4 v8, s[60:63], s41 offen lds
    v_mfma_f32_16x16x32_bf16 v[96:99], v[36:39], a[192:195], v[96:99]
    s_add_u32 m0, s40, 6144
    v_accvgpr_read_b32 v22, a83
    v_cvt_pk_bf16_f32 v179, v179, v22
    v_mfma_f32_16x16x32_bf16 v[100:103], v[36:39], a[196:199], v[100:103]
    v_accvgpr_read_b32 v180, a68
    v_accvgpr_read_b32 v181, a69
    v_mfma_f32_16x16x32_bf16 v[100:103], v[32:35], a[180:183], v[100:103]
    buffer_load_dwordx4 v9, s[60:63], s41 offen lds
    v_mfma_f32_16x16x32_bf16 v[104:107], v[32:35], a[184:187], v[104:107]
    s_add_u32 m0, s40, 7168
    v_cvt_pk_bf16_f32 v180, v180, v181
    v_accvgpr_read_b32 v181, a70
    v_mfma_f32_16x16x32_bf16 v[104:107], v[36:39], a[200:203], v[104:107]
    ds_read_b64_tr_b16 v[48:49], v57 offset:37024
    v_accvgpr_read_b32 v182, a71
    v_mfma_f32_16x16x32_bf16 v[108:111], v[36:39], a[204:207], v[108:111]
    s_waitcnt vmcnt(7)
    v_cmp_ne_u32 vcc, s22, v21
    s_nop 0
    s_cbranch_vccnz Lspin_hb
Lret_hb:
    v_mfma_f32_16x16x32_bf16 v[108:111], v[32:35], a[188:191], v[108:111]
    s_waitcnt lgkmcnt(3)
    ds_read_b64_tr_b16 v[50:51], v57 offset:41632
    ds_read_b64_tr_b16 v[52:53], v57 offset:46240
    v_mfma_f32_16x16x32_bf16 v[128:131], v[40:43], a[176:179], v[128:131]
    s_waitcnt lgkmcnt(3)
    ds_read_b64_tr_b16 v[54:55], v57 offset:50848
    v_cvt_pk_bf16_f32 v181, v181, v182
    v_mfma_f32_16x16x32_bf16 v[128:131], v[44:47], a[192:195], v[128:131]
    buffer_load_dwordx4 v10, s[60:63], s41 offen lds
    v_mfma_f32_16x16x32_bf16 v[132:135], v[44:47], a[196:199], v[132:135]
    s_add_u32 m0, s40, 8192
    v_accvgpr_read_b32 v182, a84
    v_accvgpr_read_b32 v183, a85
    v_mfma_f32_16x16x32_bf16 v[132:135], v[40:43], a[180:183], v[132:135]
    v_cvt_pk_bf16_f32 v182, v182, v183
    v_accvgpr_read_b32 v183, a86
    v_mfma_f32_16x16x32_bf16 v[136:139], v[40:43], a[184:187], v[136:139]
    v_accvgpr_read_b32 v22, a87
    v_cvt_pk_bf16_f32 v183, v183, v22
    v_mfma_f32_16x16x32_bf16 v[136:139], v[44:47], a[200:203], v[136:139]
    ds_read_b64_tr_b16 v[32:33], v57 offset:37056
    v_accvgpr_read_b32 v184, a72
    v_mfma_f32_16x16x32_bf16 v[140:143], v[44:47], a[204:207], v[140:143]
    ds_read_b64_tr_b16 v[34:35], v57 offset:41664
    v_accvgpr_read_b32 v185, a73
    v_mfma_f32_16x16x32_bf16 v[140:143], v[40:43], a[188:191], v[140:143]
    s_waitcnt lgkmcnt(4)
    ds_read_b64_tr_b16 v[36:37], v57 offset:46272
    v_cvt_pk_bf16_f32 v184, v184, v185
    v_mfma_f32_16x16x32_bf16 v[160:163], v[48:51], a[176:179], v[160:163]
    s_waitcnt lgkmcnt(3)
    ds_read_b64_tr_b16 v[38:39], v57 offset:50880
    v_accvgpr_read_b32 v185, a74
    v_mfma_f32_16x16x32_bf16 v[160:163], v[52:55], a[192:195], v[160:163]
    buffer_load_dwordx4 v11, s[60:63], s41 offen lds
    v_mfma_f32_16x16x32_bf16 v[164:167], v[52:55], a[196:199], v[164:167]
    s_add_u32 s42, s72, 1
    v_accvgpr_read_b32 v186, a75
    v_cvt_pk_bf16_f32 v185, v185, v186
    v_mfma_f32_16x16x32_bf16 v[164:167], v[48:51], a[180:183], v[164:167]
    s_and_b32 s42, s42, 3
    v_accvgpr_read_b32 v186, a88
    v_accvgpr_read_b32 v187, a89
    v_mfma_f32_16x16x32_bf16 v[168:171], v[48:51], a[184:187], v[168:171]
    s_mul_i32 s42, s42, 9
    v_cvt_pk_bf16_f32 v186, v186, v187
    v_accvgpr_read_b32 v187, a90
    v_mfma_f32_16x16x32_bf16 v[168:171], v[52:55], a[200:203], v[168:171]
    s_add_u32 s42, s42, 1
    ds_read_b64_tr_b16 v[40:41], v57 offset:37088
    v_accvgpr_read_b32 v22, a91
    v_mfma_f32_16x16x32_bf16 v[172:175], v[52:55], a[204:207], v[172:175]
    s_lshr_b32 s42, s42, 1
    ds_read_b64_tr_b16 v[42:43], v57 offset:41696
    v_cvt_pk_bf16_f32 v187, v187, v22
    v_mfma_f32_16x16x32_bf16 v[172:175], v[48:51], a[188:191], v[172:175]
    s_waitcnt lgkmcnt(4)
    s_add_u32 s42, s42, s3
    ds_read_b64_tr_b16 v[44:45], v57 offset:46304
    v_accvgpr_read_b32 v188, a76
    v_mfma_f32_16x16x32_bf16 v[192:195], v[32:35], a[176:179], v[192:195]
    s_waitcnt lgkmcnt(3)
    s_add_u32 s42, s42, 2
    ds_read_b64_tr_b16 v[46:47], v57 offset:50912
    v_accvgpr_read_b32 v189, a77
    v_mfma_f32_16x16x32_bf16 v[192:195], v[36:39], a[192:195], v[192:195]
    s_lshl_b32 s42, s42, 17
    buffer_load_dwordx4 a[0:3], v2, s[52:55], s42 offen offset:0 sc1
    v_mfma_f32_16x16x32_bf16 v[196:199], v[36:39], a[196:199], v[196:199]
    v_cvt_pk_bf16_f32 v188, v188, v189
    v_accvgpr_read_b32 v189, a78
    v_mfma_f32_16x16x32_bf16 v[196:199], v[32:35], a[180:183], v[196:199]
    v_accvgpr_read_b32 v190, a79
    v_cvt_pk_bf16_f32 v189, v189, v190
    v_mfma_f32_16x16x32_bf16 v[200:203], v[32:35], a[184:187], v[200:203]
Lpad6:
    s_cbranch_execz Lpad8
    buffer_load_dwordx4 a[4:7], v2, s[52:55], s42 offen offset:1024 sc1
    v_mfma_f32_16x16x32_bf16 v[200:203], v[36:39], a[200:203], v[200:203]
    ds_read_b64_tr_b16 v[48:49], v57 offset:37120
    v_accvgpr_read_b32 v190, a92
    v_mfma_f32_16x16x32_bf16 v[204:207], v[36:39], a[204:207], v[204:207]
    s_waitcnt vmcnt(12)
    ds_read_b64_tr_b16 v[50:51], v57 offset:41728
    v_accvgpr_read_b32 v191, a93
    v_mfma_f32_16x16x32_bf16 v[204:207], v[32:35], a[188:191], v[204:207]
    s_barrier
    ds_read_b64_tr_b16 v[52:53], v57 offset:46336
    v_cvt_pk_bf16_f32 v190, v190, v191
    s_waitcnt lgkmcnt(5)
    v_mfma_f32_16x16x32_bf16 v[224:227], v[40:43], a[176:179], v[224:227]
    s_waitcnt lgkmcnt(3)
    ds_read_b64_tr_b16 v[54:55], v57 offset:50944
    v_accvgpr_read_b32 v191, a94
    v_mfma_f32_16x16x32_bf16 v[224:227], v[44:47], a[192:195], v[224:227]
    buffer_load_dwordx4 a[8:11], v2, s[52:55], s42 offen offset:2048 sc1
    v_mfma_f32_16x16x32_bf16 v[228:231], v[44:47], a[196:199], v[228:231]
    v_accvgpr_read_b32 v22, a95
    v_cvt_pk_bf16_f32 v191, v191, v22
    v_mfma_f32_16x16x32_bf16 v[228:231], v[40:43], a[180:183], v[228:231]
    v_accvgpr_read_b32 v208, a96
    v_accvgpr_read_b32 v209, a97
    v_mfma_f32_16x16x32_bf16 v[232:235], v[40:43], a[184:187], v[232:235]
    buffer_load_dwordx4 a[12:15], v2, s[52:55], s42 offen offset:3072 sc1
    v_mfma_f32_16x16x32_bf16 v[232:235], v[44:47], a[200:203], v[232:235]
    s_add_u32 s42, s42, 131072
    ds_read_b64_tr_b16 v[32:33], v58 offset:0
    v_cvt_pk_bf16_f32 v208, v208, v209
    v_mfma_f32_16x16x32_bf16 v[236:239], v[44:47], a[204:207], v[236:239]
    ds_read_b64_tr_b16 v[34:35], v58 offset:4608
    v_accvgpr_read_b32 v209, a98
    v_mfma_f32_16x16x32_bf16 v[236:239], v[40:43], a[188:191], v[236:239]
    s_waitcnt lgkmcnt(4)
    ds_read_b64_tr_b16 v[36:37], v58 offset:9216
    v_accvgpr_read_b32 v210, a99
    v_mfma_f32_16x16x32_bf16 v[240:243], v[48:51], a[176:179], v[240:243]
    s_waitcnt lgkmcnt(3)
    ds_read_b64_tr_b16 v[38:39], v58 offset:13824
    v_cvt_pk_bf16_f32 v209, v209, v210
    v_mfma_f32_16x16x32_bf16 v[240:243], v[52:55], a[192:195], v[240:243]
    buffer_load_dwordx4 a[16:19], v2, s[52:55], s42 offen offset:0 sc1
    v_mfma_f32_16x16x32_bf16 v[244:247], v[52:55], a[196:199], v[244:247]
    v_accvgpr_read_b32 v210, a112
    v_accvgpr_read_b32 v211, a113
    v_mfma_f32_16x16x32_bf16 v[244:247], v[48:51], a[180:183], v[244:247]
    v_cvt_pk_bf16_f32 v210, v210, v211
    v_accvgpr_read_b32 v211, a114
    v_mfma_f32_16x16x32_bf16 v[248:251], v[48:51], a[184:187], v[248:251]
    buffer_load_dwordx4 a[20:23], v2, s[52:55], s42 offen offset:1024 sc1
    v_mfma_f32_16x16x32_bf16 v[248:251], v[52:55], a[200:203], v[248:251]
    ds_read_b64_tr_b16 v[40:41], v58 offset:32
    v_accvgpr_read_b32 v22, a115
    v_mfma_f32_16x16x32_bf16 v[252:255], v[52:55], a[204:207], v[252:255]
    ds_read_b64_tr_b16 v[42:43], v58 offset:4640
    v_cvt_pk_bf16_f32 v211, v211, v22
    v_mfma_f32_16x16x32_bf16 v[252:255], v[48:51], a[188:191], v[252:255]
    s_waitcnt lgkmcnt(4)
    ds_read_b64_tr_b16 v[44:45], v58 offset:9248
    v_accvgpr_read_b32 v212, a100
    v_mfma_f32_16x16x32_bf16 v[64:67], v[32:35], a[208:211], v[64:67]
    s_waitcnt lgkmcnt(3)
    ds_read_b64_tr_b16 v[46:47], v58 offset:13856
    v_accvgpr_read_b32 v213, a101
    v_mfma_f32_16x16x32_bf16 v[64:67], v[36:39], a[224:227], v[64:67]
    buffer_load_dwordx4 a[24:27], v2, s[52:55], s42 offen offset:2048 sc1
    v_mfma_f32_16x16x32_bf16 v[68:71], v[36:39], a[228:231], v[68:71]
    v_cvt_pk_bf16_f32 v212, v212, v213
    v_accvgpr_read_b32 v213, a102
    v_mfma_f32_16x16x32_bf16 v[68:71], v[32:35], a[212:215], v[68:71]
    v_accvgpr_read_b32 v214, a103
    v_cvt_pk_bf16_f32 v213, v213, v214
    v_mfma_f32_16x16x32_bf16 v[72:75], v[32:35], a[216:219], v[72:75]
    buffer_load_dwordx4 a[28:31], v2, s[52:55], s42 offen offset:3072 sc1
    v_mfma_f32_16x16x32_bf16 v[72:75], v[36:39], a[232:235], v[72:75]
    s_add_u32 s42, s72, 2
    ds_read_b64_tr_b16 v[48:49], v58 offset:64
    v_accvgpr_read_b32 v214, a116
    v_mfma_f32_16x16x32_bf16 v[76:79], v[36:39], a[236:239], v[76:79]
    s_and_b32 s42, s42, 3
    ds_read_b64_tr_b16 v[50:51], v58 offset:4672
    v_accvgpr_read_b32 v215, a117
    v_mfma_f32_16x16x32_bf16 v[76:79], v[32:35], a[220:223], v[76:79]
    s_waitcnt lgkmcnt(4)
    s_mul_i32 s42, s42, 9
    ds_read_b64_tr_b16 v[52:53], v58 offset:9280
    v_cvt_pk_bf16_f32 v214, v214, v215
    v_mfma_f32_16x16x32_bf16 a[128:131], v[40:43], a[208:211], a[128:131]
    s_waitcnt lgkmcnt(3)
    s_add_u32 s42, s42, 1
    ds_read_b64_tr_b16 v[54:55], v58 offset:13888
    v_accvgpr_read_b32 v215, a118
    v_mfma_f32_16x16x32_bf16 a[128:131], v[44:47], a[224:227], a[128:131]
    s_lshr_b32 s42, s42, 1
    v_accvgpr_read_b32 v22, a119
    v_cvt_pk_bf16_f32 v215, v215, v22
    v_mfma_f32_16x16x32_bf16 a[132:135], v[44:47], a[228:231], a[132:135]
    s_add_u32 s42, s42, s3
    v_accvgpr_read_b32 v216, a104
    v_accvgpr_read_b32 v217, a105
    v_mfma_f32_16x16x32_bf16 a[132:135], v[40:43], a[212:215], a[132:135]
    s_add_u32 s42, s42, 2
    v_cvt_pk_bf16_f32 v216, v216, v217
    v_accvgpr_read_b32 v217, a106
    v_mfma_f32_16x16x32_bf16 a[136:139], v[40:43], a[216:219], a[136:139]
    s_lshl_b32 s42, s42, 17
    buffer_load_dwordx4 a[32:35], v2, s[52:55], s42 offen offset:0 sc1
    v_mfma_f32_16x16x32_bf16 a[136:139], v[44:47], a[232:235], a[136:139]
    ds_read_b64_tr_b16 v[32:33], v58 offset:96
    v_accvgpr_read_b32 v218, a107
    v_mfma_f32_16x16x32_bf16 a[140:143], v[44:47], a[236:239], a[140:143]
    ds_read_b64_tr_b16 v[34:35], v58 offset:4704
    v_cvt_pk_bf16_f32 v217, v217, v218
    v_mfma_f32_16x16x32_bf16 a[140:143], v[40:43], a[220:223], a[140:143]
    s_waitcnt lgkmcnt(4)
    ds_read_b64_tr_b16 v[36:37], v58 offset:9312
    v_accvgpr_read_b32 v218, a120
    v_mfma_f32_16x16x32_bf16 v[80:83], v[48:51], a[208:211], v[80:83]
    s_waitcnt lgkmcnt(3)
    ds_read_b64_tr_b16 v[38:39], v58 offset:13920
    v_accvgpr_read_b32 v219, a121
    v_mfma_f32_16x16x32_bf16 v[80:83], v[52:55], a[224:227], v[80:83]
    buffer_load_dwordx4 a[36:39], v2, s[52:55], s42 offen offset:1024 sc1
    v_mfma_f32_16x16x32_bf16 v[84:87], v[52:55], a[228:231], v[84:87]
    v_cvt_pk_bf16_f32 v218, v218, v219
    v_accvgpr_read_b32 v219, a122
    v_mfma_f32_16x16x32_bf16 v[84:87], v[48:51], a[212:215], v[84:87]
    v_accvgpr_read_b32 v22, a123
    v_cvt_pk_bf16_f32 v219, v219, v22
    v_mfma_f32_16x16x32_bf16 v[88:91], v[48:51], a[216:219], v[88:91]
    buffer_load_dwordx4 a[40:43], v2, s[52:55], s42 offen offset:2048 sc1
    v_mfma_f32_16x16x32_bf16 v[88:91], v[52:55], a[232:235], v[88:91]
    ds_read_b64_tr_b16 v[40:41], v58 offset:128
    v_accvgpr_read_b32 v220, a108
    v_mfma_f32_16x16x32_bf16 v[92:95], v[52:55], a[236:239], v[92:95]
    ds_read_b64_tr_b16 v[42:43], v58 offset:4736
    v_accvgpr_read_b32 v221, a109
    v_mfma_f32_16x16x32_bf16 v[92:95], v[48:51], a[220:223], v[92:95]
    s_waitcnt lgkmcnt(4)
    ds_read_b64_tr_b16 v[44:45], v58 offset:9344
    v_cvt_pk_bf16_f32 v220, v220, v221
    v_mfma_f32_16x16x32_bf16 v[96:99], v[32:35], a[208:211], v[96:99]
    s_waitcnt lgkmcnt(3)
    ds_read_b64_tr_b16 v[46:47], v58 offset:13952
    v_accvgpr_read_b32 v221, a110
    v_mfma_f32_16x16x32_bf16 v[96:99], v[36:39], a[224:227], v[96:99]
    buffer_load_dwordx4 a[44:47], v2, s[52:55], s42 offen offset:3072 sc1
    v_mfma_f32_16x16x32_bf16 v[100:103], v[36:39], a[228:231], v[100:103]
    s_add_u32 s42, s42, 131072
    v_accvgpr_read_b32 v222, a111
    v_cvt_pk_bf16_f32 v221, v221, v222
    v_mfma_f32_16x16x32_bf16 v[100:103], v[32:35], a[212:215], v[100:103]
    v_accvgpr_read_b32 v222, a124
    v_accvgpr_read_b32 v223, a125
    v_mfma_f32_16x16x32_bf16 v[104:107], v[32:35], a[216:219], v[104:107]
    buffer_load_dwordx4 a[48:51], v2, s[52:55], s42 offen offset:0 sc1
    v_mfma_f32_16x16x32_bf16 v[104:107], v[36:39], a[232:235], v[104:107]
    ds_read_b64_tr_b16 v[48:49], v58 offset:160
    v_cvt_pk_bf16_f32 v222, v222, v223
    v_mfma_f32_16x16x32_bf16 v[108:111], v[36:39], a[236:239], v[108:111]
    ds_read_b64_tr_b16 v[50:51], v58 offset:4768
    v_accvgpr_read_b32 v223, a126
    v_mfma_f32_16x16x32_bf16 v[108:111], v[32:35], a[220:223], v[108:111]
    s_waitcnt lgkmcnt(4)
    ds_read_b64_tr_b16 v[52:53], v58 offset:9376
    v_accvgpr_read_b32 v22, a127
    v_mfma_f32_16x16x32_bf16 v[128:131], v[40:43], a[208:211], v[128:131]
    s_waitcnt lgkmcnt(3)
    ds_read_b64_tr_b16 v[54:55], v58 offset:13984
    v_cvt_pk_bf16_f32 v223, v223, v22
    v_mfma_f32_16x16x32_bf16 v[128:131], v[44:47], a[224:227], v[128:131]
    buffer_load_dwordx4 a[52:55], v2, s[52:55], s42 offen offset:1024 sc1
    v_mfma_f32_16x16x32_bf16 v[132:135], v[44:47], a[228:231], v[132:135]
    ds_read_b64_tr_b16 v[32:33], v58 offset:192
    ds_read_b64_tr_b16 v[34:35], v58 offset:4800
    v_mfma_f32_16x16x32_bf16 v[132:135], v[40:43], a[212:215], v[132:135]
    ds_read_b64_tr_b16 v[36:37], v58 offset:9408
    ds_read_b64_tr_b16 v[38:39], v58 offset:14016
    v_mfma_f32_16x16x32_bf16 v[136:139], v[40:43], a[216:219], v[136:139]
    buffer_load_dwordx4 a[56:59], v2, s[52:55], s42 offen offset:2048 sc1
    v_mfma_f32_16x16x32_bf16 v[136:139], v[44:47], a[232:235], v[136:139]
    v_xor_b32 v20, 192, v23
    v_xor_b32 v21, 128, v23
    v_mfma_f32_16x16x32_bf16 v[140:143], v[44:47], a[236:239], v[140:143]
    v_xor_b32 v22, 64, v23
    v_bfe_u32 v24, v0, 2, 4
    v_mfma_f32_16x16x32_bf16 v[140:143], v[40:43], a[220:223], v[140:143]
    s_waitcnt lgkmcnt(6)
    buffer_load_dwordx4 a[60:63], v2, s[52:55], s42 offen offset:3072 sc1
    v_mfma_f32_16x16x32_bf16 v[160:163], v[48:51], a[208:211], v[160:163]
    s_waitcnt lgkmcnt(4)
    s_mov_b32 s84, 0
    ds_read_b64_tr_b16 v[40:41], v58 offset:224
    ds_read_b64_tr_b16 v[42:43], v58 offset:4832
    v_mfma_f32_16x16x32_bf16 v[160:163], v[52:55], a[224:227], v[160:163]
    s_add_u32 m0, s83, 4096
    ds_read_b64_tr_b16 v[44:45], v58 offset:9440
    ds_read_b64_tr_b16 v[46:47], v58 offset:14048
    v_mfma_f32_16x16x32_bf16 v[164:167], v[52:55], a[228:231], v[164:167]
    buffer_load_dwordx4 v14, s[44:47], s84 offen offset:0 lds
    v_mfma_f32_16x16x32_bf16 v[164:167], v[48:51], a[212:215], v[164:167]
    v_and_b32 v25, 7, v24
    v_lshlrev_b32 v24, 8, v24
    v_mfma_f32_16x16x32_bf16 v[168:171], v[48:51], a[216:219], v[168:171]
    v_lshl_add_u32 v24, v25, 5, v24
    v_lshl_add_u32 v24, v1, 1, v24
    v_mfma_f32_16x16x32_bf16 v[168:171], v[52:55], a[232:235], v[168:171]
    v_add_u32 v24, 71680, v24
    v_xor_b32 v25, 32, v24
    v_mfma_f32_16x16x32_bf16 v[172:175], v[52:55], a[236:239], v[172:175]
    v_xor_b32 v26, 64, v24
    v_xor_b32 v27, 96, v24
    v_mfma_f32_16x16x32_bf16 v[172:175], v[48:51], a[220:223], v[172:175]
    s_waitcnt lgkmcnt(6)
    buffer_load_dwordx4 v15, s[44:47], s84 offen offset:1024 lds
    v_mfma_f32_16x16x32_bf16 v[192:195], v[32:35], a[208:211], v[192:195]
    s_waitcnt lgkmcnt(4)
    ds_read_b64_tr_b16 v[48:49], v58 offset:256
    ds_read_b64_tr_b16 v[50:51], v58 offset:4864
    v_mfma_f32_16x16x32_bf16 v[192:195], v[36:39], a[224:227], v[192:195]
    ds_read_b64_tr_b16 v[52:53], v58 offset:9472
    ds_read_b64_tr_b16 v[54:55], v58 offset:14080
    v_mfma_f32_16x16x32_bf16 v[196:199], v[36:39], a[228:231], v[196:199]
    v_xor_b32 v28, 128, v24
    v_xor_b32 v29, 160, v24
    v_mfma_f32_16x16x32_bf16 v[196:199], v[32:35], a[212:215], v[196:199]
    v_xor_b32 v30, 192, v24
    v_xor_b32 v31, 224, v24
    v_mfma_f32_16x16x32_bf16 v[200:203], v[32:35], a[216:219], v[200:203]
    buffer_load_dwordx4 v16, s[44:47], s84 offen offset:2048 lds
    v_mfma_f32_16x16x32_bf16 v[200:203], v[36:39], a[232:235], v[200:203]
    v_mfma_f32_16x16x32_bf16 v[204:207], v[36:39], a[236:239], v[204:207]
    v_mfma_f32_16x16x32_bf16 v[204:207], v[32:35], a[220:223], v[204:207]
    s_waitcnt lgkmcnt(6)
    v_mfma_f32_16x16x32_bf16 v[224:227], v[40:43], a[208:211], v[224:227]
    s_waitcnt lgkmcnt(4)
    ds_read_b64_tr_b16 v[32:33], v58 offset:18432
    ds_read_b64_tr_b16 v[34:35], v58 offset:23040
    v_mfma_f32_16x16x32_bf16 v[224:227], v[44:47], a[224:227], v[224:227]
    buffer_load_dwordx4 v17, s[44:47], s84 offen offset:3072 lds
    v_mfma_f32_16x16x32_bf16 v[228:231], v[44:47], a[228:231], v[228:231]
    s_add_u32 s42, s72, 3
    ds_read_b64_tr_b16 v[36:37], v58 offset:27648
    ds_read_b64_tr_b16 v[38:39], v58 offset:32256
    v_mfma_f32_16x16x32_bf16 v[228:231], v[40:43], a[212:215], v[228:231]
    s_and_b32 s42, s42, 3
    v_mfma_f32_16x16x32_bf16 v[232:235], v[40:43], a[216:219], v[232:235]
    s_mul_i32 s42, s42, 9
    v_mfma_f32_16x16x32_bf16 v[232:235], v[44:47], a[232:235], v[232:235]
    s_add_u32 s42, s42, 1
    v_mfma_f32_16x16x32_bf16 v[236:239], v[44:47], a[236:239], v[236:239]
    s_waitcnt vmcnt(20)
    v_mfma_f32_16x16x32_bf16 v[236:239], v[40:43], a[220:223], v[236:239]
    s_barrier
    s_waitcnt lgkmcnt(6)
    v_mfma_f32_16x16x32_bf16 v[240:243], v[48:51], a[208:211], v[240:243]
    s_waitcnt lgkmcnt(4)
    s_lshr_b32 s42, s42, 1
    ds_read_b64_tr_b16 v[40:41], v58 offset:18464
    ds_read_b64_tr_b16 v[42:43], v58 offset:23072
    v_mfma_f32_16x16x32_bf16 v[240:243], v[52:55], a[224:227], v[240:243]
    s_add_u32 s42, s42, s3
    ds_read_b64_tr_b16 v[44:45], v58 offset:27680
    ds_read_b64_tr_b16 v[46:47], v58 offset:32288
    v_mfma_f32_16x16x32_bf16 v[244:247], v[52:55], a[228:231], v[244:247]
    s_add_u32 s42, s42, 2
    v_mfma_f32_16x16x32_bf16 v[244:247], v[48:51], a[212:215], v[244:247]
    s_lshl_b32 s42, s42, 17
    buffer_load_dwordx4 a[64:67], v2, s[52:55], s42 offen offset:0 sc1
    v_mfma_f32_16x16x32_bf16 v[248:251], v[48:51], a[216:219], v[248:251]
    v_mfma_f32_16x16x32_bf16 v[248:251], v[52:55], a[232:235], v[248:251]
    v_mfma_f32_16x16x32_bf16 v[252:255], v[52:55], a[236:239], v[252:255]
    buffer_load_dwordx4 a[68:71], v2, s[52:55], s42 offen offset:1024 sc1
    v_mfma_f32_16x16x32_bf16 v[252:255], v[48:51], a[220:223], v[252:255]
    s_waitcnt vmcnt(21) lgkmcnt(6)
    v_mfma_f32_16x16x32_bf16 v[64:67], v[32:35], a[0:3], v[64:67]
    s_waitcnt vmcnt(17) lgkmcnt(4)
    ds_read_b64_tr_b16 v[48:49], v58 offset:18496
    ds_read_b64_tr_b16 v[50:51], v58 offset:23104
    v_mfma_f32_16x16x32_bf16 v[64:67], v[36:39], a[16:19], v[64:67]
    s_waitcnt vmcnt(16)
    buffer_load_dwordx4 a[72:75], v2, s[52:55], s42 offen offset:2048 sc1
    v_mfma_f32_16x16x32_bf16 v[68:71], v[36:39], a[20:23], v[68:71]
    ds_read_b64_tr_b16 v[52:53], v58 offset:27712
    ds_read_b64_tr_b16 v[54:55], v58 offset:32320
    v_mfma_f32_16x16x32_bf16 v[68:71], v[32:35], a[4:7], v[68:71]
    v_mfma_f32_16x16x32_bf16 v[72:75], v[32:35], a[8:11], v[72:75]
    s_waitcnt vmcnt(16)
    buffer_load_dwordx4 a[76:79], v2, s[52:55], s42 offen offset:3072 sc1
    v_mfma_f32_16x16x32_bf16 v[72:75], v[36:39], a[24:27], v[72:75]
    s_waitcnt vmcnt(16)
    s_add_u32 s42, s42, 131072
    v_mfma_f32_16x16x32_bf16 v[76:79], v[36:39], a[28:31], v[76:79]
    v_mfma_f32_16x16x32_bf16 v[76:79], v[32:35], a[12:15], v[76:79]
    s_waitcnt lgkmcnt(6)
    v_mfma_f32_16x16x32_bf16 a[128:131], v[40:43], a[0:3], a[128:131]
    s_waitcnt lgkmcnt(4)
    buffer_load_dwordx4 a[80:83], v2, s[52:55], s42 offen offset:0 sc1
    v_mfma_f32_16x16x32_bf16 a[128:131], v[44:47], a[16:19], a[128:131]
    ds_read_b64_tr_b16 v[32:33], v58 offset:18528
    ds_read_b64_tr_b16 v[34:35], v58 offset:23136
    v_mfma_f32_16x16x32_bf16 a[132:135], v[44:47], a[20:23], a[132:135]
    ds_read_b64_tr_b16 v[36:37], v58 offset:27744
    ds_read_b64_tr_b16 v[38:39], v58 offset:32352
    v_mfma_f32_16x16x32_bf16 a[132:135], v[40:43], a[4:7], a[132:135]
    v_mfma_f32_16x16x32_bf16 a[136:139], v[40:43], a[8:11], a[136:139]
    buffer_load_dwordx4 a[84:87], v2, s[52:55], s42 offen offset:1024 sc1
    v_mfma_f32_16x16x32_bf16 a[136:139], v[44:47], a[24:27], a[136:139]
    v_mfma_f32_16x16x32_bf16 a[140:143], v[44:47], a[28:31], a[140:143]
    v_mfma_f32_16x16x32_bf16 a[140:143], v[40:43], a[12:15], a[140:143]
    s_waitcnt lgkmcnt(6)
    v_mfma_f32_16x16x32_bf16 v[80:83], v[48:51], a[0:3], v[80:83]
    s_waitcnt lgkmcnt(4)
    ds_read_b64_tr_b16 v[40:41], v58 offset:18560
    ds_read_b64_tr_b16 v[42:43], v58 offset:23168
    v_mfma_f32_16x16x32_bf16 v[80:83], v[52:55], a[16:19], v[80:83]
    buffer_load_dwordx4 a[88:91], v2, s[52:55], s42 offen offset:2048 sc1
    v_mfma_f32_16x16x32_bf16 v[84:87], v[52:55], a[20:23], v[84:87]
    ds_read_b64_tr_b16 v[44:45], v58 offset:27776
    ds_read_b64_tr_b16 v[46:47], v58 offset:32384
    v_mfma_f32_16x16x32_bf16 v[84:87], v[48:51], a[4:7], v[84:87]
    v_mfma_f32_16x16x32_bf16 v[88:91], v[48:51], a[8:11], v[88:91]
    s_bitcmp1_b32 s71, 0
    v_mfma_f32_16x16x32_bf16 v[88:91], v[52:55], a[24:27], v[88:91]
    s_cbranch_scc0 Leven
    buffer_load_dwordx4 a[92:95], v2, s[52:55], s42 offen offset:3072 sc1
    v_mfma_f32_16x16x32_bf16 v[92:95], v[52:55], a[28:31], v[92:95]
    v_xor_b32 v19, 128, v18
    v_mfma_f32_16x16x32_bf16 v[92:95], v[48:51], a[12:15], v[92:95]
    s_waitcnt lgkmcnt(6)
    s_mov_b32 s84, 16384
    v_mfma_f32_16x16x32_bf16 v[96:99], v[32:35], a[0:3], v[96:99]
    s_waitcnt lgkmcnt(4)
    s_add_u32 m0, s83, 20480
    ds_read_b64_tr_b16 v[48:49], v58 offset:18592
    ds_read_b64_tr_b16 v[50:51], v58 offset:23200
    v_mfma_f32_16x16x32_bf16 v[96:99], v[36:39], a[16:19], v[96:99]
    ds_read_b64_tr_b16 v[52:53], v58 offset:27808
    ds_read_b64_tr_b16 v[54:55], v58 offset:32416
    v_mfma_f32_16x16x32_bf16 v[100:103], v[36:39], a[20:23], v[100:103]
    buffer_load_dwordx4 v14, s[44:47], s84 offen offset:0 lds
    v_mfma_f32_16x16x32_bf16 v[100:103], v[32:35], a[4:7], v[100:103]
    v_mfma_f32_16x16x32_bf16 v[104:107], v[32:35], a[8:11], v[104:107]
    v_mfma_f32_16x16x32_bf16 v[104:107], v[36:39], a[24:27], v[104:107]
    v_mfma_f32_16x16x32_bf16 v[108:111], v[36:39], a[28:31], v[108:111]
    v_mfma_f32_16x16x32_bf16 v[108:111], v[32:35], a[12:15], v[108:111]
    s_waitcnt lgkmcnt(6)
    buffer_load_dwordx4 v15, s[44:47], s84 offen offset:1024 lds
    v_mfma_f32_16x16x32_bf16 v[128:131], v[40:43], a[0:3], v[128:131]
    s_waitcnt lgkmcnt(4)
    ds_read_b64_tr_b16 v[32:33], v58 offset:18624
    ds_read_b64_tr_b16 v[34:35], v58 offset:23232
    v_mfma_f32_16x16x32_bf16 v[128:131], v[44:47], a[16:19], v[128:131]
    ds_read_b64_tr_b16 v[36:37], v58 offset:27840
    ds_read_b64_tr_b16 v[38:39], v58 offset:32448
    v_mfma_f32_16x16x32_bf16 v[132:135], v[44:47], a[20:23], v[132:135]
    v_mfma_f32_16x16x32_bf16 v[132:135], v[40:43], a[4:7], v[132:135]
    v_mfma_f32_16x16x32_bf16 v[136:139], v[40:43], a[8:11], v[136:139]
    buffer_load_dwordx4 v16, s[44:47], s84 offen offset:2048 lds
    v_mfma_f32_16x16x32_bf16 v[136:139], v[44:47], a[24:27], v[136:139]
    v_mfma_f32_16x16x32_bf16 v[140:143], v[44:47], a[28:31], v[140:143]
    v_mfma_f32_16x16x32_bf16 v[140:143], v[40:43], a[12:15], v[140:143]
    s_waitcnt lgkmcnt(6)
    v_mfma_f32_16x16x32_bf16 v[160:163], v[48:51], a[0:3], v[160:163]
    s_waitcnt lgkmcnt(4)
    ds_read_b64_tr_b16 v[40:41], v58 offset:18656
    ds_read_b64_tr_b16 v[42:43], v58 offset:23264
    v_mfma_f32_16x16x32_bf16 v[160:163], v[52:55], a[16:19], v[160:163]
    buffer_load_dwordx4 v17, s[44:47], s84 offen offset:3072 lds
    v_mfma_f32_16x16x32_bf16 v[164:167], v[52:55], a[20:23], v[164:167]
    s_mov_b32 s84, 0
    ds_read_b64_tr_b16 v[44:45], v58 offset:27872
    ds_read_b64_tr_b16 v[46:47], v58 offset:32480
    v_mfma_f32_16x16x32_bf16 v[164:167], v[48:51], a[4:7], v[164:167]
    s_add_u32 m0, s83, 71680
    v_mfma_f32_16x16x32_bf16 v[168:171], v[48:51], a[8:11], v[168:171]
    v_mfma_f32_16x16x32_bf16 v[168:171], v[52:55], a[24:27], v[168:171]
    v_mfma_f32_16x16x32_bf16 v[172:175], v[52:55], a[28:31], v[172:175]
    buffer_load_dwordx4 v18, s[48:51], s84 offen offset:0 lds
    v_mfma_f32_16x16x32_bf16 v[172:175], v[48:51], a[12:15], v[172:175]
    s_waitcnt lgkmcnt(6)
    v_mfma_f32_16x16x32_bf16 v[192:195], v[32:35], a[0:3], v[192:195]
    s_waitcnt lgkmcnt(4)
    ds_read_b64_tr_b16 v[48:49], v58 offset:18688
    ds_read_b64_tr_b16 v[50:51], v58 offset:23296
    v_mfma_f32_16x16x32_bf16 v[192:195], v[36:39], a[16:19], v[192:195]
    ds_read_b64_tr_b16 v[52:53], v58 offset:27904
    ds_read_b64_tr_b16 v[54:55], v58 offset:32512
    v_mfma_f32_16x16x32_bf16 v[196:199], v[36:39], a[20:23], v[196:199]
    v_mfma_f32_16x16x32_bf16 v[196:199], v[32:35], a[4:7], v[196:199]
    buffer_load_dwordx4 v19, s[48:51], s84 offen offset:1024 lds
    v_mfma_f32_16x16x32_bf16 v[200:203], v[32:35], a[8:11], v[200:203]
    v_mfma_f32_16x16x32_bf16 v[200:203], v[36:39], a[24:27], v[200:203]
    v_mfma_f32_16x16x32_bf16 v[204:207], v[36:39], a[28:31], v[204:207]
    v_mfma_f32_16x16x32_bf16 v[204:207], v[32:35], a[12:15], v[204:207]
    s_waitcnt lgkmcnt(6)
    v_mfma_f32_16x16x32_bf16 v[224:227], v[40:43], a[0:3], v[224:227]
    s_waitcnt lgkmcnt(4)
    buffer_load_dwordx4 v18, s[48:51], s84 offen offset:2048 lds
    v_mfma_f32_16x16x32_bf16 v[224:227], v[44:47], a[16:19], v[224:227]
    ds_read_b64_tr_b16 v[32:33], v58 offset:36864
    ds_read_b64_tr_b16 v[34:35], v58 offset:41472
    v_mfma_f32_16x16x32_bf16 v[228:231], v[44:47], a[20:23], v[228:231]
    ds_read_b64_tr_b16 v[36:37], v56 offset:36864
    ds_read_b64_tr_b16 v[38:39], v56 offset:41472
    v_mfma_f32_16x16x32_bf16 v[228:231], v[40:43], a[4:7], v[228:231]
    v_mfma_f32_16x16x32_bf16 v[232:235], v[40:43], a[8:11], v[232:235]
    v_mfma_f32_16x16x32_bf16 v[232:235], v[44:47], a[24:27], v[232:235]
    buffer_load_dwordx4 v19, s[48:51], s84 offen offset:3072 lds
    v_mfma_f32_16x16x32_bf16 v[236:239], v[44:47], a[28:31], v[236:239]
    v_mfma_f32_16x16x32_bf16 v[236:239], v[40:43], a[12:15], v[236:239]
    s_waitcnt lgkmcnt(6)
    v_mfma_f32_16x16x32_bf16 v[240:243], v[48:51], a[0:3], v[240:243]
    s_waitcnt lgkmcnt(4)
    ds_read_b64_tr_b16 v[40:41], v56 offset:46080
    ds_read_b64_tr_b16 v[42:43], v56 offset:50688
    v_mfma_f32_16x16x32_bf16 v[240:243], v[52:55], a[16:19], v[240:243]
    ds_read_b64_tr_b16 v[44:45], v57 offset:0
    ds_read_b64_tr_b16 v[46:47], v57 offset:4608
    v_mfma_f32_16x16x32_bf16 v[244:247], v[52:55], a[20:23], v[244:247]
    v_mfma_f32_16x16x32_bf16 v[244:247], v[48:51], a[4:7], v[244:247]
    v_mfma_f32_16x16x32_bf16 v[248:251], v[48:51], a[8:11], v[248:251]
    v_mfma_f32_16x16x32_bf16 v[248:251], v[52:55], a[24:27], v[248:251]
    v_mfma_f32_16x16x32_bf16 v[252:255], v[52:55], a[28:31], v[252:255]
    v_mfma_f32_16x16x32_bf16 v[252:255], v[48:51], a[12:15], v[252:255]
    s_waitcnt vmcnt(27) lgkmcnt(6)
    v_mfma_f32_16x16x32_bf16 v[64:67], v[32:35], a[32:35], v[64:67]
    s_waitcnt vmcnt(23) lgkmcnt(4)
    ds_read_b64_tr_b16 v[48:49], v58 offset:36896
    ds_read_b64_tr_b16 v[50:51], v58 offset:41504
    v_mfma_f32_16x16x32_bf16 v[64:67], v[36:39], a[48:51], v[64:67]
    s_waitcnt vmcnt(22)
    ds_read_b64_tr_b16 v[52:53], v56 offset:36896
    ds_read_b64_tr_b16 v[54:55], v56 offset:41504
    v_mfma_f32_16x16x32_bf16 v[68:71], v[36:39], a[52:55], v[68:71]
    v_mfma_f32_16x16x32_bf16 v[68:71], v[32:35], a[36:39], v[68:71]
    v_mfma_f32_16x16x32_bf16 v[72:75], v[32:35], a[40:43], v[72:75]
    s_waitcnt vmcnt(21)
    v_mfma_f32_16x16x32_bf16 v[72:75], v[36:39], a[56:59], v[72:75]
    s_waitcnt vmcnt(20)
    v_mfma_f32_16x16x32_bf16 v[76:79], v[36:39], a[60:63], v[76:79]
    v_mfma_f32_16x16x32_bf16 v[76:79], v[32:35], a[44:47], v[76:79]
    s_waitcnt vmcnt(15) lgkmcnt(6)
    v_mfma_f32_16x16x32_bf16 v[64:67], v[40:43], a[64:67], v[64:67]
    s_waitcnt vmcnt(11) lgkmcnt(4)
    ds_read_b64_tr_b16 v[32:33], v56 offset:46112
    ds_read_b64_tr_b16 v[34:35], v56 offset:50720
    v_mfma_f32_16x16x32_bf16 v[64:67], v[44:47], a[80:83], v[64:67]
    s_waitcnt vmcnt(10)
    ds_read_b64_tr_b16 v[36:37], v57 offset:32
    ds_read_b64_tr_b16 v[38:39], v57 offset:4640
    v_mfma_f32_16x16x32_bf16 v[68:71], v[44:47], a[84:87], v[68:71]
    v_mfma_f32_16x16x32_bf16 v[68:71], v[40:43], a[68:71], v[68:71]
    v_mfma_f32_16x16x32_bf16 v[72:75], v[40:43], a[72:75], v[72:75]
    s_waitcnt vmcnt(9)
    v_mfma_f32_16x16x32_bf16 v[72:75], v[44:47], a[88:91], v[72:75]
    s_waitcnt vmcnt(8)
    v_mfma_f32_16x16x32_bf16 v[76:79], v[44:47], a[92:95], v[76:79]
    v_mfma_f32_16x16x32_bf16 v[76:79], v[40:43], a[76:79], v[76:79]
    s_waitcnt lgkmcnt(6)
    v_mfma_f32_16x16x32_bf16 a[128:131], v[48:51], a[32:35], a[128:131]
    s_waitcnt lgkmcnt(4)
    ds_read_b64_tr_b16 v[40:41], v58 offset:36928
    ds_read_b64_tr_b16 v[42:43], v58 offset:41536
    v_mfma_f32_16x16x32_bf16 a[128:131], v[52:55], a[48:51], a[128:131]
    ds_read_b64_tr_b16 v[44:45], v56 offset:36928
    ds_read_b64_tr_b16 v[46:47], v56 offset:41536
    v_mfma_f32_16x16x32_bf16 a[132:135], v[52:55], a[52:55], a[132:135]
    v_mfma_f32_16x16x32_bf16 a[132:135], v[48:51], a[36:39], a[132:135]
    v_cvt_pk_bf16_f32 v64, v64, v65
    v_cvt_pk_bf16_f32 v65, v66, v67
    v_mfma_f32_16x16x32_bf16 a[136:139], v[48:51], a[40:43], a[136:139]
    v_cvt_pk_bf16_f32 v66, v68, v69
    v_cvt_pk_bf16_f32 v67, v70, v71
    v_mfma_f32_16x16x32_bf16 a[136:139], v[52:55], a[56:59], a[136:139]
    s_mov_b32 s90, 0
    v_cvt_pk_bf16_f32 v72, v72, v73
    v_cvt_pk_bf16_f32 v73, v74, v75
    v_mfma_f32_16x16x32_bf16 a[140:143], v[52:55], a[60:63], a[140:143]
    v_cvt_pk_bf16_f32 v74, v76, v77
    v_cvt_pk_bf16_f32 v75, v78, v79
    v_mfma_f32_16x16x32_bf16 a[140:143], v[48:51], a[44:47], a[140:143]
    s_waitcnt lgkmcnt(6)
    buffer_store_dwordx4 v[64:67], v59, s[64:67], s90 offen offset:0 sc1
    v_mfma_f32_16x16x32_bf16 a[128:131], v[32:35], a[64:67], a[128:131]
    s_waitcnt lgkmcnt(4)
    s_mov_b32 s90, 4096
    ds_read_b64_tr_b16 v[48:49], v56 offset:46144
    ds_read_b64_tr_b16 v[50:51], v56 offset:50752
    v_mfma_f32_16x16x32_bf16 a[128:131], v[36:39], a[80:83], a[128:131]
    ds_read_b64_tr_b16 v[52:53], v57 offset:64
    ds_read_b64_tr_b16 v[54:55], v57 offset:4672
    v_mfma_f32_16x16x32_bf16 a[132:135], v[36:39], a[84:87], a[132:135]
    v_mfma_f32_16x16x32_bf16 a[132:135], v[32:35], a[68:71], a[132:135]
    v_mfma_f32_16x16x32_bf16 a[136:139], v[32:35], a[72:75], a[136:139]
    v_mfma_f32_16x16x32_bf16 a[136:139], v[36:39], a[88:91], a[136:139]
    v_mfma_f32_16x16x32_bf16 a[140:143], v[36:39], a[92:95], a[140:143]
    v_mfma_f32_16x16x32_bf16 a[140:143], v[32:35], a[76:79], a[140:143]
    s_waitcnt lgkmcnt(6)
    buffer_store_dwordx4 v[72:75], v59, s[64:67], s90 offen offset:0 sc1
    v_mfma_f32_16x16x32_bf16 v[80:83], v[40:43], a[32:35], v[80:83]
    s_waitcnt lgkmcnt(4)
    ds_read_b64_tr_b16 v[32:33], v58 offset:36960
    ds_read_b64_tr_b16 v[34:35], v58 offset:41568
    v_mfma_f32_16x16x32_bf16 v[80:83], v[44:47], a[48:51], v[80:83]
    ds_read_b64_tr_b16 v[36:37], v56 offset:36960
    ds_read_b64_tr_b16 v[38:39], v56 offset:41568
    v_mfma_f32_16x16x32_bf16 v[84:87], v[44:47], a[52:55], v[84:87]
    v_mfma_f32_16x16x32_bf16 v[84:87], v[40:43], a[36:39], v[84:87]
    v_accvgpr_read_b32 v76, a132
    v_accvgpr_read_b32 v77, a133
    v_mfma_f32_16x16x32_bf16 v[88:91], v[40:43], a[40:43], v[88:91]
    v_accvgpr_read_b32 v78, a134
    v_accvgpr_read_b32 v79, a135
    v_mfma_f32_16x16x32_bf16 v[88:91], v[44:47], a[56:59], v[88:91]
    v_accvgpr_read_b32 v68, a128
    v_accvgpr_read_b32 v69, a129
    v_mfma_f32_16x16x32_bf16 v[92:95], v[44:47], a[60:63], v[92:95]
    v_accvgpr_read_b32 v70, a130
    v_accvgpr_read_b32 v71, a131
    v_mfma_f32_16x16x32_bf16 v[92:95], v[40:43], a[44:47], v[92:95]
    s_waitcnt lgkmcnt(6)
    v_cvt_pk_bf16_f32 v68, v68, v69
    v_cvt_pk_bf16_f32 v69, v70, v71
    v_mfma_f32_16x16x32_bf16 v[80:83], v[48:51], a[64:67], v[80:83]
    s_waitcnt lgkmcnt(4)
    ds_read_b64_tr_b16 v[40:41], v56 offset:46176
    ds_read_b64_tr_b16 v[42:43], v56 offset:50784
    v_mfma_f32_16x16x32_bf16 v[80:83], v[52:55], a[80:83], v[80:83]
    ds_read_b64_tr_b16 v[44:45], v57 offset:96
    ds_read_b64_tr_b16 v[46:47], v57 offset:4704
    v_mfma_f32_16x16x32_bf16 v[84:87], v[52:55], a[84:87], v[84:87]
    v_cvt_pk_bf16_f32 v70, v76, v77
    v_cvt_pk_bf16_f32 v71, v78, v79
    v_mfma_f32_16x16x32_bf16 v[84:87], v[48:51], a[68:71], v[84:87]
    s_mov_b32 s90, 0
    v_mfma_f32_16x16x32_bf16 v[88:91], v[48:51], a[72:75], v[88:91]
    v_mfma_f32_16x16x32_bf16 v[88:91], v[52:55], a[88:91], v[88:91]
    buffer_store_dwordx4 v[68:71], v59, s[64:67], s90 offen offset:1024 sc1
    v_mfma_f32_16x16x32_bf16 v[92:95], v[52:55], a[92:95], v[92:95]
    v_nop
    v_accvgpr_read_b32 v76, a140
    v_mfma_f32_16x16x32_bf16 v[92:95], v[48:51], a[76:79], v[92:95]
    s_waitcnt lgkmcnt(6)
    v_accvgpr_read_b32 v77, a141
    v_accvgpr_read_b32 v78, a142
    v_mfma_f32_16x16x32_bf16 v[96:99], v[32:35], a[32:35], v[96:99]
    s_waitcnt lgkmcnt(4)
    ds_read_b64_tr_b16 v[48:49], v58 offset:36992
    ds_read_b64_tr_b16 v[50:51], v58 offset:41600
    v_mfma_f32_16x16x32_bf16 v[96:99], v[36:39], a[48:51], v[96:99]
    ds_read_b64_tr_b16 v[52:53], v56 offset:36992
    ds_read_b64_tr_b16 v[54:55], v56 offset:41600
    v_mfma_f32_16x16x32_bf16 v[100:103], v[36:39], a[52:55], v[100:103]
    v_accvgpr_read_b32 v79, a143
    v_accvgpr_read_b32 v68, a136
    v_mfma_f32_16x16x32_bf16 v[100:103], v[32:35], a[36:39], v[100:103]
Lpad7:
    s_cbranch_execz Lpad9
    v_accvgpr_read_b32 v69, a137
    v_accvgpr_read_b32 v70, a138
    v_mfma_f32_16x16x32_bf16 v[104:107], v[32:35], a[40:43], v[104:107]
    v_accvgpr_read_b32 v71, a139
    v_cvt_pk_bf16_f32 v68, v68, v69
    v_mfma_f32_16x16x32_bf16 v[104:107], v[36:39], a[56:59], v[104:107]
    v_cvt_pk_bf16_f32 v69, v70, v71
    v_cvt_pk_bf16_f32 v70, v76, v77
    v_mfma_f32_16x16x32_bf16 v[108:111], v[36:39], a[60:63], v[108:111]
    v_cvt_pk_bf16_f32 v71, v78, v79
    v_mfma_f32_16x16x32_bf16 v[108:111], v[32:35], a[44:47], v[108:111]
    s_waitcnt lgkmcnt(6)
    s_mov_b32 s90, 4096
    v_mfma_f32_16x16x32_bf16 v[96:99], v[40:43], a[64:67], v[96:99]
    s_waitcnt lgkmcnt(4)
    ds_read_b64_tr_b16 v[32:33], v56 offset:46208
    ds_read_b64_tr_b16 v[34:35], v56 offset:50816
    v_mfma_f32_16x16x32_bf16 v[96:99], v[44:47], a[80:83], v[96:99]
    ds_read_b64_tr_b16 v[36:37], v57 offset:128
    ds_read_b64_tr_b16 v[38:39], v57 offset:4736
    v_mfma_f32_16x16x32_bf16 v[100:103], v[44:47], a[84:87], v[100:103]
    v_mfma_f32_16x16x32_bf16 v[100:103], v[40:43], a[68:71], v[100:103]
    buffer_store_dwordx4 v[68:71], v59, s[64:67], s90 offen offset:1024 sc1
    v_mfma_f32_16x16x32_bf16 v[104:107], v[40:43], a[72:75], v[104:107]
    v_nop
    v_cvt_pk_bf16_f32 v80, v80, v81
    v_mfma_f32_16x16x32_bf16 v[104:107], v[44:47], a[88:91], v[104:107]
    v_cvt_pk_bf16_f32 v81, v82, v83
    v_cvt_pk_bf16_f32 v82, v84, v85
    v_mfma_f32_16x16x32_bf16 v[108:111], v[44:47], a[92:95], v[108:111]
    v_cvt_pk_bf16_f32 v83, v86, v87
    v_cvt_pk_bf16_f32 v88, v88, v89
    v_mfma_f32_16x16x32_bf16 v[108:111], v[40:43], a[76:79], v[108:111]
    s_waitcnt lgkmcnt(6)
    s_mov_b32 s90, 0
    v_cvt_pk_bf16_f32 v89, v90, v91
    v_cvt_pk_bf16_f32 v90, v92, v93
    v_mfma_f32_16x16x32_bf16 v[128:131], v[48:51], a[32:35], v[128:131]
    s_waitcnt lgkmcnt(4)
    ds_read_b64_tr_b16 v[40:41], v58 offset:37024
    ds_read_b64_tr_b16 v[42:43], v58 offset:41632
    v_mfma_f32_16x16x32_bf16 v[128:131], v[52:55], a[48:51], v[128:131]
    ds_read_b64_tr_b16 v[44:45], v56 offset:37024
    ds_read_b64_tr_b16 v[46:47], v56 offset:41632
    v_mfma_f32_16x16x32_bf16 v[132:135], v[52:55], a[52:55], v[132:135]
    v_cvt_pk_bf16_f32 v91, v94, v95
    v_mfma_f32_16x16x32_bf16 v[132:135], v[48:51], a[36:39], v[132:135]
    v_cvt_pk_bf16_f32 v96, v96, v97
    v_cvt_pk_bf16_f32 v97, v98, v99
    v_mfma_f32_16x16x32_bf16 v[136:139], v[48:51], a[40:43], v[136:139]
    v_cvt_pk_bf16_f32 v98, v100, v101
    v_cvt_pk_bf16_f32 v99, v102, v103
    v_mfma_f32_16x16x32_bf16 v[136:139], v[52:55], a[56:59], v[136:139]
    v_accvgpr_write_b32 a212, v96
    v_accvgpr_write_b32 a213, v97
    v_mfma_f32_16x16x32_bf16 v[140:143], v[52:55], a[60:63], v[140:143]
    v_accvgpr_write_b32 a214, v98
    v_accvgpr_write_b32 a215, v99
    v_mfma_f32_16x16x32_bf16 v[140:143], v[48:51], a[44:47], v[140:143]
    s_waitcnt lgkmcnt(6)
    v_cvt_pk_bf16_f32 v104, v104, v105
    v_cvt_pk_bf16_f32 v105, v106, v107
    v_mfma_f32_16x16x32_bf16 v[128:131], v[32:35], a[64:67], v[128:131]
    s_waitcnt lgkmcnt(4)
    ds_read_b64_tr_b16 v[48:49], v56 offset:46240
    ds_read_b64_tr_b16 v[50:51], v56 offset:50848
    v_mfma_f32_16x16x32_bf16 v[128:131], v[36:39], a[80:83], v[128:131]
    buffer_store_dwordx4 v[80:83], v59, s[64:67], s90 offen offset:2048 sc1
    v_mfma_f32_16x16x32_bf16 v[132:135], v[36:39], a[84:87], v[132:135]
    s_mov_b32 s90, 4096
    ds_read_b64_tr_b16 v[52:53], v57 offset:160
    ds_read_b64_tr_b16 v[54:55], v57 offset:4768
    v_mfma_f32_16x16x32_bf16 v[132:135], v[32:35], a[68:71], v[132:135]
    v_cvt_pk_bf16_f32 v106, v108, v109
    v_cvt_pk_bf16_f32 v107, v110, v111
    v_mfma_f32_16x16x32_bf16 v[136:139], v[32:35], a[72:75], v[136:139]
    v_accvgpr_write_b32 a216, v104
    v_accvgpr_write_b32 a217, v105
    v_mfma_f32_16x16x32_bf16 v[136:139], v[36:39], a[88:91], v[136:139]
    v_accvgpr_write_b32 a218, v106
    v_accvgpr_write_b32 a219, v107
    v_mfma_f32_16x16x32_bf16 v[140:143], v[36:39], a[92:95], v[140:143]
    v_mfma_f32_16x16x32_bf16 v[140:143], v[32:35], a[76:79], v[140:143]
    s_waitcnt lgkmcnt(6)
    v_mfma_f32_16x16x32_bf16 v[160:163], v[40:43], a[32:35], v[160:163]
    s_waitcnt lgkmcnt(4)
    ds_read_b64_tr_b16 v[32:33], v58 offset:37056
    ds_read_b64_tr_b16 v[34:35], v58 offset:41664
    v_mfma_f32_16x16x32_bf16 v[160:163], v[44:47], a[48:51], v[160:163]
    ds_read_b64_tr_b16 v[36:37], v56 offset:37056
    ds_read_b64_tr_b16 v[38:39], v56 offset:41664
    v_mfma_f32_16x16x32_bf16 v[164:167], v[44:47], a[52:55], v[164:167]
    v_mfma_f32_16x16x32_bf16 v[164:167], v[40:43], a[36:39], v[164:167]
    v_cvt_pk_bf16_f32 v128, v128, v129
    v_cvt_pk_bf16_f32 v129, v130, v131
    v_mfma_f32_16x16x32_bf16 v[168:171], v[40:43], a[40:43], v[168:171]
    v_cvt_pk_bf16_f32 v130, v132, v133
    v_cvt_pk_bf16_f32 v131, v134, v135
    v_mfma_f32_16x16x32_bf16 v[168:171], v[44:47], a[56:59], v[168:171]
    v_accvgpr_write_b32 a220, v128
    v_accvgpr_write_b32 a221, v129
    v_mfma_f32_16x16x32_bf16 v[172:175], v[44:47], a[60:63], v[172:175]
    v_accvgpr_write_b32 a222, v130
    v_accvgpr_write_b32 a223, v131
    v_mfma_f32_16x16x32_bf16 v[172:175], v[40:43], a[44:47], v[172:175]
    s_waitcnt lgkmcnt(6)
    buffer_store_dwordx4 v[88:91], v59, s[64:67], s90 offen offset:2048 sc1
    v_mfma_f32_16x16x32_bf16 v[160:163], v[48:51], a[64:67], v[160:163]
    s_waitcnt lgkmcnt(4)
    ds_read_b64_tr_b16 v[40:41], v56 offset:46272
    ds_read_b64_tr_b16 v[42:43], v56 offset:50880
    v_mfma_f32_16x16x32_bf16 v[160:163], v[52:55], a[80:83], v[160:163]
    ds_read_b64_tr_b16 v[44:45], v57 offset:192
    ds_read_b64_tr_b16 v[46:47], v57 offset:4800
    v_mfma_f32_16x16x32_bf16 v[164:167], v[52:55], a[84:87], v[164:167]
    v_cvt_pk_bf16_f32 v136, v136, v137
    v_cvt_pk_bf16_f32 v137, v138, v139
    v_mfma_f32_16x16x32_bf16 v[164:167], v[48:51], a[68:71], v[164:167]
    v_cvt_pk_bf16_f32 v138, v140, v141
    v_cvt_pk_bf16_f32 v139, v142, v143
    v_mfma_f32_16x16x32_bf16 v[168:171], v[48:51], a[72:75], v[168:171]
    v_accvgpr_write_b32 a224, v136
    v_accvgpr_write_b32 a225, v137
    v_mfma_f32_16x16x32_bf16 v[168:171], v[52:55], a[88:91], v[168:171]
    v_accvgpr_write_b32 a226, v138
    v_accvgpr_write_b32 a227, v139
    v_mfma_f32_16x16x32_bf16 v[172:175], v[52:55], a[92:95], v[172:175]
    v_mfma_f32_16x16x32_bf16 v[172:175], v[48:51], a[76:79], v[172:175]
    s_waitcnt lgkmcnt(6)
    v_mfma_f32_16x16x32_bf16 v[192:195], v[32:35], a[32:35], v[192:195]
    s_waitcnt lgkmcnt(4)
    ds_read_b64_tr_b16 v[48:49], v58 offset:37088
    ds_read_b64_tr_b16 v[50:51], v58 offset:41696
    v_mfma_f32_16x16x32_bf16 v[192:195], v[36:39], a[48:51], v[192:195]
    ds_read_b64_tr_b16 v[52:53], v56 offset:37088
    ds_read_b64_tr_b16 v[54:55], v56 offset:41696
    v_mfma_f32_16x16x32_bf16 v[196:199], v[36:39], a[52:55], v[196:199]
    v_mfma_f32_16x16x32_bf16 v[196:199], v[32:35], a[36:39], v[196:199]
    v_cvt_pk_bf16_f32 v160, v160, v161
    v_cvt_pk_bf16_f32 v161, v162, v163
    v_mfma_f32_16x16x32_bf16 v[200:203], v[32:35], a[40:43], v[200:203]
    v_cvt_pk_bf16_f32 v162, v164, v165
    v_cvt_pk_bf16_f32 v163, v166, v167
    v_mfma_f32_16x16x32_bf16 v[200:203], v[36:39], a[56:59], v[200:203]
    v_accvgpr_write_b32 a228, v160
    v_accvgpr_write_b32 a229, v161
    v_mfma_f32_16x16x32_bf16 v[204:207], v[36:39], a[60:63], v[204:207]
    v_accvgpr_write_b32 a230, v162
    v_accvgpr_write_b32 a231, v163
    v_mfma_f32_16x16x32_bf16 v[204:207], v[32:35], a[44:47], v[204:207]
    s_waitcnt lgkmcnt(6)
    v_cvt_pk_bf16_f32 v168, v168, v169
    v_cvt_pk_bf16_f32 v169, v170, v171
    v_mfma_f32_16x16x32_bf16 v[192:195], v[40:43], a[64:67], v[192:195]
    s_waitcnt lgkmcnt(4)
    ds_read_b64_tr_b16 v[32:33], v56 offset:46304
    ds_read_b64_tr_b16 v[34:35], v56 offset:50912
    v_mfma_f32_16x16x32_bf16 v[192:195], v[44:47], a[80:83], v[192:195]
    ds_read_b64_tr_b16 v[36:37], v57 offset:224
    ds_read_b64_tr_b16 v[38:39], v57 offset:4832
    v_mfma_f32_16x16x32_bf16 v[196:199], v[44:47], a[84:87], v[196:199]
    v_cvt_pk_bf16_f32 v170, v172, v173
    v_cvt_pk_bf16_f32 v171, v174, v175
    v_mfma_f32_16x16x32_bf16 v[196:199], v[40:43], a[68:71], v[196:199]
    v_accvgpr_write_b32 a232, v168
    v_accvgpr_write_b32 a233, v169
    v_mfma_f32_16x16x32_bf16 v[200:203], v[40:43], a[72:75], v[200:203]
    v_accvgpr_write_b32 a234, v170
    v_accvgpr_write_b32 a235, v171
    v_mfma_f32_16x16x32_bf16 v[200:203], v[44:47], a[88:91], v[200:203]
    v_mfma_f32_16x16x32_bf16 v[204:207], v[44:47], a[92:95], v[204:207]
    v_mfma_f32_16x16x32_bf16 v[204:207], v[40:43], a[76:79], v[204:207]
    s_waitcnt lgkmcnt(6)
    v_mfma_f32_16x16x32_bf16 v[224:227], v[48:51], a[32:35], v[224:227]
    s_waitcnt lgkmcnt(4)
    ds_read_b64_tr_b16 v[40:41], v58 offset:37120
    ds_read_b64_tr_b16 v[42:43], v58 offset:41728
    v_mfma_f32_16x16x32_bf16 v[224:227], v[52:55], a[48:51], v[224:227]
    ds_read_b64_tr_b16 v[44:45], v56 offset:37120
    ds_read_b64_tr_b16 v[46:47], v56 offset:41728
    v_mfma_f32_16x16x32_bf16 v[228:231], v[52:55], a[52:55], v[228:231]
    v_mfma_f32_16x16x32_bf16 v[228:231], v[48:51], a[36:39], v[228:231]
    v_cvt_pk_bf16_f32 v192, v192, v193
    v_cvt_pk_bf16_f32 v193, v194, v195
    v_mfma_f32_16x16x32_bf16 v[232:235], v[48:51], a[40:43], v[232:235]
    v_cvt_pk_bf16_f32 v194, v196, v197
    v_cvt_pk_bf16_f32 v195, v198, v199
    v_mfma_f32_16x16x32_bf16 v[232:235], v[52:55], a[56:59], v[232:235]
    v_accvgpr_write_b32 a236, v192
    v_accvgpr_write_b32 a237, v193
    v_mfma_f32_16x16x32_bf16 v[236:239], v[52:55], a[60:63], v[236:239]
    v_accvgpr_write_b32 a238, v194
    v_accvgpr_write_b32 a239, v195
    v_mfma_f32_16x16x32_bf16 v[236:239], v[48:51], a[44:47], v[236:239]
    s_waitcnt lgkmcnt(6)
    v_cvt_pk_bf16_f32 v200, v200, v201
    v_cvt_pk_bf16_f32 v201, v202, v203
    v_mfma_f32_16x16x32_bf16 v[224:227], v[32:35], a[64:67], v[224:227]
    s_waitcnt lgkmcnt(4)
    ds_read_b64_tr_b16 v[48:49], v56 offset:46336
    ds_read_b64_tr_b16 v[50:51], v56 offset:50944
    v_mfma_f32_16x16x32_bf16 v[224:227], v[36:39], a[80:83], v[224:227]
    ds_read_b64_tr_b16 v[52:53], v57 offset:256
    ds_read_b64_tr_b16 v[54:55], v57 offset:4864
    v_mfma_f32_16x16x32_bf16 v[228:231], v[36:39], a[84:87], v[228:231]
    v_cvt_pk_bf16_f32 v202, v204, v205
    v_cvt_pk_bf16_f32 v203, v206, v207
    v_mfma_f32_16x16x32_bf16 v[228:231], v[32:35], a[68:71], v[228:231]
    v_accvgpr_write_b32 a240, v200
    v_accvgpr_write_b32 a241, v201
    v_mfma_f32_16x16x32_bf16 v[232:235], v[32:35], a[72:75], v[232:235]
    v_accvgpr_write_b32 a242, v202
    v_accvgpr_write_b32 a243, v203
    v_mfma_f32_16x16x32_bf16 v[232:235], v[36:39], a[88:91], v[232:235]
    v_mfma_f32_16x16x32_bf16 v[236:239], v[36:39], a[92:95], v[236:239]
    v_mfma_f32_16x16x32_bf16 v[236:239], v[32:35], a[76:79], v[236:239]
    s_waitcnt lgkmcnt(6)
    v_mfma_f32_16x16x32_bf16 v[240:243], v[40:43], a[32:35], v[240:243]
    s_waitcnt lgkmcnt(4)
    v_mfma_f32_16x16x32_bf16 v[240:243], v[44:47], a[48:51], v[240:243]
    v_mfma_f32_16x16x32_bf16 v[244:247], v[44:47], a[52:55], v[244:247]
    v_mfma_f32_16x16x32_bf16 v[244:247], v[40:43], a[36:39], v[244:247]
    v_cvt_pk_bf16_f32 v224, v224, v225
    v_cvt_pk_bf16_f32 v225, v226, v227
    v_mfma_f32_16x16x32_bf16 v[248:251], v[40:43], a[40:43], v[248:251]
    v_cvt_pk_bf16_f32 v226, v228, v229
    v_cvt_pk_bf16_f32 v227, v230, v231
    v_mfma_f32_16x16x32_bf16 v[248:251], v[44:47], a[56:59], v[248:251]
    v_accvgpr_write_b32 a244, v224
    v_accvgpr_write_b32 a245, v225
    v_mfma_f32_16x16x32_bf16 v[252:255], v[44:47], a[60:63], v[252:255]
    v_accvgpr_write_b32 a246, v226
    v_accvgpr_write_b32 a247, v227
    v_mfma_f32_16x16x32_bf16 v[252:255], v[40:43], a[44:47], v[252:255]
    s_waitcnt lgkmcnt(2)
    v_cvt_pk_bf16_f32 v232, v232, v233
    v_cvt_pk_bf16_f32 v233, v234, v235
    v_mfma_f32_16x16x32_bf16 v[240:243], v[48:51], a[64:67], v[240:243]
    s_waitcnt lgkmcnt(0)
    v_cvt_pk_bf16_f32 v234, v236, v237
    v_cvt_pk_bf16_f32 v235, v238, v239
    v_mfma_f32_16x16x32_bf16 v[240:243], v[52:55], a[80:83], v[240:243]
    v_accvgpr_write_b32 a248, v232
    v_accvgpr_write_b32 a249, v233
    v_mfma_f32_16x16x32_bf16 v[244:247], v[52:55], a[84:87], v[244:247]
    v_accvgpr_write_b32 a250, v234
    v_accvgpr_write_b32 a251, v235
    v_mfma_f32_16x16x32_bf16 v[244:247], v[48:51], a[68:71], v[244:247]
    v_mfma_f32_16x16x32_bf16 v[248:251], v[48:51], a[72:75], v[248:251]
    v_mfma_f32_16x16x32_bf16 v[248:251], v[52:55], a[88:91], v[248:251]
    v_mfma_f32_16x16x32_bf16 v[252:255], v[52:55], a[92:95], v[252:255]
    v_mfma_f32_16x16x32_bf16 v[252:255], v[48:51], a[76:79], v[252:255]
    s_nop 7
    v_cvt_pk_bf16_f32 v240, v240, v241
    v_cvt_pk_bf16_f32 v241, v242, v243
    v_cvt_pk_bf16_f32 v242, v244, v245
    v_cvt_pk_bf16_f32 v243, v246, v247
    v_cvt_pk_bf16_f32 v248, v248, v249
    v_cvt_pk_bf16_f32 v249, v250, v251
    v_cvt_pk_bf16_f32 v250, v252, v253
    v_cvt_pk_bf16_f32 v251, v254, v255
    s_mov_b32 s90, 73728
    buffer_store_dwordx4 v[240:243], v59, s[64:67], s90 offen offset:3072 sc1
    s_mov_b32 s90, 77824
    buffer_store_dwordx4 v[248:251], v59, s[64:67], s90 offen offset:3072 sc1
    s_branch Ljoin
Leven:
    buffer_load_dwordx4 a[92:95], v2, s[52:55], s42 offen offset:3072 sc1
    v_mfma_f32_16x16x32_bf16 v[92:95], v[52:55], a[28:31], v[92:95]
    s_add_u32 s89, s14, 1024
    v_mfma_f32_16x16x32_bf16 v[92:95], v[48:51], a[12:15], v[92:95]
    s_waitcnt lgkmcnt(6)
    v_mfma_f32_16x16x32_bf16 v[96:99], v[32:35], a[0:3], v[96:99]
    s_waitcnt lgkmcnt(4)
    buffer_load_dword v61, v1, s[56:59], s89 offen offset:64 sc1
    v_mfma_f32_16x16x32_bf16 v[96:99], v[36:39], a[16:19], v[96:99]
    s_lshl_b32 s42, s3, 17
    ds_read_b64_tr_b16 v[48:49], v58 offset:18592
    ds_read_b64_tr_b16 v[50:51], v58 offset:23200
    v_mfma_f32_16x16x32_bf16 v[100:103], v[36:39], a[20:23], v[100:103]
    s_add_u32 s42, s42, 524288
    ds_read_b64_tr_b16 v[52:53], v58 offset:27808
    ds_read_b64_tr_b16 v[54:55], v58 offset:32416
    v_mfma_f32_16x16x32_bf16 v[100:103], v[32:35], a[4:7], v[100:103]
    buffer_load_dwordx2 a[96:97], v19, s[52:55], s42 offen offset:0 sc1
    v_mfma_f32_16x16x32_bf16 v[104:107], v[32:35], a[8:11], v[104:107]
    v_mfma_f32_16x16x32_bf16 v[104:107], v[36:39], a[24:27], v[104:107]
    v_mfma_f32_16x16x32_bf16 v[108:111], v[36:39], a[28:31], v[108:111]
    buffer_load_dwordx2 a[100:101], v19, s[52:55], s42 offen offset:512 sc1
    v_mfma_f32_16x16x32_bf16 v[108:111], v[32:35], a[12:15], v[108:111]
    s_waitcnt lgkmcnt(6)
    v_mfma_f32_16x16x32_bf16 v[128:131], v[40:43], a[0:3], v[128:131]
    s_waitcnt lgkmcnt(4)
    ds_read_b64_tr_b16 v[32:33], v58 offset:18624
    ds_read_b64_tr_b16 v[34:35], v58 offset:23232
    v_mfma_f32_16x16x32_bf16 v[128:131], v[44:47], a[16:19], v[128:131]
    buffer_load_dwordx2 a[104:105], v19, s[52:55], s42 offen offset:1024 sc1
    v_mfma_f32_16x16x32_bf16 v[132:135], v[44:47], a[20:23], v[132:135]
    ds_read_b64_tr_b16 v[36:37], v58 offset:27840
    ds_read_b64_tr_b16 v[38:39], v58 offset:32448
    v_mfma_f32_16x16x32_bf16 v[132:135], v[40:43], a[4:7], v[132:135]
    v_mfma_f32_16x16x32_bf16 v[136:139], v[40:43], a[8:11], v[136:139]
    buffer_load_dwordx2 a[108:109], v19, s[52:55], s42 offen offset:1536 sc1
    v_mfma_f32_16x16x32_bf16 v[136:139], v[44:47], a[24:27], v[136:139]
    s_lshl_b32 s42, s3, 17
    v_mfma_f32_16x16x32_bf16 v[140:143], v[44:47], a[28:31], v[140:143]
    s_add_u32 s42, s42, 589824
    v_mfma_f32_16x16x32_bf16 v[140:143], v[40:43], a[12:15], v[140:143]
    s_waitcnt lgkmcnt(6)
    buffer_load_dwordx2 a[98:99], v19, s[52:55], s42 offen offset:0 sc1
    v_mfma_f32_16x16x32_bf16 v[160:163], v[48:51], a[0:3], v[160:163]
    s_waitcnt lgkmcnt(4)
    ds_read_b64_tr_b16 v[40:41], v58 offset:18656
    ds_read_b64_tr_b16 v[42:43], v58 offset:23264
    v_mfma_f32_16x16x32_bf16 v[160:163], v[52:55], a[16:19], v[160:163]
    ds_read_b64_tr_b16 v[44:45], v58 offset:27872
    ds_read_b64_tr_b16 v[46:47], v58 offset:32480
    v_mfma_f32_16x16x32_bf16 v[164:167], v[52:55], a[20:23], v[164:167]
    buffer_load_dwordx2 a[102:103], v19, s[52:55], s42 offen offset:512 sc1
    v_mfma_f32_16x16x32_bf16 v[164:167], v[48:51], a[4:7], v[164:167]
    v_mfma_f32_16x16x32_bf16 v[168:171], v[48:51], a[8:11], v[168:171]
    v_mfma_f32_16x16x32_bf16 v[168:171], v[52:55], a[24:27], v[168:171]
    buffer_load_dwordx2 a[106:107], v19, s[52:55], s42 offen offset:1024 sc1
    v_mfma_f32_16x16x32_bf16 v[172:175], v[52:55], a[28:31], v[172:175]
    v_mfma_f32_16x16x32_bf16 v[172:175], v[48:51], a[12:15], v[172:175]
    s_waitcnt lgkmcnt(6)
    v_mfma_f32_16x16x32_bf16 v[192:195], v[32:35], a[0:3], v[192:195]
    s_waitcnt lgkmcnt(4)
    buffer_load_dwordx2 a[110:111], v19, s[52:55], s42 offen offset:1536 sc1
    v_mfma_f32_16x16x32_bf16 v[192:195], v[36:39], a[16:19], v[192:195]
    s_lshl_b32 s42, s3, 17
    ds_read_b64_tr_b16 v[48:49], v58 offset:18688
    ds_read_b64_tr_b16 v[50:51], v58 offset:23296
    v_mfma_f32_16x16x32_bf16 v[196:199], v[36:39], a[20:23], v[196:199]
    s_add_u32 s42, s42, 1703936
    ds_read_b64_tr_b16 v[52:53], v58 offset:27904
    ds_read_b64_tr_b16 v[54:55], v58 offset:32512
    v_mfma_f32_16x16x32_bf16 v[196:199], v[32:35], a[4:7], v[196:199]
    buffer_load_dwordx2 a[112:113], v19, s[52:55], s42 offen offset:0 sc1
    v_mfma_f32_16x16x32_bf16 v[200:203], v[32:35], a[8:11], v[200:203]
    v_mfma_f32_16x16x32_bf16 v[200:203], v[36:39], a[24:27], v[200:203]
    v_mfma_f32_16x16x32_bf16 v[204:207], v[36:39], a[28:31], v[204:207]
    buffer_load_dwordx2 a[116:117], v19, s[52:55], s42 offen offset:512 sc1
    v_mfma_f32_16x16x32_bf16 v[204:207], v[32:35], a[12:15], v[204:207]
    s_waitcnt lgkmcnt(6)
    v_mfma_f32_16x16x32_bf16 v[224:227], v[40:43], a[0:3], v[224:227]
    s_waitcnt lgkmcnt(4)
    ds_read_b64_tr_b16 v[32:33], v58 offset:36864
    ds_read_b64_tr_b16 v[34:35], v58 offset:41472
    v_mfma_f32_16x16x32_bf16 v[224:227], v[44:47], a[16:19], v[224:227]
    buffer_load_dwordx2 a[120:121], v19, s[52:55], s42 offen offset:1024 sc1
    v_mfma_f32_16x16x32_bf16 v[228:231], v[44:47], a[20:23], v[228:231]
    ds_read_b64_tr_b16 v[36:37], v56 offset:36864
    ds_read_b64_tr_b16 v[38:39], v56 offset:41472
    v_mfma_f32_16x16x32_bf16 v[228:231], v[40:43], a[4:7], v[228:231]
    v_mfma_f32_16x16x32_bf16 v[232:235], v[40:43], a[8:11], v[232:235]
    buffer_load_dwordx2 a[124:125], v19, s[52:55], s42 offen offset:1536 sc1
    v_mfma_f32_16x16x32_bf16 v[232:235], v[44:47], a[24:27], v[232:235]
    s_lshl_b32 s42, s3, 17
    v_mfma_f32_16x16x32_bf16 v[236:239], v[44:47], a[28:31], v[236:239]
    s_add_u32 s42, s42, 1769472
    v_mfma_f32_16x16x32_bf16 v[236:239], v[40:43], a[12:15], v[236:239]
    s_waitcnt lgkmcnt(6)
    buffer_load_dwordx2 a[114:115], v19, s[52:55], s42 offen offset:0 sc1
    v_mfma_f32_16x16x32_bf16 v[240:243], v[48:51], a[0:3], v[240:243]
    s_waitcnt lgkmcnt(4)
    ds_read_b64_tr_b16 v[40:41], v58 offset:36896
    ds_read_b64_tr_b16 v[42:43], v58 offset:41504
    v_mfma_f32_16x16x32_bf16 v[240:243], v[52:55], a[16:19], v[240:243]
    ds_read_b64_tr_b16 v[44:45], v56 offset:36896
    ds_read_b64_tr_b16 v[46:47], v56 offset:41504
    v_mfma_f32_16x16x32_bf16 v[244:247], v[52:55], a[20:23], v[244:247]
    buffer_load_dwordx2 a[118:119], v19, s[52:55], s42 offen offset:512 sc1
    v_mfma_f32_16x16x32_bf16 v[244:247], v[48:51], a[4:7], v[244:247]
    v_mfma_f32_16x16x32_bf16 v[248:251], v[48:51], a[8:11], v[248:251]
    v_mfma_f32_16x16x32_bf16 v[248:251], v[52:55], a[24:27], v[248:251]
    buffer_load_dwordx2 a[122:123], v19, s[52:55], s42 offen offset:1024 sc1
    v_mfma_f32_16x16x32_bf16 v[252:255], v[52:55], a[28:31], v[252:255]
    v_mfma_f32_16x16x32_bf16 v[252:255], v[48:51], a[12:15], v[252:255]
    s_waitcnt vmcnt(35) lgkmcnt(6)
    v_mfma_f32_16x16x32_bf16 v[64:67], v[32:35], a[32:35], v[64:67]
    s_waitcnt vmcnt(15)
    v_cmp_ne_u32 vcc, s22, v61
    s_nop 0
    s_cbranch_vccnz Lspin_hp
Lret_hp:
    s_waitcnt lgkmcnt(4)
    v_mfma_f32_16x16x32_bf16 v[64:67], v[36:39], a[48:51], v[64:67]
    buffer_load_dwordx2 a[126:127], v19, s[52:55], s42 offen offset:1536 sc1
    v_mfma_f32_16x16x32_bf16 v[68:71], v[36:39], a[52:55], v[68:71]
    ds_read_b64_tr_b16 v[48:49], v58 offset:36928
    ds_read_b64_tr_b16 v[50:51], v58 offset:41536
    v_mfma_f32_16x16x32_bf16 v[68:71], v[32:35], a[36:39], v[68:71]
    ds_read_b64_tr_b16 v[52:53], v56 offset:36928
    ds_read_b64_tr_b16 v[54:55], v56 offset:41536
    v_mfma_f32_16x16x32_bf16 v[72:75], v[32:35], a[40:43], v[72:75]
    v_add_u32 v61, 4096, v60
    v_mfma_f32_16x16x32_bf16 v[72:75], v[36:39], a[56:59], v[72:75]
    v_mfma_f32_16x16x32_bf16 v[76:79], v[36:39], a[60:63], v[76:79]
    v_mfma_f32_16x16x32_bf16 v[76:79], v[32:35], a[44:47], v[76:79]
    s_waitcnt lgkmcnt(6)
    s_nop 0
    v_mfma_f32_16x16x32_bf16 a[128:131], v[40:43], a[32:35], a[128:131]
    s_barrier
    ds_read_b64_tr_b16 v[32:33], v58 offset:36960
    ds_read_b64_tr_b16 v[34:35], v58 offset:41568
    s_waitcnt lgkmcnt(6)
    v_mfma_f32_16x16x32_bf16 a[128:131], v[44:47], a[48:51], a[128:131]
    s_mul_i32 s41, s70, 331776
    ds_read_b64_tr_b16 v[36:37], v56 offset:36960
    ds_read_b64_tr_b16 v[38:39], v56 offset:41568
    v_mfma_f32_16x16x32_bf16 a[132:135], v[44:47], a[52:55], a[132:135]
    s_add_u32 s41, s41, 147456
    v_mfma_f32_16x16x32_bf16 a[132:135], v[40:43], a[36:39], a[132:135]
    s_add_u32 s40, s81, 92160
    v_mfma_f32_16x16x32_bf16 a[136:139], v[40:43], a[40:43], a[136:139]
    s_mov_b32 s62, 1327104
    v_mfma_f32_16x16x32_bf16 a[136:139], v[44:47], a[56:59], a[136:139]
    s_add_u32 m0, s40, 0
    v_mfma_f32_16x16x32_bf16 a[140:143], v[44:47], a[60:63], a[140:143]
    buffer_load_dwordx4 v3, s[60:63], s41 offen lds
    v_mfma_f32_16x16x32_bf16 a[140:143], v[40:43], a[44:47], a[140:143]
    s_waitcnt lgkmcnt(6)
    s_add_u32 m0, s40, 1024
    v_mfma_f32_16x16x32_bf16 v[80:83], v[48:51], a[32:35], v[80:83]
    s_waitcnt lgkmcnt(4)
    ds_read_b64_tr_b16 v[40:41], v58 offset:36992
    ds_read_b64_tr_b16 v[42:43], v58 offset:41600
    v_mfma_f32_16x16x32_bf16 v[80:83], v[52:55], a[48:51], v[80:83]
    buffer_load_dwordx4 v4, s[60:63], s41 offen lds
    v_mfma_f32_16x16x32_bf16 v[84:87], v[52:55], a[52:55], v[84:87]
    s_add_u32 m0, s40, 2048
    ds_read_b64_tr_b16 v[44:45], v56 offset:36992
    ds_read_b64_tr_b16 v[46:47], v56 offset:41600
    v_mfma_f32_16x16x32_bf16 v[84:87], v[48:51], a[36:39], v[84:87]
    v_mfma_f32_16x16x32_bf16 v[88:91], v[48:51], a[40:43], v[88:91]
    buffer_load_dwordx4 v5, s[60:63], s41 offen lds
    v_mfma_f32_16x16x32_bf16 v[88:91], v[52:55], a[56:59], v[88:91]
    s_add_u32 m0, s40, 3072
    v_mfma_f32_16x16x32_bf16 v[92:95], v[52:55], a[60:63], v[92:95]
    v_mfma_f32_16x16x32_bf16 v[92:95], v[48:51], a[44:47], v[92:95]
    s_waitcnt lgkmcnt(6)
    buffer_load_dwordx4 v6, s[60:63], s41 offen lds
    v_mfma_f32_16x16x32_bf16 v[96:99], v[32:35], a[32:35], v[96:99]
    s_waitcnt lgkmcnt(4)
    s_add_u32 m0, s40, 4096
    ds_read_b64_tr_b16 v[48:49], v58 offset:37024
    ds_read_b64_tr_b16 v[50:51], v58 offset:41632
    v_mfma_f32_16x16x32_bf16 v[96:99], v[36:39], a[48:51], v[96:99]
    ds_read_b64_tr_b16 v[52:53], v56 offset:37024
    ds_read_b64_tr_b16 v[54:55], v56 offset:41632
    v_mfma_f32_16x16x32_bf16 v[100:103], v[36:39], a[52:55], v[100:103]
    v_mfma_f32_16x16x32_bf16 v[100:103], v[32:35], a[36:39], v[100:103]
    v_mfma_f32_16x16x32_bf16 v[104:107], v[32:35], a[40:43], v[104:107]
    buffer_load_dwordx4 v7, s[60:63], s41 offen lds
    v_mfma_f32_16x16x32_bf16 v[104:107], v[36:39], a[56:59], v[104:107]
    s_add_u32 m0, s40, 5120
    v_mfma_f32_16x16x32_bf16 v[108:111], v[36:39], a[60:63], v[108:111]
    v_mfma_f32_16x16x32_bf16 v[108:111], v[32:35], a[44:47], v[108:111]
    s_waitcnt lgkmcnt(6)
    v_mfma_f32_16x16x32_bf16 v[128:131], v[40:43], a[32:35], v[128:131]
    s_waitcnt lgkmcnt(4)
    ds_read_b64_tr_b16 v[32:33], v58 offset:37056
    ds_read_b64_tr_b16 v[34:35], v58 offset:41664
    v_mfma_f32_16x16x32_bf16 v[128:131], v[44:47], a[48:51], v[128:131]
    buffer_load_dwordx4 v8, s[60:63], s41 offen lds
    v_mfma_f32_16x16x32_bf16 v[132:135], v[44:47], a[52:55], v[132:135]
    s_add_u32 m0, s40, 6144
    ds_read_b64_tr_b16 v[36:37], v56 offset:37056
    ds_read_b64_tr_b16 v[38:39], v56 offset:41664
    v_mfma_f32_16x16x32_bf16 v[132:135], v[40:43], a[36:39], v[132:135]
    v_mfma_f32_16x16x32_bf16 v[136:139], v[40:43], a[40:43], v[136:139]
    v_mfma_f32_16x16x32_bf16 v[136:139], v[44:47], a[56:59], v[136:139]
    v_mfma_f32_16x16x32_bf16 v[140:143], v[44:47], a[60:63], v[140:143]
    buffer_load_dwordx4 v9, s[60:63], s41 offen lds
    v_mfma_f32_16x16x32_bf16 v[140:143], v[40:43], a[44:47], v[140:143]
    s_waitcnt lgkmcnt(6)
    s_add_u32 m0, s40, 7168
    v_mfma_f32_16x16x32_bf16 v[160:163], v[48:51], a[32:35], v[160:163]
    s_waitcnt lgkmcnt(4)
    ds_read_b64_tr_b16 v[40:41], v58 offset:37088
    ds_read_b64_tr_b16 v[42:43], v58 offset:41696
    v_mfma_f32_16x16x32_bf16 v[160:163], v[52:55], a[48:51], v[160:163]
    ds_read_b64_tr_b16 v[44:45], v56 offset:37088
    ds_read_b64_tr_b16 v[46:47], v56 offset:41696
    v_mfma_f32_16x16x32_bf16 v[164:167], v[52:55], a[52:55], v[164:167]
    v_mfma_f32_16x16x32_bf16 v[164:167], v[48:51], a[36:39], v[164:167]
    buffer_load_dwordx4 v10, s[60:63], s41 offen lds
    v_mfma_f32_16x16x32_bf16 v[168:171], v[48:51], a[40:43], v[168:171]
    s_add_u32 m0, s40, 8192
    v_mfma_f32_16x16x32_bf16 v[168:171], v[52:55], a[56:59], v[168:171]
    v_mfma_f32_16x16x32_bf16 v[172:175], v[52:55], a[60:63], v[172:175]
    v_mfma_f32_16x16x32_bf16 v[172:175], v[48:51], a[44:47], v[172:175]
    s_waitcnt lgkmcnt(6)
    v_mfma_f32_16x16x32_bf16 v[192:195], v[32:35], a[32:35], v[192:195]
    s_waitcnt lgkmcnt(4)
    buffer_load_dwordx4 v11, s[60:63], s41 offen lds
    v_mfma_f32_16x16x32_bf16 v[192:195], v[36:39], a[48:51], v[192:195]
    s_lshl_b32 s42, s3, 17
    ds_read_b64_tr_b16 v[48:49], v58 offset:37120
    ds_read_b64_tr_b16 v[50:51], v58 offset:41728
    v_mfma_f32_16x16x32_bf16 v[196:199], v[36:39], a[52:55], v[196:199]
    s_add_u32 s42, s42, 2883584
    ds_read_b64_tr_b16 v[52:53], v56 offset:37120
    ds_read_b64_tr_b16 v[54:55], v56 offset:41728
    v_mfma_f32_16x16x32_bf16 v[196:199], v[32:35], a[36:39], v[196:199]
    v_mfma_f32_16x16x32_bf16 v[200:203], v[32:35], a[40:43], v[200:203]
    v_mfma_f32_16x16x32_bf16 v[200:203], v[36:39], a[56:59], v[200:203]
    buffer_load_dwordx2 a[144:145], v19, s[52:55], s42 offen offset:0 sc1
    v_mfma_f32_16x16x32_bf16 v[204:207], v[36:39], a[60:63], v[204:207]
    v_mfma_f32_16x16x32_bf16 v[204:207], v[32:35], a[44:47], v[204:207]
    s_waitcnt lgkmcnt(6)
    v_mfma_f32_16x16x32_bf16 v[224:227], v[40:43], a[32:35], v[224:227]
    s_waitcnt lgkmcnt(4)
    buffer_load_dwordx2 a[148:149], v19, s[52:55], s42 offen offset:512 sc1
    v_mfma_f32_16x16x32_bf16 v[224:227], v[44:47], a[48:51], v[224:227]
    ds_read_b64_tr_b16 v[32:33], v56 offset:46080
    ds_read_b64_tr_b16 v[34:35], v56 offset:50688
    v_mfma_f32_16x16x32_bf16 v[228:231], v[44:47], a[52:55], v[228:231]
    ds_read_b64_tr_b16 v[36:37], v57 offset:0
    ds_read_b64_tr_b16 v[38:39], v57 offset:4608
    v_mfma_f32_16x16x32_bf16 v[228:231], v[40:43], a[36:39], v[228:231]
    buffer_load_dwordx2 a[152:153], v19, s[52:55], s42 offen offset:1024 sc1
    v_mfma_f32_16x16x32_bf16 v[232:235], v[40:43], a[40:43], v[232:235]
    v_mfma_f32_16x16x32_bf16 v[232:235], v[44:47], a[56:59], v[232:235]
    v_mfma_f32_16x16x32_bf16 v[236:239], v[44:47], a[60:63], v[236:239]
    buffer_load_dwordx2 a[156:157], v19, s[52:55], s42 offen offset:1536 sc1
    v_mfma_f32_16x16x32_bf16 v[236:239], v[40:43], a[44:47], v[236:239]
    s_waitcnt lgkmcnt(6)
    s_lshl_b32 s42, s3, 17
    v_mfma_f32_16x16x32_bf16 v[240:243], v[48:51], a[32:35], v[240:243]
    s_waitcnt lgkmcnt(4)
    s_add_u32 s42, s42, 2949120
    ds_read_b64_tr_b16 v[40:41], v56 offset:46112
    ds_read_b64_tr_b16 v[42:43], v56 offset:50720
    v_mfma_f32_16x16x32_bf16 v[240:243], v[52:55], a[48:51], v[240:243]
    buffer_load_dwordx2 a[146:147], v19, s[52:55], s42 offen offset:0 sc1
    v_mfma_f32_16x16x32_bf16 v[244:247], v[52:55], a[52:55], v[244:247]
    ds_read_b64_tr_b16 v[44:45], v57 offset:32
    ds_read_b64_tr_b16 v[46:47], v57 offset:4640
    v_mfma_f32_16x16x32_bf16 v[244:247], v[48:51], a[36:39], v[244:247]
    v_mfma_f32_16x16x32_bf16 v[248:251], v[48:51], a[40:43], v[248:251]
    buffer_load_dwordx2 a[150:151], v19, s[52:55], s42 offen offset:512 sc1
    v_mfma_f32_16x16x32_bf16 v[248:251], v[52:55], a[56:59], v[248:251]
    v_mfma_f32_16x16x32_bf16 v[252:255], v[52:55], a[60:63], v[252:255]
    v_mfma_f32_16x16x32_bf16 v[252:255], v[48:51], a[44:47], v[252:255]
    s_waitcnt lgkmcnt(6)
    buffer_load_dwordx2 a[154:155], v19, s[52:55], s42 offen offset:1024 sc1
    v_mfma_f32_16x16x32_bf16 v[64:67], v[32:35], a[64:67], v[64:67]
    s_waitcnt lgkmcnt(4)
    ds_read_b64_tr_b16 v[48:49], v56 offset:46144
    ds_read_b64_tr_b16 v[50:51], v56 offset:50752
Lpad8:
    s_cbranch_execz Lpad10
    v_mfma_f32_16x16x32_bf16 v[64:67], v[36:39], a[80:83], v[64:67]
    ds_read_b64_tr_b16 v[52:53], v57 offset:64
    ds_read_b64_tr_b16 v[54:55], v57 offset:4672
    v_mfma_f32_16x16x32_bf16 v[68:71], v[36:39], a[84:87], v[68:71]
    buffer_load_dwordx2 a[158:159], v19, s[52:55], s42 offen offset:1536 sc1
    v_mfma_f32_16x16x32_bf16 v[68:71], v[32:35], a[68:71], v[68:71]
    s_lshl_b32 s42, s3, 17
    v_mfma_f32_16x16x32_bf16 v[72:75], v[32:35], a[72:75], v[72:75]
    s_add_u32 s42, s42, 4063232
    v_mfma_f32_16x16x32_bf16 v[72:75], v[36:39], a[88:91], v[72:75]
    buffer_load_dwordx2 a[160:161], v19, s[52:55], s42 offen offset:0 sc1
    v_mfma_f32_16x16x32_bf16 v[76:79], v[36:39], a[92:95], v[76:79]
    v_mfma_f32_16x16x32_bf16 v[76:79], v[32:35], a[76:79], v[76:79]
    s_waitcnt lgkmcnt(6)
    v_mfma_f32_16x16x32_bf16 a[128:131], v[40:43], a[64:67], a[128:131]
    s_waitcnt lgkmcnt(4)
    buffer_load_dwordx2 a[164:165], v19, s[52:55], s42 offen offset:512 sc1
    v_mfma_f32_16x16x32_bf16 a[128:131], v[44:47], a[80:83], a[128:131]
    ds_read_b64_tr_b16 v[32:33], v56 offset:46176
    ds_read_b64_tr_b16 v[34:35], v56 offset:50784
    v_mfma_f32_16x16x32_bf16 a[132:135], v[44:47], a[84:87], a[132:135]
    ds_read_b64_tr_b16 v[36:37], v57 offset:96
    ds_read_b64_tr_b16 v[38:39], v57 offset:4704
    v_mfma_f32_16x16x32_bf16 a[132:135], v[40:43], a[68:71], a[132:135]
    buffer_load_dwordx2 a[168:169], v19, s[52:55], s42 offen offset:1024 sc1
    v_mfma_f32_16x16x32_bf16 a[136:139], v[40:43], a[72:75], a[136:139]
    v_mfma_f32_16x16x32_bf16 a[136:139], v[44:47], a[88:91], a[136:139]
    v_mfma_f32_16x16x32_bf16 a[140:143], v[44:47], a[92:95], a[140:143]
    buffer_load_dwordx2 a[172:173], v19, s[52:55], s42 offen offset:1536 sc1
    v_mfma_f32_16x16x32_bf16 a[140:143], v[40:43], a[76:79], a[140:143]
    s_waitcnt lgkmcnt(6)
    s_lshl_b32 s42, s3, 17
    v_mfma_f32_16x16x32_bf16 v[80:83], v[48:51], a[64:67], v[80:83]
    s_waitcnt lgkmcnt(4)
    s_add_u32 s42, s42, 4128768
    ds_read_b64_tr_b16 v[40:41], v56 offset:46208
    ds_read_b64_tr_b16 v[42:43], v56 offset:50816
    v_mfma_f32_16x16x32_bf16 v[80:83], v[52:55], a[80:83], v[80:83]
    buffer_load_dwordx2 a[162:163], v19, s[52:55], s42 offen offset:0 sc1
    v_mfma_f32_16x16x32_bf16 v[84:87], v[52:55], a[84:87], v[84:87]
    ds_read_b64_tr_b16 v[44:45], v57 offset:128
    ds_read_b64_tr_b16 v[46:47], v57 offset:4736
    v_mfma_f32_16x16x32_bf16 v[84:87], v[48:51], a[68:71], v[84:87]
    v_mfma_f32_16x16x32_bf16 v[88:91], v[48:51], a[72:75], v[88:91]
    buffer_load_dwordx2 a[166:167], v19, s[52:55], s42 offen offset:512 sc1
    v_mfma_f32_16x16x32_bf16 v[88:91], v[52:55], a[88:91], v[88:91]
    v_mfma_f32_16x16x32_bf16 v[92:95], v[52:55], a[92:95], v[92:95]
    v_mfma_f32_16x16x32_bf16 v[92:95], v[48:51], a[76:79], v[92:95]
    s_waitcnt lgkmcnt(6)
    buffer_load_dwordx2 a[170:171], v19, s[52:55], s42 offen offset:1024 sc1
    v_mfma_f32_16x16x32_bf16 v[96:99], v[32:35], a[64:67], v[96:99]
    s_waitcnt lgkmcnt(4)
    ds_read_b64_tr_b16 v[48:49], v56 offset:46240
    ds_read_b64_tr_b16 v[50:51], v56 offset:50848
    v_mfma_f32_16x16x32_bf16 v[96:99], v[36:39], a[80:83], v[96:99]
    ds_read_b64_tr_b16 v[52:53], v57 offset:160
    ds_read_b64_tr_b16 v[54:55], v57 offset:4768
    v_mfma_f32_16x16x32_bf16 v[100:103], v[36:39], a[84:87], v[100:103]
    buffer_load_dwordx2 a[174:175], v19, s[52:55], s42 offen offset:1536 sc1
    v_mfma_f32_16x16x32_bf16 v[100:103], v[32:35], a[68:71], v[100:103]
    v_xor_b32 v19, 128, v18
    v_mfma_f32_16x16x32_bf16 v[104:107], v[32:35], a[72:75], v[104:107]
    s_mov_b32 s84, 16384
    v_mfma_f32_16x16x32_bf16 v[104:107], v[36:39], a[88:91], v[104:107]
    s_add_u32 m0, s83, 20480
    v_mfma_f32_16x16x32_bf16 v[108:111], v[36:39], a[92:95], v[108:111]
    buffer_load_dwordx4 v14, s[44:47], s84 offen offset:0 lds
    v_mfma_f32_16x16x32_bf16 v[108:111], v[32:35], a[76:79], v[108:111]
    s_waitcnt lgkmcnt(6)
    v_mfma_f32_16x16x32_bf16 v[128:131], v[40:43], a[64:67], v[128:131]
    s_waitcnt lgkmcnt(4)
    ds_read_b64_tr_b16 v[32:33], v56 offset:46272
    ds_read_b64_tr_b16 v[34:35], v56 offset:50880
    v_mfma_f32_16x16x32_bf16 v[128:131], v[44:47], a[80:83], v[128:131]
    buffer_load_dwordx4 v15, s[44:47], s84 offen offset:1024 lds
    v_mfma_f32_16x16x32_bf16 v[132:135], v[44:47], a[84:87], v[132:135]
    ds_read_b64_tr_b16 v[36:37], v57 offset:192
    ds_read_b64_tr_b16 v[38:39], v57 offset:4800
    v_mfma_f32_16x16x32_bf16 v[132:135], v[40:43], a[68:71], v[132:135]
    v_mfma_f32_16x16x32_bf16 v[136:139], v[40:43], a[72:75], v[136:139]
    buffer_load_dwordx4 v16, s[44:47], s84 offen offset:2048 lds
    v_mfma_f32_16x16x32_bf16 v[136:139], v[44:47], a[88:91], v[136:139]
    v_mfma_f32_16x16x32_bf16 v[140:143], v[44:47], a[92:95], v[140:143]
    v_mfma_f32_16x16x32_bf16 v[140:143], v[40:43], a[76:79], v[140:143]
    s_waitcnt lgkmcnt(6)
    buffer_load_dwordx4 v17, s[44:47], s84 offen offset:3072 lds
    v_mfma_f32_16x16x32_bf16 v[160:163], v[48:51], a[64:67], v[160:163]
    s_waitcnt lgkmcnt(4)
    s_mov_b32 s84, 0
    ds_read_b64_tr_b16 v[40:41], v56 offset:46304
    ds_read_b64_tr_b16 v[42:43], v56 offset:50912
    v_mfma_f32_16x16x32_bf16 v[160:163], v[52:55], a[80:83], v[160:163]
    s_add_u32 m0, s83, 71680
    ds_read_b64_tr_b16 v[44:45], v57 offset:224
    ds_read_b64_tr_b16 v[46:47], v57 offset:4832
    v_mfma_f32_16x16x32_bf16 v[164:167], v[52:55], a[84:87], v[164:167]
    v_mfma_f32_16x16x32_bf16 v[164:167], v[48:51], a[68:71], v[164:167]
    v_mfma_f32_16x16x32_bf16 v[168:171], v[48:51], a[72:75], v[168:171]
    buffer_load_dwordx4 v18, s[48:51], s84 offen offset:0 lds
    v_mfma_f32_16x16x32_bf16 v[168:171], v[52:55], a[88:91], v[168:171]
    v_mfma_f32_16x16x32_bf16 v[172:175], v[52:55], a[92:95], v[172:175]
    v_mfma_f32_16x16x32_bf16 v[172:175], v[48:51], a[76:79], v[172:175]
    s_waitcnt lgkmcnt(6)
    v_mfma_f32_16x16x32_bf16 v[192:195], v[32:35], a[64:67], v[192:195]
    s_waitcnt lgkmcnt(4)
    ds_read_b64_tr_b16 v[48:49], v56 offset:46336
    ds_read_b64_tr_b16 v[50:51], v56 offset:50944
    v_mfma_f32_16x16x32_bf16 v[192:195], v[36:39], a[80:83], v[192:195]
    buffer_load_dwordx4 v19, s[48:51], s84 offen offset:1024 lds
    v_mfma_f32_16x16x32_bf16 v[196:199], v[36:39], a[84:87], v[196:199]
    ds_read_b64_tr_b16 v[52:53], v57 offset:256
    ds_read_b64_tr_b16 v[54:55], v57 offset:4864
    v_mfma_f32_16x16x32_bf16 v[196:199], v[32:35], a[68:71], v[196:199]
    v_mfma_f32_16x16x32_bf16 v[200:203], v[32:35], a[72:75], v[200:203]
    v_mfma_f32_16x16x32_bf16 v[200:203], v[36:39], a[88:91], v[200:203]
    v_mfma_f32_16x16x32_bf16 v[204:207], v[36:39], a[92:95], v[204:207]
    s_waitcnt vmcnt(22)
    buffer_load_dwordx4 v18, s[48:51], s84 offen offset:2048 lds
    v_mfma_f32_16x16x32_bf16 v[204:207], v[32:35], a[76:79], v[204:207]
    s_barrier
    s_waitcnt lgkmcnt(6)
    v_mfma_f32_16x16x32_bf16 v[224:227], v[40:43], a[64:67], v[224:227]
    s_waitcnt lgkmcnt(4)
    ds_read_b64_tr_b16 v[32:33], v57 offset:36864
    ds_read_b64_tr_b16 v[34:35], v57 offset:41472
    v_mfma_f32_16x16x32_bf16 v[224:227], v[44:47], a[80:83], v[224:227]
    ds_read_b64_tr_b16 v[36:37], v57 offset:46080
    ds_read_b64_tr_b16 v[38:39], v57 offset:50688
    v_mfma_f32_16x16x32_bf16 v[228:231], v[44:47], a[84:87], v[228:231]
    v_mfma_f32_16x16x32_bf16 v[228:231], v[40:43], a[68:71], v[228:231]
    buffer_load_dwordx4 v19, s[48:51], s84 offen offset:3072 lds
    v_mfma_f32_16x16x32_bf16 v[232:235], v[40:43], a[72:75], v[232:235]
    v_mfma_f32_16x16x32_bf16 v[232:235], v[44:47], a[88:91], v[232:235]
    v_mfma_f32_16x16x32_bf16 v[236:239], v[44:47], a[92:95], v[236:239]
    v_mfma_f32_16x16x32_bf16 v[236:239], v[40:43], a[76:79], v[236:239]
    s_waitcnt lgkmcnt(6)
    v_mfma_f32_16x16x32_bf16 v[240:243], v[48:51], a[64:67], v[240:243]
    s_waitcnt lgkmcnt(4)
    ds_read_b64_tr_b16 v[40:41], v58 offset:0
    ds_read_b64_tr_b16 v[42:43], v58 offset:4608
    v_mfma_f32_16x16x32_bf16 v[240:243], v[52:55], a[80:83], v[240:243]
    ds_read_b64_tr_b16 v[44:45], v58 offset:9216
    ds_read_b64_tr_b16 v[46:47], v58 offset:13824
    v_mfma_f32_16x16x32_bf16 v[244:247], v[52:55], a[84:87], v[244:247]
    v_mfma_f32_16x16x32_bf16 v[244:247], v[48:51], a[68:71], v[244:247]
    v_mfma_f32_16x16x32_bf16 v[248:251], v[48:51], a[72:75], v[248:251]
    v_mfma_f32_16x16x32_bf16 v[248:251], v[52:55], a[88:91], v[248:251]
    v_mfma_f32_16x16x32_bf16 v[252:255], v[52:55], a[92:95], v[252:255]
    v_mfma_f32_16x16x32_bf16 v[252:255], v[48:51], a[76:79], v[252:255]
    s_waitcnt lgkmcnt(6)
    v_mfma_f32_16x16x32_bf16 v[64:67], v[32:35], a[96:99], v[64:67]
    s_waitcnt lgkmcnt(4)
    ds_read_b64_tr_b16 v[48:49], v57 offset:36896
    ds_read_b64_tr_b16 v[50:51], v57 offset:41504
    v_mfma_f32_16x16x32_bf16 v[64:67], v[36:39], a[112:115], v[64:67]
    ds_read_b64_tr_b16 v[52:53], v57 offset:46112
    ds_read_b64_tr_b16 v[54:55], v57 offset:50720
    v_mfma_f32_16x16x32_bf16 v[68:71], v[36:39], a[116:119], v[68:71]
    v_mfma_f32_16x16x32_bf16 v[68:71], v[32:35], a[100:103], v[68:71]
    v_mfma_f32_16x16x32_bf16 v[72:75], v[32:35], a[104:107], v[72:75]
    v_mfma_f32_16x16x32_bf16 v[72:75], v[36:39], a[120:123], v[72:75]
    v_mfma_f32_16x16x32_bf16 v[76:79], v[36:39], a[124:127], v[76:79]
    v_mfma_f32_16x16x32_bf16 v[76:79], v[32:35], a[108:111], v[76:79]
    s_waitcnt vmcnt(19) lgkmcnt(6)
    v_mfma_f32_16x16x32_bf16 v[64:67], v[40:43], a[144:147], v[64:67]
    s_waitcnt vmcnt(11) lgkmcnt(4)
    ds_read_b64_tr_b16 v[32:33], v58 offset:32
    ds_read_b64_tr_b16 v[34:35], v58 offset:4640
    v_mfma_f32_16x16x32_bf16 v[64:67], v[44:47], a[160:163], v[64:67]
    s_waitcnt vmcnt(10)
    ds_read_b64_tr_b16 v[36:37], v58 offset:9248
    ds_read_b64_tr_b16 v[38:39], v58 offset:13856
    v_mfma_f32_16x16x32_bf16 v[68:71], v[44:47], a[164:167], v[68:71]
    v_mfma_f32_16x16x32_bf16 v[68:71], v[40:43], a[148:151], v[68:71]
    v_mfma_f32_16x16x32_bf16 v[72:75], v[40:43], a[152:155], v[72:75]
    s_waitcnt vmcnt(9)
    v_mfma_f32_16x16x32_bf16 v[72:75], v[44:47], a[168:171], v[72:75]
    s_waitcnt vmcnt(8)
    v_mfma_f32_16x16x32_bf16 v[76:79], v[44:47], a[172:175], v[76:79]
    v_mfma_f32_16x16x32_bf16 v[76:79], v[40:43], a[156:159], v[76:79]
    s_waitcnt lgkmcnt(6)
    v_mfma_f32_16x16x32_bf16 a[128:131], v[48:51], a[96:99], a[128:131]
    s_waitcnt lgkmcnt(4)
    ds_read_b64_tr_b16 v[40:41], v57 offset:36928
    ds_read_b64_tr_b16 v[42:43], v57 offset:41536
    v_mfma_f32_16x16x32_bf16 a[128:131], v[52:55], a[112:115], a[128:131]
    ds_read_b64_tr_b16 v[44:45], v57 offset:46144
    ds_read_b64_tr_b16 v[46:47], v57 offset:50752
    v_mfma_f32_16x16x32_bf16 a[132:135], v[52:55], a[116:119], a[132:135]
    v_mfma_f32_16x16x32_bf16 a[132:135], v[48:51], a[100:103], a[132:135]
    v_cvt_pk_bf16_f32 v64, v64, v65
    v_cvt_pk_bf16_f32 v65, v66, v67
    v_mfma_f32_16x16x32_bf16 a[136:139], v[48:51], a[104:107], a[136:139]
    v_cvt_pk_bf16_f32 v66, v68, v69
    v_cvt_pk_bf16_f32 v67, v70, v71
    v_mfma_f32_16x16x32_bf16 a[136:139], v[52:55], a[120:123], a[136:139]
    s_mov_b32 s90, 0
    v_cvt_pk_bf16_f32 v72, v72, v73
    v_cvt_pk_bf16_f32 v73, v74, v75
    v_mfma_f32_16x16x32_bf16 a[140:143], v[52:55], a[124:127], a[140:143]
    v_cvt_pk_bf16_f32 v74, v76, v77
    v_cvt_pk_bf16_f32 v75, v78, v79
    v_mfma_f32_16x16x32_bf16 a[140:143], v[48:51], a[108:111], a[140:143]
    s_waitcnt lgkmcnt(6)
    buffer_store_dwordx4 v[64:67], v59, s[64:67], s90 offen offset:0 sc1
    v_mfma_f32_16x16x32_bf16 a[128:131], v[32:35], a[144:147], a[128:131]
    s_waitcnt lgkmcnt(4)
    s_mov_b32 s90, 4096
    ds_read_b64_tr_b16 v[48:49], v58 offset:64
    ds_read_b64_tr_b16 v[50:51], v58 offset:4672
    v_mfma_f32_16x16x32_bf16 a[128:131], v[36:39], a[160:163], a[128:131]
    ds_read_b64_tr_b16 v[52:53], v58 offset:9280
    ds_read_b64_tr_b16 v[54:55], v58 offset:13888
    v_mfma_f32_16x16x32_bf16 a[132:135], v[36:39], a[164:167], a[132:135]
    v_mfma_f32_16x16x32_bf16 a[132:135], v[32:35], a[148:151], a[132:135]
    v_mfma_f32_16x16x32_bf16 a[136:139], v[32:35], a[152:155], a[136:139]
    v_mfma_f32_16x16x32_bf16 a[136:139], v[36:39], a[168:171], a[136:139]
    v_mfma_f32_16x16x32_bf16 a[140:143], v[36:39], a[172:175], a[140:143]
    v_mfma_f32_16x16x32_bf16 a[140:143], v[32:35], a[156:159], a[140:143]
    s_waitcnt lgkmcnt(6)
    buffer_store_dwordx4 v[72:75], v59, s[64:67], s90 offen offset:0 sc1
    v_mfma_f32_16x16x32_bf16 v[80:83], v[40:43], a[96:99], v[80:83]
    s_waitcnt lgkmcnt(4)
    ds_read_b64_tr_b16 v[32:33], v57 offset:36960
    ds_read_b64_tr_b16 v[34:35], v57 offset:41568
    v_mfma_f32_16x16x32_bf16 v[80:83], v[44:47], a[112:115], v[80:83]
    ds_read_b64_tr_b16 v[36:37], v57 offset:46176
    ds_read_b64_tr_b16 v[38:39], v57 offset:50784
    v_mfma_f32_16x16x32_bf16 v[84:87], v[44:47], a[116:119], v[84:87]
    v_mfma_f32_16x16x32_bf16 v[84:87], v[40:43], a[100:103], v[84:87]
    v_accvgpr_read_b32 v76, a132
    v_accvgpr_read_b32 v77, a133
    v_mfma_f32_16x16x32_bf16 v[88:91], v[40:43], a[104:107], v[88:91]
    v_accvgpr_read_b32 v78, a134
    v_accvgpr_read_b32 v79, a135
    v_mfma_f32_16x16x32_bf16 v[88:91], v[44:47], a[120:123], v[88:91]
    v_accvgpr_read_b32 v68, a128
    v_accvgpr_read_b32 v69, a129
    v_mfma_f32_16x16x32_bf16 v[92:95], v[44:47], a[124:127], v[92:95]
    v_accvgpr_read_b32 v70, a130
    v_accvgpr_read_b32 v71, a131
    v_mfma_f32_16x16x32_bf16 v[92:95], v[40:43], a[108:111], v[92:95]
    s_waitcnt lgkmcnt(6)
    v_cvt_pk_bf16_f32 v68, v68, v69
    v_cvt_pk_bf16_f32 v69, v70, v71
    v_mfma_f32_16x16x32_bf16 v[80:83], v[48:51], a[144:147], v[80:83]
    s_waitcnt lgkmcnt(4)
    ds_read_b64_tr_b16 v[40:41], v58 offset:96
    ds_read_b64_tr_b16 v[42:43], v58 offset:4704
    v_mfma_f32_16x16x32_bf16 v[80:83], v[52:55], a[160:163], v[80:83]
    ds_read_b64_tr_b16 v[44:45], v58 offset:9312
    ds_read_b64_tr_b16 v[46:47], v58 offset:13920
    v_mfma_f32_16x16x32_bf16 v[84:87], v[52:55], a[164:167], v[84:87]
    v_cvt_pk_bf16_f32 v70, v76, v77
    v_cvt_pk_bf16_f32 v71, v78, v79
    v_mfma_f32_16x16x32_bf16 v[84:87], v[48:51], a[148:151], v[84:87]
    s_mov_b32 s90, 0
    v_mfma_f32_16x16x32_bf16 v[88:91], v[48:51], a[152:155], v[88:91]
    v_mfma_f32_16x16x32_bf16 v[88:91], v[52:55], a[168:171], v[88:91]
    buffer_store_dwordx4 v[68:71], v59, s[64:67], s90 offen offset:1024 sc1
    v_mfma_f32_16x16x32_bf16 v[92:95], v[52:55], a[172:175], v[92:95]
    v_nop
    v_accvgpr_read_b32 v76, a140
    v_mfma_f32_16x16x32_bf16 v[92:95], v[48:51], a[156:159], v[92:95]
    s_waitcnt lgkmcnt(6)
    v_accvgpr_read_b32 v77, a141
    v_accvgpr_read_b32 v78, a142
    v_mfma_f32_16x16x32_bf16 v[96:99], v[32:35], a[96:99], v[96:99]
    s_waitcnt lgkmcnt(4)
    ds_read_b64_tr_b16 v[48:49], v57 offset:36992
    ds_read_b64_tr_b16 v[50:51], v57 offset:41600
    v_mfma_f32_16x16x32_bf16 v[96:99], v[36:39], a[112:115], v[96:99]
    ds_read_b64_tr_b16 v[52:53], v57 offset:46208
    ds_read_b64_tr_b16 v[54:55], v57 offset:50816
    v_mfma_f32_16x16x32_bf16 v[100:103], v[36:39], a[116:119], v[100:103]
    v_accvgpr_read_b32 v79, a143
    v_accvgpr_read_b32 v68, a136
    v_mfma_f32_16x16x32_bf16 v[100:103], v[32:35], a[100:103], v[100:103]
    v_accvgpr_read_b32 v69, a137
    v_accvgpr_read_b32 v70, a138
    v_mfma_f32_16x16x32_bf16 v[104:107], v[32:35], a[104:107], v[104:107]
    v_accvgpr_read_b32 v71, a139
    v_cvt_pk_bf16_f32 v68, v68, v69
    v_mfma_f32_16x16x32_bf16 v[104:107], v[36:39], a[120:123], v[104:107]
    v_cvt_pk_bf16_f32 v69, v70, v71
    v_cvt_pk_bf16_f32 v70, v76, v77
    v_mfma_f32_16x16x32_bf16 v[108:111], v[36:39], a[124:127], v[108:111]
    v_cvt_pk_bf16_f32 v71, v78, v79
    v_mfma_f32_16x16x32_bf16 v[108:111], v[32:35], a[108:111], v[108:111]
    s_waitcnt lgkmcnt(6)
    s_mov_b32 s90, 4096
    v_mfma_f32_16x16x32_bf16 v[96:99], v[40:43], a[144:147], v[96:99]
    s_waitcnt lgkmcnt(4)
    ds_read_b64_tr_b16 v[32:33], v58 offset:128
    ds_read_b64_tr_b16 v[34:35], v58 offset:4736
    v_mfma_f32_16x16x32_bf16 v[96:99], v[44:47], a[160:163], v[96:99]
    ds_read_b64_tr_b16 v[36:37], v58 offset:9344
    ds_read_b64_tr_b16 v[38:39], v58 offset:13952
    v_mfma_f32_16x16x32_bf16 v[100:103], v[44:47], a[164:167], v[100:103]
    v_mfma_f32_16x16x32_bf16 v[100:103], v[40:43], a[148:151], v[100:103]
    buffer_store_dwordx4 v[68:71], v59, s[64:67], s90 offen offset:1024 sc1
    v_mfma_f32_16x16x32_bf16 v[104:107], v[40:43], a[152:155], v[104:107]
    v_nop
    v_cvt_pk_bf16_f32 v80, v80, v81
    v_mfma_f32_16x16x32_bf16 v[104:107], v[44:47], a[168:171], v[104:107]
    v_cvt_pk_bf16_f32 v81, v82, v83
    v_cvt_pk_bf16_f32 v82, v84, v85
    v_mfma_f32_16x16x32_bf16 v[108:111], v[44:47], a[172:175], v[108:111]
    v_cvt_pk_bf16_f32 v83, v86, v87
    v_cvt_pk_bf16_f32 v88, v88, v89
    v_mfma_f32_16x16x32_bf16 v[108:111], v[40:43], a[156:159], v[108:111]
    s_waitcnt lgkmcnt(6)
    s_mov_b32 s90, 0
    v_cvt_pk_bf16_f32 v89, v90, v91
    v_cvt_pk_bf16_f32 v90, v92, v93
    v_mfma_f32_16x16x32_bf16 v[128:131], v[48:51], a[96:99], v[128:131]
    s_waitcnt lgkmcnt(4)
    ds_read_b64_tr_b16 v[40:41], v57 offset:37024
    ds_read_b64_tr_b16 v[42:43], v57 offset:41632
    v_mfma_f32_16x16x32_bf16 v[128:131], v[52:55], a[112:115], v[128:131]
    ds_read_b64_tr_b16 v[44:45], v57 offset:46240
    ds_read_b64_tr_b16 v[46:47], v57 offset:50848
    v_mfma_f32_16x16x32_bf16 v[132:135], v[52:55], a[116:119], v[132:135]
    v_cvt_pk_bf16_f32 v91, v94, v95
    v_mfma_f32_16x16x32_bf16 v[132:135], v[48:51], a[100:103], v[132:135]
    v_cvt_pk_bf16_f32 v96, v96, v97
    v_cvt_pk_bf16_f32 v97, v98, v99
    v_mfma_f32_16x16x32_bf16 v[136:139], v[48:51], a[104:107], v[136:139]
    v_cvt_pk_bf16_f32 v98, v100, v101
    v_cvt_pk_bf16_f32 v99, v102, v103
    v_mfma_f32_16x16x32_bf16 v[136:139], v[52:55], a[120:123], v[136:139]
    v_accvgpr_write_b32 a212, v96
    v_accvgpr_write_b32 a213, v97
    v_mfma_f32_16x16x32_bf16 v[140:143], v[52:55], a[124:127], v[140:143]
    v_accvgpr_write_b32 a214, v98
    v_accvgpr_write_b32 a215, v99
    v_mfma_f32_16x16x32_bf16 v[140:143], v[48:51], a[108:111], v[140:143]
    s_waitcnt lgkmcnt(6)
    v_cvt_pk_bf16_f32 v104, v104, v105
    v_cvt_pk_bf16_f32 v105, v106, v107
    v_mfma_f32_16x16x32_bf16 v[128:131], v[32:35], a[144:147], v[128:131]
    s_waitcnt lgkmcnt(4)
    ds_read_b64_tr_b16 v[48:49], v58 offset:160
    ds_read_b64_tr_b16 v[50:51], v58 offset:4768
    v_mfma_f32_16x16x32_bf16 v[128:131], v[36:39], a[160:163], v[128:131]
    buffer_store_dwordx4 v[80:83], v59, s[64:67], s90 offen offset:2048 sc1
    v_mfma_f32_16x16x32_bf16 v[132:135], v[36:39], a[164:167], v[132:135]
    s_mov_b32 s90, 4096
    ds_read_b64_tr_b16 v[52:53], v58 offset:9376
    ds_read_b64_tr_b16 v[54:55], v58 offset:13984
    v_mfma_f32_16x16x32_bf16 v[132:135], v[32:35], a[148:151], v[132:135]
    v_cvt_pk_bf16_f32 v106, v108, v109
    v_cvt_pk_bf16_f32 v107, v110, v111
    v_mfma_f32_16x16x32_bf16 v[136:139], v[32:35], a[152:155], v[136:139]
    v_accvgpr_write_b32 a216, v104
    v_accvgpr_write_b32 a217, v105
    v_mfma_f32_16x16x32_bf16 v[136:139], v[36:39], a[168:171], v[136:139]
    v_accvgpr_write_b32 a218, v106
    v_accvgpr_write_b32 a219, v107
    v_mfma_f32_16x16x32_bf16 v[140:143], v[36:39], a[172:175], v[140:143]
    v_mfma_f32_16x16x32_bf16 v[140:143], v[32:35], a[156:159], v[140:143]
    s_waitcnt lgkmcnt(6)
    v_mfma_f32_16x16x32_bf16 v[160:163], v[40:43], a[96:99], v[160:163]
    s_waitcnt lgkmcnt(4)
    ds_read_b64_tr_b16 v[32:33], v57 offset:37056
    ds_read_b64_tr_b16 v[34:35], v57 offset:41664
    v_mfma_f32_16x16x32_bf16 v[160:163], v[44:47], a[112:115], v[160:163]
    ds_read_b64_tr_b16 v[36:37], v57 offset:46272
    ds_read_b64_tr_b16 v[38:39], v57 offset:50880
    v_mfma_f32_16x16x32_bf16 v[164:167], v[44:47], a[116:119], v[164:167]
    v_mfma_f32_16x16x32_bf16 v[164:167], v[40:43], a[100:103], v[164:167]
    v_cvt_pk_bf16_f32 v128, v128, v129
    v_cvt_pk_bf16_f32 v129, v130, v131
    v_mfma_f32_16x16x32_bf16 v[168:171], v[40:43], a[104:107], v[168:171]
    v_cvt_pk_bf16_f32 v130, v132, v133
    v_cvt_pk_bf16_f32 v131, v134, v135
    v_mfma_f32_16x16x32_bf16 v[168:171], v[44:47], a[120:123], v[168:171]
    v_accvgpr_write_b32 a220, v128
    v_accvgpr_write_b32 a221, v129
    v_mfma_f32_16x16x32_bf16 v[172:175], v[44:47], a[124:127], v[172:175]
    v_accvgpr_write_b32 a222, v130
    v_accvgpr_write_b32 a223, v131
    v_mfma_f32_16x16x32_bf16 v[172:175], v[40:43], a[108:111], v[172:175]
    s_waitcnt lgkmcnt(6)
    buffer_store_dwordx4 v[88:91], v59, s[64:67], s90 offen offset:2048 sc1
    v_mfma_f32_16x16x32_bf16 v[160:163], v[48:51], a[144:147], v[160:163]
    s_waitcnt lgkmcnt(4)
    ds_read_b64_tr_b16 v[40:41], v58 offset:192
    ds_read_b64_tr_b16 v[42:43], v58 offset:4800
    v_mfma_f32_16x16x32_bf16 v[160:163], v[52:55], a[160:163], v[160:163]
    ds_read_b64_tr_b16 v[44:45], v58 offset:9408
    ds_read_b64_tr_b16 v[46:47], v58 offset:14016
    v_mfma_f32_16x16x32_bf16 v[164:167], v[52:55], a[164:167], v[164:167]
    v_cvt_pk_bf16_f32 v136, v136, v137
    v_cvt_pk_bf16_f32 v137, v138, v139
    v_mfma_f32_16x16x32_bf16 v[164:167], v[48:51], a[148:151], v[164:167]
    v_cvt_pk_bf16_f32 v138, v140, v141
    v_cvt_pk_bf16_f32 v139, v142, v143
    v_mfma_f32_16x16x32_bf16 v[168:171], v[48:51], a[152:155], v[168:171]
    v_accvgpr_write_b32 a224, v136
    v_accvgpr_write_b32 a225, v137
    v_mfma_f32_16x16x32_bf16 v[168:171], v[52:55], a[168:171], v[168:171]
    v_accvgpr_write_b32 a226, v138
    v_accvgpr_write_b32 a227, v139
    v_mfma_f32_16x16x32_bf16 v[172:175], v[52:55], a[172:175], v[172:175]
    v_mfma_f32_16x16x32_bf16 v[172:175], v[48:51], a[156:159], v[172:175]
    s_waitcnt lgkmcnt(6)
    v_mfma_f32_16x16x32_bf16 v[192:195], v[32:35], a[96:99], v[192:195]
    s_waitcnt lgkmcnt(4)
    ds_read_b64_tr_b16 v[48:49], v57 offset:37088
    ds_read_b64_tr_b16 v[50:51], v57 offset:41696
    v_mfma_f32_16x16x32_bf16 v[192:195], v[36:39], a[112:115], v[192:195]
    ds_read_b64_tr_b16 v[52:53], v57 offset:46304
    ds_read_b64_tr_b16 v[54:55], v57 offset:50912
    v_mfma_f32_16x16x32_bf16 v[196:199], v[36:39], a[116:119], v[196:199]
    v_mfma_f32_16x16x32_bf16 v[196:199], v[32:35], a[100:103], v[196:199]
    v_cvt_pk_bf16_f32 v160, v160, v161
    v_cvt_pk_bf16_f32 v161, v162, v163
    v_mfma_f32_16x16x32_bf16 v[200:203], v[32:35], a[104:107], v[200:203]
    v_cvt_pk_bf16_f32 v162, v164, v165
    v_cvt_pk_bf16_f32 v163, v166, v167
    v_mfma_f32_16x16x32_bf16 v[200:203], v[36:39], a[120:123], v[200:203]
    v_accvgpr_write_b32 a228, v160
    v_accvgpr_write_b32 a229, v161
    v_mfma_f32_16x16x32_bf16 v[204:207], v[36:39], a[124:127], v[204:207]
    v_accvgpr_write_b32 a230, v162
    v_accvgpr_write_b32 a231, v163
    v_mfma_f32_16x16x32_bf16 v[204:207], v[32:35], a[108:111], v[204:207]
    s_waitcnt lgkmcnt(6)
    v_cvt_pk_bf16_f32 v168, v168, v169
    v_cvt_pk_bf16_f32 v169, v170, v171
    v_mfma_f32_16x16x32_bf16 v[192:195], v[40:43], a[144:147], v[192:195]
    s_waitcnt lgkmcnt(4)
    ds_read_b64_tr_b16 v[32:33], v58 offset:224
    ds_read_b64_tr_b16 v[34:35], v58 offset:4832
    v_mfma_f32_16x16x32_bf16 v[192:195], v[44:47], a[160:163], v[192:195]
    ds_read_b64_tr_b16 v[36:37], v58 offset:9440
    ds_read_b64_tr_b16 v[38:39], v58 offset:14048
    v_mfma_f32_16x16x32_bf16 v[196:199], v[44:47], a[164:167], v[196:199]
    v_cvt_pk_bf16_f32 v170, v172, v173
    v_cvt_pk_bf16_f32 v171, v174, v175
    v_mfma_f32_16x16x32_bf16 v[196:199], v[40:43], a[148:151], v[196:199]
    v_accvgpr_write_b32 a232, v168
    v_accvgpr_write_b32 a233, v169
    v_mfma_f32_16x16x32_bf16 v[200:203], v[40:43], a[152:155], v[200:203]
    v_accvgpr_write_b32 a234, v170
    v_accvgpr_write_b32 a235, v171
    v_mfma_f32_16x16x32_bf16 v[200:203], v[44:47], a[168:171], v[200:203]
    v_mfma_f32_16x16x32_bf16 v[204:207], v[44:47], a[172:175], v[204:207]
    v_mfma_f32_16x16x32_bf16 v[204:207], v[40:43], a[156:159], v[204:207]
    s_waitcnt lgkmcnt(6)
    v_mfma_f32_16x16x32_bf16 v[224:227], v[48:51], a[96:99], v[224:227]
    s_waitcnt lgkmcnt(4)
    ds_read_b64_tr_b16 v[40:41], v57 offset:37120
    ds_read_b64_tr_b16 v[42:43], v57 offset:41728
    v_mfma_f32_16x16x32_bf16 v[224:227], v[52:55], a[112:115], v[224:227]
    ds_read_b64_tr_b16 v[44:45], v57 offset:46336
    ds_read_b64_tr_b16 v[46:47], v57 offset:50944
    v_mfma_f32_16x16x32_bf16 v[228:231], v[52:55], a[116:119], v[228:231]
    v_mfma_f32_16x16x32_bf16 v[228:231], v[48:51], a[100:103], v[228:231]
    v_cvt_pk_bf16_f32 v192, v192, v193
    v_cvt_pk_bf16_f32 v193, v194, v195
    v_mfma_f32_16x16x32_bf16 v[232:235], v[48:51], a[104:107], v[232:235]
    v_cvt_pk_bf16_f32 v194, v196, v197
    v_cvt_pk_bf16_f32 v195, v198, v199
    v_mfma_f32_16x16x32_bf16 v[232:235], v[52:55], a[120:123], v[232:235]
    v_accvgpr_write_b32 a236, v192
    v_accvgpr_write_b32 a237, v193
    v_mfma_f32_16x16x32_bf16 v[236:239], v[52:55], a[124:127], v[236:239]
    v_accvgpr_write_b32 a238, v194
    v_accvgpr_write_b32 a239, v195
    v_mfma_f32_16x16x32_bf16 v[236:239], v[48:51], a[108:111], v[236:239]
    s_waitcnt lgkmcnt(6)
    v_cvt_pk_bf16_f32 v200, v200, v201
    v_cvt_pk_bf16_f32 v201, v202, v203
    v_mfma_f32_16x16x32_bf16 v[224:227], v[32:35], a[144:147], v[224:227]
    s_waitcnt lgkmcnt(4)
    ds_read_b64_tr_b16 v[48:49], v58 offset:256
    ds_read_b64_tr_b16 v[50:51], v58 offset:4864
    v_mfma_f32_16x16x32_bf16 v[224:227], v[36:39], a[160:163], v[224:227]
    ds_read_b64_tr_b16 v[52:53], v58 offset:9472
    ds_read_b64_tr_b16 v[54:55], v58 offset:14080
    v_mfma_f32_16x16x32_bf16 v[228:231], v[36:39], a[164:167], v[228:231]
    v_cvt_pk_bf16_f32 v202, v204, v205
    v_cvt_pk_bf16_f32 v203, v206, v207
    v_mfma_f32_16x16x32_bf16 v[228:231], v[32:35], a[148:151], v[228:231]
    v_accvgpr_write_b32 a240, v200
    v_accvgpr_write_b32 a241, v201
    v_mfma_f32_16x16x32_bf16 v[232:235], v[32:35], a[152:155], v[232:235]
    v_accvgpr_write_b32 a242, v202
    v_accvgpr_write_b32 a243, v203
    v_mfma_f32_16x16x32_bf16 v[232:235], v[36:39], a[168:171], v[232:235]
    v_mfma_f32_16x16x32_bf16 v[236:239], v[36:39], a[172:175], v[236:239]
    v_mfma_f32_16x16x32_bf16 v[236:239], v[32:35], a[156:159], v[236:239]
    s_waitcnt lgkmcnt(6)
    v_mfma_f32_16x16x32_bf16 v[240:243], v[40:43], a[96:99], v[240:243]
    s_waitcnt lgkmcnt(4)
    v_mfma_f32_16x16x32_bf16 v[240:243], v[44:47], a[112:115], v[240:243]
    v_mfma_f32_16x16x32_bf16 v[244:247], v[44:47], a[116:119], v[244:247]
    v_mfma_f32_16x16x32_bf16 v[244:247], v[40:43], a[100:103], v[244:247]
    v_cvt_pk_bf16_f32 v224, v224, v225
    v_cvt_pk_bf16_f32 v225, v226, v227
    v_mfma_f32_16x16x32_bf16 v[248:251], v[40:43], a[104:107], v[248:251]
    v_cvt_pk_bf16_f32 v226, v228, v229
    v_cvt_pk_bf16_f32 v227, v230, v231
    v_mfma_f32_16x16x32_bf16 v[248:251], v[44:47], a[120:123], v[248:251]
    v_accvgpr_write_b32 a244, v224
    v_accvgpr_write_b32 a245, v225
    v_mfma_f32_16x16x32_bf16 v[252:255], v[44:47], a[124:127], v[252:255]
    v_accvgpr_write_b32 a246, v226
    v_accvgpr_write_b32 a247, v227
    v_mfma_f32_16x16x32_bf16 v[252:255], v[40:43], a[108:111], v[252:255]
    s_waitcnt lgkmcnt(2)
    v_cvt_pk_bf16_f32 v232, v232, v233
    v_cvt_pk_bf16_f32 v233, v234, v235
    v_mfma_f32_16x16x32_bf16 v[240:243], v[48:51], a[144:147], v[240:243]
    s_waitcnt lgkmcnt(0)
    v_cvt_pk_bf16_f32 v234, v236, v237
    v_cvt_pk_bf16_f32 v235, v238, v239
    v_mfma_f32_16x16x32_bf16 v[240:243], v[52:55], a[160:163], v[240:243]
    v_accvgpr_write_b32 a248, v232
    v_accvgpr_write_b32 a249, v233
    v_mfma_f32_16x16x32_bf16 v[244:247], v[52:55], a[164:167], v[244:247]
    v_accvgpr_write_b32 a250, v234
    v_accvgpr_write_b32 a251, v235
    v_mfma_f32_16x16x32_bf16 v[244:247], v[48:51], a[148:151], v[244:247]
    v_mfma_f32_16x16x32_bf16 v[248:251], v[48:51], a[152:155], v[248:251]
    v_mfma_f32_16x16x32_bf16 v[248:251], v[52:55], a[168:171], v[248:251]
    v_mfma_f32_16x16x32_bf16 v[252:255], v[52:55], a[172:175], v[252:255]
    v_mfma_f32_16x16x32_bf16 v[252:255], v[48:51], a[156:159], v[252:255]
    s_nop 7
    v_cvt_pk_bf16_f32 v240, v240, v241
    v_cvt_pk_bf16_f32 v241, v242, v243
    v_cvt_pk_bf16_f32 v242, v244, v245
    v_cvt_pk_bf16_f32 v243, v246, v247
    v_cvt_pk_bf16_f32 v248, v248, v249
    v_cvt_pk_bf16_f32 v249, v250, v251
    v_cvt_pk_bf16_f32 v250, v252, v253
    v_cvt_pk_bf16_f32 v251, v254, v255
    s_mov_b32 s90, 73728
    buffer_store_dwordx4 v[240:243], v59, s[64:67], s90 offen offset:3072 sc1
    s_mov_b32 s90, 77824
    buffer_store_dwordx4 v[248:251], v59, s[64:67], s90 offen offset:3072 sc1
Ljoin:
    v_mov_b32 v32, 0xff800000
Lpad9:
    s_cbranch_execz Lpad11
    v_mov_b32 v33, 0xff800000
    v_mov_b32 v34, 0xff800000
    v_mov_b32 v35, 0xff800000
Latt:
    s_waitcnt vmcnt(24)
    s_barrier
    ds_read_b128 a[144:147], v20 offset:0
    ds_read_b128 a[148:151], v21 offset:0
    ds_read_b128 a[152:155], v22 offset:0
    ds_read_b128 a[156:159], v23 offset:0
    ds_read_b128 a[160:163], v20 offset:4096
    ds_read_b128 a[164:167], v21 offset:4096
    ds_read_b128 a[168:171], v22 offset:4096
    ds_read_b128 a[172:175], v23 offset:4096
    s_mov_b32 s84, 32768
    s_mov_b32 s85, 16384
    s_mov_b32 s86, 6
    v_mov_b32 v45, 158720
    v_mov_b32 v160, 0
    ds_write_b32 v45, v160
    s_lshr_b32 s89, s2, 3
    s_lshl2_add_u32 s89, s89, s70
    s_lshl_b32 s89, s89, 11
    s_add_u32 s80, s72, 0
    s_and_b32 s80, s80, 3
    s_mul_i32 s80, s80, 9
    s_add_u32 s80, s80, 1
    s_lshr_b32 s80, s80, 1
    s_add_u32 s80, s80, s3
    s_lshl_b32 s80, s80, 17
    s_add_u32 s73, s80, 262144
    s_lshl_b32 s88, s69, 14
    s_lshl2_add_u32 s91, s71, s15
    s_and_b32 s74, s71, 1
    s_lshl_b32 s74, s74, 8
    s_mov_b32 s26, 0
    s_waitcnt lgkmcnt(8)
    v_mfma_f32_16x16x32_bf16 v[64:67], a[144:147], v[112:115], 0
    s_waitcnt lgkmcnt(7)
    s_add_u32 m0, s83, 88064
    v_mov_b32 v161, 0x3f803f80
    v_accvgpr_write_b32 a208, v161
    v_mfma_f32_16x16x32_bf16 v[64:67], a[148:151], v[144:147], v[64:67]
    s_waitcnt lgkmcnt(6)
    buffer_load_dwordx4 v18, s[48:51], s85 offen offset:0 lds
    v_mfma_f32_16x16x32_bf16 v[64:67], a[152:155], v[176:179], v[64:67]
    s_waitcnt lgkmcnt(5)
    v_accvgpr_write_b32 a209, v161
    v_accvgpr_write_b32 a210, v161
    v_mfma_f32_16x16x32_bf16 v[64:67], a[156:159], v[208:211], v[64:67]
    v_accvgpr_write_b32 a211, v161
    v_mov_b32 v43, s22
    v_mfma_f32_16x16x32_bf16 v[68:71], a[156:159], v[212:215], 0
    v_and_b32 v42, 15, v0
    v_lshl_add_u32 v42, v42, 7, s89
    v_mfma_f32_16x16x32_bf16 v[68:71], a[152:155], v[180:183], v[68:71]
    buffer_load_dwordx4 v19, s[48:51], s85 offen offset:1024 lds
    v_mfma_f32_16x16x32_bf16 v[68:71], a[148:151], v[148:151], v[68:71]
    v_and_b32 v41, 127, v0
    v_lshlrev_b32 v41, 7, v41
    v_mfma_f32_16x16x32_bf16 v[68:71], a[144:147], v[116:119], v[68:71]
    v_lshrrev_b32 v162, 7, v0
    v_lshl_add_u32 v41, v162, 17, v41
    v_mfma_f32_16x16x32_bf16 v[72:75], a[144:147], v[120:123], 0
    v_add_u32 v41, s88, v41
    v_and_b32 v46, 7, v0
    v_mfma_f32_16x16x32_bf16 v[72:75], a[148:151], v[152:155], v[72:75]
    buffer_load_dwordx4 v18, s[48:51], s85 offen offset:2048 lds
    v_mfma_f32_16x16x32_bf16 v[72:75], a[152:155], v[184:187], v[72:75]
    v_lshlrev_b32 v46, 2, v46
    v_and_b32 v47, 8, v0
    v_mfma_f32_16x16x32_bf16 v[72:75], a[156:159], v[216:219], v[72:75]
    v_cmp_eq_u32 vcc, 0, v47
    v_add_u32 v47, s15, v46
    v_mfma_f32_16x16x32_bf16 v[76:79], a[156:159], v[220:223], 0
    v_add_u32 v44, s14, v1
    v_add_u32 v44, 80, v44
    v_mfma_f32_16x16x32_bf16 v[76:79], a[152:155], v[188:191], v[76:79]
    buffer_load_dwordx4 v19, s[48:51], s85 offen offset:3072 lds
    v_mfma_f32_16x16x32_bf16 v[76:79], a[148:151], v[156:159], v[76:79]
    v_and_b32 v163, 4, v0
    v_mul_u32_u24 v163, s74, v163
    v_mfma_f32_16x16x32_bf16 v[76:79], a[144:147], v[124:127], v[76:79]
    s_waitcnt lgkmcnt(4)
    v_sub_u32 v44, v44, v163
    v_cndmask_b32 v47, v44, v47, vcc
    v_mfma_f32_16x16x32_bf16 v[80:83], a[160:163], v[112:115], 0
    s_waitcnt lgkmcnt(3)
    s_add_u32 m0, s83, 36864
    v_bfe_u32 v170, v0, 2, 2
    v_bfe_u32 v171, v0, 4, 2
    v_mfma_f32_16x16x32_bf16 v[80:83], a[164:167], v[144:147], v[80:83]
    s_waitcnt lgkmcnt(2)
    buffer_load_dwordx4 v14, s[44:47], s84 offen offset:0 lds
    v_mfma_f32_16x16x32_bf16 v[80:83], a[168:171], v[176:179], v[80:83]
    s_waitcnt lgkmcnt(1)
    ds_read_b128 a[144:147], v20 offset:8192
    v_cmp_eq_u32 vcc, v170, v171
    v_and_b32 v170, 1, v0
    v_mfma_f32_16x16x32_bf16 v[80:83], a[172:175], v[208:211], v[80:83]
    v_lshlrev_b32 v170, 4, v170
    v_mov_b32 v171, 0x3f80
    v_mfma_f32_16x16x32_bf16 v[84:87], a[172:175], v[212:215], 0
    v_lshlrev_b32 v170, v170, v171
    v_cndmask_b32 v170, 0, v170, vcc
    v_mfma_f32_16x16x32_bf16 v[84:87], a[168:171], v[180:183], v[84:87]
    buffer_load_dwordx4 v15, s[44:47], s84 offen offset:1024 lds
    v_mfma_f32_16x16x32_bf16 v[84:87], a[164:167], v[148:151], v[84:87]
    ds_read_b128 a[148:151], v21 offset:8192
    v_and_b32 v171, 2, v0
    v_cmp_eq_u32 vcc, 0, v171
    v_mfma_f32_16x16x32_bf16 v[84:87], a[160:163], v[116:119], v[84:87]
    v_nop
    v_nop
    v_mfma_f32_16x16x32_bf16 v[88:91], a[160:163], v[120:123], 0
    v_cndmask_b32 v166, 0, v170, vcc
    v_cndmask_b32 v167, v170, 0, vcc
    v_mfma_f32_16x16x32_bf16 v[88:91], a[164:167], v[152:155], v[88:91]
    buffer_load_dwordx4 v16, s[44:47], s84 offen offset:2048 lds
    v_mfma_f32_16x16x32_bf16 v[88:91], a[168:171], v[184:187], v[88:91]
    ds_read_b128 a[152:155], v22 offset:8192
    v_accvgpr_write_b32 a252, v166
    v_accvgpr_write_b32 a253, v167
    v_mfma_f32_16x16x32_bf16 v[88:91], a[172:175], v[216:219], v[88:91]
    v_accvgpr_write_b32 a254, 0
    v_accvgpr_write_b32 a255, 0
    v_mfma_f32_16x16x32_bf16 v[92:95], a[172:175], v[220:223], 0
    v_mfma_f32_16x16x32_bf16 v[92:95], a[168:171], v[188:191], v[92:95]
    ds_read_b128 a[156:159], v23 offset:8192
    buffer_load_dwordx4 v17, s[44:47], s84 offen offset:3072 lds
    v_mfma_f32_16x16x32_bf16 v[92:95], a[164:167], v[156:159], v[92:95]
    v_mfma_f32_16x16x32_bf16 v[92:95], a[160:163], v[124:127], v[92:95]
    s_nop 2
    v_max3_f32 v224, v64, v65, v32
    v_max3_f32 v225, v66, v67, v80
    v_max3_f32 v224, v224, v81, v82
    v_max3_f32 v224, v224, v225, v83
    v_max3_f32 v228, v68, v69, v33
    v_max3_f32 v229, v70, v71, v84
    v_max3_f32 v228, v228, v85, v86
    v_max3_f32 v228, v228, v229, v87
    v_max3_f32 v232, v72, v73, v34
    v_max3_f32 v233, v74, v75, v88
    v_max3_f32 v232, v232, v89, v90
    v_max3_f32 v232, v232, v233, v91
    v_max3_f32 v236, v76, v77, v35
    v_max3_f32 v237, v78, v79, v92
    v_max3_f32 v236, v236, v93, v94
    v_max3_f32 v236, v236, v237, v95
    v_mov_b32 v225, v224
    v_mov_b32 v229, v228
    v_mov_b32 v233, v232
    v_mov_b32 v237, v236
    v_permlane32_swap_b32 v224, v225
    v_permlane32_swap_b32 v228, v229
    v_permlane32_swap_b32 v232, v233
    v_permlane32_swap_b32 v236, v237
    v_max_f32 v224, v224, v225
    v_max_f32 v228, v228, v229
    v_max_f32 v232, v232, v233
    v_max_f32 v236, v236, v237
    v_mov_b32 v225, v224
    v_mov_b32 v229, v228
    v_mov_b32 v233, v232
    v_mov_b32 v237, v236
    v_permlane16_swap_b32 v224, v225
    v_permlane16_swap_b32 v228, v229
    v_permlane16_swap_b32 v232, v233
    v_permlane16_swap_b32 v236, v237
    v_max_f32 v224, v224, v225
    v_max_f32 v228, v228, v229
    v_max_f32 v232, v232, v233
    v_max_f32 v236, v236, v237
    v_sub_f32 v224, 0, v224
    v_mov_b32 v225, v224
    v_mov_b32 v226, v224
    v_mov_b32 v227, v224
    v_add_f32 v64, v64, v224
    v_add_f32 v65, v65, v224
    v_add_f32 v66, v66, v224
    v_add_f32 v67, v67, v224
    v_add_f32 v80, v80, v224
    v_add_f32 v81, v81, v224
    v_add_f32 v82, v82, v224
    v_add_f32 v83, v83, v224
    v_sub_f32 v228, 0, v228
    v_mov_b32 v229, v228
    v_mov_b32 v230, v228
    v_mov_b32 v231, v228
    v_add_f32 v68, v68, v228
    v_add_f32 v69, v69, v228
    v_add_f32 v70, v70, v228
    v_add_f32 v71, v71, v228
    v_add_f32 v84, v84, v228
    v_add_f32 v85, v85, v228
    v_add_f32 v86, v86, v228
    v_add_f32 v87, v87, v228
    v_sub_f32 v232, 0, v232
    v_mov_b32 v233, v232
    v_mov_b32 v234, v232
    v_mov_b32 v235, v232
    v_add_f32 v72, v72, v232
    v_add_f32 v73, v73, v232
    v_add_f32 v74, v74, v232
    v_add_f32 v75, v75, v232
    v_add_f32 v88, v88, v232
    v_add_f32 v89, v89, v232
    v_add_f32 v90, v90, v232
    v_add_f32 v91, v91, v232
    v_sub_f32 v236, 0, v236
    v_mov_b32 v237, v236
    v_mov_b32 v238, v236
    v_mov_b32 v239, v236
    v_add_f32 v76, v76, v236
    v_add_f32 v77, v77, v236
    v_add_f32 v78, v78, v236
    v_add_f32 v79, v79, v236
    v_add_f32 v92, v92, v236
    v_add_f32 v93, v93, v236
    v_add_f32 v94, v94, v236
    v_add_f32 v95, v95, v236
    s_nop 1
    s_waitcnt lgkmcnt(3)
    v_mfma_f32_16x16x32_bf16 v[96:99], a[144:147], v[112:115], v[224:227]
    s_waitcnt lgkmcnt(2)
    ds_read_b128 a[160:163], v20 offset:12288
    ds_read_b128 a[164:167], v21 offset:12288
    ds_read_b128 a[168:171], v22 offset:12288
    ds_read_b128 a[172:175], v23 offset:12288
    v_exp_f32 v64, v64
    v_exp_f32 v65, v65
    v_mfma_f32_16x16x32_bf16 v[96:99], a[148:151], v[144:147], v[96:99]
    s_waitcnt lgkmcnt(5)
    v_cvt_pk_bf16_f32 v160, v64, v65
    v_exp_f32 v66, v66
    v_mfma_f32_16x16x32_bf16 v[96:99], a[152:155], v[176:179], v[96:99]
    s_waitcnt lgkmcnt(4)
    s_mov_b32 s90, 0
    v_exp_f32 v67, v67
    v_mfma_f32_16x16x32_bf16 v[96:99], a[156:159], v[208:211], v[96:99]
    buffer_store_dwordx4 a[212:215], v59, s[64:67], s90 offen offset:3072 sc1
    v_cvt_pk_bf16_f32 v161, v66, v67
    v_exp_f32 v80, v80
    v_mfma_f32_16x16x32_bf16 v[100:103], a[156:159], v[212:215], v[228:231]
    v_exp_f32 v81, v81
    v_mfma_f32_16x16x32_bf16 v[100:103], a[152:155], v[180:183], v[100:103]
    v_cvt_pk_bf16_f32 v162, v80, v81
    v_exp_f32 v82, v82
    v_mfma_f32_16x16x32_bf16 v[100:103], a[148:151], v[148:151], v[100:103]
    v_exp_f32 v83, v83
    v_mfma_f32_16x16x32_bf16 v[100:103], a[144:147], v[116:119], v[100:103]
    v_cvt_pk_bf16_f32 v163, v82, v83
    v_exp_f32 v68, v68
    v_mfma_f32_16x16x32_bf16 v[104:107], a[144:147], v[120:123], v[232:235]
    v_exp_f32 v69, v69
    v_mfma_f32_16x16x32_bf16 v[104:107], a[148:151], v[152:155], v[104:107]
    v_cvt_pk_bf16_f32 v164, v68, v69
    v_exp_f32 v70, v70
    v_mfma_f32_16x16x32_bf16 v[104:107], a[152:155], v[184:187], v[104:107]
    v_exp_f32 v71, v71
    v_mfma_f32_16x16x32_bf16 v[104:107], a[156:159], v[216:219], v[104:107]
    s_add_u32 s84, s84, 16384
    v_cvt_pk_bf16_f32 v165, v70, v71
    v_exp_f32 v84, v84
    v_mfma_f32_16x16x32_bf16 v[108:111], a[156:159], v[220:223], v[236:239]
    s_waitcnt vmcnt(17)
    v_exp_f32 v85, v85
    v_mfma_f32_16x16x32_bf16 v[108:111], a[152:155], v[188:191], v[108:111]
    s_barrier
    v_cvt_pk_bf16_f32 v166, v84, v85
    v_exp_f32 v86, v86
    v_mfma_f32_16x16x32_bf16 v[108:111], a[148:151], v[156:159], v[108:111]
    s_add_u32 s85, s85, 16384
    v_exp_f32 v87, v87
    v_mfma_f32_16x16x32_bf16 v[108:111], a[144:147], v[124:127], v[108:111]
    s_waitcnt lgkmcnt(3)
    v_cvt_pk_bf16_f32 v167, v86, v87
    v_exp_f32 v72, v72
    v_exp_f32 v73, v73
    v_mfma_f32_16x16x32_bf16 v[128:131], a[160:163], v[112:115], v[224:227]
    s_waitcnt lgkmcnt(2)
    s_mov_b32 s90, 4096
    ds_read_b128 a[144:147], v20 offset:16384
    ds_read_b128 a[148:151], v21 offset:16384
    ds_read_b128 a[152:155], v22 offset:16384
    v_cvt_pk_bf16_f32 v168, v72, v73
    v_exp_f32 v74, v74
    v_mfma_f32_16x16x32_bf16 v[128:131], a[164:167], v[144:147], v[128:131]
    s_waitcnt lgkmcnt(4)
    buffer_store_dwordx4 a[216:219], v59, s[64:67], s90 offen offset:3072 sc1
    ds_read_b128 a[156:159], v23 offset:16384
    v_exp_f32 v75, v75
    v_mfma_f32_16x16x32_bf16 v[128:131], a[168:171], v[176:179], v[128:131]
    s_waitcnt lgkmcnt(4)
    v_cvt_pk_bf16_f32 v169, v74, v75
    v_exp_f32 v88, v88
    v_mfma_f32_16x16x32_bf16 v[128:131], a[172:175], v[208:211], v[128:131]
    v_exp_f32 v89, v89
    v_mfma_f32_16x16x32_bf16 v[132:135], a[172:175], v[212:215], v[228:231]
    v_cvt_pk_bf16_f32 v170, v88, v89
    v_exp_f32 v90, v90
    v_mfma_f32_16x16x32_bf16 v[132:135], a[168:171], v[180:183], v[132:135]
    s_add_u32 m0, s83, 53248
    v_exp_f32 v91, v91
    v_mfma_f32_16x16x32_bf16 v[132:135], a[164:167], v[148:151], v[132:135]
    buffer_load_dwordx4 v14, s[44:47], s84 offen offset:0 lds
    v_cvt_pk_bf16_f32 v171, v90, v91
    v_exp_f32 v76, v76
    v_mfma_f32_16x16x32_bf16 v[132:135], a[160:163], v[116:119], v[132:135]
    v_exp_f32 v77, v77
    v_mfma_f32_16x16x32_bf16 v[136:139], a[160:163], v[120:123], v[232:235]
    v_cvt_pk_bf16_f32 v172, v76, v77
    v_exp_f32 v78, v78
    v_mfma_f32_16x16x32_bf16 v[136:139], a[164:167], v[152:155], v[136:139]
    v_exp_f32 v79, v79
    v_mfma_f32_16x16x32_bf16 v[136:139], a[168:171], v[184:187], v[136:139]
    v_cvt_pk_bf16_f32 v173, v78, v79
    v_exp_f32 v92, v92
    v_mfma_f32_16x16x32_bf16 v[136:139], a[172:175], v[216:219], v[136:139]
    buffer_load_dwordx4 v15, s[44:47], s84 offen offset:1024 lds
    v_exp_f32 v93, v93
    v_mfma_f32_16x16x32_bf16 v[140:143], a[172:175], v[220:223], v[236:239]
    v_cvt_pk_bf16_f32 v174, v92, v93
    v_exp_f32 v94, v94
    v_mfma_f32_16x16x32_bf16 v[140:143], a[168:171], v[188:191], v[140:143]
    v_exp_f32 v95, v95
    v_mfma_f32_16x16x32_bf16 v[140:143], a[164:167], v[156:159], v[140:143]
    v_cvt_pk_bf16_f32 v175, v94, v95
    v_mfma_f32_16x16x32_bf16 v[140:143], a[160:163], v[124:127], v[140:143]
    s_waitcnt lgkmcnt(3)
    v_mfma_f32_16x16x32_bf16 v[64:67], a[144:147], v[112:115], v[224:227]
    s_waitcnt lgkmcnt(2)
    ds_read_b128 a[160:163], v20 offset:20480
    ds_read_b128 a[164:167], v21 offset:20480
    ds_read_b128 a[168:171], v22 offset:20480
    ds_read_b128 a[172:175], v23 offset:20480
    v_exp_f32 v96, v96
    v_exp_f32 v97, v97
    v_mfma_f32_16x16x32_bf16 v[64:67], a[148:151], v[144:147], v[64:67]
    s_waitcnt lgkmcnt(5)
    v_cvt_pk_bf16_f32 v192, v96, v97
    v_exp_f32 v98, v98
    v_mfma_f32_16x16x32_bf16 v[64:67], a[152:155], v[176:179], v[64:67]
    s_waitcnt lgkmcnt(4)
    v_exp_f32 v99, v99
    v_mfma_f32_16x16x32_bf16 v[64:67], a[156:159], v[208:211], v[64:67]
    buffer_load_dwordx4 v16, s[44:47], s84 offen offset:2048 lds
    v_cvt_pk_bf16_f32 v193, v98, v99
    v_exp_f32 v128, v128
    v_mfma_f32_16x16x32_bf16 v[68:71], a[156:159], v[212:215], v[228:231]
    v_exp_f32 v129, v129
    v_mfma_f32_16x16x32_bf16 v[68:71], a[152:155], v[180:183], v[68:71]
    v_cvt_pk_bf16_f32 v194, v128, v129
    v_exp_f32 v130, v130
    v_mfma_f32_16x16x32_bf16 v[68:71], a[148:151], v[148:151], v[68:71]
    v_exp_f32 v131, v131
    v_mfma_f32_16x16x32_bf16 v[68:71], a[144:147], v[116:119], v[68:71]
    buffer_load_dwordx4 v17, s[44:47], s84 offen offset:3072 lds
    v_cvt_pk_bf16_f32 v195, v130, v131
    v_exp_f32 v100, v100
    v_mfma_f32_16x16x32_bf16 v[72:75], a[144:147], v[120:123], v[232:235]
    v_exp_f32 v101, v101
    v_mfma_f32_16x16x32_bf16 v[72:75], a[148:151], v[152:155], v[72:75]
    v_cvt_pk_bf16_f32 v196, v100, v101
    v_exp_f32 v102, v102
    v_mfma_f32_16x16x32_bf16 v[72:75], a[152:155], v[184:187], v[72:75]
    s_mov_b32 s90, 8192
    v_exp_f32 v103, v103
    v_mfma_f32_16x16x32_bf16 v[72:75], a[156:159], v[216:219], v[72:75]
    buffer_store_dwordx4 a[220:223], v59, s[64:67], s90 offen offset:0 sc1
    v_cvt_pk_bf16_f32 v197, v102, v103
    v_exp_f32 v132, v132
    v_mfma_f32_16x16x32_bf16 v[76:79], a[156:159], v[220:223], v[236:239]
    v_exp_f32 v133, v133
    v_mfma_f32_16x16x32_bf16 v[76:79], a[152:155], v[188:191], v[76:79]
    v_cvt_pk_bf16_f32 v198, v132, v133
    v_exp_f32 v134, v134
    v_mfma_f32_16x16x32_bf16 v[76:79], a[148:151], v[156:159], v[76:79]
    v_exp_f32 v135, v135
    v_mfma_f32_16x16x32_bf16 v[76:79], a[144:147], v[124:127], v[76:79]
    s_waitcnt lgkmcnt(3)
    v_cvt_pk_bf16_f32 v199, v134, v135
    v_exp_f32 v104, v104
    v_exp_f32 v105, v105
    v_mfma_f32_16x16x32_bf16 v[80:83], a[160:163], v[112:115], v[224:227]
    s_waitcnt lgkmcnt(2)
    s_mov_b32 s90, 81920
    ds_read_b128 a[144:147], v20 offset:24576
    ds_read_b128 a[148:151], v21 offset:24576
    ds_read_b128 a[152:155], v22 offset:24576
    v_cvt_pk_bf16_f32 v200, v104, v105
    v_exp_f32 v106, v106
    v_mfma_f32_16x16x32_bf16 v[80:83], a[164:167], v[144:147], v[80:83]
    s_waitcnt lgkmcnt(4)
    buffer_store_dwordx4 a[224:227], v59, s[64:67], s90 offen offset:0 sc1
    ds_read_b128 a[156:159], v23 offset:24576
    ds_read_b64_tr_b16 a[176:177], v24 offset:0
    ds_read_b64_tr_b16 a[178:179], v24 offset:4096
    ds_read_b64_tr_b16 a[180:181], v24 offset:8192
    v_exp_f32 v107, v107
    v_mfma_f32_16x16x32_bf16 v[80:83], a[168:171], v[176:179], v[80:83]
    s_waitcnt lgkmcnt(7)
    ds_read_b64_tr_b16 a[182:183], v24 offset:12288
    ds_read_b64_tr_b16 a[184:185], v25 offset:0
    ds_read_b64_tr_b16 a[186:187], v25 offset:4096
    v_cvt_pk_bf16_f32 v201, v106, v107
    v_exp_f32 v136, v136
    v_mfma_f32_16x16x32_bf16 v[80:83], a[172:175], v[208:211], v[80:83]
    ds_read_b64_tr_b16 a[188:189], v25 offset:8192
    ds_read_b64_tr_b16 a[190:191], v25 offset:12288
    v_exp_f32 v137, v137
    v_mfma_f32_16x16x32_bf16 v[84:87], a[172:175], v[212:215], v[228:231]
    v_cvt_pk_bf16_f32 v202, v136, v137
    v_exp_f32 v138, v138
    v_mfma_f32_16x16x32_bf16 v[84:87], a[168:171], v[180:183], v[84:87]
    s_add_u32 m0, s83, 104448
    v_exp_f32 v139, v139
    v_mfma_f32_16x16x32_bf16 v[84:87], a[164:167], v[148:151], v[84:87]
    buffer_load_dwordx4 v18, s[48:51], s85 offen offset:0 lds
    v_cvt_pk_bf16_f32 v203, v138, v139
    v_exp_f32 v108, v108
    v_mfma_f32_16x16x32_bf16 v[84:87], a[160:163], v[116:119], v[84:87]
    v_exp_f32 v109, v109
    v_mfma_f32_16x16x32_bf16 v[88:91], a[160:163], v[120:123], v[232:235]
    v_cvt_pk_bf16_f32 v204, v108, v109
    v_exp_f32 v110, v110
    v_mfma_f32_16x16x32_bf16 v[88:91], a[164:167], v[152:155], v[88:91]
    v_exp_f32 v111, v111
    v_mfma_f32_16x16x32_bf16 v[88:91], a[168:171], v[184:187], v[88:91]
    v_cvt_pk_bf16_f32 v205, v110, v111
    v_exp_f32 v140, v140
    v_mfma_f32_16x16x32_bf16 v[88:91], a[172:175], v[216:219], v[88:91]
    buffer_load_dwordx4 v19, s[48:51], s85 offen offset:1024 lds
    v_exp_f32 v141, v141
    v_mfma_f32_16x16x32_bf16 v[92:95], a[172:175], v[220:223], v[236:239]
    v_cvt_pk_bf16_f32 v206, v140, v141
    v_exp_f32 v142, v142
    v_mfma_f32_16x16x32_bf16 v[92:95], a[168:171], v[188:191], v[92:95]
    v_exp_f32 v143, v143
    v_mfma_f32_16x16x32_bf16 v[92:95], a[164:167], v[156:159], v[92:95]
    v_cvt_pk_bf16_f32 v207, v142, v143
    v_mfma_f32_16x16x32_bf16 v[92:95], a[160:163], v[124:127], v[92:95]
    s_waitcnt lgkmcnt(11)
    v_mfma_f32_16x16x32_bf16 v[96:99], a[144:147], v[112:115], v[224:227]
    s_waitcnt lgkmcnt(10)
    v_exp_f32 v64, v64
    v_mfma_f32_16x16x32_bf16 v[96:99], a[148:151], v[144:147], v[96:99]
    s_waitcnt lgkmcnt(9)
    v_exp_f32 v65, v65
    v_mfma_f32_16x16x32_bf16 v[96:99], a[152:155], v[176:179], v[96:99]
    s_waitcnt lgkmcnt(8)
    ds_read_b128 a[160:163], v20 offset:28672
    v_cvt_pk_bf16_f32 v240, v64, v65
    v_mfma_f32_16x16x32_bf16 v[96:99], a[156:159], v[208:211], v[96:99]
    v_exp_f32 v66, v66
    v_mfma_f32_16x16x32_bf16 v[100:103], a[156:159], v[212:215], v[228:231]
    ds_read_b128 a[164:167], v21 offset:28672
    v_mfma_f32_16x16x32_bf16 v[100:103], a[152:155], v[180:183], v[100:103]
    v_exp_f32 v67, v67
    v_mfma_f32_16x16x32_bf16 v[100:103], a[148:151], v[148:151], v[100:103]
    ds_read_b128 a[168:171], v22 offset:28672
    v_cvt_pk_bf16_f32 v241, v66, v67
    v_mfma_f32_16x16x32_bf16 v[100:103], a[144:147], v[116:119], v[100:103]
    buffer_load_dwordx4 v18, s[48:51], s85 offen offset:2048 lds
    v_mfma_f32_16x16x32_bf16 v[104:107], a[144:147], v[120:123], v[232:235]
    v_exp_f32 v80, v80
    v_mfma_f32_16x16x32_bf16 v[104:107], a[148:151], v[152:155], v[104:107]
    ds_read_b128 a[172:175], v23 offset:28672
    v_mfma_f32_16x16x32_bf16 v[104:107], a[152:155], v[184:187], v[104:107]
    v_exp_f32 v81, v81
    v_mfma_f32_16x16x32_bf16 v[104:107], a[156:159], v[216:219], v[104:107]
    ds_read_b64_tr_b16 a[192:193], v26 offset:0
    v_cvt_pk_bf16_f32 v242, v80, v81
    v_mfma_f32_16x16x32_bf16 v[108:111], a[156:159], v[220:223], v[236:239]
    v_exp_f32 v82, v82
    v_mfma_f32_16x16x32_bf16 v[108:111], a[152:155], v[188:191], v[108:111]
    ds_read_b64_tr_b16 a[194:195], v26 offset:4096
    v_mfma_f32_16x16x32_bf16 v[108:111], a[148:151], v[156:159], v[108:111]
    v_exp_f32 v83, v83
    v_mfma_f32_16x16x32_bf16 v[108:111], a[144:147], v[124:127], v[108:111]
    s_waitcnt lgkmcnt(12)
    ds_read_b64_tr_b16 a[196:197], v26 offset:8192
    v_cvt_pk_bf16_f32 v243, v82, v83
    v_mfma_f32_16x16x32_bf16 a[0:3], a[176:179], v[160:163], 0
    s_waitcnt lgkmcnt(11)
    v_exp_f32 v68, v68
    v_mfma_f32_16x16x32_bf16 a[0:3], a[180:183], v[192:195], a[0:3]
    ds_read_b64_tr_b16 a[198:199], v26 offset:12288
    v_mfma_f32_16x16x32_bf16 a[32:35], a[180:183], v[196:199], 0
    buffer_load_dwordx4 v19, s[48:51], s85 offen offset:3072 lds
    v_mfma_f32_16x16x32_bf16 a[32:35], a[176:179], v[164:167], a[32:35]
    v_exp_f32 v69, v69
    v_mfma_f32_16x16x32_bf16 a[64:67], a[176:179], v[168:171], 0
    ds_read_b64_tr_b16 a[200:201], v27 offset:0
    v_cvt_pk_bf16_f32 v244, v68, v69
    v_mfma_f32_16x16x32_bf16 a[64:67], a[180:183], v[200:203], a[64:67]
    v_exp_f32 v70, v70
    v_mfma_f32_16x16x32_bf16 a[96:99], a[180:183], v[204:207], 0
    ds_read_b64_tr_b16 a[202:203], v27 offset:4096
    v_mfma_f32_16x16x32_bf16 a[96:99], a[176:179], v[172:175], a[96:99]
    s_waitcnt lgkmcnt(12)
    v_exp_f32 v71, v71
    v_mfma_f32_16x16x32_bf16 a[4:7], a[184:187], v[160:163], 0
    s_waitcnt lgkmcnt(10)
    ds_read_b64_tr_b16 a[204:205], v27 offset:8192
    v_cvt_pk_bf16_f32 v245, v70, v71
    v_mfma_f32_16x16x32_bf16 a[4:7], a[188:191], v[192:195], a[4:7]
    v_exp_f32 v84, v84
    v_mfma_f32_16x16x32_bf16 a[36:39], a[188:191], v[196:199], 0
    s_mov_b32 s90, 73728
    ds_read_b64_tr_b16 a[206:207], v27 offset:12288
    v_mfma_f32_16x16x32_bf16 a[36:39], a[184:187], v[164:167], a[36:39]
    buffer_store_dwordx4 a[228:231], v59, s[64:67], s90 offen offset:0 sc1
    v_mfma_f32_16x16x32_bf16 a[68:71], a[184:187], v[168:171], 0
    v_exp_f32 v85, v85
    v_mfma_f32_16x16x32_bf16 a[68:71], a[188:191], v[200:203], a[68:71]
    s_add_u32 s84, s84, 16384
    v_cvt_pk_bf16_f32 v246, v84, v85
    v_mfma_f32_16x16x32_bf16 a[100:103], a[188:191], v[204:207], 0
    s_waitcnt vmcnt(13)
    v_exp_f32 v86, v86
    v_mfma_f32_16x16x32_bf16 a[100:103], a[184:187], v[172:175], a[100:103]
    s_barrier
    v_mfma_f32_16x16x32_bf16 a[128:131], a[208:211], v[160:163], 0
    s_add_u32 s85, s85, 16384
    v_exp_f32 v87, v87
    v_mfma_f32_16x16x32_bf16 a[128:131], a[208:211], v[192:195], a[128:131]
    s_waitcnt lgkmcnt(11)
    ds_read_b128 a[144:147], v20 offset:32768
    v_cvt_pk_bf16_f32 v247, v86, v87
    v_mfma_f32_16x16x32_bf16 v[128:131], a[160:163], v[112:115], v[224:227]
    s_waitcnt lgkmcnt(11)
    v_exp_f32 v72, v72
    v_mfma_f32_16x16x32_bf16 v[128:131], a[164:167], v[144:147], v[128:131]
    s_waitcnt lgkmcnt(10)
    v_exp_f32 v73, v73
    v_mfma_f32_16x16x32_bf16 v[128:131], a[168:171], v[176:179], v[128:131]
    s_waitcnt lgkmcnt(9)
    ds_read_b128 a[148:151], v21 offset:32768
    v_cvt_pk_bf16_f32 v248, v72, v73
    v_mfma_f32_16x16x32_bf16 v[128:131], a[172:175], v[208:211], v[128:131]
    v_exp_f32 v74, v74
    v_mfma_f32_16x16x32_bf16 v[132:135], a[172:175], v[212:215], v[228:231]
    ds_read_b128 a[152:155], v22 offset:32768
    v_mfma_f32_16x16x32_bf16 v[132:135], a[168:171], v[180:183], v[132:135]
    v_exp_f32 v75, v75
    v_mfma_f32_16x16x32_bf16 v[132:135], a[164:167], v[148:151], v[132:135]
    s_mov_b32 s90, 77824
    ds_read_b128 a[156:159], v23 offset:32768
    v_cvt_pk_bf16_f32 v249, v74, v75
    v_mfma_f32_16x16x32_bf16 v[132:135], a[160:163], v[116:119], v[132:135]
    buffer_store_dwordx4 a[232:235], v59, s[64:67], s90 offen offset:0 sc1
    v_mfma_f32_16x16x32_bf16 v[136:139], a[160:163], v[120:123], v[232:235]
    v_exp_f32 v88, v88
    v_mfma_f32_16x16x32_bf16 v[136:139], a[164:167], v[152:155], v[136:139]
    ds_read_b64_tr_b16 a[176:177], v28 offset:0
    v_mfma_f32_16x16x32_bf16 v[136:139], a[168:171], v[184:187], v[136:139]
    v_exp_f32 v89, v89
    v_mfma_f32_16x16x32_bf16 v[136:139], a[172:175], v[216:219], v[136:139]
    ds_read_b64_tr_b16 a[178:179], v28 offset:4096
    v_cvt_pk_bf16_f32 v250, v88, v89
    v_mfma_f32_16x16x32_bf16 v[140:143], a[172:175], v[220:223], v[236:239]
    v_exp_f32 v90, v90
    v_mfma_f32_16x16x32_bf16 v[140:143], a[168:171], v[188:191], v[140:143]
    ds_read_b64_tr_b16 a[180:181], v28 offset:8192
    v_mfma_f32_16x16x32_bf16 v[140:143], a[164:167], v[156:159], v[140:143]
    v_exp_f32 v91, v91
    v_mfma_f32_16x16x32_bf16 v[140:143], a[160:163], v[124:127], v[140:143]
    s_waitcnt lgkmcnt(13)
    ds_read_b64_tr_b16 a[182:183], v28 offset:12288
    v_cvt_pk_bf16_f32 v251, v90, v91
    v_mfma_f32_16x16x32_bf16 a[8:11], a[192:195], v[160:163], 0
    s_waitcnt lgkmcnt(12)
    v_exp_f32 v76, v76
    v_mfma_f32_16x16x32_bf16 a[8:11], a[196:199], v[192:195], a[8:11]
    s_add_u32 m0, s83, 4096
    ds_read_b64_tr_b16 a[184:185], v29 offset:0
    v_mfma_f32_16x16x32_bf16 a[40:43], a[196:199], v[196:199], 0
    buffer_load_dwordx4 v14, s[44:47], s84 offen offset:0 nt lds
    v_mfma_f32_16x16x32_bf16 a[40:43], a[192:195], v[164:167], a[40:43]
    v_exp_f32 v77, v77
    v_mfma_f32_16x16x32_bf16 a[72:75], a[192:195], v[168:171], 0
    ds_read_b64_tr_b16 a[186:187], v29 offset:4096
    v_cvt_pk_bf16_f32 v252, v76, v77
    v_mfma_f32_16x16x32_bf16 a[72:75], a[196:199], v[200:203], a[72:75]
    v_exp_f32 v78, v78
    v_mfma_f32_16x16x32_bf16 a[104:107], a[196:199], v[204:207], 0
    ds_read_b64_tr_b16 a[188:189], v29 offset:8192
    v_mfma_f32_16x16x32_bf16 a[104:107], a[192:195], v[172:175], a[104:107]
    s_waitcnt lgkmcnt(13)
    v_exp_f32 v79, v79
    v_mfma_f32_16x16x32_bf16 a[12:15], a[200:203], v[160:163], 0
    s_waitcnt lgkmcnt(11)
    ds_read_b64_tr_b16 a[190:191], v29 offset:12288
    v_cvt_pk_bf16_f32 v253, v78, v79
    v_mfma_f32_16x16x32_bf16 a[12:15], a[204:207], v[192:195], a[12:15]
    v_exp_f32 v92, v92
    v_mfma_f32_16x16x32_bf16 a[44:47], a[204:207], v[196:199], 0
    v_mfma_f32_16x16x32_bf16 a[44:47], a[200:203], v[164:167], a[44:47]
    buffer_load_dwordx4 v15, s[44:47], s84 offen offset:1024 nt lds
    v_mfma_f32_16x16x32_bf16 a[76:79], a[200:203], v[168:171], 0
    v_exp_f32 v93, v93
    v_mfma_f32_16x16x32_bf16 a[76:79], a[204:207], v[200:203], a[76:79]
    v_cvt_pk_bf16_f32 v254, v92, v93
    v_mfma_f32_16x16x32_bf16 a[108:111], a[204:207], v[204:207], 0
    v_exp_f32 v94, v94
    v_mfma_f32_16x16x32_bf16 a[108:111], a[200:203], v[172:175], a[108:111]
    v_mfma_f32_16x16x32_bf16 a[132:135], a[208:211], v[196:199], 0
    v_exp_f32 v95, v95
    v_mfma_f32_16x16x32_bf16 a[132:135], a[208:211], v[164:167], a[132:135]
    v_cvt_pk_bf16_f32 v255, v94, v95
    s_waitcnt lgkmcnt(11)
    v_mfma_f32_16x16x32_bf16 v[64:67], a[144:147], v[112:115], v[224:227]
    s_waitcnt lgkmcnt(10)
    v_exp_f32 v96, v96
    v_mfma_f32_16x16x32_bf16 v[64:67], a[148:151], v[144:147], v[64:67]
    s_waitcnt lgkmcnt(9)
    v_exp_f32 v97, v97
    v_mfma_f32_16x16x32_bf16 v[64:67], a[152:155], v[176:179], v[64:67]
    s_waitcnt lgkmcnt(8)
    ds_read_b128 a[160:163], v20 offset:36864
    v_cvt_pk_bf16_f32 v32, v96, v97
    v_mfma_f32_16x16x32_bf16 v[64:67], a[156:159], v[208:211], v[64:67]
    v_exp_f32 v98, v98
    v_mfma_f32_16x16x32_bf16 v[68:71], a[156:159], v[212:215], v[228:231]
    ds_read_b128 a[164:167], v21 offset:36864
    v_mfma_f32_16x16x32_bf16 v[68:71], a[152:155], v[180:183], v[68:71]
    v_exp_f32 v99, v99
    v_mfma_f32_16x16x32_bf16 v[68:71], a[148:151], v[148:151], v[68:71]
    ds_read_b128 a[168:171], v22 offset:36864
    v_cvt_pk_bf16_f32 v33, v98, v99
    v_mfma_f32_16x16x32_bf16 v[68:71], a[144:147], v[116:119], v[68:71]
    buffer_load_dwordx4 v16, s[44:47], s84 offen offset:2048 nt lds
    v_mfma_f32_16x16x32_bf16 v[72:75], a[144:147], v[120:123], v[232:235]
    v_exp_f32 v128, v128
    v_mfma_f32_16x16x32_bf16 v[72:75], a[148:151], v[152:155], v[72:75]
    ds_read_b128 a[172:175], v23 offset:36864
    v_mfma_f32_16x16x32_bf16 v[72:75], a[152:155], v[184:187], v[72:75]
    v_exp_f32 v129, v129
    v_mfma_f32_16x16x32_bf16 v[72:75], a[156:159], v[216:219], v[72:75]
    ds_read_b64_tr_b16 a[192:193], v30 offset:0
    v_cvt_pk_bf16_f32 v34, v128, v129
    v_mfma_f32_16x16x32_bf16 v[76:79], a[156:159], v[220:223], v[236:239]
Lpad10:
    s_cbranch_execz Lpad12
    v_exp_f32 v130, v130
    v_mfma_f32_16x16x32_bf16 v[76:79], a[152:155], v[188:191], v[76:79]
    ds_read_b64_tr_b16 a[194:195], v30 offset:4096
    v_mfma_f32_16x16x32_bf16 v[76:79], a[148:151], v[156:159], v[76:79]
    v_exp_f32 v131, v131
    v_mfma_f32_16x16x32_bf16 v[76:79], a[144:147], v[124:127], v[76:79]
    s_waitcnt lgkmcnt(12)
    ds_read_b64_tr_b16 a[196:197], v30 offset:8192
    v_cvt_pk_bf16_f32 v35, v130, v131
    v_mfma_f32_16x16x32_bf16 a[16:19], a[176:179], v[160:163], 0
    s_waitcnt lgkmcnt(11)
    v_exp_f32 v100, v100
    v_mfma_f32_16x16x32_bf16 a[16:19], a[180:183], v[192:195], a[16:19]
    ds_read_b64_tr_b16 a[198:199], v30 offset:12288
    v_mfma_f32_16x16x32_bf16 a[48:51], a[180:183], v[196:199], 0
    buffer_load_dwordx4 v17, s[44:47], s84 offen offset:3072 nt lds
    v_mfma_f32_16x16x32_bf16 a[48:51], a[176:179], v[164:167], a[48:51]
    v_exp_f32 v101, v101
    v_mfma_f32_16x16x32_bf16 a[80:83], a[176:179], v[168:171], 0
    ds_read_b64_tr_b16 a[200:201], v31 offset:0
    v_cvt_pk_bf16_f32 v36, v100, v101
    v_mfma_f32_16x16x32_bf16 a[80:83], a[180:183], v[200:203], a[80:83]
    v_exp_f32 v102, v102
    v_mfma_f32_16x16x32_bf16 a[112:115], a[180:183], v[204:207], 0
    ds_read_b64_tr_b16 a[202:203], v31 offset:4096
    v_mfma_f32_16x16x32_bf16 a[112:115], a[176:179], v[172:175], a[112:115]
    s_waitcnt lgkmcnt(12)
    v_exp_f32 v103, v103
    v_mfma_f32_16x16x32_bf16 a[20:23], a[184:187], v[160:163], 0
    s_waitcnt lgkmcnt(10)
    ds_read_b64_tr_b16 a[204:205], v31 offset:8192
    v_cvt_pk_bf16_f32 v37, v102, v103
    v_mfma_f32_16x16x32_bf16 a[20:23], a[188:191], v[192:195], a[20:23]
    v_exp_f32 v132, v132
    v_mfma_f32_16x16x32_bf16 a[52:55], a[188:191], v[196:199], 0
    s_mov_b32 s90, 73728
    ds_read_b64_tr_b16 a[206:207], v31 offset:12288
    v_mfma_f32_16x16x32_bf16 a[52:55], a[184:187], v[164:167], a[52:55]
    buffer_store_dwordx4 a[236:239], v59, s[64:67], s90 offen offset:1024 sc1
    v_mfma_f32_16x16x32_bf16 a[84:87], a[184:187], v[168:171], 0
    v_exp_f32 v133, v133
    v_mfma_f32_16x16x32_bf16 a[84:87], a[188:191], v[200:203], a[84:87]
    v_cvt_pk_bf16_f32 v38, v132, v133
    v_mfma_f32_16x16x32_bf16 a[116:119], a[188:191], v[204:207], 0
    v_exp_f32 v134, v134
    v_mfma_f32_16x16x32_bf16 a[116:119], a[184:187], v[172:175], a[116:119]
    v_mfma_f32_16x16x32_bf16 a[136:139], a[208:211], v[168:171], 0
    v_exp_f32 v135, v135
    v_mfma_f32_16x16x32_bf16 a[136:139], a[208:211], v[200:203], a[136:139]
    s_waitcnt lgkmcnt(11)
    ds_read_b128 a[144:147], v20 offset:40960
    v_cvt_pk_bf16_f32 v39, v134, v135
    v_mfma_f32_16x16x32_bf16 v[80:83], a[160:163], v[112:115], v[224:227]
    s_waitcnt lgkmcnt(11)
    v_exp_f32 v104, v104
    v_mfma_f32_16x16x32_bf16 v[80:83], a[164:167], v[144:147], v[80:83]
    s_waitcnt lgkmcnt(10)
    v_exp_f32 v105, v105
    v_mfma_f32_16x16x32_bf16 v[80:83], a[168:171], v[176:179], v[80:83]
    s_waitcnt lgkmcnt(9)
    ds_read_b128 a[148:151], v21 offset:40960
    v_cvt_pk_bf16_f32 v48, v104, v105
    v_mfma_f32_16x16x32_bf16 v[80:83], a[172:175], v[208:211], v[80:83]
    v_exp_f32 v106, v106
    v_mfma_f32_16x16x32_bf16 v[84:87], a[172:175], v[212:215], v[228:231]
    ds_read_b128 a[152:155], v22 offset:40960
    v_mfma_f32_16x16x32_bf16 v[84:87], a[168:171], v[180:183], v[84:87]
    v_exp_f32 v107, v107
    v_mfma_f32_16x16x32_bf16 v[84:87], a[164:167], v[148:151], v[84:87]
    s_mov_b32 s90, 77824
    ds_read_b128 a[156:159], v23 offset:40960
    v_cvt_pk_bf16_f32 v49, v106, v107
    v_mfma_f32_16x16x32_bf16 v[84:87], a[160:163], v[116:119], v[84:87]
    buffer_store_dwordx4 a[240:243], v59, s[64:67], s90 offen offset:1024 sc1
    v_mfma_f32_16x16x32_bf16 v[88:91], a[160:163], v[120:123], v[232:235]
    v_exp_f32 v136, v136
    v_mfma_f32_16x16x32_bf16 v[88:91], a[164:167], v[152:155], v[88:91]
    ds_read_b64_tr_b16 a[176:177], v24 offset:16384
    v_mfma_f32_16x16x32_bf16 v[88:91], a[168:171], v[184:187], v[88:91]
    v_exp_f32 v137, v137
    v_mfma_f32_16x16x32_bf16 v[88:91], a[172:175], v[216:219], v[88:91]
    ds_read_b64_tr_b16 a[178:179], v24 offset:20480
    v_cvt_pk_bf16_f32 v50, v136, v137
    v_mfma_f32_16x16x32_bf16 v[92:95], a[172:175], v[220:223], v[236:239]
    v_exp_f32 v138, v138
    v_mfma_f32_16x16x32_bf16 v[92:95], a[168:171], v[188:191], v[92:95]
    ds_read_b64_tr_b16 a[180:181], v24 offset:24576
    v_mfma_f32_16x16x32_bf16 v[92:95], a[164:167], v[156:159], v[92:95]
    v_exp_f32 v139, v139
    v_mfma_f32_16x16x32_bf16 v[92:95], a[160:163], v[124:127], v[92:95]
    s_waitcnt lgkmcnt(13)
    ds_read_b64_tr_b16 a[182:183], v24 offset:28672
    v_cvt_pk_bf16_f32 v51, v138, v139
    v_mfma_f32_16x16x32_bf16 a[24:27], a[192:195], v[160:163], 0
    s_waitcnt lgkmcnt(12)
    v_exp_f32 v108, v108
    v_mfma_f32_16x16x32_bf16 a[24:27], a[196:199], v[192:195], a[24:27]
    s_add_u32 m0, s83, 120832
    ds_read_b64_tr_b16 a[184:185], v25 offset:16384
    v_mfma_f32_16x16x32_bf16 a[56:59], a[196:199], v[196:199], 0
    buffer_load_dwordx4 v18, s[48:51], s85 offen offset:0 lds
    v_mfma_f32_16x16x32_bf16 a[56:59], a[192:195], v[164:167], a[56:59]
    v_exp_f32 v109, v109
    v_mfma_f32_16x16x32_bf16 a[88:91], a[192:195], v[168:171], 0
    ds_read_b64_tr_b16 a[186:187], v25 offset:20480
    v_cvt_pk_bf16_f32 v52, v108, v109
    v_mfma_f32_16x16x32_bf16 a[88:91], a[196:199], v[200:203], a[88:91]
    v_exp_f32 v110, v110
    v_mfma_f32_16x16x32_bf16 a[120:123], a[196:199], v[204:207], 0
    ds_read_b64_tr_b16 a[188:189], v25 offset:24576
    v_mfma_f32_16x16x32_bf16 a[120:123], a[192:195], v[172:175], a[120:123]
    s_waitcnt lgkmcnt(13)
    v_exp_f32 v111, v111
    v_mfma_f32_16x16x32_bf16 a[28:31], a[200:203], v[160:163], 0
    s_waitcnt lgkmcnt(11)
    ds_read_b64_tr_b16 a[190:191], v25 offset:28672
    v_cvt_pk_bf16_f32 v53, v110, v111
    v_mfma_f32_16x16x32_bf16 a[28:31], a[204:207], v[192:195], a[28:31]
    v_exp_f32 v140, v140
    v_mfma_f32_16x16x32_bf16 a[60:63], a[204:207], v[196:199], 0
    v_mfma_f32_16x16x32_bf16 a[60:63], a[200:203], v[164:167], a[60:63]
    buffer_load_dwordx4 v19, s[48:51], s85 offen offset:1024 lds
    v_mfma_f32_16x16x32_bf16 a[92:95], a[200:203], v[168:171], 0
    v_exp_f32 v141, v141
    v_mfma_f32_16x16x32_bf16 a[92:95], a[204:207], v[200:203], a[92:95]
    v_cvt_pk_bf16_f32 v54, v140, v141
    v_mfma_f32_16x16x32_bf16 a[124:127], a[204:207], v[204:207], 0
    v_exp_f32 v142, v142
    v_mfma_f32_16x16x32_bf16 a[124:127], a[200:203], v[172:175], a[124:127]
    v_mfma_f32_16x16x32_bf16 a[140:143], a[208:211], v[204:207], 0
    v_exp_f32 v143, v143
    v_mfma_f32_16x16x32_bf16 a[140:143], a[208:211], v[172:175], a[140:143]
    v_cvt_pk_bf16_f32 v55, v142, v143
    s_waitcnt lgkmcnt(11)
    v_mfma_f32_16x16x32_bf16 v[96:99], a[144:147], v[112:115], v[224:227]
    s_waitcnt lgkmcnt(10)
    v_exp_f32 v64, v64
    v_mfma_f32_16x16x32_bf16 v[96:99], a[148:151], v[144:147], v[96:99]
    s_waitcnt lgkmcnt(9)
    v_exp_f32 v65, v65
    v_mfma_f32_16x16x32_bf16 v[96:99], a[152:155], v[176:179], v[96:99]
    s_waitcnt lgkmcnt(8)
    ds_read_b128 a[160:163], v20 offset:45056
    v_cvt_pk_bf16_f32 v160, v64, v65
    v_mfma_f32_16x16x32_bf16 v[96:99], a[156:159], v[208:211], v[96:99]
    v_exp_f32 v66, v66
    v_mfma_f32_16x16x32_bf16 v[100:103], a[156:159], v[212:215], v[228:231]
    ds_read_b128 a[164:167], v21 offset:45056
    v_mfma_f32_16x16x32_bf16 v[100:103], a[152:155], v[180:183], v[100:103]
    v_exp_f32 v67, v67
    v_mfma_f32_16x16x32_bf16 v[100:103], a[148:151], v[148:151], v[100:103]
    ds_read_b128 a[168:171], v22 offset:45056
    v_cvt_pk_bf16_f32 v161, v66, v67
    v_mfma_f32_16x16x32_bf16 v[100:103], a[144:147], v[116:119], v[100:103]
    buffer_load_dwordx4 v18, s[48:51], s85 offen offset:2048 lds
    v_mfma_f32_16x16x32_bf16 v[104:107], a[144:147], v[120:123], v[232:235]
    v_exp_f32 v80, v80
    v_mfma_f32_16x16x32_bf16 v[104:107], a[148:151], v[152:155], v[104:107]
    ds_read_b128 a[172:175], v23 offset:45056
    v_mfma_f32_16x16x32_bf16 v[104:107], a[152:155], v[184:187], v[104:107]
    v_exp_f32 v81, v81
    v_mfma_f32_16x16x32_bf16 v[104:107], a[156:159], v[216:219], v[104:107]
    ds_read_b64_tr_b16 a[192:193], v26 offset:16384
    v_cvt_pk_bf16_f32 v162, v80, v81
    v_mfma_f32_16x16x32_bf16 v[108:111], a[156:159], v[220:223], v[236:239]
    v_exp_f32 v82, v82
    v_mfma_f32_16x16x32_bf16 v[108:111], a[152:155], v[188:191], v[108:111]
    ds_read_b64_tr_b16 a[194:195], v26 offset:20480
    v_mfma_f32_16x16x32_bf16 v[108:111], a[148:151], v[156:159], v[108:111]
    v_exp_f32 v83, v83
    v_mfma_f32_16x16x32_bf16 v[108:111], a[144:147], v[124:127], v[108:111]
    s_waitcnt lgkmcnt(12)
    ds_read_b64_tr_b16 a[196:197], v26 offset:24576
    v_cvt_pk_bf16_f32 v163, v82, v83
    v_mfma_f32_16x16x32_bf16 a[0:3], a[176:179], v[240:243], a[0:3]
    s_waitcnt lgkmcnt(11)
    v_exp_f32 v68, v68
    v_mfma_f32_16x16x32_bf16 a[0:3], a[180:183], v[32:35], a[0:3]
    ds_read_b64_tr_b16 a[198:199], v26 offset:28672
    v_mfma_f32_16x16x32_bf16 a[32:35], a[180:183], v[36:39], a[32:35]
    buffer_load_dwordx4 v19, s[48:51], s85 offen offset:3072 lds
    v_mfma_f32_16x16x32_bf16 a[32:35], a[176:179], v[244:247], a[32:35]
    v_exp_f32 v69, v69
    v_mfma_f32_16x16x32_bf16 a[64:67], a[176:179], v[248:251], a[64:67]
    ds_read_b64_tr_b16 a[200:201], v27 offset:16384
    v_cvt_pk_bf16_f32 v164, v68, v69
    v_mfma_f32_16x16x32_bf16 a[64:67], a[180:183], v[48:51], a[64:67]
    v_exp_f32 v70, v70
    v_mfma_f32_16x16x32_bf16 a[96:99], a[180:183], v[52:55], a[96:99]
    ds_read_b64_tr_b16 a[202:203], v27 offset:20480
    v_mfma_f32_16x16x32_bf16 a[96:99], a[176:179], v[252:255], a[96:99]
    s_waitcnt lgkmcnt(12)
    v_exp_f32 v71, v71
    v_mfma_f32_16x16x32_bf16 a[4:7], a[184:187], v[240:243], a[4:7]
    s_waitcnt lgkmcnt(10)
    ds_read_b64_tr_b16 a[204:205], v27 offset:24576
    v_cvt_pk_bf16_f32 v165, v70, v71
    v_mfma_f32_16x16x32_bf16 a[4:7], a[188:191], v[32:35], a[4:7]
    v_exp_f32 v84, v84
    v_mfma_f32_16x16x32_bf16 a[36:39], a[188:191], v[36:39], a[36:39]
    s_mov_b32 s90, 73728
    ds_read_b64_tr_b16 a[206:207], v27 offset:28672
    v_mfma_f32_16x16x32_bf16 a[36:39], a[184:187], v[244:247], a[36:39]
    buffer_store_dwordx4 a[244:247], v59, s[64:67], s90 offen offset:2048 sc1
    v_mfma_f32_16x16x32_bf16 a[68:71], a[184:187], v[248:251], a[68:71]
    v_exp_f32 v85, v85
    v_mfma_f32_16x16x32_bf16 a[68:71], a[188:191], v[48:51], a[68:71]
    s_add_u32 s84, s84, 16384
    v_cvt_pk_bf16_f32 v166, v84, v85
    v_mfma_f32_16x16x32_bf16 a[100:103], a[188:191], v[52:55], a[100:103]
    s_waitcnt vmcnt(13)
    v_exp_f32 v86, v86
    v_mfma_f32_16x16x32_bf16 a[100:103], a[184:187], v[252:255], a[100:103]
    s_barrier
    v_mfma_f32_16x16x32_bf16 a[128:131], a[208:211], v[240:243], a[128:131]
    s_add_u32 s85, s85, 16384
    v_exp_f32 v87, v87
    v_mfma_f32_16x16x32_bf16 a[128:131], a[208:211], v[32:35], a[128:131]
    s_waitcnt lgkmcnt(11)
    ds_read_b128 a[144:147], v20 offset:49152
    v_cvt_pk_bf16_f32 v167, v86, v87
    v_mfma_f32_16x16x32_bf16 v[128:131], a[160:163], v[112:115], v[224:227]
    s_waitcnt lgkmcnt(11)
    v_exp_f32 v72, v72
    v_mfma_f32_16x16x32_bf16 v[128:131], a[164:167], v[144:147], v[128:131]
    s_waitcnt lgkmcnt(10)
    v_exp_f32 v73, v73
    v_mfma_f32_16x16x32_bf16 v[128:131], a[168:171], v[176:179], v[128:131]
    s_waitcnt lgkmcnt(9)
    ds_read_b128 a[148:151], v21 offset:49152
    v_cvt_pk_bf16_f32 v168, v72, v73
    v_mfma_f32_16x16x32_bf16 v[128:131], a[172:175], v[208:211], v[128:131]
    v_exp_f32 v74, v74
    v_mfma_f32_16x16x32_bf16 v[132:135], a[172:175], v[212:215], v[228:231]
    ds_read_b128 a[152:155], v22 offset:49152
    v_mfma_f32_16x16x32_bf16 v[132:135], a[168:171], v[180:183], v[132:135]
    v_exp_f32 v75, v75
    v_mfma_f32_16x16x32_bf16 v[132:135], a[164:167], v[148:151], v[132:135]
    s_mov_b32 s90, 77824
    ds_read_b128 a[156:159], v23 offset:49152
    v_cvt_pk_bf16_f32 v169, v74, v75
    v_mfma_f32_16x16x32_bf16 v[132:135], a[160:163], v[116:119], v[132:135]
    buffer_store_dwordx4 a[248:251], v59, s[64:67], s90 offen offset:2048 sc1
    v_mfma_f32_16x16x32_bf16 v[136:139], a[160:163], v[120:123], v[232:235]
    v_exp_f32 v88, v88
    v_mfma_f32_16x16x32_bf16 v[136:139], a[164:167], v[152:155], v[136:139]
    ds_read_b64_tr_b16 a[176:177], v28 offset:16384
    v_mfma_f32_16x16x32_bf16 v[136:139], a[168:171], v[184:187], v[136:139]
    v_exp_f32 v89, v89
    v_mfma_f32_16x16x32_bf16 v[136:139], a[172:175], v[216:219], v[136:139]
    ds_read_b64_tr_b16 a[178:179], v28 offset:20480
    v_cvt_pk_bf16_f32 v170, v88, v89
    v_mfma_f32_16x16x32_bf16 v[140:143], a[172:175], v[220:223], v[236:239]
    v_exp_f32 v90, v90
    v_mfma_f32_16x16x32_bf16 v[140:143], a[168:171], v[188:191], v[140:143]
    ds_read_b64_tr_b16 a[180:181], v28 offset:24576
    v_mfma_f32_16x16x32_bf16 v[140:143], a[164:167], v[156:159], v[140:143]
    v_exp_f32 v91, v91
    v_mfma_f32_16x16x32_bf16 v[140:143], a[160:163], v[124:127], v[140:143]
    s_waitcnt lgkmcnt(13)
    ds_read_b64_tr_b16 a[182:183], v28 offset:28672
    v_cvt_pk_bf16_f32 v171, v90, v91
    v_mfma_f32_16x16x32_bf16 a[8:11], a[192:195], v[240:243], a[8:11]
    s_waitcnt lgkmcnt(12)
    v_exp_f32 v76, v76
    v_mfma_f32_16x16x32_bf16 a[8:11], a[196:199], v[32:35], a[8:11]
    s_add_u32 m0, s83, 20480
    ds_read_b64_tr_b16 a[184:185], v29 offset:16384
    v_mfma_f32_16x16x32_bf16 a[40:43], a[196:199], v[36:39], a[40:43]
    buffer_load_dwordx4 v14, s[44:47], s84 offen offset:0 nt lds
    v_mfma_f32_16x16x32_bf16 a[40:43], a[192:195], v[244:247], a[40:43]
    v_exp_f32 v77, v77
    v_mfma_f32_16x16x32_bf16 a[72:75], a[192:195], v[248:251], a[72:75]
    ds_read_b64_tr_b16 a[186:187], v29 offset:20480
    v_cvt_pk_bf16_f32 v172, v76, v77
    v_mfma_f32_16x16x32_bf16 a[72:75], a[196:199], v[48:51], a[72:75]
    v_exp_f32 v78, v78
    v_mfma_f32_16x16x32_bf16 a[104:107], a[196:199], v[52:55], a[104:107]
    ds_read_b64_tr_b16 a[188:189], v29 offset:24576
    v_mfma_f32_16x16x32_bf16 a[104:107], a[192:195], v[252:255], a[104:107]
    s_waitcnt lgkmcnt(13)
    v_exp_f32 v79, v79
    v_mfma_f32_16x16x32_bf16 a[12:15], a[200:203], v[240:243], a[12:15]
    s_waitcnt lgkmcnt(11)
    ds_read_b64_tr_b16 a[190:191], v29 offset:28672
    v_cvt_pk_bf16_f32 v173, v78, v79
    v_mfma_f32_16x16x32_bf16 a[12:15], a[204:207], v[32:35], a[12:15]
    v_exp_f32 v92, v92
    v_mfma_f32_16x16x32_bf16 a[44:47], a[204:207], v[36:39], a[44:47]
    v_mfma_f32_16x16x32_bf16 a[44:47], a[200:203], v[244:247], a[44:47]
    buffer_load_dwordx4 v15, s[44:47], s84 offen offset:1024 nt lds
    v_mfma_f32_16x16x32_bf16 a[76:79], a[200:203], v[248:251], a[76:79]
    v_exp_f32 v93, v93
    v_mfma_f32_16x16x32_bf16 a[76:79], a[204:207], v[48:51], a[76:79]
    v_cvt_pk_bf16_f32 v174, v92, v93
    v_mfma_f32_16x16x32_bf16 a[108:111], a[204:207], v[52:55], a[108:111]
    v_exp_f32 v94, v94
    v_mfma_f32_16x16x32_bf16 a[108:111], a[200:203], v[252:255], a[108:111]
    v_mfma_f32_16x16x32_bf16 a[132:135], a[208:211], v[36:39], a[132:135]
    v_exp_f32 v95, v95
    v_mfma_f32_16x16x32_bf16 a[132:135], a[208:211], v[244:247], a[132:135]
    v_cvt_pk_bf16_f32 v175, v94, v95
    s_waitcnt lgkmcnt(11)
    v_mfma_f32_16x16x32_bf16 v[64:67], a[144:147], v[112:115], v[224:227]
    s_waitcnt lgkmcnt(10)
    v_exp_f32 v96, v96
    v_mfma_f32_16x16x32_bf16 v[64:67], a[148:151], v[144:147], v[64:67]
    s_waitcnt lgkmcnt(9)
    v_exp_f32 v97, v97
    v_mfma_f32_16x16x32_bf16 v[64:67], a[152:155], v[176:179], v[64:67]
    s_waitcnt lgkmcnt(8)
    ds_read_b128 a[160:163], v20 offset:53248
    v_cvt_pk_bf16_f32 v192, v96, v97
    v_mfma_f32_16x16x32_bf16 v[64:67], a[156:159], v[208:211], v[64:67]
    v_exp_f32 v98, v98
    v_mfma_f32_16x16x32_bf16 v[68:71], a[156:159], v[212:215], v[228:231]
    ds_read_b128 a[164:167], v21 offset:53248
    v_mfma_f32_16x16x32_bf16 v[68:71], a[152:155], v[180:183], v[68:71]
    v_exp_f32 v99, v99
    v_mfma_f32_16x16x32_bf16 v[68:71], a[148:151], v[148:151], v[68:71]
    ds_read_b128 a[168:171], v22 offset:53248
    v_cvt_pk_bf16_f32 v193, v98, v99
    v_mfma_f32_16x16x32_bf16 v[68:71], a[144:147], v[116:119], v[68:71]
    buffer_load_dwordx4 v16, s[44:47], s84 offen offset:2048 nt lds
    v_mfma_f32_16x16x32_bf16 v[72:75], a[144:147], v[120:123], v[232:235]
    v_exp_f32 v128, v128
    v_mfma_f32_16x16x32_bf16 v[72:75], a[148:151], v[152:155], v[72:75]
    ds_read_b128 a[172:175], v23 offset:53248
    v_mfma_f32_16x16x32_bf16 v[72:75], a[152:155], v[184:187], v[72:75]
    v_exp_f32 v129, v129
    v_mfma_f32_16x16x32_bf16 v[72:75], a[156:159], v[216:219], v[72:75]
    ds_read_b64_tr_b16 a[192:193], v30 offset:16384
    v_cvt_pk_bf16_f32 v194, v128, v129
    v_mfma_f32_16x16x32_bf16 v[76:79], a[156:159], v[220:223], v[236:239]
    v_exp_f32 v130, v130
    v_mfma_f32_16x16x32_bf16 v[76:79], a[152:155], v[188:191], v[76:79]
    ds_read_b64_tr_b16 a[194:195], v30 offset:20480
    v_mfma_f32_16x16x32_bf16 v[76:79], a[148:151], v[156:159], v[76:79]
    v_exp_f32 v131, v131
    v_mfma_f32_16x16x32_bf16 v[76:79], a[144:147], v[124:127], v[76:79]
    s_waitcnt lgkmcnt(12)
    ds_read_b64_tr_b16 a[196:197], v30 offset:24576
    v_cvt_pk_bf16_f32 v195, v130, v131
    v_mfma_f32_16x16x32_bf16 a[16:19], a[176:179], v[240:243], a[16:19]
    s_waitcnt lgkmcnt(11)
    v_exp_f32 v100, v100
    v_mfma_f32_16x16x32_bf16 a[16:19], a[180:183], v[32:35], a[16:19]
    ds_read_b64_tr_b16 a[198:199], v30 offset:28672
    v_mfma_f32_16x16x32_bf16 a[48:51], a[180:183], v[36:39], a[48:51]
    buffer_load_dwordx4 v17, s[44:47], s84 offen offset:3072 nt lds
    v_mfma_f32_16x16x32_bf16 a[48:51], a[176:179], v[244:247], a[48:51]
    v_exp_f32 v101, v101
    v_mfma_f32_16x16x32_bf16 a[80:83], a[176:179], v[248:251], a[80:83]
    ds_read_b64_tr_b16 a[200:201], v31 offset:16384
    v_cvt_pk_bf16_f32 v196, v100, v101
    v_mfma_f32_16x16x32_bf16 a[80:83], a[180:183], v[48:51], a[80:83]
    v_exp_f32 v102, v102
    v_mfma_f32_16x16x32_bf16 a[112:115], a[180:183], v[52:55], a[112:115]
    ds_read_b64_tr_b16 a[202:203], v31 offset:20480
    v_mfma_f32_16x16x32_bf16 a[112:115], a[176:179], v[252:255], a[112:115]
    s_waitcnt lgkmcnt(12)
    v_exp_f32 v103, v103
    v_mfma_f32_16x16x32_bf16 a[20:23], a[184:187], v[240:243], a[20:23]
    s_waitcnt lgkmcnt(10)
    ds_read_b64_tr_b16 a[204:205], v31 offset:24576
    v_cvt_pk_bf16_f32 v197, v102, v103
    v_mfma_f32_16x16x32_bf16 a[20:23], a[188:191], v[32:35], a[20:23]
    v_exp_f32 v132, v132
    v_mfma_f32_16x16x32_bf16 a[52:55], a[188:191], v[36:39], a[52:55]
    s_lshl2_add_u32 s89, s72, s14
    ds_read_b64_tr_b16 a[206:207], v31 offset:28672
    v_mfma_f32_16x16x32_bf16 a[52:55], a[184:187], v[244:247], a[52:55]
    buffer_store_dword v43, v63, s[56:59], s89 offen offset:80 sc1
    v_mfma_f32_16x16x32_bf16 a[84:87], a[184:187], v[248:251], a[84:87]
    v_exp_f32 v133, v133
    v_mfma_f32_16x16x32_bf16 a[84:87], a[188:191], v[48:51], a[84:87]
    v_cvt_pk_bf16_f32 v198, v132, v133
    v_mfma_f32_16x16x32_bf16 a[116:119], a[188:191], v[52:55], a[116:119]
    v_exp_f32 v134, v134
    v_mfma_f32_16x16x32_bf16 a[116:119], a[184:187], v[252:255], a[116:119]
    v_mfma_f32_16x16x32_bf16 a[136:139], a[208:211], v[248:251], a[136:139]
    v_exp_f32 v135, v135
    v_mfma_f32_16x16x32_bf16 a[136:139], a[208:211], v[48:51], a[136:139]
    s_waitcnt lgkmcnt(11)
    ds_read_b128 a[144:147], v20 offset:57344
    v_cvt_pk_bf16_f32 v199, v134, v135
    v_mfma_f32_16x16x32_bf16 v[80:83], a[160:163], v[112:115], v[224:227]
    s_waitcnt lgkmcnt(11)
    v_exp_f32 v104, v104
    v_mfma_f32_16x16x32_bf16 v[80:83], a[164:167], v[144:147], v[80:83]
    s_waitcnt lgkmcnt(10)
    ds_read_b128 a[148:151], v21 offset:57344
    v_mfma_f32_16x16x32_bf16 v[80:83], a[168:171], v[176:179], v[80:83]
    s_waitcnt lgkmcnt(10)
    v_exp_f32 v105, v105
    v_mfma_f32_16x16x32_bf16 v[80:83], a[172:175], v[208:211], v[80:83]
    ds_read_b128 a[152:155], v22 offset:57344
    v_cvt_pk_bf16_f32 v200, v104, v105
    v_mfma_f32_16x16x32_bf16 v[84:87], a[172:175], v[212:215], v[228:231]
    v_exp_f32 v106, v106
    v_mfma_f32_16x16x32_bf16 v[84:87], a[168:171], v[180:183], v[84:87]
    ds_read_b128 a[156:159], v23 offset:57344
    v_mfma_f32_16x16x32_bf16 v[84:87], a[164:167], v[148:151], v[84:87]
    v_exp_f32 v107, v107
    v_mfma_f32_16x16x32_bf16 v[84:87], a[160:163], v[116:119], v[84:87]
    s_add_u32 m0, s83, 71680
    ds_read_b64_tr_b16 a[176:177], v24 offset:32768
    v_cvt_pk_bf16_f32 v201, v106, v107
    v_mfma_f32_16x16x32_bf16 v[88:91], a[160:163], v[120:123], v[232:235]
    buffer_load_dwordx4 v18, s[48:51], s85 offen offset:0 nt lds
    v_mfma_f32_16x16x32_bf16 v[88:91], a[164:167], v[152:155], v[88:91]
    v_exp_f32 v136, v136
    v_mfma_f32_16x16x32_bf16 v[88:91], a[168:171], v[184:187], v[88:91]
    ds_read_b64_tr_b16 a[178:179], v24 offset:36864
    v_mfma_f32_16x16x32_bf16 v[88:91], a[172:175], v[216:219], v[88:91]
    v_exp_f32 v137, v137
    v_mfma_f32_16x16x32_bf16 v[92:95], a[172:175], v[220:223], v[236:239]
    ds_read_b64_tr_b16 a[180:181], v24 offset:40960
    v_cvt_pk_bf16_f32 v202, v136, v137
    v_mfma_f32_16x16x32_bf16 v[92:95], a[168:171], v[188:191], v[92:95]
    v_exp_f32 v138, v138
    v_mfma_f32_16x16x32_bf16 v[92:95], a[164:167], v[156:159], v[92:95]
    ds_read_b64_tr_b16 a[182:183], v24 offset:45056
    v_mfma_f32_16x16x32_bf16 v[92:95], a[160:163], v[124:127], v[92:95]
    s_waitcnt lgkmcnt(14)
    v_exp_f32 v139, v139
    v_mfma_f32_16x16x32_bf16 a[24:27], a[192:195], v[240:243], a[24:27]
    s_waitcnt lgkmcnt(12)
    ds_read_b64_tr_b16 a[184:185], v25 offset:32768
    v_cvt_pk_bf16_f32 v203, v138, v139
    v_mfma_f32_16x16x32_bf16 a[24:27], a[196:199], v[32:35], a[24:27]
    v_exp_f32 v108, v108
    v_mfma_f32_16x16x32_bf16 a[56:59], a[196:199], v[36:39], a[56:59]
    ds_read_b64_tr_b16 a[186:187], v25 offset:36864
    v_mfma_f32_16x16x32_bf16 a[56:59], a[192:195], v[244:247], a[56:59]
    v_exp_f32 v109, v109
    v_mfma_f32_16x16x32_bf16 a[88:91], a[192:195], v[248:251], a[88:91]
    ds_read_b64_tr_b16 a[188:189], v25 offset:40960
    v_cvt_pk_bf16_f32 v204, v108, v109
    v_mfma_f32_16x16x32_bf16 a[88:91], a[196:199], v[48:51], a[88:91]
    v_exp_f32 v110, v110
    v_mfma_f32_16x16x32_bf16 a[120:123], a[196:199], v[52:55], a[120:123]
    ds_read_b64_tr_b16 a[190:191], v25 offset:45056
    v_mfma_f32_16x16x32_bf16 a[120:123], a[192:195], v[252:255], a[120:123]
    s_waitcnt lgkmcnt(14)
    v_exp_f32 v111, v111
    v_mfma_f32_16x16x32_bf16 a[28:31], a[200:203], v[240:243], a[28:31]
    s_waitcnt lgkmcnt(12)
    v_cvt_pk_bf16_f32 v205, v110, v111
    v_mfma_f32_16x16x32_bf16 a[28:31], a[204:207], v[32:35], a[28:31]
    buffer_load_dwordx4 v19, s[48:51], s85 offen offset:1024 nt lds
    v_mfma_f32_16x16x32_bf16 a[60:63], a[204:207], v[36:39], a[60:63]
    v_exp_f32 v140, v140
    v_mfma_f32_16x16x32_bf16 a[60:63], a[200:203], v[244:247], a[60:63]
    v_mfma_f32_16x16x32_bf16 a[92:95], a[200:203], v[248:251], a[92:95]
    v_exp_f32 v141, v141
    v_mfma_f32_16x16x32_bf16 a[92:95], a[204:207], v[48:51], a[92:95]
    v_cvt_pk_bf16_f32 v206, v140, v141
    v_mfma_f32_16x16x32_bf16 a[124:127], a[204:207], v[52:55], a[124:127]
    v_exp_f32 v142, v142
    v_mfma_f32_16x16x32_bf16 a[124:127], a[200:203], v[252:255], a[124:127]
    v_mfma_f32_16x16x32_bf16 a[140:143], a[208:211], v[52:55], a[140:143]
    v_exp_f32 v143, v143
    v_mfma_f32_16x16x32_bf16 a[140:143], a[208:211], v[252:255], a[140:143]
    v_cvt_pk_bf16_f32 v207, v142, v143
    s_waitcnt lgkmcnt(11)
    v_mfma_f32_16x16x32_bf16 v[96:99], a[144:147], v[112:115], v[224:227]
    s_waitcnt lgkmcnt(10)
    v_exp_f32 v64, v64
    v_mfma_f32_16x16x32_bf16 v[96:99], a[148:151], v[144:147], v[96:99]
    s_waitcnt lgkmcnt(9)
    ds_read_b128 a[160:163], v20 offset:61440
    v_accvgpr_write_b32 a224, 0
    v_mfma_f32_16x16x32_bf16 v[96:99], a[152:155], v[176:179], v[96:99]
    s_waitcnt lgkmcnt(9)
    v_exp_f32 v65, v65
    v_mfma_f32_16x16x32_bf16 v[96:99], a[156:159], v[208:211], v[96:99]
    ds_read_b128 a[164:167], v21 offset:61440
    v_cvt_pk_bf16_f32 v240, v64, v65
    v_mfma_f32_16x16x32_bf16 v[100:103], a[156:159], v[212:215], v[228:231]
    v_exp_f32 v66, v66
    v_mfma_f32_16x16x32_bf16 v[100:103], a[152:155], v[180:183], v[100:103]
    ds_read_b128 a[168:171], v22 offset:61440
    v_accvgpr_write_b32 a225, 0
    v_mfma_f32_16x16x32_bf16 v[100:103], a[148:151], v[148:151], v[100:103]
    v_exp_f32 v67, v67
    v_mfma_f32_16x16x32_bf16 v[100:103], a[144:147], v[116:119], v[100:103]
    ds_read_b128 a[172:175], v23 offset:61440
    v_cvt_pk_bf16_f32 v241, v66, v67
    v_mfma_f32_16x16x32_bf16 v[104:107], a[144:147], v[120:123], v[232:235]
    buffer_load_dwordx4 v18, s[48:51], s85 offen offset:2048 nt lds
    v_mfma_f32_16x16x32_bf16 v[104:107], a[148:151], v[152:155], v[104:107]
    v_exp_f32 v80, v80
    v_mfma_f32_16x16x32_bf16 v[104:107], a[152:155], v[184:187], v[104:107]
    ds_read_b64_tr_b16 a[192:193], v26 offset:32768
    v_accvgpr_write_b32 a226, 0
    v_mfma_f32_16x16x32_bf16 v[104:107], a[156:159], v[216:219], v[104:107]
    v_exp_f32 v81, v81
    v_mfma_f32_16x16x32_bf16 v[108:111], a[156:159], v[220:223], v[236:239]
    ds_read_b64_tr_b16 a[194:195], v26 offset:36864
    v_cvt_pk_bf16_f32 v242, v80, v81
    v_mfma_f32_16x16x32_bf16 v[108:111], a[152:155], v[188:191], v[108:111]
    v_exp_f32 v82, v82
    v_mfma_f32_16x16x32_bf16 v[108:111], a[148:151], v[156:159], v[108:111]
    ds_read_b64_tr_b16 a[196:197], v26 offset:40960
    v_accvgpr_write_b32 a227, 0
    v_mfma_f32_16x16x32_bf16 v[108:111], a[144:147], v[124:127], v[108:111]
    s_waitcnt lgkmcnt(13)
    v_exp_f32 v83, v83
    v_mfma_f32_16x16x32_bf16 a[0:3], a[176:179], v[160:163], a[0:3]
    s_waitcnt lgkmcnt(11)
    ds_read_b64_tr_b16 a[198:199], v26 offset:45056
    v_cvt_pk_bf16_f32 v243, v82, v83
    v_mfma_f32_16x16x32_bf16 a[0:3], a[180:183], v[192:195], a[0:3]
    v_exp_f32 v68, v68
    v_mfma_f32_16x16x32_bf16 a[32:35], a[180:183], v[196:199], a[32:35]
    ds_read_b64_tr_b16 a[200:201], v27 offset:32768
    v_accvgpr_write_b32 a228, 0
    v_mfma_f32_16x16x32_bf16 a[32:35], a[176:179], v[164:167], a[32:35]
    v_exp_f32 v69, v69
    v_mfma_f32_16x16x32_bf16 a[64:67], a[176:179], v[168:171], a[64:67]
    ds_read_b64_tr_b16 a[202:203], v27 offset:36864
    v_cvt_pk_bf16_f32 v244, v68, v69
    v_mfma_f32_16x16x32_bf16 a[64:67], a[180:183], v[200:203], a[64:67]
    v_exp_f32 v70, v70
    v_mfma_f32_16x16x32_bf16 a[96:99], a[180:183], v[204:207], a[96:99]
    ds_read_b64_tr_b16 a[204:205], v27 offset:40960
    v_accvgpr_write_b32 a229, 0
    v_mfma_f32_16x16x32_bf16 a[96:99], a[176:179], v[172:175], a[96:99]
    s_waitcnt lgkmcnt(13)
    v_exp_f32 v71, v71
    v_mfma_f32_16x16x32_bf16 a[4:7], a[184:187], v[160:163], a[4:7]
    s_waitcnt lgkmcnt(11)
    ds_read_b64_tr_b16 a[206:207], v27 offset:45056
    v_cvt_pk_bf16_f32 v245, v70, v71
    v_mfma_f32_16x16x32_bf16 a[4:7], a[188:191], v[192:195], a[4:7]
    buffer_load_dwordx4 v19, s[48:51], s85 offen offset:3072 nt lds
    v_mfma_f32_16x16x32_bf16 a[36:39], a[188:191], v[196:199], a[36:39]
    v_exp_f32 v84, v84
    v_mfma_f32_16x16x32_bf16 a[36:39], a[184:187], v[164:167], a[36:39]
    v_accvgpr_write_b32 a230, 0
    v_accvgpr_write_b32 a231, 0
    v_mfma_f32_16x16x32_bf16 a[68:71], a[184:187], v[168:171], a[68:71]
    v_exp_f32 v85, v85
    v_mfma_f32_16x16x32_bf16 a[68:71], a[188:191], v[200:203], a[68:71]
    s_add_u32 s84, s84, 16384
    v_cvt_pk_bf16_f32 v246, v84, v85
    v_accvgpr_write_b32 a232, 0
    v_mfma_f32_16x16x32_bf16 a[100:103], a[188:191], v[204:207], a[100:103]
    s_waitcnt vmcnt(9)
    v_exp_f32 v86, v86
    v_mfma_f32_16x16x32_bf16 a[100:103], a[184:187], v[172:175], a[100:103]
    s_barrier
    v_accvgpr_write_b32 a233, 0
    v_accvgpr_write_b32 a234, 0
    v_mfma_f32_16x16x32_bf16 a[128:131], a[208:211], v[160:163], a[128:131]
    s_add_u32 s85, s85, 16384
    v_exp_f32 v87, v87
    v_mfma_f32_16x16x32_bf16 a[128:131], a[208:211], v[192:195], a[128:131]
    s_waitcnt lgkmcnt(11)
    ds_read_b128 a[144:147], v20 offset:0
    v_cvt_pk_bf16_f32 v247, v86, v87
    v_mfma_f32_16x16x32_bf16 v[128:131], a[160:163], v[112:115], v[224:227]
    s_waitcnt lgkmcnt(11)
    v_exp_f32 v72, v72
    v_mfma_f32_16x16x32_bf16 v[128:131], a[164:167], v[144:147], v[128:131]
    s_waitcnt lgkmcnt(10)
    v_exp_f32 v73, v73
    v_mfma_f32_16x16x32_bf16 v[128:131], a[168:171], v[176:179], v[128:131]
    s_waitcnt lgkmcnt(9)
    ds_read_b128 a[148:151], v21 offset:0
    v_cvt_pk_bf16_f32 v248, v72, v73
    v_mfma_f32_16x16x32_bf16 v[128:131], a[172:175], v[208:211], v[128:131]
    v_exp_f32 v74, v74
    v_mfma_f32_16x16x32_bf16 v[132:135], a[172:175], v[212:215], v[228:231]
    ds_read_b128 a[152:155], v22 offset:0
    v_accvgpr_write_b32 a235, 0
    v_mfma_f32_16x16x32_bf16 v[132:135], a[168:171], v[180:183], v[132:135]
    v_exp_f32 v75, v75
    v_mfma_f32_16x16x32_bf16 v[132:135], a[164:167], v[148:151], v[132:135]
    ds_read_b128 a[156:159], v23 offset:0
    v_cvt_pk_bf16_f32 v249, v74, v75
    v_mfma_f32_16x16x32_bf16 v[132:135], a[160:163], v[116:119], v[132:135]
    buffer_store_dword v43, v63, s[56:59], s91 offen sc1
    v_mfma_f32_16x16x32_bf16 v[136:139], a[160:163], v[120:123], v[232:235]
    v_exp_f32 v88, v88
    v_mfma_f32_16x16x32_bf16 v[136:139], a[164:167], v[152:155], v[136:139]
    ds_read_b64_tr_b16 a[176:177], v28 offset:32768
    v_accvgpr_write_b32 a236, 0
    v_mfma_f32_16x16x32_bf16 v[136:139], a[168:171], v[184:187], v[136:139]
    v_exp_f32 v89, v89
    v_mfma_f32_16x16x32_bf16 v[136:139], a[172:175], v[216:219], v[136:139]
    ds_read_b64_tr_b16 a[178:179], v28 offset:36864
    v_cvt_pk_bf16_f32 v250, v88, v89
    v_mfma_f32_16x16x32_bf16 v[140:143], a[172:175], v[220:223], v[236:239]
    v_exp_f32 v90, v90
    v_mfma_f32_16x16x32_bf16 v[140:143], a[168:171], v[188:191], v[140:143]
    ds_read_b64_tr_b16 a[180:181], v28 offset:40960
    v_mfma_f32_16x16x32_bf16 v[140:143], a[164:167], v[156:159], v[140:143]
Lpad11:
    s_cbranch_execz Lpad13
    v_exp_f32 v91, v91
    v_mfma_f32_16x16x32_bf16 v[140:143], a[160:163], v[124:127], v[140:143]
    s_waitcnt lgkmcnt(13)
    ds_read_b64_tr_b16 a[182:183], v28 offset:45056
    v_cvt_pk_bf16_f32 v251, v90, v91
    v_mfma_f32_16x16x32_bf16 a[8:11], a[192:195], v[160:163], a[8:11]
    s_waitcnt lgkmcnt(12)
    v_exp_f32 v76, v76
    v_mfma_f32_16x16x32_bf16 a[8:11], a[196:199], v[192:195], a[8:11]
    s_add_u32 m0, s83, 36864
    ds_read_b64_tr_b16 a[184:185], v29 offset:32768
    v_mfma_f32_16x16x32_bf16 a[40:43], a[196:199], v[196:199], a[40:43]
    buffer_load_dwordx4 v14, s[44:47], s84 offen offset:0 nt lds
    v_mfma_f32_16x16x32_bf16 a[40:43], a[192:195], v[164:167], a[40:43]
    v_exp_f32 v77, v77
    v_mfma_f32_16x16x32_bf16 a[72:75], a[192:195], v[168:171], a[72:75]
    ds_read_b64_tr_b16 a[186:187], v29 offset:36864
    v_cvt_pk_bf16_f32 v252, v76, v77
    v_mfma_f32_16x16x32_bf16 a[72:75], a[196:199], v[200:203], a[72:75]
    v_exp_f32 v78, v78
    v_mfma_f32_16x16x32_bf16 a[104:107], a[196:199], v[204:207], a[104:107]
    ds_read_b64_tr_b16 a[188:189], v29 offset:40960
    v_mfma_f32_16x16x32_bf16 a[104:107], a[192:195], v[172:175], a[104:107]
    s_waitcnt lgkmcnt(13)
    v_exp_f32 v79, v79
    v_mfma_f32_16x16x32_bf16 a[12:15], a[200:203], v[160:163], a[12:15]
    s_waitcnt lgkmcnt(11)
    ds_read_b64_tr_b16 a[190:191], v29 offset:45056
    v_cvt_pk_bf16_f32 v253, v78, v79
    v_mfma_f32_16x16x32_bf16 a[12:15], a[204:207], v[192:195], a[12:15]
    v_exp_f32 v92, v92
    v_mfma_f32_16x16x32_bf16 a[44:47], a[204:207], v[196:199], a[44:47]
    v_mfma_f32_16x16x32_bf16 a[44:47], a[200:203], v[164:167], a[44:47]
    buffer_load_dwordx4 v15, s[44:47], s84 offen offset:1024 nt lds
    v_mfma_f32_16x16x32_bf16 a[76:79], a[200:203], v[168:171], a[76:79]
    v_exp_f32 v93, v93
    v_mfma_f32_16x16x32_bf16 a[76:79], a[204:207], v[200:203], a[76:79]
    v_cvt_pk_bf16_f32 v254, v92, v93
    v_mfma_f32_16x16x32_bf16 a[108:111], a[204:207], v[204:207], a[108:111]
    v_exp_f32 v94, v94
    v_mfma_f32_16x16x32_bf16 a[108:111], a[200:203], v[172:175], a[108:111]
    v_mfma_f32_16x16x32_bf16 a[132:135], a[208:211], v[196:199], a[132:135]
    v_exp_f32 v95, v95
    v_mfma_f32_16x16x32_bf16 a[132:135], a[208:211], v[164:167], a[132:135]
    v_cvt_pk_bf16_f32 v255, v94, v95
    s_waitcnt lgkmcnt(11)
    v_mfma_f32_16x16x32_bf16 v[64:67], a[144:147], v[112:115], v[224:227]
    s_waitcnt lgkmcnt(10)
    v_exp_f32 v96, v96
    v_mfma_f32_16x16x32_bf16 v[64:67], a[148:151], v[144:147], v[64:67]
    s_waitcnt lgkmcnt(9)
    ds_read_b128 a[160:163], v20 offset:4096
    v_mfma_f32_16x16x32_bf16 v[64:67], a[152:155], v[176:179], v[64:67]
    s_waitcnt lgkmcnt(9)
    v_exp_f32 v97, v97
    v_mfma_f32_16x16x32_bf16 v[64:67], a[156:159], v[208:211], v[64:67]
    ds_read_b128 a[164:167], v21 offset:4096
    v_cvt_pk_bf16_f32 v32, v96, v97
    v_mfma_f32_16x16x32_bf16 v[68:71], a[156:159], v[212:215], v[228:231]
    v_exp_f32 v98, v98
    v_mfma_f32_16x16x32_bf16 v[68:71], a[152:155], v[180:183], v[68:71]
    ds_read_b128 a[168:171], v22 offset:4096
    v_mfma_f32_16x16x32_bf16 v[68:71], a[148:151], v[148:151], v[68:71]
    v_exp_f32 v99, v99
    v_mfma_f32_16x16x32_bf16 v[68:71], a[144:147], v[116:119], v[68:71]
    ds_read_b128 a[172:175], v23 offset:4096
    v_cvt_pk_bf16_f32 v33, v98, v99
    v_mfma_f32_16x16x32_bf16 v[72:75], a[144:147], v[120:123], v[232:235]
    buffer_load_dwordx4 v16, s[44:47], s84 offen offset:2048 nt lds
    v_mfma_f32_16x16x32_bf16 v[72:75], a[148:151], v[152:155], v[72:75]
    v_exp_f32 v128, v128
    v_mfma_f32_16x16x32_bf16 v[72:75], a[152:155], v[184:187], v[72:75]
    ds_read_b64_tr_b16 a[192:193], v30 offset:32768
    v_mfma_f32_16x16x32_bf16 v[72:75], a[156:159], v[216:219], v[72:75]
    v_exp_f32 v129, v129
    v_mfma_f32_16x16x32_bf16 v[76:79], a[156:159], v[220:223], v[236:239]
    ds_read_b64_tr_b16 a[194:195], v30 offset:36864
    v_cvt_pk_bf16_f32 v34, v128, v129
    v_mfma_f32_16x16x32_bf16 v[76:79], a[152:155], v[188:191], v[76:79]
    v_exp_f32 v130, v130
    v_mfma_f32_16x16x32_bf16 v[76:79], a[148:151], v[156:159], v[76:79]
    ds_read_b64_tr_b16 a[196:197], v30 offset:40960
    v_mfma_f32_16x16x32_bf16 v[76:79], a[144:147], v[124:127], v[76:79]
    s_waitcnt lgkmcnt(13)
    v_exp_f32 v131, v131
    v_mfma_f32_16x16x32_bf16 a[16:19], a[176:179], v[160:163], a[16:19]
    s_waitcnt lgkmcnt(11)
    ds_read_b64_tr_b16 a[198:199], v30 offset:45056
    v_cvt_pk_bf16_f32 v35, v130, v131
    v_mfma_f32_16x16x32_bf16 a[16:19], a[180:183], v[192:195], a[16:19]
    v_exp_f32 v100, v100
    v_mfma_f32_16x16x32_bf16 a[48:51], a[180:183], v[196:199], a[48:51]
    ds_read_b64_tr_b16 a[200:201], v31 offset:32768
    v_mfma_f32_16x16x32_bf16 a[48:51], a[176:179], v[164:167], a[48:51]
    v_exp_f32 v101, v101
    v_mfma_f32_16x16x32_bf16 a[80:83], a[176:179], v[168:171], a[80:83]
    ds_read_b64_tr_b16 a[202:203], v31 offset:36864
    v_cvt_pk_bf16_f32 v36, v100, v101
    v_mfma_f32_16x16x32_bf16 a[80:83], a[180:183], v[200:203], a[80:83]
    v_exp_f32 v102, v102
    v_mfma_f32_16x16x32_bf16 a[112:115], a[180:183], v[204:207], a[112:115]
    ds_read_b64_tr_b16 a[204:205], v31 offset:40960
    v_mfma_f32_16x16x32_bf16 a[112:115], a[176:179], v[172:175], a[112:115]
    s_waitcnt lgkmcnt(13)
    v_exp_f32 v103, v103
    v_mfma_f32_16x16x32_bf16 a[20:23], a[184:187], v[160:163], a[20:23]
    s_waitcnt lgkmcnt(11)
    ds_read_b64_tr_b16 a[206:207], v31 offset:45056
    v_cvt_pk_bf16_f32 v37, v102, v103
    v_mfma_f32_16x16x32_bf16 a[20:23], a[188:191], v[192:195], a[20:23]
    buffer_load_dwordx4 v17, s[44:47], s84 offen offset:3072 nt lds
    v_mfma_f32_16x16x32_bf16 a[52:55], a[188:191], v[196:199], a[52:55]
    v_exp_f32 v132, v132
    v_mfma_f32_16x16x32_bf16 a[52:55], a[184:187], v[164:167], a[52:55]
    v_mfma_f32_16x16x32_bf16 a[84:87], a[184:187], v[168:171], a[84:87]
    v_exp_f32 v133, v133
    v_mfma_f32_16x16x32_bf16 a[84:87], a[188:191], v[200:203], a[84:87]
    v_cvt_pk_bf16_f32 v38, v132, v133
    v_mfma_f32_16x16x32_bf16 a[116:119], a[188:191], v[204:207], a[116:119]
    v_exp_f32 v134, v134
    v_mfma_f32_16x16x32_bf16 a[116:119], a[184:187], v[172:175], a[116:119]
    v_mfma_f32_16x16x32_bf16 a[136:139], a[208:211], v[168:171], a[136:139]
    v_exp_f32 v135, v135
    v_mfma_f32_16x16x32_bf16 a[136:139], a[208:211], v[200:203], a[136:139]
    s_waitcnt lgkmcnt(11)
    ds_read_b128 a[144:147], v20 offset:8192
    v_cvt_pk_bf16_f32 v39, v134, v135
    v_mfma_f32_16x16x32_bf16 v[80:83], a[160:163], v[112:115], v[224:227]
    s_waitcnt lgkmcnt(11)
    v_exp_f32 v104, v104
    v_mfma_f32_16x16x32_bf16 v[80:83], a[164:167], v[144:147], v[80:83]
    s_waitcnt lgkmcnt(10)
    v_exp_f32 v105, v105
    v_mfma_f32_16x16x32_bf16 v[80:83], a[168:171], v[176:179], v[80:83]
    s_waitcnt lgkmcnt(9)
    ds_read_b128 a[148:151], v21 offset:8192
    v_cvt_pk_bf16_f32 v48, v104, v105
    v_mfma_f32_16x16x32_bf16 v[80:83], a[172:175], v[208:211], v[80:83]
    v_exp_f32 v106, v106
    v_mfma_f32_16x16x32_bf16 v[84:87], a[172:175], v[212:215], v[228:231]
    ds_read_b128 a[152:155], v22 offset:8192
    v_mfma_f32_16x16x32_bf16 v[84:87], a[168:171], v[180:183], v[84:87]
    v_exp_f32 v107, v107
    v_mfma_f32_16x16x32_bf16 v[84:87], a[164:167], v[148:151], v[84:87]
    ds_read_b128 a[156:159], v23 offset:8192
    v_cvt_pk_bf16_f32 v49, v106, v107
    v_mfma_f32_16x16x32_bf16 v[84:87], a[160:163], v[116:119], v[84:87]
    buffer_load_dword v40, v41, s[52:55], s80 offen sc1
    v_mfma_f32_16x16x32_bf16 v[88:91], a[160:163], v[120:123], v[232:235]
    v_exp_f32 v136, v136
    v_mfma_f32_16x16x32_bf16 v[88:91], a[164:167], v[152:155], v[88:91]
    ds_read_b64_tr_b16 a[176:177], v24 offset:49152
    v_mfma_f32_16x16x32_bf16 v[88:91], a[168:171], v[184:187], v[88:91]
    v_exp_f32 v137, v137
    v_mfma_f32_16x16x32_bf16 v[88:91], a[172:175], v[216:219], v[88:91]
    ds_read_b64_tr_b16 a[178:179], v24 offset:53248
    v_cvt_pk_bf16_f32 v50, v136, v137
    v_mfma_f32_16x16x32_bf16 v[92:95], a[172:175], v[220:223], v[236:239]
    v_exp_f32 v138, v138
    v_mfma_f32_16x16x32_bf16 v[92:95], a[168:171], v[188:191], v[92:95]
    ds_read_b64_tr_b16 a[180:181], v24 offset:57344
    v_mfma_f32_16x16x32_bf16 v[92:95], a[164:167], v[156:159], v[92:95]
    v_exp_f32 v139, v139
    v_mfma_f32_16x16x32_bf16 v[92:95], a[160:163], v[124:127], v[92:95]
    s_waitcnt lgkmcnt(13)
    ds_read_b64_tr_b16 a[182:183], v24 offset:61440
    v_cvt_pk_bf16_f32 v51, v138, v139
    v_mfma_f32_16x16x32_bf16 a[24:27], a[192:195], v[160:163], a[24:27]
    s_waitcnt lgkmcnt(12)
    v_exp_f32 v108, v108
    v_mfma_f32_16x16x32_bf16 a[24:27], a[196:199], v[192:195], a[24:27]
    s_add_u32 m0, s83, 88064
    ds_read_b64_tr_b16 a[184:185], v25 offset:49152
    v_mfma_f32_16x16x32_bf16 a[56:59], a[196:199], v[196:199], a[56:59]
    buffer_load_dwordx4 v18, s[48:51], s85 offen offset:0 nt lds
    v_mfma_f32_16x16x32_bf16 a[56:59], a[192:195], v[164:167], a[56:59]
    v_exp_f32 v109, v109
    v_mfma_f32_16x16x32_bf16 a[88:91], a[192:195], v[168:171], a[88:91]
    ds_read_b64_tr_b16 a[186:187], v25 offset:53248
    v_cvt_pk_bf16_f32 v52, v108, v109
    v_mfma_f32_16x16x32_bf16 a[88:91], a[196:199], v[200:203], a[88:91]
    v_exp_f32 v110, v110
    v_mfma_f32_16x16x32_bf16 a[120:123], a[196:199], v[204:207], a[120:123]
    ds_read_b64_tr_b16 a[188:189], v25 offset:57344
    v_mfma_f32_16x16x32_bf16 a[120:123], a[192:195], v[172:175], a[120:123]
    s_waitcnt lgkmcnt(13)
    v_exp_f32 v111, v111
    v_mfma_f32_16x16x32_bf16 a[28:31], a[200:203], v[160:163], a[28:31]
    s_waitcnt lgkmcnt(11)
    ds_read_b64_tr_b16 a[190:191], v25 offset:61440
    v_cvt_pk_bf16_f32 v53, v110, v111
    v_mfma_f32_16x16x32_bf16 a[28:31], a[204:207], v[192:195], a[28:31]
    v_exp_f32 v140, v140
    v_mfma_f32_16x16x32_bf16 a[60:63], a[204:207], v[196:199], a[60:63]
    v_mfma_f32_16x16x32_bf16 a[60:63], a[200:203], v[164:167], a[60:63]
    buffer_load_dwordx4 v19, s[48:51], s85 offen offset:1024 nt lds
    v_mfma_f32_16x16x32_bf16 a[92:95], a[200:203], v[168:171], a[92:95]
    v_exp_f32 v141, v141
    v_mfma_f32_16x16x32_bf16 a[92:95], a[204:207], v[200:203], a[92:95]
    v_cvt_pk_bf16_f32 v54, v140, v141
    v_mfma_f32_16x16x32_bf16 a[124:127], a[204:207], v[204:207], a[124:127]
    v_exp_f32 v142, v142
    v_mfma_f32_16x16x32_bf16 a[124:127], a[200:203], v[172:175], a[124:127]
    v_mfma_f32_16x16x32_bf16 a[140:143], a[208:211], v[204:207], a[140:143]
    v_exp_f32 v143, v143
    v_mfma_f32_16x16x32_bf16 a[140:143], a[208:211], v[172:175], a[140:143]
    v_cvt_pk_bf16_f32 v55, v142, v143
    s_waitcnt lgkmcnt(11)
    v_mfma_f32_16x16x32_bf16 v[96:99], a[144:147], v[112:115], v[224:227]
    s_waitcnt lgkmcnt(10)
    v_exp_f32 v64, v64
    v_mfma_f32_16x16x32_bf16 v[96:99], a[148:151], v[144:147], v[96:99]
    s_waitcnt lgkmcnt(9)
    v_exp_f32 v65, v65
    v_mfma_f32_16x16x32_bf16 v[96:99], a[152:155], v[176:179], v[96:99]
    s_waitcnt lgkmcnt(8)
    ds_read_b128 a[160:163], v20 offset:12288
    v_cvt_pk_bf16_f32 v160, v64, v65
    v_mfma_f32_16x16x32_bf16 v[96:99], a[156:159], v[208:211], v[96:99]
    v_exp_f32 v66, v66
    v_mfma_f32_16x16x32_bf16 v[100:103], a[156:159], v[212:215], v[228:231]
    ds_read_b128 a[164:167], v21 offset:12288
    v_accvgpr_write_b32 a237, 0
    v_mfma_f32_16x16x32_bf16 v[100:103], a[152:155], v[180:183], v[100:103]
    v_exp_f32 v67, v67
    v_mfma_f32_16x16x32_bf16 v[100:103], a[148:151], v[148:151], v[100:103]
    ds_read_b128 a[168:171], v22 offset:12288
    v_cvt_pk_bf16_f32 v161, v66, v67
    v_mfma_f32_16x16x32_bf16 v[100:103], a[144:147], v[116:119], v[100:103]
    buffer_load_dwordx4 v18, s[48:51], s85 offen offset:2048 nt lds
    v_mfma_f32_16x16x32_bf16 v[104:107], a[144:147], v[120:123], v[232:235]
    v_exp_f32 v80, v80
    v_mfma_f32_16x16x32_bf16 v[104:107], a[148:151], v[152:155], v[104:107]
    ds_read_b128 a[172:175], v23 offset:12288
    v_accvgpr_write_b32 a238, 0
    v_mfma_f32_16x16x32_bf16 v[104:107], a[152:155], v[184:187], v[104:107]
    v_exp_f32 v81, v81
    v_mfma_f32_16x16x32_bf16 v[104:107], a[156:159], v[216:219], v[104:107]
    ds_read_b64_tr_b16 a[192:193], v26 offset:49152
    v_cvt_pk_bf16_f32 v162, v80, v81
    v_mfma_f32_16x16x32_bf16 v[108:111], a[156:159], v[220:223], v[236:239]
    v_exp_f32 v82, v82
    v_mfma_f32_16x16x32_bf16 v[108:111], a[152:155], v[188:191], v[108:111]
    ds_read_b64_tr_b16 a[194:195], v26 offset:53248
    v_accvgpr_write_b32 a239, 0
    v_mfma_f32_16x16x32_bf16 v[108:111], a[148:151], v[156:159], v[108:111]
    v_exp_f32 v83, v83
    v_mfma_f32_16x16x32_bf16 v[108:111], a[144:147], v[124:127], v[108:111]
    s_waitcnt lgkmcnt(12)
    ds_read_b64_tr_b16 a[196:197], v26 offset:57344
    v_cvt_pk_bf16_f32 v163, v82, v83
    v_mfma_f32_16x16x32_bf16 a[0:3], a[176:179], v[240:243], a[0:3]
    s_waitcnt lgkmcnt(11)
    v_exp_f32 v68, v68
    v_mfma_f32_16x16x32_bf16 a[0:3], a[180:183], v[32:35], a[0:3]
    ds_read_b64_tr_b16 a[198:199], v26 offset:61440
    v_accvgpr_write_b32 a240, 0
    v_mfma_f32_16x16x32_bf16 a[32:35], a[180:183], v[36:39], a[32:35]
    buffer_load_dwordx4 v19, s[48:51], s85 offen offset:3072 nt lds
    v_mfma_f32_16x16x32_bf16 a[32:35], a[176:179], v[244:247], a[32:35]
    v_exp_f32 v69, v69
    v_mfma_f32_16x16x32_bf16 a[64:67], a[176:179], v[248:251], a[64:67]
    ds_read_b64_tr_b16 a[200:201], v27 offset:49152
    v_cvt_pk_bf16_f32 v164, v68, v69
    v_mfma_f32_16x16x32_bf16 a[64:67], a[180:183], v[48:51], a[64:67]
    v_exp_f32 v70, v70
    v_mfma_f32_16x16x32_bf16 a[96:99], a[180:183], v[52:55], a[96:99]
    ds_read_b64_tr_b16 a[202:203], v27 offset:53248
    v_accvgpr_write_b32 a241, 0
    v_mfma_f32_16x16x32_bf16 a[96:99], a[176:179], v[252:255], a[96:99]
    s_waitcnt lgkmcnt(12)
    v_exp_f32 v71, v71
    v_mfma_f32_16x16x32_bf16 a[4:7], a[184:187], v[240:243], a[4:7]
    s_waitcnt lgkmcnt(10)
    ds_read_b64_tr_b16 a[204:205], v27 offset:57344
    v_cvt_pk_bf16_f32 v165, v70, v71
    v_mfma_f32_16x16x32_bf16 a[4:7], a[188:191], v[32:35], a[4:7]
    v_exp_f32 v84, v84
    v_mfma_f32_16x16x32_bf16 a[36:39], a[188:191], v[36:39], a[36:39]
    ds_read_b64_tr_b16 a[206:207], v27 offset:61440
    v_accvgpr_write_b32 a242, 0
    v_mfma_f32_16x16x32_bf16 a[36:39], a[184:187], v[244:247], a[36:39]
    buffer_load_dword v40, v41, s[52:55], s73 offen sc1
    v_mfma_f32_16x16x32_bf16 a[68:71], a[184:187], v[248:251], a[68:71]
    v_exp_f32 v85, v85
    v_mfma_f32_16x16x32_bf16 a[68:71], a[188:191], v[48:51], a[68:71]
    s_add_u32 s84, s84, 16384
    v_cvt_pk_bf16_f32 v166, v84, v85
    v_accvgpr_write_b32 a243, 0
    v_mfma_f32_16x16x32_bf16 a[100:103], a[188:191], v[52:55], a[100:103]
    s_waitcnt vmcnt(11)
    v_exp_f32 v86, v86
    v_mfma_f32_16x16x32_bf16 a[100:103], a[184:187], v[252:255], a[100:103]
    s_barrier
    v_accvgpr_write_b32 a244, 0
    v_accvgpr_write_b32 a245, 0
    v_mfma_f32_16x16x32_bf16 a[128:131], a[208:211], v[240:243], a[128:131]
    s_add_u32 s85, s85, 16384
    v_exp_f32 v87, v87
    v_mfma_f32_16x16x32_bf16 a[128:131], a[208:211], v[32:35], a[128:131]
    s_waitcnt lgkmcnt(11)
    ds_read_b128 a[144:147], v20 offset:16384
    v_cvt_pk_bf16_f32 v167, v86, v87
    v_mfma_f32_16x16x32_bf16 v[128:131], a[160:163], v[112:115], v[224:227]
    s_waitcnt lgkmcnt(11)
    v_exp_f32 v72, v72
    v_mfma_f32_16x16x32_bf16 v[128:131], a[164:167], v[144:147], v[128:131]
    s_waitcnt lgkmcnt(10)
    ds_read_b128 a[148:151], v21 offset:16384
    v_accvgpr_write_b32 a246, 0
    v_mfma_f32_16x16x32_bf16 v[128:131], a[168:171], v[176:179], v[128:131]
    s_waitcnt lgkmcnt(10)
    v_exp_f32 v73, v73
    v_mfma_f32_16x16x32_bf16 v[128:131], a[172:175], v[208:211], v[128:131]
    ds_read_b128 a[152:155], v22 offset:16384
    v_cvt_pk_bf16_f32 v168, v72, v73
    v_mfma_f32_16x16x32_bf16 v[132:135], a[172:175], v[212:215], v[228:231]
    v_exp_f32 v74, v74
    v_mfma_f32_16x16x32_bf16 v[132:135], a[168:171], v[180:183], v[132:135]
    ds_read_b128 a[156:159], v23 offset:16384
    v_accvgpr_write_b32 a247, 0
    v_mfma_f32_16x16x32_bf16 v[132:135], a[164:167], v[148:151], v[132:135]
    v_exp_f32 v75, v75
    v_mfma_f32_16x16x32_bf16 v[132:135], a[160:163], v[116:119], v[132:135]
    s_add_u32 m0, s83, 53248
    ds_read_b64_tr_b16 a[176:177], v28 offset:49152
    v_cvt_pk_bf16_f32 v169, v74, v75
    v_mfma_f32_16x16x32_bf16 v[136:139], a[160:163], v[120:123], v[232:235]
    buffer_load_dwordx4 v14, s[44:47], s84 offen offset:0 nt lds
    v_mfma_f32_16x16x32_bf16 v[136:139], a[164:167], v[152:155], v[136:139]
    v_exp_f32 v88, v88
    v_mfma_f32_16x16x32_bf16 v[136:139], a[168:171], v[184:187], v[136:139]
    ds_read_b64_tr_b16 a[178:179], v28 offset:53248
    v_accvgpr_write_b32 a250, 0
    v_mfma_f32_16x16x32_bf16 v[136:139], a[172:175], v[216:219], v[136:139]
    v_exp_f32 v89, v89
    v_mfma_f32_16x16x32_bf16 v[140:143], a[172:175], v[220:223], v[236:239]
    ds_read_b64_tr_b16 a[180:181], v28 offset:57344
    v_cvt_pk_bf16_f32 v170, v88, v89
    v_mfma_f32_16x16x32_bf16 v[140:143], a[168:171], v[188:191], v[140:143]
    v_exp_f32 v90, v90
    v_mfma_f32_16x16x32_bf16 v[140:143], a[164:167], v[156:159], v[140:143]
    ds_read_b64_tr_b16 a[182:183], v28 offset:61440
    v_accvgpr_write_b32 a251, 0
    v_mfma_f32_16x16x32_bf16 v[140:143], a[160:163], v[124:127], v[140:143]
    s_waitcnt lgkmcnt(14)
    v_exp_f32 v91, v91
    v_mfma_f32_16x16x32_bf16 a[8:11], a[192:195], v[240:243], a[8:11]
    s_waitcnt lgkmcnt(12)
    ds_read_b64_tr_b16 a[184:185], v29 offset:49152
    v_cvt_pk_bf16_f32 v171, v90, v91
    v_mfma_f32_16x16x32_bf16 a[8:11], a[196:199], v[32:35], a[8:11]
    v_exp_f32 v76, v76
    v_mfma_f32_16x16x32_bf16 a[40:43], a[196:199], v[36:39], a[40:43]
    ds_read_b64_tr_b16 a[186:187], v29 offset:53248
    v_mfma_f32_16x16x32_bf16 a[40:43], a[192:195], v[244:247], a[40:43]
    v_exp_f32 v77, v77
    v_mfma_f32_16x16x32_bf16 a[72:75], a[192:195], v[248:251], a[72:75]
    ds_read_b64_tr_b16 a[188:189], v29 offset:57344
    v_cvt_pk_bf16_f32 v172, v76, v77
    v_mfma_f32_16x16x32_bf16 a[72:75], a[196:199], v[48:51], a[72:75]
    v_exp_f32 v78, v78
    v_mfma_f32_16x16x32_bf16 a[104:107], a[196:199], v[52:55], a[104:107]
    ds_read_b64_tr_b16 a[190:191], v29 offset:61440
    v_mfma_f32_16x16x32_bf16 a[104:107], a[192:195], v[252:255], a[104:107]
    s_waitcnt lgkmcnt(14)
    v_exp_f32 v79, v79
    v_mfma_f32_16x16x32_bf16 a[12:15], a[200:203], v[240:243], a[12:15]
    s_waitcnt lgkmcnt(12)
    v_cvt_pk_bf16_f32 v173, v78, v79
    v_mfma_f32_16x16x32_bf16 a[12:15], a[204:207], v[32:35], a[12:15]
    buffer_load_dwordx4 v15, s[44:47], s84 offen offset:1024 nt lds
    v_mfma_f32_16x16x32_bf16 a[44:47], a[204:207], v[36:39], a[44:47]
    v_exp_f32 v92, v92
    v_mfma_f32_16x16x32_bf16 a[44:47], a[200:203], v[244:247], a[44:47]
    v_mfma_f32_16x16x32_bf16 a[76:79], a[200:203], v[248:251], a[76:79]
    v_exp_f32 v93, v93
    v_mfma_f32_16x16x32_bf16 a[76:79], a[204:207], v[48:51], a[76:79]
    v_cvt_pk_bf16_f32 v174, v92, v93
    v_mfma_f32_16x16x32_bf16 a[108:111], a[204:207], v[52:55], a[108:111]
    v_exp_f32 v94, v94
    v_mfma_f32_16x16x32_bf16 a[108:111], a[200:203], v[252:255], a[108:111]
    v_mfma_f32_16x16x32_bf16 a[132:135], a[208:211], v[36:39], a[132:135]
    v_exp_f32 v95, v95
    v_mfma_f32_16x16x32_bf16 a[132:135], a[208:211], v[244:247], a[132:135]
    v_cvt_pk_bf16_f32 v175, v94, v95
    s_waitcnt lgkmcnt(11)
    v_mfma_f32_16x16x32_bf16 v[64:67], a[144:147], v[112:115], v[224:227]
    s_waitcnt lgkmcnt(10)
    v_exp_f32 v96, v96
    v_mfma_f32_16x16x32_bf16 v[64:67], a[148:151], v[144:147], v[64:67]
    s_waitcnt lgkmcnt(9)
    v_exp_f32 v97, v97
    v_mfma_f32_16x16x32_bf16 v[64:67], a[152:155], v[176:179], v[64:67]
    s_waitcnt lgkmcnt(8)
    ds_read_b128 a[160:163], v20 offset:20480
    v_cvt_pk_bf16_f32 v192, v96, v97
    v_mfma_f32_16x16x32_bf16 v[64:67], a[156:159], v[208:211], v[64:67]
    v_exp_f32 v98, v98
    v_mfma_f32_16x16x32_bf16 v[68:71], a[156:159], v[212:215], v[228:231]
    ds_read_b128 a[164:167], v21 offset:20480
    v_mfma_f32_16x16x32_bf16 v[68:71], a[152:155], v[180:183], v[68:71]
    v_exp_f32 v99, v99
    v_mfma_f32_16x16x32_bf16 v[68:71], a[148:151], v[148:151], v[68:71]
    ds_read_b128 a[168:171], v22 offset:20480
    v_cvt_pk_bf16_f32 v193, v98, v99
    v_mfma_f32_16x16x32_bf16 v[68:71], a[144:147], v[116:119], v[68:71]
    buffer_load_dwordx4 v16, s[44:47], s84 offen offset:2048 nt lds
    v_mfma_f32_16x16x32_bf16 v[72:75], a[144:147], v[120:123], v[232:235]
    v_exp_f32 v128, v128
    v_mfma_f32_16x16x32_bf16 v[72:75], a[148:151], v[152:155], v[72:75]
    ds_read_b128 a[172:175], v23 offset:20480
    v_mfma_f32_16x16x32_bf16 v[72:75], a[152:155], v[184:187], v[72:75]
    v_exp_f32 v129, v129
    v_mfma_f32_16x16x32_bf16 v[72:75], a[156:159], v[216:219], v[72:75]
    ds_read_b64_tr_b16 a[192:193], v30 offset:49152
    v_cvt_pk_bf16_f32 v194, v128, v129
    v_mfma_f32_16x16x32_bf16 v[76:79], a[156:159], v[220:223], v[236:239]
    v_exp_f32 v130, v130
    v_mfma_f32_16x16x32_bf16 v[76:79], a[152:155], v[188:191], v[76:79]
    ds_read_b64_tr_b16 a[194:195], v30 offset:53248
    v_mfma_f32_16x16x32_bf16 v[76:79], a[148:151], v[156:159], v[76:79]
    v_exp_f32 v131, v131
    v_mfma_f32_16x16x32_bf16 v[76:79], a[144:147], v[124:127], v[76:79]
    s_waitcnt lgkmcnt(12)
    ds_read_b64_tr_b16 a[196:197], v30 offset:57344
    v_cvt_pk_bf16_f32 v195, v130, v131
    v_mfma_f32_16x16x32_bf16 a[16:19], a[176:179], v[240:243], a[16:19]
    s_waitcnt lgkmcnt(11)
    v_exp_f32 v100, v100
    v_mfma_f32_16x16x32_bf16 a[16:19], a[180:183], v[32:35], a[16:19]
    ds_read_b64_tr_b16 a[198:199], v30 offset:61440
    v_mfma_f32_16x16x32_bf16 a[48:51], a[180:183], v[36:39], a[48:51]
    buffer_load_dwordx4 v17, s[44:47], s84 offen offset:3072 nt lds
    v_mfma_f32_16x16x32_bf16 a[48:51], a[176:179], v[244:247], a[48:51]
    v_exp_f32 v101, v101
    v_mfma_f32_16x16x32_bf16 a[80:83], a[176:179], v[248:251], a[80:83]
    ds_read_b64_tr_b16 a[200:201], v31 offset:49152
    v_cvt_pk_bf16_f32 v196, v100, v101
    v_mfma_f32_16x16x32_bf16 a[80:83], a[180:183], v[48:51], a[80:83]
    v_exp_f32 v102, v102
    v_mfma_f32_16x16x32_bf16 a[112:115], a[180:183], v[52:55], a[112:115]
    ds_read_b64_tr_b16 a[202:203], v31 offset:53248
    v_mfma_f32_16x16x32_bf16 a[112:115], a[176:179], v[252:255], a[112:115]
    s_waitcnt lgkmcnt(12)
    v_exp_f32 v103, v103
    v_mfma_f32_16x16x32_bf16 a[20:23], a[184:187], v[240:243], a[20:23]
    s_waitcnt lgkmcnt(10)
    ds_read_b64_tr_b16 a[204:205], v31 offset:57344
    v_cvt_pk_bf16_f32 v197, v102, v103
    v_mfma_f32_16x16x32_bf16 a[20:23], a[188:191], v[32:35], a[20:23]
    v_exp_f32 v132, v132
    v_mfma_f32_16x16x32_bf16 a[52:55], a[188:191], v[36:39], a[52:55]
    s_mov_b32 s74, 0
    ds_read_b64_tr_b16 a[206:207], v31 offset:61440
    v_mfma_f32_16x16x32_bf16 a[52:55], a[184:187], v[244:247], a[52:55]
    buffer_load_dword v40, v42, s[92:95], 0 offen sc1
    v_mfma_f32_16x16x32_bf16 a[84:87], a[184:187], v[248:251], a[84:87]
    v_exp_f32 v133, v133
    v_mfma_f32_16x16x32_bf16 a[84:87], a[188:191], v[48:51], a[84:87]
    v_cvt_pk_bf16_f32 v198, v132, v133
    v_mfma_f32_16x16x32_bf16 a[116:119], a[188:191], v[52:55], a[116:119]
    v_exp_f32 v134, v134
    v_mfma_f32_16x16x32_bf16 a[116:119], a[184:187], v[252:255], a[116:119]
    v_mfma_f32_16x16x32_bf16 a[136:139], a[208:211], v[248:251], a[136:139]
    v_exp_f32 v135, v135
    v_mfma_f32_16x16x32_bf16 a[136:139], a[208:211], v[48:51], a[136:139]
    s_waitcnt lgkmcnt(11)
    ds_read_b128 a[144:147], v20 offset:24576
    v_cvt_pk_bf16_f32 v199, v134, v135
    v_mfma_f32_16x16x32_bf16 v[80:83], a[160:163], v[112:115], v[224:227]
    s_waitcnt lgkmcnt(11)
    v_exp_f32 v104, v104
    v_mfma_f32_16x16x32_bf16 v[80:83], a[164:167], v[144:147], v[80:83]
    s_waitcnt lgkmcnt(10)
    ds_read_b128 a[148:151], v21 offset:24576
    v_mfma_f32_16x16x32_bf16 v[80:83], a[168:171], v[176:179], v[80:83]
    s_waitcnt lgkmcnt(10)
    v_exp_f32 v105, v105
    v_mfma_f32_16x16x32_bf16 v[80:83], a[172:175], v[208:211], v[80:83]
    ds_read_b128 a[152:155], v22 offset:24576
    v_cvt_pk_bf16_f32 v200, v104, v105
    v_mfma_f32_16x16x32_bf16 v[84:87], a[172:175], v[212:215], v[228:231]
    v_exp_f32 v106, v106
    v_mfma_f32_16x16x32_bf16 v[84:87], a[168:171], v[180:183], v[84:87]
    ds_read_b128 a[156:159], v23 offset:24576
    v_mfma_f32_16x16x32_bf16 v[84:87], a[164:167], v[148:151], v[84:87]
    v_exp_f32 v107, v107
    v_mfma_f32_16x16x32_bf16 v[84:87], a[160:163], v[116:119], v[84:87]
    s_add_u32 m0, s83, 104448
    ds_read_b64_tr_b16 a[176:177], v24 offset:0
    v_cvt_pk_bf16_f32 v201, v106, v107
    v_mfma_f32_16x16x32_bf16 v[88:91], a[160:163], v[120:123], v[232:235]
    buffer_load_dwordx4 v18, s[48:51], s85 offen offset:0 nt lds
    v_mfma_f32_16x16x32_bf16 v[88:91], a[164:167], v[152:155], v[88:91]
    v_exp_f32 v136, v136
    v_mfma_f32_16x16x32_bf16 v[88:91], a[168:171], v[184:187], v[88:91]
    ds_read_b64_tr_b16 a[178:179], v24 offset:4096
    v_mfma_f32_16x16x32_bf16 v[88:91], a[172:175], v[216:219], v[88:91]
    v_exp_f32 v137, v137
    v_mfma_f32_16x16x32_bf16 v[92:95], a[172:175], v[220:223], v[236:239]
    ds_read_b64_tr_b16 a[180:181], v24 offset:8192
    v_cvt_pk_bf16_f32 v202, v136, v137
    v_mfma_f32_16x16x32_bf16 v[92:95], a[168:171], v[188:191], v[92:95]
    v_exp_f32 v138, v138
    v_mfma_f32_16x16x32_bf16 v[92:95], a[164:167], v[156:159], v[92:95]
    ds_read_b64_tr_b16 a[182:183], v24 offset:12288
    v_mfma_f32_16x16x32_bf16 v[92:95], a[160:163], v[124:127], v[92:95]
    s_waitcnt lgkmcnt(14)
    v_exp_f32 v139, v139
    v_mfma_f32_16x16x32_bf16 a[24:27], a[192:195], v[240:243], a[24:27]
    s_waitcnt lgkmcnt(12)
    ds_read_b64_tr_b16 a[184:185], v25 offset:0
    v_cvt_pk_bf16_f32 v203, v138, v139
    v_mfma_f32_16x16x32_bf16 a[24:27], a[196:199], v[32:35], a[24:27]
    v_exp_f32 v108, v108
    v_mfma_f32_16x16x32_bf16 a[56:59], a[196:199], v[36:39], a[56:59]
    ds_read_b64_tr_b16 a[186:187], v25 offset:4096
    v_mfma_f32_16x16x32_bf16 a[56:59], a[192:195], v[244:247], a[56:59]
    v_exp_f32 v109, v109
    v_mfma_f32_16x16x32_bf16 a[88:91], a[192:195], v[248:251], a[88:91]
    ds_read_b64_tr_b16 a[188:189], v25 offset:8192
    v_cvt_pk_bf16_f32 v204, v108, v109
    v_mfma_f32_16x16x32_bf16 a[88:91], a[196:199], v[48:51], a[88:91]
    v_exp_f32 v110, v110
    v_mfma_f32_16x16x32_bf16 a[120:123], a[196:199], v[52:55], a[120:123]
    ds_read_b64_tr_b16 a[190:191], v25 offset:12288
    v_mfma_f32_16x16x32_bf16 a[120:123], a[192:195], v[252:255], a[120:123]
    s_waitcnt lgkmcnt(14)
    v_exp_f32 v111, v111
    v_mfma_f32_16x16x32_bf16 a[28:31], a[200:203], v[240:243], a[28:31]
    s_waitcnt lgkmcnt(12)
    v_cvt_pk_bf16_f32 v205, v110, v111
    v_mfma_f32_16x16x32_bf16 a[28:31], a[204:207], v[32:35], a[28:31]
    buffer_load_dwordx4 v19, s[48:51], s85 offen offset:1024 nt lds
    v_mfma_f32_16x16x32_bf16 a[60:63], a[204:207], v[36:39], a[60:63]
    v_exp_f32 v140, v140
    v_mfma_f32_16x16x32_bf16 a[60:63], a[200:203], v[244:247], a[60:63]
    v_mfma_f32_16x16x32_bf16 a[92:95], a[200:203], v[248:251], a[92:95]
    v_exp_f32 v141, v141
    v_mfma_f32_16x16x32_bf16 a[92:95], a[204:207], v[48:51], a[92:95]
    v_cvt_pk_bf16_f32 v206, v140, v141
    v_mfma_f32_16x16x32_bf16 a[124:127], a[204:207], v[52:55], a[124:127]
    v_exp_f32 v142, v142
    v_mfma_f32_16x16x32_bf16 a[124:127], a[200:203], v[252:255], a[124:127]
    v_mfma_f32_16x16x32_bf16 a[140:143], a[208:211], v[52:55], a[140:143]
    v_exp_f32 v143, v143
    v_mfma_f32_16x16x32_bf16 a[140:143], a[208:211], v[252:255], a[140:143]
    v_cvt_pk_bf16_f32 v207, v142, v143
    s_mov_b64 exec, 0
    s_cmp_eq_u32 s70, 0
    s_cbranch_scc1 Lqad0
    s_cmp_eq_u32 s70, 1
    s_cbranch_scc1 Lqad1
    s_cmp_eq_u32 s70, 2
    s_cbranch_scc1 Lqad2
    s_branch Lqad3
Lwalk2_done:
    s_mov_b64 exec, -1
    s_nop 1
.p2align 6
Lloop:
    s_waitcnt lgkmcnt(11)
    v_mfma_f32_16x16x32_bf16 v[96:99], a[144:147], v[112:115], v[224:227]
    s_waitcnt lgkmcnt(10)
    v_exp_f32 v64, v64
    v_mfma_f32_16x16x32_bf16 v[96:99], a[148:151], v[144:147], v[96:99]
    s_waitcnt lgkmcnt(9)
    ds_read_b128 a[160:163], v20 offset:28672
    v_mfma_f32_16x16x32_bf16 v[96:99], a[152:155], v[176:179], v[96:99]
    s_waitcnt lgkmcnt(9)
    v_exp_f32 v65, v65
    v_mfma_f32_16x16x32_bf16 v[96:99], a[156:159], v[208:211], v[96:99]
    ds_read_b128 a[164:167], v21 offset:28672
    v_cvt_pk_bf16_f32 v240, v64, v65
    v_mfma_f32_16x16x32_bf16 v[100:103], a[156:159], v[212:215], v[228:231]
    v_exp_f32 v66, v66
    v_mfma_f32_16x16x32_bf16 v[100:103], a[152:155], v[180:183], v[100:103]
    ds_read_b128 a[168:171], v22 offset:28672
    v_mfma_f32_16x16x32_bf16 v[100:103], a[148:151], v[148:151], v[100:103]
    v_exp_f32 v67, v67
    v_mfma_f32_16x16x32_bf16 v[100:103], a[144:147], v[116:119], v[100:103]
    ds_read_b128 a[172:175], v23 offset:28672
    v_cvt_pk_bf16_f32 v241, v66, v67
    v_mfma_f32_16x16x32_bf16 v[104:107], a[144:147], v[120:123], v[232:235]
    buffer_load_dwordx4 v18, s[48:51], s85 offen offset:2048 nt lds
    v_mfma_f32_16x16x32_bf16 v[104:107], a[148:151], v[152:155], v[104:107]
    v_exp_f32 v80, v80
    v_mfma_f32_16x16x32_bf16 v[104:107], a[152:155], v[184:187], v[104:107]
    ds_read_b64_tr_b16 a[192:193], v26 offset:0
    v_mfma_f32_16x16x32_bf16 v[104:107], a[156:159], v[216:219], v[104:107]
    v_exp_f32 v81, v81
    v_mfma_f32_16x16x32_bf16 v[108:111], a[156:159], v[220:223], v[236:239]
    ds_read_b64_tr_b16 a[194:195], v26 offset:4096
    v_cvt_pk_bf16_f32 v242, v80, v81
    v_mfma_f32_16x16x32_bf16 v[108:111], a[152:155], v[188:191], v[108:111]
    v_exp_f32 v82, v82
    v_mfma_f32_16x16x32_bf16 v[108:111], a[148:151], v[156:159], v[108:111]
    ds_read_b64_tr_b16 a[196:197], v26 offset:8192
    v_mfma_f32_16x16x32_bf16 v[108:111], a[144:147], v[124:127], v[108:111]
    s_waitcnt lgkmcnt(13)
    v_exp_f32 v83, v83
    v_mfma_f32_16x16x32_bf16 a[0:3], a[176:179], v[160:163], a[0:3]
    s_waitcnt lgkmcnt(11)
    ds_read_b64_tr_b16 a[198:199], v26 offset:12288
    v_cvt_pk_bf16_f32 v243, v82, v83
Lpad12:
    s_cbranch_execz Lpad14
    v_mfma_f32_16x16x32_bf16 a[0:3], a[180:183], v[192:195], a[0:3]
    v_exp_f32 v68, v68
    v_mfma_f32_16x16x32_bf16 a[32:35], a[180:183], v[196:199], a[32:35]
    ds_read_b64_tr_b16 a[200:201], v27 offset:0
    v_mfma_f32_16x16x32_bf16 a[32:35], a[176:179], v[164:167], a[32:35]
    v_exp_f32 v69, v69
    v_mfma_f32_16x16x32_bf16 a[64:67], a[176:179], v[168:171], a[64:67]
    ds_read_b64_tr_b16 a[202:203], v27 offset:4096
    v_cvt_pk_bf16_f32 v244, v68, v69
    v_mfma_f32_16x16x32_bf16 a[64:67], a[180:183], v[200:203], a[64:67]
    v_exp_f32 v70, v70
    v_mfma_f32_16x16x32_bf16 a[96:99], a[180:183], v[204:207], a[96:99]
    ds_read_b64_tr_b16 a[204:205], v27 offset:8192
    v_mfma_f32_16x16x32_bf16 a[96:99], a[176:179], v[172:175], a[96:99]
    s_waitcnt lgkmcnt(13)
    v_exp_f32 v71, v71
    v_mfma_f32_16x16x32_bf16 a[4:7], a[184:187], v[160:163], a[4:7]
    s_waitcnt lgkmcnt(11)
    ds_read_b64_tr_b16 a[206:207], v27 offset:12288
    v_cvt_pk_bf16_f32 v245, v70, v71
    v_mfma_f32_16x16x32_bf16 a[4:7], a[188:191], v[192:195], a[4:7]
    buffer_load_dwordx4 v19, s[48:51], s85 offen offset:3072 nt lds
    v_mfma_f32_16x16x32_bf16 a[36:39], a[188:191], v[196:199], a[36:39]
    v_exp_f32 v84, v84
    v_mfma_f32_16x16x32_bf16 a[36:39], a[184:187], v[164:167], a[36:39]
    v_mfma_f32_16x16x32_bf16 a[68:71], a[184:187], v[168:171], a[68:71]
    v_exp_f32 v85, v85
    v_mfma_f32_16x16x32_bf16 a[68:71], a[188:191], v[200:203], a[68:71]
    s_add_u32 s84, s84, 16384
    v_cvt_pk_bf16_f32 v246, v84, v85
    v_mfma_f32_16x16x32_bf16 a[100:103], a[188:191], v[204:207], a[100:103]
    s_waitcnt vmcnt(8)
    v_exp_f32 v86, v86
    v_mfma_f32_16x16x32_bf16 a[100:103], a[184:187], v[172:175], a[100:103]
    s_barrier
    v_mfma_f32_16x16x32_bf16 a[128:131], a[208:211], v[160:163], a[128:131]
    s_add_u32 s85, s85, 16384
    v_exp_f32 v87, v87
    v_mfma_f32_16x16x32_bf16 a[128:131], a[208:211], v[192:195], a[128:131]
    s_waitcnt lgkmcnt(11)
    ds_read_b128 a[144:147], v20 offset:32768
    v_cvt_pk_bf16_f32 v247, v86, v87
    v_mfma_f32_16x16x32_bf16 v[128:131], a[160:163], v[112:115], v[224:227]
    s_waitcnt lgkmcnt(11)
    v_exp_f32 v72, v72
    v_mfma_f32_16x16x32_bf16 v[128:131], a[164:167], v[144:147], v[128:131]
    s_waitcnt lgkmcnt(10)
    ds_read_b128 a[148:151], v21 offset:32768
    v_mfma_f32_16x16x32_bf16 v[128:131], a[168:171], v[176:179], v[128:131]
    s_waitcnt lgkmcnt(10)
    v_exp_f32 v73, v73
    v_mfma_f32_16x16x32_bf16 v[128:131], a[172:175], v[208:211], v[128:131]
    ds_read_b128 a[152:155], v22 offset:32768
    v_cvt_pk_bf16_f32 v248, v72, v73
    v_mfma_f32_16x16x32_bf16 v[132:135], a[172:175], v[212:215], v[228:231]
    v_exp_f32 v74, v74
    v_mfma_f32_16x16x32_bf16 v[132:135], a[168:171], v[180:183], v[132:135]
    ds_read_b128 a[156:159], v23 offset:32768
    v_mfma_f32_16x16x32_bf16 v[132:135], a[164:167], v[148:151], v[132:135]
    v_exp_f32 v75, v75
    v_mfma_f32_16x16x32_bf16 v[132:135], a[160:163], v[116:119], v[132:135]
    s_add_u32 m0, s83, 4096
    ds_read_b64_tr_b16 a[176:177], v28 offset:0
    v_cvt_pk_bf16_f32 v249, v74, v75
    v_mfma_f32_16x16x32_bf16 v[136:139], a[160:163], v[120:123], v[232:235]
    buffer_load_dwordx4 v14, s[44:47], s84 offen offset:0 nt lds
    v_mfma_f32_16x16x32_bf16 v[136:139], a[164:167], v[152:155], v[136:139]
    v_exp_f32 v88, v88
    v_mfma_f32_16x16x32_bf16 v[136:139], a[168:171], v[184:187], v[136:139]
    ds_read_b64_tr_b16 a[178:179], v28 offset:4096
    v_mfma_f32_16x16x32_bf16 v[136:139], a[172:175], v[216:219], v[136:139]
    v_exp_f32 v89, v89
    v_mfma_f32_16x16x32_bf16 v[140:143], a[172:175], v[220:223], v[236:239]
    ds_read_b64_tr_b16 a[180:181], v28 offset:8192
    v_cvt_pk_bf16_f32 v250, v88, v89
    v_mfma_f32_16x16x32_bf16 v[140:143], a[168:171], v[188:191], v[140:143]
    v_exp_f32 v90, v90
    v_mfma_f32_16x16x32_bf16 v[140:143], a[164:167], v[156:159], v[140:143]
    ds_read_b64_tr_b16 a[182:183], v28 offset:12288
    v_mfma_f32_16x16x32_bf16 v[140:143], a[160:163], v[124:127], v[140:143]
    s_waitcnt lgkmcnt(14)
    v_exp_f32 v91, v91
    v_mfma_f32_16x16x32_bf16 a[8:11], a[192:195], v[160:163], a[8:11]
    s_waitcnt lgkmcnt(12)
    ds_read_b64_tr_b16 a[184:185], v29 offset:0
    v_cvt_pk_bf16_f32 v251, v90, v91
    v_mfma_f32_16x16x32_bf16 a[8:11], a[196:199], v[192:195], a[8:11]
    v_exp_f32 v76, v76
    v_mfma_f32_16x16x32_bf16 a[40:43], a[196:199], v[196:199], a[40:43]
    ds_read_b64_tr_b16 a[186:187], v29 offset:4096
    v_mfma_f32_16x16x32_bf16 a[40:43], a[192:195], v[164:167], a[40:43]
    v_exp_f32 v77, v77
    v_mfma_f32_16x16x32_bf16 a[72:75], a[192:195], v[168:171], a[72:75]
    ds_read_b64_tr_b16 a[188:189], v29 offset:8192
    v_cvt_pk_bf16_f32 v252, v76, v77
    v_mfma_f32_16x16x32_bf16 a[72:75], a[196:199], v[200:203], a[72:75]
    v_exp_f32 v78, v78
    v_mfma_f32_16x16x32_bf16 a[104:107], a[196:199], v[204:207], a[104:107]
    ds_read_b64_tr_b16 a[190:191], v29 offset:12288
    v_mfma_f32_16x16x32_bf16 a[104:107], a[192:195], v[172:175], a[104:107]
    s_waitcnt lgkmcnt(14)
    v_exp_f32 v79, v79
    v_mfma_f32_16x16x32_bf16 a[12:15], a[200:203], v[160:163], a[12:15]
    s_waitcnt lgkmcnt(12)
    v_cvt_pk_bf16_f32 v253, v78, v79
    v_mfma_f32_16x16x32_bf16 a[12:15], a[204:207], v[192:195], a[12:15]
    buffer_load_dwordx4 v15, s[44:47], s84 offen offset:1024 nt lds
    v_mfma_f32_16x16x32_bf16 a[44:47], a[204:207], v[196:199], a[44:47]
    v_exp_f32 v92, v92
    v_mfma_f32_16x16x32_bf16 a[44:47], a[200:203], v[164:167], a[44:47]
    v_mfma_f32_16x16x32_bf16 a[76:79], a[200:203], v[168:171], a[76:79]
    v_exp_f32 v93, v93
    v_mfma_f32_16x16x32_bf16 a[76:79], a[204:207], v[200:203], a[76:79]
    v_cvt_pk_bf16_f32 v254, v92, v93
    v_mfma_f32_16x16x32_bf16 a[108:111], a[204:207], v[204:207], a[108:111]
    v_exp_f32 v94, v94
    v_mfma_f32_16x16x32_bf16 a[108:111], a[200:203], v[172:175], a[108:111]
    v_mfma_f32_16x16x32_bf16 a[132:135], a[208:211], v[196:199], a[132:135]
    v_exp_f32 v95, v95
    v_mfma_f32_16x16x32_bf16 a[132:135], a[208:211], v[164:167], a[132:135]
    v_cvt_pk_bf16_f32 v255, v94, v95
    s_waitcnt lgkmcnt(11)
    v_mfma_f32_16x16x32_bf16 v[64:67], a[144:147], v[112:115], v[224:227]
    s_waitcnt lgkmcnt(10)
    v_exp_f32 v96, v96
    v_mfma_f32_16x16x32_bf16 v[64:67], a[148:151], v[144:147], v[64:67]
    s_waitcnt lgkmcnt(9)
    v_exp_f32 v97, v97
    v_mfma_f32_16x16x32_bf16 v[64:67], a[152:155], v[176:179], v[64:67]
    s_waitcnt lgkmcnt(8)
    ds_read_b128 a[160:163], v20 offset:36864
    v_cvt_pk_bf16_f32 v32, v96, v97
    v_mfma_f32_16x16x32_bf16 v[64:67], a[156:159], v[208:211], v[64:67]
    v_exp_f32 v98, v98
    v_mfma_f32_16x16x32_bf16 v[68:71], a[156:159], v[212:215], v[228:231]
    ds_read_b128 a[164:167], v21 offset:36864
    v_mfma_f32_16x16x32_bf16 v[68:71], a[152:155], v[180:183], v[68:71]
    v_exp_f32 v99, v99
    v_mfma_f32_16x16x32_bf16 v[68:71], a[148:151], v[148:151], v[68:71]
    ds_read_b128 a[168:171], v22 offset:36864
    v_cvt_pk_bf16_f32 v33, v98, v99
    v_mfma_f32_16x16x32_bf16 v[68:71], a[144:147], v[116:119], v[68:71]
    buffer_load_dwordx4 v16, s[44:47], s84 offen offset:2048 nt lds
    v_mfma_f32_16x16x32_bf16 v[72:75], a[144:147], v[120:123], v[232:235]
    v_exp_f32 v128, v128
    v_mfma_f32_16x16x32_bf16 v[72:75], a[148:151], v[152:155], v[72:75]
    ds_read_b128 a[172:175], v23 offset:36864
    v_mfma_f32_16x16x32_bf16 v[72:75], a[152:155], v[184:187], v[72:75]
    v_exp_f32 v129, v129
    v_mfma_f32_16x16x32_bf16 v[72:75], a[156:159], v[216:219], v[72:75]
    ds_read_b64_tr_b16 a[192:193], v30 offset:0
    v_cvt_pk_bf16_f32 v34, v128, v129
    v_mfma_f32_16x16x32_bf16 v[76:79], a[156:159], v[220:223], v[236:239]
    v_exp_f32 v130, v130
    v_mfma_f32_16x16x32_bf16 v[76:79], a[152:155], v[188:191], v[76:79]
    ds_read_b64_tr_b16 a[194:195], v30 offset:4096
    v_mfma_f32_16x16x32_bf16 v[76:79], a[148:151], v[156:159], v[76:79]
    v_exp_f32 v131, v131
    v_mfma_f32_16x16x32_bf16 v[76:79], a[144:147], v[124:127], v[76:79]
    s_waitcnt lgkmcnt(12)
    ds_read_b64_tr_b16 a[196:197], v30 offset:8192
    v_cvt_pk_bf16_f32 v35, v130, v131
    v_mfma_f32_16x16x32_bf16 a[16:19], a[176:179], v[160:163], a[16:19]
    s_waitcnt lgkmcnt(11)
    v_exp_f32 v100, v100
    v_mfma_f32_16x16x32_bf16 a[16:19], a[180:183], v[192:195], a[16:19]
    ds_read_b64_tr_b16 a[198:199], v30 offset:12288
    v_mfma_f32_16x16x32_bf16 a[48:51], a[180:183], v[196:199], a[48:51]
    buffer_load_dwordx4 v17, s[44:47], s84 offen offset:3072 nt lds
    v_mfma_f32_16x16x32_bf16 a[48:51], a[176:179], v[164:167], a[48:51]
    v_exp_f32 v101, v101
    v_mfma_f32_16x16x32_bf16 a[80:83], a[176:179], v[168:171], a[80:83]
    ds_read_b64_tr_b16 a[200:201], v31 offset:0
    v_cvt_pk_bf16_f32 v36, v100, v101
    v_mfma_f32_16x16x32_bf16 a[80:83], a[180:183], v[200:203], a[80:83]
    v_exp_f32 v102, v102
    v_mfma_f32_16x16x32_bf16 a[112:115], a[180:183], v[204:207], a[112:115]
    ds_read_b64_tr_b16 a[202:203], v31 offset:4096
    v_mfma_f32_16x16x32_bf16 a[112:115], a[176:179], v[172:175], a[112:115]
    s_waitcnt lgkmcnt(12)
    v_exp_f32 v103, v103
    v_mfma_f32_16x16x32_bf16 a[20:23], a[184:187], v[160:163], a[20:23]
    s_waitcnt lgkmcnt(10)
    ds_read_b64_tr_b16 a[204:205], v31 offset:8192
    v_cvt_pk_bf16_f32 v37, v102, v103
    v_mfma_f32_16x16x32_bf16 a[20:23], a[188:191], v[192:195], a[20:23]
    v_exp_f32 v132, v132
    v_mfma_f32_16x16x32_bf16 a[52:55], a[188:191], v[196:199], a[52:55]
    ds_read_b64_tr_b16 a[206:207], v31 offset:12288
    v_mfma_f32_16x16x32_bf16 a[52:55], a[184:187], v[164:167], a[52:55]
    buffer_load_dword v44, v47, s[56:59], 0 offen offset:0 sc1
    v_mfma_f32_16x16x32_bf16 a[84:87], a[184:187], v[168:171], a[84:87]
    v_exp_f32 v133, v133
    v_mfma_f32_16x16x32_bf16 a[84:87], a[188:191], v[200:203], a[84:87]
    v_cvt_pk_bf16_f32 v38, v132, v133
    v_mfma_f32_16x16x32_bf16 a[116:119], a[188:191], v[204:207], a[116:119]
    v_exp_f32 v134, v134
    v_mfma_f32_16x16x32_bf16 a[116:119], a[184:187], v[172:175], a[116:119]
    v_mfma_f32_16x16x32_bf16 a[136:139], a[208:211], v[168:171], a[136:139]
    v_exp_f32 v135, v135
    v_mfma_f32_16x16x32_bf16 a[136:139], a[208:211], v[200:203], a[136:139]
    s_waitcnt lgkmcnt(11)
    ds_read_b128 a[144:147], v20 offset:40960
    v_cvt_pk_bf16_f32 v39, v134, v135
    v_mfma_f32_16x16x32_bf16 v[80:83], a[160:163], v[112:115], v[224:227]
    s_waitcnt lgkmcnt(11)
    v_exp_f32 v104, v104
    v_mfma_f32_16x16x32_bf16 v[80:83], a[164:167], v[144:147], v[80:83]
    s_waitcnt lgkmcnt(10)
    ds_read_b128 a[148:151], v21 offset:40960
    v_mfma_f32_16x16x32_bf16 v[80:83], a[168:171], v[176:179], v[80:83]
    s_waitcnt lgkmcnt(10)
    v_exp_f32 v105, v105
    v_mfma_f32_16x16x32_bf16 v[80:83], a[172:175], v[208:211], v[80:83]
    ds_read_b128 a[152:155], v22 offset:40960
    v_cvt_pk_bf16_f32 v48, v104, v105
    v_mfma_f32_16x16x32_bf16 v[84:87], a[172:175], v[212:215], v[228:231]
    v_exp_f32 v106, v106
    v_mfma_f32_16x16x32_bf16 v[84:87], a[168:171], v[180:183], v[84:87]
    ds_read_b128 a[156:159], v23 offset:40960
    v_mfma_f32_16x16x32_bf16 v[84:87], a[164:167], v[148:151], v[84:87]
    v_exp_f32 v107, v107
    v_mfma_f32_16x16x32_bf16 v[84:87], a[160:163], v[116:119], v[84:87]
    s_add_u32 m0, s83, 120832
    ds_read_b64_tr_b16 a[176:177], v24 offset:16384
    v_cvt_pk_bf16_f32 v49, v106, v107
    v_mfma_f32_16x16x32_bf16 v[88:91], a[160:163], v[120:123], v[232:235]
    buffer_load_dwordx4 v18, s[48:51], s85 offen offset:0 nt lds
    v_mfma_f32_16x16x32_bf16 v[88:91], a[164:167], v[152:155], v[88:91]
    v_exp_f32 v136, v136
    v_mfma_f32_16x16x32_bf16 v[88:91], a[168:171], v[184:187], v[88:91]
    ds_read_b64_tr_b16 a[178:179], v24 offset:20480
    v_mfma_f32_16x16x32_bf16 v[88:91], a[172:175], v[216:219], v[88:91]
    v_exp_f32 v137, v137
    v_mfma_f32_16x16x32_bf16 v[92:95], a[172:175], v[220:223], v[236:239]
    ds_read_b64_tr_b16 a[180:181], v24 offset:24576
    v_cvt_pk_bf16_f32 v50, v136, v137
    v_mfma_f32_16x16x32_bf16 v[92:95], a[168:171], v[188:191], v[92:95]
    v_exp_f32 v138, v138
    v_mfma_f32_16x16x32_bf16 v[92:95], a[164:167], v[156:159], v[92:95]
    ds_read_b64_tr_b16 a[182:183], v24 offset:28672
    v_mfma_f32_16x16x32_bf16 v[92:95], a[160:163], v[124:127], v[92:95]
    s_waitcnt lgkmcnt(14)
    v_exp_f32 v139, v139
    v_mfma_f32_16x16x32_bf16 a[24:27], a[192:195], v[160:163], a[24:27]
    s_waitcnt lgkmcnt(12)
    ds_read_b64_tr_b16 a[184:185], v25 offset:16384
    v_cvt_pk_bf16_f32 v51, v138, v139
    v_mfma_f32_16x16x32_bf16 a[24:27], a[196:199], v[192:195], a[24:27]
    v_exp_f32 v108, v108
    v_mfma_f32_16x16x32_bf16 a[56:59], a[196:199], v[196:199], a[56:59]
    ds_read_b64_tr_b16 a[186:187], v25 offset:20480
    v_mfma_f32_16x16x32_bf16 a[56:59], a[192:195], v[164:167], a[56:59]
    v_exp_f32 v109, v109
    v_mfma_f32_16x16x32_bf16 a[88:91], a[192:195], v[168:171], a[88:91]
    ds_read_b64_tr_b16 a[188:189], v25 offset:24576
    v_cvt_pk_bf16_f32 v52, v108, v109
    v_mfma_f32_16x16x32_bf16 a[88:91], a[196:199], v[200:203], a[88:91]
    v_exp_f32 v110, v110
    v_mfma_f32_16x16x32_bf16 a[120:123], a[196:199], v[204:207], a[120:123]
    ds_read_b64_tr_b16 a[190:191], v25 offset:28672
    v_mfma_f32_16x16x32_bf16 a[120:123], a[192:195], v[172:175], a[120:123]
    s_waitcnt lgkmcnt(14)
    v_exp_f32 v111, v111
    v_mfma_f32_16x16x32_bf16 a[28:31], a[200:203], v[160:163], a[28:31]
    s_waitcnt lgkmcnt(12)
    v_cvt_pk_bf16_f32 v53, v110, v111
    v_mfma_f32_16x16x32_bf16 a[28:31], a[204:207], v[192:195], a[28:31]
    buffer_load_dwordx4 v19, s[48:51], s85 offen offset:1024 nt lds
    v_mfma_f32_16x16x32_bf16 a[60:63], a[204:207], v[196:199], a[60:63]
    v_exp_f32 v140, v140
    v_mfma_f32_16x16x32_bf16 a[60:63], a[200:203], v[164:167], a[60:63]
    v_mfma_f32_16x16x32_bf16 a[92:95], a[200:203], v[168:171], a[92:95]
    v_exp_f32 v141, v141
    v_mfma_f32_16x16x32_bf16 a[92:95], a[204:207], v[200:203], a[92:95]
    v_cvt_pk_bf16_f32 v54, v140, v141
    v_mfma_f32_16x16x32_bf16 a[124:127], a[204:207], v[204:207], a[124:127]
    v_exp_f32 v142, v142
    v_mfma_f32_16x16x32_bf16 a[124:127], a[200:203], v[172:175], a[124:127]
    v_mfma_f32_16x16x32_bf16 a[140:143], a[208:211], v[204:207], a[140:143]
    v_exp_f32 v143, v143
    v_mfma_f32_16x16x32_bf16 a[140:143], a[208:211], v[172:175], a[140:143]
    v_cvt_pk_bf16_f32 v55, v142, v143
    s_waitcnt lgkmcnt(11)
    v_mfma_f32_16x16x32_bf16 v[96:99], a[144:147], v[112:115], v[224:227]
    s_waitcnt lgkmcnt(10)
    v_exp_f32 v64, v64
    v_mfma_f32_16x16x32_bf16 v[96:99], a[148:151], v[144:147], v[96:99]
    s_waitcnt lgkmcnt(9)
    ds_read_b128 a[160:163], v20 offset:45056
    v_mfma_f32_16x16x32_bf16 v[96:99], a[152:155], v[176:179], v[96:99]
    s_waitcnt lgkmcnt(9)
    v_exp_f32 v65, v65
    v_mfma_f32_16x16x32_bf16 v[96:99], a[156:159], v[208:211], v[96:99]
    ds_read_b128 a[164:167], v21 offset:45056
    v_cvt_pk_bf16_f32 v160, v64, v65
    v_mfma_f32_16x16x32_bf16 v[100:103], a[156:159], v[212:215], v[228:231]
    v_exp_f32 v66, v66
    v_mfma_f32_16x16x32_bf16 v[100:103], a[152:155], v[180:183], v[100:103]
    ds_read_b128 a[168:171], v22 offset:45056
    v_mfma_f32_16x16x32_bf16 v[100:103], a[148:151], v[148:151], v[100:103]
    v_exp_f32 v67, v67
    v_mfma_f32_16x16x32_bf16 v[100:103], a[144:147], v[116:119], v[100:103]
    ds_read_b128 a[172:175], v23 offset:45056
    v_cvt_pk_bf16_f32 v161, v66, v67
    v_mfma_f32_16x16x32_bf16 v[104:107], a[144:147], v[120:123], v[232:235]
    buffer_load_dwordx4 v18, s[48:51], s85 offen offset:2048 nt lds
    v_mfma_f32_16x16x32_bf16 v[104:107], a[148:151], v[152:155], v[104:107]
    v_exp_f32 v80, v80
    v_mfma_f32_16x16x32_bf16 v[104:107], a[152:155], v[184:187], v[104:107]
    ds_read_b64_tr_b16 a[192:193], v26 offset:16384
    v_mfma_f32_16x16x32_bf16 v[104:107], a[156:159], v[216:219], v[104:107]
    v_exp_f32 v81, v81
    v_mfma_f32_16x16x32_bf16 v[108:111], a[156:159], v[220:223], v[236:239]
    ds_read_b64_tr_b16 a[194:195], v26 offset:20480
    v_cvt_pk_bf16_f32 v162, v80, v81
    v_mfma_f32_16x16x32_bf16 v[108:111], a[152:155], v[188:191], v[108:111]
    v_exp_f32 v82, v82
    v_mfma_f32_16x16x32_bf16 v[108:111], a[148:151], v[156:159], v[108:111]
    ds_read_b64_tr_b16 a[196:197], v26 offset:24576
    v_mfma_f32_16x16x32_bf16 v[108:111], a[144:147], v[124:127], v[108:111]
    s_waitcnt lgkmcnt(13)
    v_exp_f32 v83, v83
    v_mfma_f32_16x16x32_bf16 a[0:3], a[176:179], v[240:243], a[0:3]
    s_waitcnt lgkmcnt(11)
    ds_read_b64_tr_b16 a[198:199], v26 offset:28672
    v_cvt_pk_bf16_f32 v163, v82, v83
    v_mfma_f32_16x16x32_bf16 a[0:3], a[180:183], v[32:35], a[0:3]
    v_exp_f32 v68, v68
    v_mfma_f32_16x16x32_bf16 a[32:35], a[180:183], v[36:39], a[32:35]
    ds_read_b64_tr_b16 a[200:201], v27 offset:16384
    v_mfma_f32_16x16x32_bf16 a[32:35], a[176:179], v[244:247], a[32:35]
    v_exp_f32 v69, v69
    v_mfma_f32_16x16x32_bf16 a[64:67], a[176:179], v[248:251], a[64:67]
    ds_read_b64_tr_b16 a[202:203], v27 offset:20480
    v_cvt_pk_bf16_f32 v164, v68, v69
    v_mfma_f32_16x16x32_bf16 a[64:67], a[180:183], v[48:51], a[64:67]
    v_exp_f32 v70, v70
    v_mfma_f32_16x16x32_bf16 a[96:99], a[180:183], v[52:55], a[96:99]
    ds_read_b64_tr_b16 a[204:205], v27 offset:24576
    v_mfma_f32_16x16x32_bf16 a[96:99], a[176:179], v[252:255], a[96:99]
    s_waitcnt lgkmcnt(13)
    v_exp_f32 v71, v71
    v_mfma_f32_16x16x32_bf16 a[4:7], a[184:187], v[240:243], a[4:7]
    s_waitcnt lgkmcnt(11)
    ds_read_b64_tr_b16 a[206:207], v27 offset:28672
    v_cvt_pk_bf16_f32 v165, v70, v71
    v_mfma_f32_16x16x32_bf16 a[4:7], a[188:191], v[32:35], a[4:7]
    buffer_load_dwordx4 v19, s[48:51], s85 offen offset:3072 nt lds
    v_mfma_f32_16x16x32_bf16 a[36:39], a[188:191], v[36:39], a[36:39]
    v_exp_f32 v84, v84
    v_mfma_f32_16x16x32_bf16 a[36:39], a[184:187], v[244:247], a[36:39]
    v_mfma_f32_16x16x32_bf16 a[68:71], a[184:187], v[248:251], a[68:71]
    v_exp_f32 v85, v85
    v_mfma_f32_16x16x32_bf16 a[68:71], a[188:191], v[48:51], a[68:71]
    s_add_u32 s84, s84, 16384
    v_cvt_pk_bf16_f32 v166, v84, v85
    v_mfma_f32_16x16x32_bf16 a[100:103], a[188:191], v[52:55], a[100:103]
    s_waitcnt vmcnt(9)
    v_exp_f32 v86, v86
    v_mfma_f32_16x16x32_bf16 a[100:103], a[184:187], v[252:255], a[100:103]
    s_barrier
    v_mfma_f32_16x16x32_bf16 a[128:131], a[208:211], v[240:243], a[128:131]
    s_add_u32 s85, s85, 16384
    v_exp_f32 v87, v87
    v_mfma_f32_16x16x32_bf16 a[128:131], a[208:211], v[32:35], a[128:131]
    s_waitcnt lgkmcnt(11)
    ds_read_b128 a[144:147], v20 offset:49152
    v_cvt_pk_bf16_f32 v167, v86, v87
    v_mfma_f32_16x16x32_bf16 v[128:131], a[160:163], v[112:115], v[224:227]
    s_waitcnt lgkmcnt(11)
    v_exp_f32 v72, v72
    v_mfma_f32_16x16x32_bf16 v[128:131], a[164:167], v[144:147], v[128:131]
    s_waitcnt lgkmcnt(10)
    ds_read_b128 a[148:151], v21 offset:49152
    v_mfma_f32_16x16x32_bf16 v[128:131], a[168:171], v[176:179], v[128:131]
    s_waitcnt lgkmcnt(10)
    v_exp_f32 v73, v73
    v_mfma_f32_16x16x32_bf16 v[128:131], a[172:175], v[208:211], v[128:131]
    ds_read_b128 a[152:155], v22 offset:49152
    v_cvt_pk_bf16_f32 v168, v72, v73
    v_mfma_f32_16x16x32_bf16 v[132:135], a[172:175], v[212:215], v[228:231]
    v_exp_f32 v74, v74
    v_mfma_f32_16x16x32_bf16 v[132:135], a[168:171], v[180:183], v[132:135]
    ds_read_b128 a[156:159], v23 offset:49152
    v_mfma_f32_16x16x32_bf16 v[132:135], a[164:167], v[148:151], v[132:135]
    v_exp_f32 v75, v75
    v_mfma_f32_16x16x32_bf16 v[132:135], a[160:163], v[116:119], v[132:135]
    s_add_u32 m0, s83, 20480
    ds_read_b64_tr_b16 a[176:177], v28 offset:16384
    v_cvt_pk_bf16_f32 v169, v74, v75
    v_mfma_f32_16x16x32_bf16 v[136:139], a[160:163], v[120:123], v[232:235]
    buffer_load_dwordx4 v14, s[44:47], s84 offen offset:0 nt lds
    v_mfma_f32_16x16x32_bf16 v[136:139], a[164:167], v[152:155], v[136:139]
    v_exp_f32 v88, v88
    v_mfma_f32_16x16x32_bf16 v[136:139], a[168:171], v[184:187], v[136:139]
    ds_read_b64_tr_b16 a[178:179], v28 offset:20480
    v_mfma_f32_16x16x32_bf16 v[136:139], a[172:175], v[216:219], v[136:139]
    v_exp_f32 v89, v89
    v_mfma_f32_16x16x32_bf16 v[140:143], a[172:175], v[220:223], v[236:239]
    ds_read_b64_tr_b16 a[180:181], v28 offset:24576
    v_cvt_pk_bf16_f32 v170, v88, v89
    v_mfma_f32_16x16x32_bf16 v[140:143], a[168:171], v[188:191], v[140:143]
    v_exp_f32 v90, v90
    v_mfma_f32_16x16x32_bf16 v[140:143], a[164:167], v[156:159], v[140:143]
    ds_read_b64_tr_b16 a[182:183], v28 offset:28672
    v_mfma_f32_16x16x32_bf16 v[140:143], a[160:163], v[124:127], v[140:143]
    s_waitcnt lgkmcnt(14)
    v_exp_f32 v91, v91
    v_mfma_f32_16x16x32_bf16 a[8:11], a[192:195], v[240:243], a[8:11]
    s_waitcnt lgkmcnt(12)
    ds_read_b64_tr_b16 a[184:185], v29 offset:16384
    v_cvt_pk_bf16_f32 v171, v90, v91
    v_mfma_f32_16x16x32_bf16 a[8:11], a[196:199], v[32:35], a[8:11]
    v_exp_f32 v76, v76
    v_mfma_f32_16x16x32_bf16 a[40:43], a[196:199], v[36:39], a[40:43]
    ds_read_b64_tr_b16 a[186:187], v29 offset:20480
    v_mfma_f32_16x16x32_bf16 a[40:43], a[192:195], v[244:247], a[40:43]
    v_exp_f32 v77, v77
    v_mfma_f32_16x16x32_bf16 a[72:75], a[192:195], v[248:251], a[72:75]
    ds_read_b64_tr_b16 a[188:189], v29 offset:24576
    v_cvt_pk_bf16_f32 v172, v76, v77
    v_mfma_f32_16x16x32_bf16 a[72:75], a[196:199], v[48:51], a[72:75]
    v_exp_f32 v78, v78
    v_mfma_f32_16x16x32_bf16 a[104:107], a[196:199], v[52:55], a[104:107]
    ds_read_b64_tr_b16 a[190:191], v29 offset:28672
    v_mfma_f32_16x16x32_bf16 a[104:107], a[192:195], v[252:255], a[104:107]
    s_waitcnt lgkmcnt(14)
    v_exp_f32 v79, v79
    v_mfma_f32_16x16x32_bf16 a[12:15], a[200:203], v[240:243], a[12:15]
    s_waitcnt lgkmcnt(12)
    v_cvt_pk_bf16_f32 v173, v78, v79
    v_mfma_f32_16x16x32_bf16 a[12:15], a[204:207], v[32:35], a[12:15]
    buffer_load_dwordx4 v15, s[44:47], s84 offen offset:1024 nt lds
    v_mfma_f32_16x16x32_bf16 a[44:47], a[204:207], v[36:39], a[44:47]
    v_exp_f32 v92, v92
    v_mfma_f32_16x16x32_bf16 a[44:47], a[200:203], v[244:247], a[44:47]
    v_mfma_f32_16x16x32_bf16 a[76:79], a[200:203], v[248:251], a[76:79]
    v_exp_f32 v93, v93
    v_mfma_f32_16x16x32_bf16 a[76:79], a[204:207], v[48:51], a[76:79]
    v_cvt_pk_bf16_f32 v174, v92, v93
    v_mfma_f32_16x16x32_bf16 a[108:111], a[204:207], v[52:55], a[108:111]
    v_exp_f32 v94, v94
    v_mfma_f32_16x16x32_bf16 a[108:111], a[200:203], v[252:255], a[108:111]
    v_mfma_f32_16x16x32_bf16 a[132:135], a[208:211], v[36:39], a[132:135]
    v_exp_f32 v95, v95
    v_mfma_f32_16x16x32_bf16 a[132:135], a[208:211], v[244:247], a[132:135]
    v_cvt_pk_bf16_f32 v175, v94, v95
    s_waitcnt lgkmcnt(11)
    v_mfma_f32_16x16x32_bf16 v[64:67], a[144:147], v[112:115], v[224:227]
    s_waitcnt lgkmcnt(10)
    v_exp_f32 v96, v96
    v_mfma_f32_16x16x32_bf16 v[64:67], a[148:151], v[144:147], v[64:67]
    s_waitcnt vmcnt(6)
    v_exp_f32 v97, v97
    v_cmp_ne_u32 vcc, s22, v44
    s_nop 0
    s_cbranch_vccnz Lspin_g
Lret_g:
    s_waitcnt lgkmcnt(9)
    v_mfma_f32_16x16x32_bf16 v[64:67], a[152:155], v[176:179], v[64:67]
    s_waitcnt lgkmcnt(8)
    ds_read_b128 a[160:163], v20 offset:53248
    v_cvt_pk_bf16_f32 v192, v96, v97
    v_mfma_f32_16x16x32_bf16 v[64:67], a[156:159], v[208:211], v[64:67]
    v_exp_f32 v98, v98
    v_mfma_f32_16x16x32_bf16 v[68:71], a[156:159], v[212:215], v[228:231]
    ds_read_b128 a[164:167], v21 offset:53248
    v_mfma_f32_16x16x32_bf16 v[68:71], a[152:155], v[180:183], v[68:71]
    v_exp_f32 v99, v99
    v_mfma_f32_16x16x32_bf16 v[68:71], a[148:151], v[148:151], v[68:71]
    ds_read_b128 a[168:171], v22 offset:53248
    v_cvt_pk_bf16_f32 v193, v98, v99
    v_mfma_f32_16x16x32_bf16 v[68:71], a[144:147], v[116:119], v[68:71]
    buffer_load_dwordx4 v16, s[44:47], s84 offen offset:2048 nt lds
    v_mfma_f32_16x16x32_bf16 v[72:75], a[144:147], v[120:123], v[232:235]
    v_exp_f32 v128, v128
    v_mfma_f32_16x16x32_bf16 v[72:75], a[148:151], v[152:155], v[72:75]
    ds_read_b128 a[172:175], v23 offset:53248
    v_mfma_f32_16x16x32_bf16 v[72:75], a[152:155], v[184:187], v[72:75]
    v_exp_f32 v129, v129
    v_mfma_f32_16x16x32_bf16 v[72:75], a[156:159], v[216:219], v[72:75]
    ds_read_b64_tr_b16 a[192:193], v30 offset:16384
    v_cvt_pk_bf16_f32 v194, v128, v129
    v_mfma_f32_16x16x32_bf16 v[76:79], a[156:159], v[220:223], v[236:239]
    v_exp_f32 v130, v130
    v_mfma_f32_16x16x32_bf16 v[76:79], a[152:155], v[188:191], v[76:79]
    ds_read_b64_tr_b16 a[194:195], v30 offset:20480
    v_mfma_f32_16x16x32_bf16 v[76:79], a[148:151], v[156:159], v[76:79]
    v_exp_f32 v131, v131
    v_mfma_f32_16x16x32_bf16 v[76:79], a[144:147], v[124:127], v[76:79]
    s_waitcnt lgkmcnt(12)
    ds_read_b64_tr_b16 a[196:197], v30 offset:24576
    v_cvt_pk_bf16_f32 v195, v130, v131
    v_mfma_f32_16x16x32_bf16 a[16:19], a[176:179], v[240:243], a[16:19]
    s_waitcnt lgkmcnt(11)
    v_exp_f32 v100, v100
    v_mfma_f32_16x16x32_bf16 a[16:19], a[180:183], v[32:35], a[16:19]
    ds_read_b64_tr_b16 a[198:199], v30 offset:28672
    v_mfma_f32_16x16x32_bf16 a[48:51], a[180:183], v[36:39], a[48:51]
    buffer_load_dwordx4 v17, s[44:47], s84 offen offset:3072 nt lds
    v_mfma_f32_16x16x32_bf16 a[48:51], a[176:179], v[244:247], a[48:51]
    v_exp_f32 v101, v101
    v_mfma_f32_16x16x32_bf16 a[80:83], a[176:179], v[248:251], a[80:83]
    ds_read_b64_tr_b16 a[200:201], v31 offset:16384
    v_cvt_pk_bf16_f32 v196, v100, v101
    v_mfma_f32_16x16x32_bf16 a[80:83], a[180:183], v[48:51], a[80:83]
    v_exp_f32 v102, v102
    v_mfma_f32_16x16x32_bf16 a[112:115], a[180:183], v[52:55], a[112:115]
    ds_read_b64_tr_b16 a[202:203], v31 offset:20480
    v_mfma_f32_16x16x32_bf16 a[112:115], a[176:179], v[252:255], a[112:115]
    s_waitcnt lgkmcnt(12)
    v_exp_f32 v103, v103
    v_mfma_f32_16x16x32_bf16 a[20:23], a[184:187], v[240:243], a[20:23]
    s_waitcnt lgkmcnt(10)
    ds_read_b64_tr_b16 a[204:205], v31 offset:24576
    v_cvt_pk_bf16_f32 v197, v102, v103
    v_mfma_f32_16x16x32_bf16 a[20:23], a[188:191], v[32:35], a[20:23]
    v_exp_f32 v132, v132
    v_mfma_f32_16x16x32_bf16 a[52:55], a[188:191], v[36:39], a[52:55]
    ds_read_b64_tr_b16 a[206:207], v31 offset:28672
    v_mfma_f32_16x16x32_bf16 a[52:55], a[184:187], v[244:247], a[52:55]
    buffer_load_dwordx4 a[212:215], v60, s[64:67], s26 offen sc1 nt
    v_mfma_f32_16x16x32_bf16 a[84:87], a[184:187], v[248:251], a[84:87]
    v_exp_f32 v133, v133
    v_mfma_f32_16x16x32_bf16 a[84:87], a[188:191], v[48:51], a[84:87]
    v_cvt_pk_bf16_f32 v198, v132, v133
    v_mfma_f32_16x16x32_bf16 a[116:119], a[188:191], v[52:55], a[116:119]
    v_exp_f32 v134, v134
    v_mfma_f32_16x16x32_bf16 a[116:119], a[184:187], v[252:255], a[116:119]
    v_mfma_f32_16x16x32_bf16 a[136:139], a[208:211], v[248:251], a[136:139]
    v_exp_f32 v135, v135
    v_mfma_f32_16x16x32_bf16 a[136:139], a[208:211], v[48:51], a[136:139]
    s_waitcnt lgkmcnt(11)
    ds_read_b128 a[144:147], v20 offset:57344
    v_cvt_pk_bf16_f32 v199, v134, v135
    v_mfma_f32_16x16x32_bf16 v[80:83], a[160:163], v[112:115], v[224:227]
    s_waitcnt lgkmcnt(11)
    v_exp_f32 v104, v104
    v_mfma_f32_16x16x32_bf16 v[80:83], a[164:167], v[144:147], v[80:83]
    s_waitcnt lgkmcnt(10)
    v_exp_f32 v105, v105
    v_mfma_f32_16x16x32_bf16 v[80:83], a[168:171], v[176:179], v[80:83]
    s_waitcnt lgkmcnt(9)
    ds_read_b128 a[148:151], v21 offset:57344
    v_cvt_pk_bf16_f32 v200, v104, v105
    v_mfma_f32_16x16x32_bf16 v[80:83], a[172:175], v[208:211], v[80:83]
    v_exp_f32 v106, v106
    v_mfma_f32_16x16x32_bf16 v[84:87], a[172:175], v[212:215], v[228:231]
    ds_read_b128 a[152:155], v22 offset:57344
    v_mfma_f32_16x16x32_bf16 v[84:87], a[168:171], v[180:183], v[84:87]
    v_exp_f32 v107, v107
    v_mfma_f32_16x16x32_bf16 v[84:87], a[164:167], v[148:151], v[84:87]
    ds_read_b128 a[156:159], v23 offset:57344
    v_cvt_pk_bf16_f32 v201, v106, v107
    v_mfma_f32_16x16x32_bf16 v[84:87], a[160:163], v[116:119], v[84:87]
    buffer_load_dwordx4 a[216:219], v61, s[64:67], s26 offen sc1 nt
    v_mfma_f32_16x16x32_bf16 v[88:91], a[160:163], v[120:123], v[232:235]
    v_exp_f32 v136, v136
    v_mfma_f32_16x16x32_bf16 v[88:91], a[164:167], v[152:155], v[88:91]
    ds_read_b64_tr_b16 a[176:177], v24 offset:32768
    v_mfma_f32_16x16x32_bf16 v[88:91], a[168:171], v[184:187], v[88:91]
    v_exp_f32 v137, v137
    v_mfma_f32_16x16x32_bf16 v[88:91], a[172:175], v[216:219], v[88:91]
    ds_read_b64_tr_b16 a[178:179], v24 offset:36864
    v_cvt_pk_bf16_f32 v202, v136, v137
    v_mfma_f32_16x16x32_bf16 v[92:95], a[172:175], v[220:223], v[236:239]
    v_exp_f32 v138, v138
    v_mfma_f32_16x16x32_bf16 v[92:95], a[168:171], v[188:191], v[92:95]
    ds_read_b64_tr_b16 a[180:181], v24 offset:40960
    v_mfma_f32_16x16x32_bf16 v[92:95], a[164:167], v[156:159], v[92:95]
    v_exp_f32 v139, v139
    v_mfma_f32_16x16x32_bf16 v[92:95], a[160:163], v[124:127], v[92:95]
    s_waitcnt lgkmcnt(13)
    ds_read_b64_tr_b16 a[182:183], v24 offset:45056
    v_cvt_pk_bf16_f32 v203, v138, v139
    v_mfma_f32_16x16x32_bf16 a[24:27], a[192:195], v[240:243], a[24:27]
    s_waitcnt lgkmcnt(12)
    v_exp_f32 v108, v108
    v_mfma_f32_16x16x32_bf16 a[24:27], a[196:199], v[32:35], a[24:27]
    s_add_u32 m0, s83, 71680
    ds_read_b64_tr_b16 a[184:185], v25 offset:32768
    v_mfma_f32_16x16x32_bf16 a[56:59], a[196:199], v[36:39], a[56:59]
    buffer_load_dwordx4 v18, s[48:51], s85 offen offset:0 nt lds
    v_mfma_f32_16x16x32_bf16 a[56:59], a[192:195], v[244:247], a[56:59]
    v_exp_f32 v109, v109
    v_mfma_f32_16x16x32_bf16 a[88:91], a[192:195], v[248:251], a[88:91]
    ds_read_b64_tr_b16 a[186:187], v25 offset:36864
    v_cvt_pk_bf16_f32 v204, v108, v109
    v_mfma_f32_16x16x32_bf16 a[88:91], a[196:199], v[48:51], a[88:91]
    v_exp_f32 v110, v110
    v_mfma_f32_16x16x32_bf16 a[120:123], a[196:199], v[52:55], a[120:123]
    ds_read_b64_tr_b16 a[188:189], v25 offset:40960
    v_mfma_f32_16x16x32_bf16 a[120:123], a[192:195], v[252:255], a[120:123]
    s_waitcnt lgkmcnt(13)
    v_exp_f32 v111, v111
    v_mfma_f32_16x16x32_bf16 a[28:31], a[200:203], v[240:243], a[28:31]
    s_waitcnt lgkmcnt(11)
    ds_read_b64_tr_b16 a[190:191], v25 offset:45056
    v_cvt_pk_bf16_f32 v205, v110, v111
    v_mfma_f32_16x16x32_bf16 a[28:31], a[204:207], v[32:35], a[28:31]
Lpad13:
    s_cbranch_execz Lwalk_done
    v_exp_f32 v140, v140
    v_mfma_f32_16x16x32_bf16 a[60:63], a[204:207], v[36:39], a[60:63]
    v_mfma_f32_16x16x32_bf16 a[60:63], a[200:203], v[244:247], a[60:63]
    buffer_load_dwordx4 v19, s[48:51], s85 offen offset:1024 nt lds
    v_mfma_f32_16x16x32_bf16 a[92:95], a[200:203], v[248:251], a[92:95]
    v_exp_f32 v141, v141
    v_mfma_f32_16x16x32_bf16 a[92:95], a[204:207], v[48:51], a[92:95]
    v_cvt_pk_bf16_f32 v206, v140, v141
    v_mfma_f32_16x16x32_bf16 a[124:127], a[204:207], v[52:55], a[124:127]
    v_exp_f32 v142, v142
    v_mfma_f32_16x16x32_bf16 a[124:127], a[200:203], v[252:255], a[124:127]
    v_mfma_f32_16x16x32_bf16 a[140:143], a[208:211], v[52:55], a[140:143]
    v_exp_f32 v143, v143
    v_mfma_f32_16x16x32_bf16 a[140:143], a[208:211], v[252:255], a[140:143]
    v_cvt_pk_bf16_f32 v207, v142, v143
    s_waitcnt lgkmcnt(11)
    v_mfma_f32_16x16x32_bf16 v[96:99], a[144:147], v[112:115], v[224:227]
    s_waitcnt lgkmcnt(10)
    v_exp_f32 v64, v64
    v_mfma_f32_16x16x32_bf16 v[96:99], a[148:151], v[144:147], v[96:99]
    s_waitcnt lgkmcnt(9)
    v_exp_f32 v65, v65
    v_mfma_f32_16x16x32_bf16 v[96:99], a[152:155], v[176:179], v[96:99]
    s_waitcnt lgkmcnt(8)
    ds_read_b128 a[160:163], v20 offset:61440
    v_cvt_pk_bf16_f32 v240, v64, v65
    v_mfma_f32_16x16x32_bf16 v[96:99], a[156:159], v[208:211], v[96:99]
    v_exp_f32 v66, v66
    v_mfma_f32_16x16x32_bf16 v[100:103], a[156:159], v[212:215], v[228:231]
    ds_read_b128 a[164:167], v21 offset:61440
    v_mfma_f32_16x16x32_bf16 v[100:103], a[152:155], v[180:183], v[100:103]
    v_exp_f32 v67, v67
    v_mfma_f32_16x16x32_bf16 v[100:103], a[148:151], v[148:151], v[100:103]
    ds_read_b128 a[168:171], v22 offset:61440
    v_cvt_pk_bf16_f32 v241, v66, v67
    v_mfma_f32_16x16x32_bf16 v[100:103], a[144:147], v[116:119], v[100:103]
    buffer_load_dwordx4 v18, s[48:51], s85 offen offset:2048 nt lds
    v_mfma_f32_16x16x32_bf16 v[104:107], a[144:147], v[120:123], v[232:235]
    v_exp_f32 v80, v80
    v_mfma_f32_16x16x32_bf16 v[104:107], a[148:151], v[152:155], v[104:107]
    ds_read_b128 a[172:175], v23 offset:61440
    v_mfma_f32_16x16x32_bf16 v[104:107], a[152:155], v[184:187], v[104:107]
    v_exp_f32 v81, v81
    v_mfma_f32_16x16x32_bf16 v[104:107], a[156:159], v[216:219], v[104:107]
    ds_read_b64_tr_b16 a[192:193], v26 offset:32768
    v_cvt_pk_bf16_f32 v242, v80, v81
    v_mfma_f32_16x16x32_bf16 v[108:111], a[156:159], v[220:223], v[236:239]
    v_exp_f32 v82, v82
    v_mfma_f32_16x16x32_bf16 v[108:111], a[152:155], v[188:191], v[108:111]
    ds_read_b64_tr_b16 a[194:195], v26 offset:36864
    v_mfma_f32_16x16x32_bf16 v[108:111], a[148:151], v[156:159], v[108:111]
    v_exp_f32 v83, v83
    v_mfma_f32_16x16x32_bf16 v[108:111], a[144:147], v[124:127], v[108:111]
    s_waitcnt lgkmcnt(12)
    ds_read_b64_tr_b16 a[196:197], v26 offset:40960
    v_cvt_pk_bf16_f32 v243, v82, v83
    v_mfma_f32_16x16x32_bf16 a[0:3], a[176:179], v[160:163], a[0:3]
    s_waitcnt lgkmcnt(11)
    v_exp_f32 v68, v68
    v_mfma_f32_16x16x32_bf16 a[0:3], a[180:183], v[192:195], a[0:3]
    ds_read_b64_tr_b16 a[198:199], v26 offset:45056
    v_mfma_f32_16x16x32_bf16 a[32:35], a[180:183], v[196:199], a[32:35]
    buffer_load_dwordx4 v19, s[48:51], s85 offen offset:3072 nt lds
    v_mfma_f32_16x16x32_bf16 a[32:35], a[176:179], v[164:167], a[32:35]
    v_exp_f32 v69, v69
    v_mfma_f32_16x16x32_bf16 a[64:67], a[176:179], v[168:171], a[64:67]
    ds_read_b64_tr_b16 a[200:201], v27 offset:32768
    v_cvt_pk_bf16_f32 v244, v68, v69
    v_mfma_f32_16x16x32_bf16 a[64:67], a[180:183], v[200:203], a[64:67]
    v_exp_f32 v70, v70
    v_mfma_f32_16x16x32_bf16 a[96:99], a[180:183], v[204:207], a[96:99]
    ds_read_b64_tr_b16 a[202:203], v27 offset:36864
    v_mfma_f32_16x16x32_bf16 a[96:99], a[176:179], v[172:175], a[96:99]
    s_waitcnt lgkmcnt(12)
    v_exp_f32 v71, v71
    v_mfma_f32_16x16x32_bf16 a[4:7], a[184:187], v[160:163], a[4:7]
    s_waitcnt lgkmcnt(10)
    ds_read_b64_tr_b16 a[204:205], v27 offset:40960
    v_cvt_pk_bf16_f32 v245, v70, v71
    v_mfma_f32_16x16x32_bf16 a[4:7], a[188:191], v[192:195], a[4:7]
    v_exp_f32 v84, v84
    v_mfma_f32_16x16x32_bf16 a[36:39], a[188:191], v[196:199], a[36:39]
    ds_read_b64_tr_b16 a[206:207], v27 offset:45056
    v_mfma_f32_16x16x32_bf16 a[36:39], a[184:187], v[164:167], a[36:39]
    buffer_load_dwordx4 a[220:223], v62, s[64:67], s26 offen sc1 nt
    v_mfma_f32_16x16x32_bf16 a[68:71], a[184:187], v[168:171], a[68:71]
    v_exp_f32 v85, v85
    v_mfma_f32_16x16x32_bf16 a[68:71], a[188:191], v[200:203], a[68:71]
    s_add_u32 s84, s84, 16384
    v_cvt_pk_bf16_f32 v246, v84, v85
    v_mfma_f32_16x16x32_bf16 a[100:103], a[188:191], v[204:207], a[100:103]
    s_waitcnt vmcnt(11)
    v_exp_f32 v86, v86
    v_mfma_f32_16x16x32_bf16 a[100:103], a[184:187], v[172:175], a[100:103]
    s_barrier
    v_mfma_f32_16x16x32_bf16 a[128:131], a[208:211], v[160:163], a[128:131]
    s_add_u32 s85, s85, 16384
    v_exp_f32 v87, v87
    v_mfma_f32_16x16x32_bf16 a[128:131], a[208:211], v[192:195], a[128:131]
    s_waitcnt lgkmcnt(11)
    ds_read_b128 a[144:147], v20 offset:0
    v_cvt_pk_bf16_f32 v247, v86, v87
    v_mfma_f32_16x16x32_bf16 v[128:131], a[160:163], v[112:115], v[224:227]
    s_waitcnt lgkmcnt(11)
    v_exp_f32 v72, v72
    v_mfma_f32_16x16x32_bf16 v[128:131], a[164:167], v[144:147], v[128:131]
    s_waitcnt lgkmcnt(10)
    ds_read_b128 a[148:151], v21 offset:0
    v_mfma_f32_16x16x32_bf16 v[128:131], a[168:171], v[176:179], v[128:131]
    s_waitcnt lgkmcnt(10)
    v_exp_f32 v73, v73
    v_mfma_f32_16x16x32_bf16 v[128:131], a[172:175], v[208:211], v[128:131]
    ds_read_b128 a[152:155], v22 offset:0
    v_cvt_pk_bf16_f32 v248, v72, v73
    v_mfma_f32_16x16x32_bf16 v[132:135], a[172:175], v[212:215], v[228:231]
    v_exp_f32 v74, v74
    v_mfma_f32_16x16x32_bf16 v[132:135], a[168:171], v[180:183], v[132:135]
    ds_read_b128 a[156:159], v23 offset:0
    v_mfma_f32_16x16x32_bf16 v[132:135], a[164:167], v[148:151], v[132:135]
    s_add_u32 s26, s26, 9216
    v_exp_f32 v75, v75
    v_mfma_f32_16x16x32_bf16 v[132:135], a[160:163], v[116:119], v[132:135]
    s_add_u32 m0, s83, 36864
    ds_read_b64_tr_b16 a[176:177], v28 offset:32768
    v_cvt_pk_bf16_f32 v249, v74, v75
    v_mfma_f32_16x16x32_bf16 v[136:139], a[160:163], v[120:123], v[232:235]
    buffer_load_dwordx4 v14, s[44:47], s84 offen offset:0 nt lds
    v_mfma_f32_16x16x32_bf16 v[136:139], a[164:167], v[152:155], v[136:139]
    v_exp_f32 v88, v88
    v_mfma_f32_16x16x32_bf16 v[136:139], a[168:171], v[184:187], v[136:139]
    ds_read_b64_tr_b16 a[178:179], v28 offset:36864
    v_mfma_f32_16x16x32_bf16 v[136:139], a[172:175], v[216:219], v[136:139]
    v_exp_f32 v89, v89
    v_mfma_f32_16x16x32_bf16 v[140:143], a[172:175], v[220:223], v[236:239]
    ds_read_b64_tr_b16 a[180:181], v28 offset:40960
    v_cvt_pk_bf16_f32 v250, v88, v89
    v_mfma_f32_16x16x32_bf16 v[140:143], a[168:171], v[188:191], v[140:143]
    v_exp_f32 v90, v90
    v_mfma_f32_16x16x32_bf16 v[140:143], a[164:167], v[156:159], v[140:143]
    ds_read_b64_tr_b16 a[182:183], v28 offset:45056
    v_mfma_f32_16x16x32_bf16 v[140:143], a[160:163], v[124:127], v[140:143]
    s_waitcnt lgkmcnt(14)
    v_exp_f32 v91, v91
    v_mfma_f32_16x16x32_bf16 a[8:11], a[192:195], v[160:163], a[8:11]
    s_waitcnt lgkmcnt(12)
    ds_read_b64_tr_b16 a[184:185], v29 offset:32768
    v_cvt_pk_bf16_f32 v251, v90, v91
    v_mfma_f32_16x16x32_bf16 a[8:11], a[196:199], v[192:195], a[8:11]
    v_exp_f32 v76, v76
    v_mfma_f32_16x16x32_bf16 a[40:43], a[196:199], v[196:199], a[40:43]
    ds_read_b64_tr_b16 a[186:187], v29 offset:36864
    v_mfma_f32_16x16x32_bf16 a[40:43], a[192:195], v[164:167], a[40:43]
    v_exp_f32 v77, v77
    v_mfma_f32_16x16x32_bf16 a[72:75], a[192:195], v[168:171], a[72:75]
    ds_read_b64_tr_b16 a[188:189], v29 offset:40960
    v_cvt_pk_bf16_f32 v252, v76, v77
    v_mfma_f32_16x16x32_bf16 a[72:75], a[196:199], v[200:203], a[72:75]
    v_exp_f32 v78, v78
    v_mfma_f32_16x16x32_bf16 a[104:107], a[196:199], v[204:207], a[104:107]
    ds_read_b64_tr_b16 a[190:191], v29 offset:45056
    v_mfma_f32_16x16x32_bf16 a[104:107], a[192:195], v[172:175], a[104:107]
    s_waitcnt lgkmcnt(14)
    v_exp_f32 v79, v79
    v_mfma_f32_16x16x32_bf16 a[12:15], a[200:203], v[160:163], a[12:15]
    s_waitcnt lgkmcnt(12)
    v_cvt_pk_bf16_f32 v253, v78, v79
    v_mfma_f32_16x16x32_bf16 a[12:15], a[204:207], v[192:195], a[12:15]
    buffer_load_dwordx4 v15, s[44:47], s84 offen offset:1024 nt lds
    v_mfma_f32_16x16x32_bf16 a[44:47], a[204:207], v[196:199], a[44:47]
    v_exp_f32 v92, v92
    v_mfma_f32_16x16x32_bf16 a[44:47], a[200:203], v[164:167], a[44:47]
    v_mfma_f32_16x16x32_bf16 a[76:79], a[200:203], v[168:171], a[76:79]
    v_exp_f32 v93, v93
    v_mfma_f32_16x16x32_bf16 a[76:79], a[204:207], v[200:203], a[76:79]
    v_cvt_pk_bf16_f32 v254, v92, v93
    v_mfma_f32_16x16x32_bf16 a[108:111], a[204:207], v[204:207], a[108:111]
    v_exp_f32 v94, v94
    v_mfma_f32_16x16x32_bf16 a[108:111], a[200:203], v[172:175], a[108:111]
    v_mfma_f32_16x16x32_bf16 a[132:135], a[208:211], v[196:199], a[132:135]
    v_exp_f32 v95, v95
    v_mfma_f32_16x16x32_bf16 a[132:135], a[208:211], v[164:167], a[132:135]
    v_cvt_pk_bf16_f32 v255, v94, v95
    s_waitcnt lgkmcnt(11)
    v_mfma_f32_16x16x32_bf16 v[64:67], a[144:147], v[112:115], v[224:227]
    s_waitcnt lgkmcnt(10)
    v_exp_f32 v96, v96
    v_mfma_f32_16x16x32_bf16 v[64:67], a[148:151], v[144:147], v[64:67]
    s_waitcnt lgkmcnt(9)
    v_exp_f32 v97, v97
    v_mfma_f32_16x16x32_bf16 v[64:67], a[152:155], v[176:179], v[64:67]
    s_waitcnt lgkmcnt(8)
    ds_read_b128 a[160:163], v20 offset:4096
    v_cvt_pk_bf16_f32 v32, v96, v97
    v_mfma_f32_16x16x32_bf16 v[64:67], a[156:159], v[208:211], v[64:67]
    v_exp_f32 v98, v98
    v_mfma_f32_16x16x32_bf16 v[68:71], a[156:159], v[212:215], v[228:231]
    ds_read_b128 a[164:167], v21 offset:4096
    v_mfma_f32_16x16x32_bf16 v[68:71], a[152:155], v[180:183], v[68:71]
    v_exp_f32 v99, v99
    v_mfma_f32_16x16x32_bf16 v[68:71], a[148:151], v[148:151], v[68:71]
    ds_read_b128 a[168:171], v22 offset:4096
    v_cvt_pk_bf16_f32 v33, v98, v99
    v_mfma_f32_16x16x32_bf16 v[68:71], a[144:147], v[116:119], v[68:71]
    buffer_load_dwordx4 v16, s[44:47], s84 offen offset:2048 nt lds
    v_mfma_f32_16x16x32_bf16 v[72:75], a[144:147], v[120:123], v[232:235]
    v_exp_f32 v128, v128
    v_mfma_f32_16x16x32_bf16 v[72:75], a[148:151], v[152:155], v[72:75]
    ds_read_b128 a[172:175], v23 offset:4096
    v_mfma_f32_16x16x32_bf16 v[72:75], a[152:155], v[184:187], v[72:75]
    v_exp_f32 v129, v129
    v_mfma_f32_16x16x32_bf16 v[72:75], a[156:159], v[216:219], v[72:75]
    ds_read_b64_tr_b16 a[192:193], v30 offset:32768
    v_cvt_pk_bf16_f32 v34, v128, v129
    v_mfma_f32_16x16x32_bf16 v[76:79], a[156:159], v[220:223], v[236:239]
    v_exp_f32 v130, v130
    v_mfma_f32_16x16x32_bf16 v[76:79], a[152:155], v[188:191], v[76:79]
    ds_read_b64_tr_b16 a[194:195], v30 offset:36864
    v_mfma_f32_16x16x32_bf16 v[76:79], a[148:151], v[156:159], v[76:79]
    v_exp_f32 v131, v131
    v_mfma_f32_16x16x32_bf16 v[76:79], a[144:147], v[124:127], v[76:79]
    s_waitcnt lgkmcnt(12)
    ds_read_b64_tr_b16 a[196:197], v30 offset:40960
    v_cvt_pk_bf16_f32 v35, v130, v131
    v_mfma_f32_16x16x32_bf16 a[16:19], a[176:179], v[160:163], a[16:19]
    s_waitcnt lgkmcnt(11)
    v_exp_f32 v100, v100
    v_mfma_f32_16x16x32_bf16 a[16:19], a[180:183], v[192:195], a[16:19]
    ds_read_b64_tr_b16 a[198:199], v30 offset:45056
    v_mfma_f32_16x16x32_bf16 a[48:51], a[180:183], v[196:199], a[48:51]
    buffer_load_dwordx4 v17, s[44:47], s84 offen offset:3072 nt lds
    v_mfma_f32_16x16x32_bf16 a[48:51], a[176:179], v[164:167], a[48:51]
    v_exp_f32 v101, v101
    v_mfma_f32_16x16x32_bf16 a[80:83], a[176:179], v[168:171], a[80:83]
    ds_read_b64_tr_b16 a[200:201], v31 offset:32768
    v_cvt_pk_bf16_f32 v36, v100, v101
    v_mfma_f32_16x16x32_bf16 a[80:83], a[180:183], v[200:203], a[80:83]
    v_exp_f32 v102, v102
    v_mfma_f32_16x16x32_bf16 a[112:115], a[180:183], v[204:207], a[112:115]
    ds_read_b64_tr_b16 a[202:203], v31 offset:36864
    v_mfma_f32_16x16x32_bf16 a[112:115], a[176:179], v[172:175], a[112:115]
    s_waitcnt lgkmcnt(12)
    v_exp_f32 v103, v103
    v_mfma_f32_16x16x32_bf16 a[20:23], a[184:187], v[160:163], a[20:23]
    s_waitcnt lgkmcnt(10)
    ds_read_b64_tr_b16 a[204:205], v31 offset:40960
    v_cvt_pk_bf16_f32 v37, v102, v103
    v_mfma_f32_16x16x32_bf16 a[20:23], a[188:191], v[192:195], a[20:23]
    v_exp_f32 v132, v132
    v_mfma_f32_16x16x32_bf16 a[52:55], a[188:191], v[196:199], a[52:55]
    ds_read_b64_tr_b16 a[206:207], v31 offset:45056
    v_mfma_f32_16x16x32_bf16 a[52:55], a[184:187], v[164:167], a[52:55]
    buffer_load_dword v40, v42, s[28:31], s74 offen sc1
    v_mfma_f32_16x16x32_bf16 a[84:87], a[184:187], v[168:171], a[84:87]
    v_exp_f32 v133, v133
    v_mfma_f32_16x16x32_bf16 a[84:87], a[188:191], v[200:203], a[84:87]
    v_cvt_pk_bf16_f32 v38, v132, v133
    v_mfma_f32_16x16x32_bf16 a[116:119], a[188:191], v[204:207], a[116:119]
    v_exp_f32 v134, v134
    v_mfma_f32_16x16x32_bf16 a[116:119], a[184:187], v[172:175], a[116:119]
    v_mfma_f32_16x16x32_bf16 a[136:139], a[208:211], v[168:171], a[136:139]
    v_exp_f32 v135, v135
    v_mfma_f32_16x16x32_bf16 a[136:139], a[208:211], v[200:203], a[136:139]
    s_waitcnt lgkmcnt(11)
    ds_read_b128 a[144:147], v20 offset:8192
    v_cvt_pk_bf16_f32 v39, v134, v135
    v_mfma_f32_16x16x32_bf16 v[80:83], a[160:163], v[112:115], v[224:227]
    s_waitcnt lgkmcnt(11)
    v_exp_f32 v104, v104
    v_mfma_f32_16x16x32_bf16 v[80:83], a[164:167], v[144:147], v[80:83]
    s_waitcnt lgkmcnt(10)
    ds_read_b128 a[148:151], v21 offset:8192
    v_mfma_f32_16x16x32_bf16 v[80:83], a[168:171], v[176:179], v[80:83]
    s_waitcnt lgkmcnt(10)
    v_exp_f32 v105, v105
    v_mfma_f32_16x16x32_bf16 v[80:83], a[172:175], v[208:211], v[80:83]
    ds_read_b128 a[152:155], v22 offset:8192
    v_cvt_pk_bf16_f32 v48, v104, v105
    v_mfma_f32_16x16x32_bf16 v[84:87], a[172:175], v[212:215], v[228:231]
    v_exp_f32 v106, v106
    v_mfma_f32_16x16x32_bf16 v[84:87], a[168:171], v[180:183], v[84:87]
    ds_read_b128 a[156:159], v23 offset:8192
    v_mfma_f32_16x16x32_bf16 v[84:87], a[164:167], v[148:151], v[84:87]
    v_exp_f32 v107, v107
    v_mfma_f32_16x16x32_bf16 v[84:87], a[160:163], v[116:119], v[84:87]
    s_add_u32 m0, s83, 88064
    ds_read_b64_tr_b16 a[176:177], v24 offset:49152
    v_cvt_pk_bf16_f32 v49, v106, v107
    v_mfma_f32_16x16x32_bf16 v[88:91], a[160:163], v[120:123], v[232:235]
    buffer_load_dwordx4 v18, s[48:51], s85 offen offset:0 nt lds
    v_mfma_f32_16x16x32_bf16 v[88:91], a[164:167], v[152:155], v[88:91]
    v_exp_f32 v136, v136
    v_mfma_f32_16x16x32_bf16 v[88:91], a[168:171], v[184:187], v[88:91]
    s_add_u32 s74, s74, 262144
    ds_read_b64_tr_b16 a[178:179], v24 offset:53248
    v_mfma_f32_16x16x32_bf16 v[88:91], a[172:175], v[216:219], v[88:91]
    v_exp_f32 v137, v137
    v_mfma_f32_16x16x32_bf16 v[92:95], a[172:175], v[220:223], v[236:239]
    ds_read_b64_tr_b16 a[180:181], v24 offset:57344
    v_cvt_pk_bf16_f32 v50, v136, v137
    v_mfma_f32_16x16x32_bf16 v[92:95], a[168:171], v[188:191], v[92:95]
    v_exp_f32 v138, v138
    v_mfma_f32_16x16x32_bf16 v[92:95], a[164:167], v[156:159], v[92:95]
    ds_read_b64_tr_b16 a[182:183], v24 offset:61440
    v_mfma_f32_16x16x32_bf16 v[92:95], a[160:163], v[124:127], v[92:95]
    s_waitcnt lgkmcnt(14)
    v_exp_f32 v139, v139
    v_mfma_f32_16x16x32_bf16 a[24:27], a[192:195], v[160:163], a[24:27]
    s_waitcnt lgkmcnt(12)
    ds_read_b64_tr_b16 a[184:185], v25 offset:49152
    v_cvt_pk_bf16_f32 v51, v138, v139
    v_mfma_f32_16x16x32_bf16 a[24:27], a[196:199], v[192:195], a[24:27]
    v_exp_f32 v108, v108
    v_mfma_f32_16x16x32_bf16 a[56:59], a[196:199], v[196:199], a[56:59]
    ds_read_b64_tr_b16 a[186:187], v25 offset:53248
    v_mfma_f32_16x16x32_bf16 a[56:59], a[192:195], v[164:167], a[56:59]
    v_exp_f32 v109, v109
    v_mfma_f32_16x16x32_bf16 a[88:91], a[192:195], v[168:171], a[88:91]
    ds_read_b64_tr_b16 a[188:189], v25 offset:57344
    v_cvt_pk_bf16_f32 v52, v108, v109
    v_mfma_f32_16x16x32_bf16 a[88:91], a[196:199], v[200:203], a[88:91]
    v_exp_f32 v110, v110
    v_mfma_f32_16x16x32_bf16 a[120:123], a[196:199], v[204:207], a[120:123]
    ds_read_b64_tr_b16 a[190:191], v25 offset:61440
    v_mfma_f32_16x16x32_bf16 a[120:123], a[192:195], v[172:175], a[120:123]
    s_waitcnt lgkmcnt(14)
    v_exp_f32 v111, v111
    v_mfma_f32_16x16x32_bf16 a[28:31], a[200:203], v[160:163], a[28:31]
    s_waitcnt lgkmcnt(12)
    v_cvt_pk_bf16_f32 v53, v110, v111
    v_mfma_f32_16x16x32_bf16 a[28:31], a[204:207], v[192:195], a[28:31]
    buffer_load_dwordx4 v19, s[48:51], s85 offen offset:1024 nt lds
    v_mfma_f32_16x16x32_bf16 a[60:63], a[204:207], v[196:199], a[60:63]
    v_exp_f32 v140, v140
    v_mfma_f32_16x16x32_bf16 a[60:63], a[200:203], v[164:167], a[60:63]
    v_mfma_f32_16x16x32_bf16 a[92:95], a[200:203], v[168:171], a[92:95]
    v_exp_f32 v141, v141
    v_mfma_f32_16x16x32_bf16 a[92:95], a[204:207], v[200:203], a[92:95]
    v_cvt_pk_bf16_f32 v54, v140, v141
    v_mfma_f32_16x16x32_bf16 a[124:127], a[204:207], v[204:207], a[124:127]
    v_exp_f32 v142, v142
    v_mfma_f32_16x16x32_bf16 a[124:127], a[200:203], v[172:175], a[124:127]
    v_mfma_f32_16x16x32_bf16 a[140:143], a[208:211], v[204:207], a[140:143]
    v_exp_f32 v143, v143
    v_mfma_f32_16x16x32_bf16 a[140:143], a[208:211], v[172:175], a[140:143]
    v_cvt_pk_bf16_f32 v55, v142, v143
    s_waitcnt lgkmcnt(11)
    v_mfma_f32_16x16x32_bf16 v[96:99], a[144:147], v[112:115], v[224:227]
    s_waitcnt lgkmcnt(10)
    v_exp_f32 v64, v64
    v_mfma_f32_16x16x32_bf16 v[96:99], a[148:151], v[144:147], v[96:99]
    s_waitcnt lgkmcnt(9)
    ds_read_b128 a[160:163], v20 offset:12288
    v_mfma_f32_16x16x32_bf16 v[96:99], a[152:155], v[176:179], v[96:99]
    s_waitcnt lgkmcnt(9)
    v_exp_f32 v65, v65
    v_mfma_f32_16x16x32_bf16 v[96:99], a[156:159], v[208:211], v[96:99]
    ds_read_b128 a[164:167], v21 offset:12288
    v_cvt_pk_bf16_f32 v160, v64, v65
    v_mfma_f32_16x16x32_bf16 v[100:103], a[156:159], v[212:215], v[228:231]
    v_exp_f32 v66, v66
    v_mfma_f32_16x16x32_bf16 v[100:103], a[152:155], v[180:183], v[100:103]
    ds_read_b128 a[168:171], v22 offset:12288
    v_mfma_f32_16x16x32_bf16 v[100:103], a[148:151], v[148:151], v[100:103]
    v_exp_f32 v67, v67
    v_mfma_f32_16x16x32_bf16 v[100:103], a[144:147], v[116:119], v[100:103]
    ds_read_b128 a[172:175], v23 offset:12288
    v_cvt_pk_bf16_f32 v161, v66, v67
    v_mfma_f32_16x16x32_bf16 v[104:107], a[144:147], v[120:123], v[232:235]
    buffer_load_dwordx4 v18, s[48:51], s85 offen offset:2048 nt lds
    v_mfma_f32_16x16x32_bf16 v[104:107], a[148:151], v[152:155], v[104:107]
    v_exp_f32 v80, v80
    v_mfma_f32_16x16x32_bf16 v[104:107], a[152:155], v[184:187], v[104:107]
    ds_read_b64_tr_b16 a[192:193], v26 offset:49152
    v_mfma_f32_16x16x32_bf16 v[104:107], a[156:159], v[216:219], v[104:107]
    v_exp_f32 v81, v81
    v_mfma_f32_16x16x32_bf16 v[108:111], a[156:159], v[220:223], v[236:239]
    ds_read_b64_tr_b16 a[194:195], v26 offset:53248
    v_cvt_pk_bf16_f32 v162, v80, v81
    v_mfma_f32_16x16x32_bf16 v[108:111], a[152:155], v[188:191], v[108:111]
    v_exp_f32 v82, v82
    v_mfma_f32_16x16x32_bf16 v[108:111], a[148:151], v[156:159], v[108:111]
    ds_read_b64_tr_b16 a[196:197], v26 offset:57344
    v_mfma_f32_16x16x32_bf16 v[108:111], a[144:147], v[124:127], v[108:111]
    s_waitcnt lgkmcnt(13)
    v_exp_f32 v83, v83
    v_mfma_f32_16x16x32_bf16 a[0:3], a[176:179], v[240:243], a[0:3]
    s_waitcnt lgkmcnt(11)
    ds_read_b64_tr_b16 a[198:199], v26 offset:61440
    v_cvt_pk_bf16_f32 v163, v82, v83
    v_mfma_f32_16x16x32_bf16 a[0:3], a[180:183], v[32:35], a[0:3]
    v_exp_f32 v68, v68
    v_mfma_f32_16x16x32_bf16 a[32:35], a[180:183], v[36:39], a[32:35]
    ds_read_b64_tr_b16 a[200:201], v27 offset:49152
    v_mfma_f32_16x16x32_bf16 a[32:35], a[176:179], v[244:247], a[32:35]
    v_exp_f32 v69, v69
    v_mfma_f32_16x16x32_bf16 a[64:67], a[176:179], v[248:251], a[64:67]
    ds_read_b64_tr_b16 a[202:203], v27 offset:53248
    v_cvt_pk_bf16_f32 v164, v68, v69
    v_mfma_f32_16x16x32_bf16 a[64:67], a[180:183], v[48:51], a[64:67]
    v_exp_f32 v70, v70
    v_mfma_f32_16x16x32_bf16 a[96:99], a[180:183], v[52:55], a[96:99]
    ds_read_b64_tr_b16 a[204:205], v27 offset:57344
    v_mfma_f32_16x16x32_bf16 a[96:99], a[176:179], v[252:255], a[96:99]
    s_waitcnt lgkmcnt(13)
    v_exp_f32 v71, v71
    v_mfma_f32_16x16x32_bf16 a[4:7], a[184:187], v[240:243], a[4:7]
    s_waitcnt lgkmcnt(11)
    ds_read_b64_tr_b16 a[206:207], v27 offset:61440
    v_cvt_pk_bf16_f32 v165, v70, v71
    v_mfma_f32_16x16x32_bf16 a[4:7], a[188:191], v[32:35], a[4:7]
    buffer_load_dwordx4 v19, s[48:51], s85 offen offset:3072 nt lds
    v_mfma_f32_16x16x32_bf16 a[36:39], a[188:191], v[36:39], a[36:39]
    v_exp_f32 v84, v84
    v_mfma_f32_16x16x32_bf16 a[36:39], a[184:187], v[244:247], a[36:39]
    v_mfma_f32_16x16x32_bf16 a[68:71], a[184:187], v[248:251], a[68:71]
    v_exp_f32 v85, v85
    v_mfma_f32_16x16x32_bf16 a[68:71], a[188:191], v[48:51], a[68:71]
    s_add_u32 s84, s84, 16384
    v_cvt_pk_bf16_f32 v166, v84, v85
    v_mfma_f32_16x16x32_bf16 a[100:103], a[188:191], v[52:55], a[100:103]
    s_waitcnt vmcnt(10)
    v_exp_f32 v86, v86
    v_mfma_f32_16x16x32_bf16 a[100:103], a[184:187], v[252:255], a[100:103]
    s_barrier
    v_mfma_f32_16x16x32_bf16 a[128:131], a[208:211], v[240:243], a[128:131]
    s_add_u32 s85, s85, 16384
    v_exp_f32 v87, v87
    v_mfma_f32_16x16x32_bf16 a[128:131], a[208:211], v[32:35], a[128:131]
    s_waitcnt lgkmcnt(11)
    ds_read_b128 a[144:147], v20 offset:16384
    v_cvt_pk_bf16_f32 v167, v86, v87
    v_mfma_f32_16x16x32_bf16 v[128:131], a[160:163], v[112:115], v[224:227]
    s_waitcnt lgkmcnt(11)
    v_exp_f32 v72, v72
    v_mfma_f32_16x16x32_bf16 v[128:131], a[164:167], v[144:147], v[128:131]
    s_waitcnt lgkmcnt(10)
    ds_read_b128 a[148:151], v21 offset:16384
    v_mfma_f32_16x16x32_bf16 v[128:131], a[168:171], v[176:179], v[128:131]
    s_waitcnt lgkmcnt(10)
    v_exp_f32 v73, v73
    v_mfma_f32_16x16x32_bf16 v[128:131], a[172:175], v[208:211], v[128:131]
    ds_read_b128 a[152:155], v22 offset:16384
    v_cvt_pk_bf16_f32 v168, v72, v73
    v_mfma_f32_16x16x32_bf16 v[132:135], a[172:175], v[212:215], v[228:231]
    v_exp_f32 v74, v74
    v_mfma_f32_16x16x32_bf16 v[132:135], a[168:171], v[180:183], v[132:135]
    ds_read_b128 a[156:159], v23 offset:16384
    v_mfma_f32_16x16x32_bf16 v[132:135], a[164:167], v[148:151], v[132:135]
    v_exp_f32 v75, v75
    v_mfma_f32_16x16x32_bf16 v[132:135], a[160:163], v[116:119], v[132:135]
    s_add_u32 m0, s83, 53248
    ds_read_b64_tr_b16 a[176:177], v28 offset:49152
    v_cvt_pk_bf16_f32 v169, v74, v75
    v_mfma_f32_16x16x32_bf16 v[136:139], a[160:163], v[120:123], v[232:235]
    buffer_load_dwordx4 v14, s[44:47], s84 offen offset:0 nt lds
    v_mfma_f32_16x16x32_bf16 v[136:139], a[164:167], v[152:155], v[136:139]
    v_exp_f32 v88, v88
    v_mfma_f32_16x16x32_bf16 v[136:139], a[168:171], v[184:187], v[136:139]
    ds_read_b64_tr_b16 a[178:179], v28 offset:53248
    v_mfma_f32_16x16x32_bf16 v[136:139], a[172:175], v[216:219], v[136:139]
    v_exp_f32 v89, v89
    v_mfma_f32_16x16x32_bf16 v[140:143], a[172:175], v[220:223], v[236:239]
    ds_read_b64_tr_b16 a[180:181], v28 offset:57344
    v_cvt_pk_bf16_f32 v170, v88, v89
    v_mfma_f32_16x16x32_bf16 v[140:143], a[168:171], v[188:191], v[140:143]
    v_exp_f32 v90, v90
    v_mfma_f32_16x16x32_bf16 v[140:143], a[164:167], v[156:159], v[140:143]
    ds_read_b64_tr_b16 a[182:183], v28 offset:61440
    v_mfma_f32_16x16x32_bf16 v[140:143], a[160:163], v[124:127], v[140:143]
    s_waitcnt lgkmcnt(14)
    v_exp_f32 v91, v91
    v_mfma_f32_16x16x32_bf16 a[8:11], a[192:195], v[240:243], a[8:11]
    s_waitcnt lgkmcnt(12)
    ds_read_b64_tr_b16 a[184:185], v29 offset:49152
    v_cvt_pk_bf16_f32 v171, v90, v91
    v_mfma_f32_16x16x32_bf16 a[8:11], a[196:199], v[32:35], a[8:11]
    v_exp_f32 v76, v76
    v_mfma_f32_16x16x32_bf16 a[40:43], a[196:199], v[36:39], a[40:43]
    ds_read_b64_tr_b16 a[186:187], v29 offset:53248
    v_mfma_f32_16x16x32_bf16 a[40:43], a[192:195], v[244:247], a[40:43]
    v_exp_f32 v77, v77
    v_mfma_f32_16x16x32_bf16 a[72:75], a[192:195], v[248:251], a[72:75]
    ds_read_b64_tr_b16 a[188:189], v29 offset:57344
    v_cvt_pk_bf16_f32 v172, v76, v77
    v_mfma_f32_16x16x32_bf16 a[72:75], a[196:199], v[48:51], a[72:75]
    v_exp_f32 v78, v78
    v_mfma_f32_16x16x32_bf16 a[104:107], a[196:199], v[52:55], a[104:107]
    ds_read_b64_tr_b16 a[190:191], v29 offset:61440
    v_mfma_f32_16x16x32_bf16 a[104:107], a[192:195], v[252:255], a[104:107]
    s_waitcnt lgkmcnt(14)
    v_exp_f32 v79, v79
    v_mfma_f32_16x16x32_bf16 a[12:15], a[200:203], v[240:243], a[12:15]
    s_waitcnt lgkmcnt(12)
    v_cvt_pk_bf16_f32 v173, v78, v79
    v_mfma_f32_16x16x32_bf16 a[12:15], a[204:207], v[32:35], a[12:15]
    buffer_load_dwordx4 v15, s[44:47], s84 offen offset:1024 nt lds
    v_mfma_f32_16x16x32_bf16 a[44:47], a[204:207], v[36:39], a[44:47]
    v_exp_f32 v92, v92
    v_mfma_f32_16x16x32_bf16 a[44:47], a[200:203], v[244:247], a[44:47]
    v_mfma_f32_16x16x32_bf16 a[76:79], a[200:203], v[248:251], a[76:79]
    v_exp_f32 v93, v93
    v_mfma_f32_16x16x32_bf16 a[76:79], a[204:207], v[48:51], a[76:79]
    v_cvt_pk_bf16_f32 v174, v92, v93
    v_mfma_f32_16x16x32_bf16 a[108:111], a[204:207], v[52:55], a[108:111]
    v_exp_f32 v94, v94
    v_mfma_f32_16x16x32_bf16 a[108:111], a[200:203], v[252:255], a[108:111]
    v_mfma_f32_16x16x32_bf16 a[132:135], a[208:211], v[36:39], a[132:135]
    v_exp_f32 v95, v95
    v_mfma_f32_16x16x32_bf16 a[132:135], a[208:211], v[244:247], a[132:135]
    v_cvt_pk_bf16_f32 v175, v94, v95
    s_waitcnt lgkmcnt(11)
    v_mfma_f32_16x16x32_bf16 v[64:67], a[144:147], v[112:115], v[224:227]
    s_waitcnt lgkmcnt(10)
    v_exp_f32 v96, v96
    v_mfma_f32_16x16x32_bf16 v[64:67], a[148:151], v[144:147], v[64:67]
    s_waitcnt lgkmcnt(9)
    ds_read_b128 a[160:163], v20 offset:20480
    v_mfma_f32_16x16x32_bf16 v[64:67], a[152:155], v[176:179], v[64:67]
    s_waitcnt lgkmcnt(9)
    v_exp_f32 v97, v97
    v_mfma_f32_16x16x32_bf16 v[64:67], a[156:159], v[208:211], v[64:67]
    ds_read_b128 a[164:167], v21 offset:20480
    v_cvt_pk_bf16_f32 v192, v96, v97
    v_mfma_f32_16x16x32_bf16 v[68:71], a[156:159], v[212:215], v[228:231]
    v_exp_f32 v98, v98
    v_mfma_f32_16x16x32_bf16 v[68:71], a[152:155], v[180:183], v[68:71]
    ds_read_b128 a[168:171], v22 offset:20480
    v_mfma_f32_16x16x32_bf16 v[68:71], a[148:151], v[148:151], v[68:71]
    v_exp_f32 v99, v99
    v_mfma_f32_16x16x32_bf16 v[68:71], a[144:147], v[116:119], v[68:71]
    ds_read_b128 a[172:175], v23 offset:20480
    v_cvt_pk_bf16_f32 v193, v98, v99
    v_mfma_f32_16x16x32_bf16 v[72:75], a[144:147], v[120:123], v[232:235]
    v_exp_f32 v128, v128
    v_mfma_f32_16x16x32_bf16 v[72:75], a[148:151], v[152:155], v[72:75]
    ds_read_b64_tr_b16 a[192:193], v30 offset:49152
    v_mfma_f32_16x16x32_bf16 v[72:75], a[152:155], v[184:187], v[72:75]
    buffer_load_dwordx4 v16, s[44:47], s84 offen offset:2048 nt lds
    v_mfma_f32_16x16x32_bf16 v[72:75], a[156:159], v[216:219], v[72:75]
    v_exp_f32 v129, v129
    v_mfma_f32_16x16x32_bf16 v[76:79], a[156:159], v[220:223], v[236:239]
    ds_read_b64_tr_b16 a[194:195], v30 offset:53248
    v_cvt_pk_bf16_f32 v194, v128, v129
    v_mfma_f32_16x16x32_bf16 v[76:79], a[152:155], v[188:191], v[76:79]
    ds_read_b64_tr_b16 a[196:197], v30 offset:57344
    v_mfma_f32_16x16x32_bf16 v[76:79], a[148:151], v[156:159], v[76:79]
    v_exp_f32 v130, v130
    v_mfma_f32_16x16x32_bf16 v[76:79], a[144:147], v[124:127], v[76:79]
    ds_read_b64_tr_b16 a[198:199], v30 offset:61440
    v_mfma_f32_16x16x32_bf16 a[224:227], a[252:255], a[212:215], a[224:227]
    v_exp_f32 v131, v131
    v_mfma_f32_16x16x32_bf16 a[228:231], a[250:253], a[212:215], a[228:231]
    ds_read_b64_tr_b16 a[200:201], v31 offset:49152
    v_cvt_pk_bf16_f32 v195, v130, v131
    v_mfma_f32_16x16x32_bf16 a[232:235], a[252:255], a[216:219], a[232:235]
    s_waitcnt lgkmcnt(14)
    v_exp_f32 v100, v100
    v_mfma_f32_16x16x32_bf16 a[16:19], a[176:179], v[240:243], a[16:19]
    s_waitcnt lgkmcnt(13)
    ds_read_b64_tr_b16 a[202:203], v31 offset:53248
    v_mfma_f32_16x16x32_bf16 a[16:19], a[180:183], v[32:35], a[16:19]
    v_exp_f32 v101, v101
    v_mfma_f32_16x16x32_bf16 a[48:51], a[180:183], v[36:39], a[48:51]
    ds_read_b64_tr_b16 a[204:205], v31 offset:57344
    v_cvt_pk_bf16_f32 v196, v100, v101
    v_mfma_f32_16x16x32_bf16 a[48:51], a[176:179], v[244:247], a[48:51]
    v_exp_f32 v102, v102
    v_mfma_f32_16x16x32_bf16 a[80:83], a[176:179], v[248:251], a[80:83]
    ds_read_b64_tr_b16 a[206:207], v31 offset:61440
    v_mfma_f32_16x16x32_bf16 a[80:83], a[180:183], v[48:51], a[80:83]
    v_mfma_f32_16x16x32_bf16 a[112:115], a[180:183], v[52:55], a[112:115]
    v_exp_f32 v103, v103
    v_mfma_f32_16x16x32_bf16 a[112:115], a[176:179], v[252:255], a[112:115]
    s_waitcnt lgkmcnt(14)
    v_cvt_pk_bf16_f32 v197, v102, v103
    v_mfma_f32_16x16x32_bf16 a[20:23], a[184:187], v[240:243], a[20:23]
    s_waitcnt lgkmcnt(12)
    buffer_load_dwordx4 v17, s[44:47], s84 offen offset:3072 nt lds
    v_mfma_f32_16x16x32_bf16 a[20:23], a[188:191], v[32:35], a[20:23]
    v_exp_f32 v132, v132
    v_mfma_f32_16x16x32_bf16 a[52:55], a[188:191], v[36:39], a[52:55]
    v_mfma_f32_16x16x32_bf16 a[52:55], a[184:187], v[244:247], a[52:55]
    v_exp_f32 v133, v133
    v_mfma_f32_16x16x32_bf16 a[84:87], a[184:187], v[248:251], a[84:87]
    v_cvt_pk_bf16_f32 v198, v132, v133
    v_mfma_f32_16x16x32_bf16 a[84:87], a[188:191], v[48:51], a[84:87]
    v_exp_f32 v134, v134
    v_mfma_f32_16x16x32_bf16 a[116:119], a[188:191], v[52:55], a[116:119]
    v_mfma_f32_16x16x32_bf16 a[116:119], a[184:187], v[252:255], a[116:119]
    v_exp_f32 v135, v135
    v_mfma_f32_16x16x32_bf16 a[136:139], a[208:211], v[248:251], a[136:139]
    ds_read_b128 a[144:147], v20 offset:24576
    v_cvt_pk_bf16_f32 v199, v134, v135
    v_mfma_f32_16x16x32_bf16 a[136:139], a[208:211], v[48:51], a[136:139]
    s_waitcnt lgkmcnt(12)
    ds_read_b128 a[148:151], v21 offset:24576
    v_mfma_f32_16x16x32_bf16 v[80:83], a[160:163], v[112:115], v[224:227]
    s_waitcnt lgkmcnt(12)
    v_exp_f32 v104, v104
    v_mfma_f32_16x16x32_bf16 v[80:83], a[164:167], v[144:147], v[80:83]
    s_waitcnt lgkmcnt(11)
    ds_read_b128 a[152:155], v22 offset:24576
    v_mfma_f32_16x16x32_bf16 v[80:83], a[168:171], v[176:179], v[80:83]
    s_waitcnt lgkmcnt(11)
    v_exp_f32 v105, v105
Lpad14:
    s_cbranch_execz Lwalk_done
    v_mfma_f32_16x16x32_bf16 v[80:83], a[172:175], v[208:211], v[80:83]
    ds_read_b128 a[156:159], v23 offset:24576
    v_cvt_pk_bf16_f32 v200, v104, v105
    v_mfma_f32_16x16x32_bf16 v[84:87], a[172:175], v[212:215], v[228:231]
    v_exp_f32 v106, v106
    v_mfma_f32_16x16x32_bf16 v[84:87], a[168:171], v[180:183], v[84:87]
    ds_read_b64_tr_b16 a[176:177], v24 offset:0
    v_mfma_f32_16x16x32_bf16 v[84:87], a[164:167], v[148:151], v[84:87]
    v_exp_f32 v107, v107
    v_mfma_f32_16x16x32_bf16 v[84:87], a[160:163], v[116:119], v[84:87]
    ds_read_b64_tr_b16 a[178:179], v24 offset:4096
    v_cvt_pk_bf16_f32 v201, v106, v107
    v_mfma_f32_16x16x32_bf16 v[88:91], a[160:163], v[120:123], v[232:235]
    v_exp_f32 v136, v136
    v_mfma_f32_16x16x32_bf16 v[88:91], a[164:167], v[152:155], v[88:91]
    s_add_u32 m0, s83, 104448
    ds_read_b64_tr_b16 a[180:181], v24 offset:8192
    v_mfma_f32_16x16x32_bf16 v[88:91], a[168:171], v[184:187], v[88:91]
    buffer_load_dwordx4 v18, s[48:51], s85 offen offset:0 nt lds
    v_mfma_f32_16x16x32_bf16 v[88:91], a[172:175], v[216:219], v[88:91]
    v_exp_f32 v137, v137
    v_mfma_f32_16x16x32_bf16 v[92:95], a[172:175], v[220:223], v[236:239]
    ds_read_b64_tr_b16 a[182:183], v24 offset:12288
    v_cvt_pk_bf16_f32 v202, v136, v137
    v_mfma_f32_16x16x32_bf16 v[92:95], a[168:171], v[188:191], v[92:95]
    ds_read_b64_tr_b16 a[184:185], v25 offset:0
    v_mfma_f32_16x16x32_bf16 v[92:95], a[164:167], v[156:159], v[92:95]
    v_exp_f32 v138, v138
    v_mfma_f32_16x16x32_bf16 v[92:95], a[160:163], v[124:127], v[92:95]
    ds_read_b64_tr_b16 a[186:187], v25 offset:4096
    v_mfma_f32_16x16x32_bf16 a[236:239], a[250:253], a[216:219], a[236:239]
    s_waitcnt vmcnt(14)
    v_exp_f32 v139, v139
    v_mfma_f32_16x16x32_bf16 a[240:243], a[252:255], a[220:223], a[240:243]
    ds_read_b64_tr_b16 a[188:189], v25 offset:8192
    v_cvt_pk_bf16_f32 v203, v138, v139
    v_mfma_f32_16x16x32_bf16 a[244:247], a[250:253], a[220:223], a[244:247]
    s_waitcnt lgkmcnt(14)
    v_exp_f32 v108, v108
    v_mfma_f32_16x16x32_bf16 a[24:27], a[192:195], v[240:243], a[24:27]
    ds_read_b64_tr_b16 a[190:191], v25 offset:12288
    v_mfma_f32_16x16x32_bf16 a[24:27], a[196:199], v[32:35], a[24:27]
    v_exp_f32 v109, v109
    v_mfma_f32_16x16x32_bf16 a[56:59], a[196:199], v[36:39], a[56:59]
    v_cvt_pk_bf16_f32 v204, v108, v109
    v_mfma_f32_16x16x32_bf16 a[56:59], a[192:195], v[244:247], a[56:59]
    v_exp_f32 v110, v110
    v_mfma_f32_16x16x32_bf16 a[88:91], a[192:195], v[248:251], a[88:91]
    v_mfma_f32_16x16x32_bf16 a[88:91], a[196:199], v[48:51], a[88:91]
    v_mfma_f32_16x16x32_bf16 a[120:123], a[196:199], v[52:55], a[120:123]
    v_exp_f32 v111, v111
    v_mfma_f32_16x16x32_bf16 a[120:123], a[192:195], v[252:255], a[120:123]
    s_waitcnt lgkmcnt(14)
    v_cvt_pk_bf16_f32 v205, v110, v111
    v_mfma_f32_16x16x32_bf16 a[28:31], a[200:203], v[240:243], a[28:31]
    s_waitcnt lgkmcnt(12)
    buffer_load_dwordx4 v19, s[48:51], s85 offen offset:1024 nt lds
    v_mfma_f32_16x16x32_bf16 a[28:31], a[204:207], v[32:35], a[28:31]
    v_exp_f32 v140, v140
    v_mfma_f32_16x16x32_bf16 a[60:63], a[204:207], v[36:39], a[60:63]
    v_mfma_f32_16x16x32_bf16 a[60:63], a[200:203], v[244:247], a[60:63]
    v_exp_f32 v141, v141
    v_mfma_f32_16x16x32_bf16 a[92:95], a[200:203], v[248:251], a[92:95]
    s_sub_u32 s86, s86, 1
    v_cvt_pk_bf16_f32 v206, v140, v141
    v_mfma_f32_16x16x32_bf16 a[92:95], a[204:207], v[48:51], a[92:95]
    s_cmp_lg_u32 s86, 0
    v_exp_f32 v142, v142
    v_mfma_f32_16x16x32_bf16 a[124:127], a[204:207], v[52:55], a[124:127]
    v_mfma_f32_16x16x32_bf16 a[124:127], a[200:203], v[252:255], a[124:127]
    v_exp_f32 v143, v143
    v_mfma_f32_16x16x32_bf16 a[140:143], a[208:211], v[52:55], a[140:143]
    v_cvt_pk_bf16_f32 v207, v142, v143
    v_mfma_f32_16x16x32_bf16 a[140:143], a[208:211], v[252:255], a[140:143]
    s_cbranch_scc1 Lloop
    s_waitcnt lgkmcnt(11)
    v_mfma_f32_16x16x32_bf16 v[96:99], a[144:147], v[112:115], v[224:227]
    s_waitcnt lgkmcnt(10)
    v_exp_f32 v64, v64
    v_mfma_f32_16x16x32_bf16 v[96:99], a[148:151], v[144:147], v[96:99]
    s_waitcnt lgkmcnt(9)
    v_exp_f32 v65, v65
    v_mfma_f32_16x16x32_bf16 v[96:99], a[152:155], v[176:179], v[96:99]
    s_waitcnt lgkmcnt(8)
    s_lshl_b32 s76, s69, 5
    ds_read_b128 a[160:163], v20 offset:28672
    v_cvt_pk_bf16_f32 v240, v64, v65
    v_mfma_f32_16x16x32_bf16 v[96:99], a[156:159], v[208:211], v[96:99]
    v_exp_f32 v66, v66
    v_mfma_f32_16x16x32_bf16 v[100:103], a[156:159], v[212:215], v[228:231]
    ds_read_b128 a[164:167], v21 offset:28672
    ds_read_b128 a[168:171], v22 offset:28672
    v_mfma_f32_16x16x32_bf16 v[100:103], a[152:155], v[180:183], v[100:103]
    s_add_u32 s76, s76, s68
    buffer_load_dwordx4 v18, s[48:51], s85 offen offset:2048 nt lds
    v_mfma_f32_16x16x32_bf16 v[100:103], a[148:151], v[148:151], v[100:103]
    v_exp_f32 v67, v67
    v_mfma_f32_16x16x32_bf16 v[100:103], a[144:147], v[116:119], v[100:103]
    ds_read_b128 a[172:175], v23 offset:28672
    v_cvt_pk_bf16_f32 v241, v66, v67
    v_mfma_f32_16x16x32_bf16 v[104:107], a[144:147], v[120:123], v[232:235]
    s_lshl1_add_u32 s76, s76, s70
    v_exp_f32 v80, v80
    v_mfma_f32_16x16x32_bf16 v[104:107], a[148:151], v[152:155], v[104:107]
    ds_read_b64_tr_b16 a[192:193], v26 offset:0
    ds_read_b64_tr_b16 a[194:195], v26 offset:4096
    v_mfma_f32_16x16x32_bf16 v[104:107], a[152:155], v[184:187], v[104:107]
    buffer_load_dwordx4 v19, s[48:51], s85 offen offset:3072 nt lds
    v_mfma_f32_16x16x32_bf16 v[104:107], a[156:159], v[216:219], v[104:107]
    s_lshl_b32 s77, s76, 7
    v_exp_f32 v81, v81
    v_mfma_f32_16x16x32_bf16 v[108:111], a[156:159], v[220:223], v[236:239]
    v_exp_f32 v82, v82
    v_mfma_f32_16x16x32_bf16 v[108:111], a[152:155], v[188:191], v[108:111]
    ds_read_b64_tr_b16 a[196:197], v26 offset:8192
    v_cvt_pk_bf16_f32 v242, v80, v81
    v_mfma_f32_16x16x32_bf16 v[108:111], a[148:151], v[156:159], v[108:111]
    s_add_u32 s77, s77, 16352
    v_exp_f32 v83, v83
    v_mfma_f32_16x16x32_bf16 v[108:111], a[144:147], v[124:127], v[108:111]
    s_waitcnt lgkmcnt(13)
    ds_read_b64_tr_b16 a[198:199], v26 offset:12288
    v_cvt_pk_bf16_f32 v243, v82, v83
    v_mfma_f32_16x16x32_bf16 a[0:3], a[176:179], v[160:163], a[0:3]
    s_waitcnt lgkmcnt(12)
    v_exp_f32 v68, v68
    v_mfma_f32_16x16x32_bf16 a[0:3], a[180:183], v[192:195], a[0:3]
    s_mov_b32 s88, 55296
    ds_read_b64_tr_b16 a[200:201], v27 offset:0
    ds_read_b64_tr_b16 a[202:203], v27 offset:4096
    v_mfma_f32_16x16x32_bf16 a[32:35], a[180:183], v[196:199], a[32:35]
    s_lshl_b32 s76, s76, 5
    buffer_load_dwordx4 a[212:215], v60, s[64:67], s88 offen sc1 nt
    v_mfma_f32_16x16x32_bf16 a[32:35], a[176:179], v[164:167], a[32:35]
    v_exp_f32 v69, v69
    v_mfma_f32_16x16x32_bf16 a[64:67], a[176:179], v[168:171], a[64:67]
    s_add_u32 s76, s76, 81924
    ds_read_b64_tr_b16 a[204:205], v27 offset:8192
    v_cvt_pk_bf16_f32 v244, v68, v69
    v_mfma_f32_16x16x32_bf16 a[64:67], a[180:183], v[200:203], a[64:67]
    v_exp_f32 v70, v70
    v_mfma_f32_16x16x32_bf16 a[96:99], a[180:183], v[204:207], a[96:99]
    v_exp_f32 v71, v71
    v_mfma_f32_16x16x32_bf16 a[96:99], a[176:179], v[172:175], a[96:99]
    s_waitcnt lgkmcnt(13)
    s_cmp_lt_u32 s70, 2
    s_cselect_b32 s78, 0, 1879048192
    ds_read_b64_tr_b16 a[206:207], v27 offset:12288
    v_cvt_pk_bf16_f32 v245, v70, v71
    v_mfma_f32_16x16x32_bf16 a[4:7], a[184:187], v[160:163], a[4:7]
    s_waitcnt lgkmcnt(12)
    buffer_load_dwordx4 a[216:219], v61, s[64:67], s88 offen sc1 nt
    v_mfma_f32_16x16x32_bf16 a[4:7], a[188:191], v[192:195], a[4:7]
    v_exp_f32 v84, v84
    v_mfma_f32_16x16x32_bf16 a[36:39], a[188:191], v[196:199], a[36:39]
    v_mfma_f32_16x16x32_bf16 a[36:39], a[184:187], v[164:167], a[36:39]
    v_exp_f32 v85, v85
    v_mfma_f32_16x16x32_bf16 a[68:71], a[184:187], v[168:171], a[68:71]
    v_cvt_pk_bf16_f32 v246, v84, v85
    v_mfma_f32_16x16x32_bf16 a[68:71], a[188:191], v[200:203], a[68:71]
    s_add_u32 s84, s84, 16384
    buffer_load_dwordx4 a[220:223], v62, s[64:67], s88 offen sc1 nt
    v_mfma_f32_16x16x32_bf16 a[100:103], a[188:191], v[204:207], a[100:103]
    s_waitcnt vmcnt(11)
    s_waitcnt lgkmcnt(0)
    v_exp_f32 v86, v86
    v_mfma_f32_16x16x32_bf16 a[100:103], a[184:187], v[172:175], a[100:103]
    s_barrier
    v_mfma_f32_16x16x32_bf16 a[128:131], a[208:211], v[160:163], a[128:131]
    s_add_u32 s85, s85, 16384
    v_exp_f32 v87, v87
    v_mfma_f32_16x16x32_bf16 a[128:131], a[208:211], v[192:195], a[128:131]
    s_add_u32 s41, s72, 0
    ds_read_b128 a[144:147], v20 offset:32768
    v_cvt_pk_bf16_f32 v247, v86, v87
    v_mfma_f32_16x16x32_bf16 v[128:131], a[160:163], v[112:115], v[224:227]
    s_and_b32 s41, s41, 3
    v_exp_f32 v72, v72
    v_mfma_f32_16x16x32_bf16 v[128:131], a[164:167], v[144:147], v[128:131]
    s_lshl2_add_u32 s41, s41, s70
    v_exp_f32 v73, v73
    v_mfma_f32_16x16x32_bf16 v[128:131], a[168:171], v[176:179], v[128:131]
    s_mul_i32 s41, s41, 36864
    ds_read_b128 a[148:151], v21 offset:32768
    v_cvt_pk_bf16_f32 v248, v72, v73
    v_mfma_f32_16x16x32_bf16 v[128:131], a[172:175], v[208:211], v[128:131]
    s_add_u32 s40, s81, 0
    v_exp_f32 v74, v74
    v_mfma_f32_16x16x32_bf16 v[132:135], a[172:175], v[212:215], v[228:231]
    s_add_u32 m0, s40, 0
    ds_read_b128 a[152:155], v22 offset:32768
    v_mfma_f32_16x16x32_bf16 v[132:135], a[168:171], v[180:183], v[132:135]
    buffer_load_dwordx4 v3, s[28:31], s41 offen lds
    v_mfma_f32_16x16x32_bf16 v[132:135], a[164:167], v[148:151], v[132:135]
    v_exp_f32 v75, v75
    v_mfma_f32_16x16x32_bf16 v[132:135], a[160:163], v[116:119], v[132:135]
    ds_read_b128 a[156:159], v23 offset:32768
    v_cvt_pk_bf16_f32 v249, v74, v75
    v_mfma_f32_16x16x32_bf16 v[136:139], a[160:163], v[120:123], v[232:235]
    v_exp_f32 v88, v88
    v_mfma_f32_16x16x32_bf16 v[136:139], a[164:167], v[152:155], v[136:139]
    ds_read_b64_tr_b16 a[176:177], v28 offset:0
    v_mfma_f32_16x16x32_bf16 v[136:139], a[168:171], v[184:187], v[136:139]
    v_exp_f32 v89, v89
    v_mfma_f32_16x16x32_bf16 v[136:139], a[172:175], v[216:219], v[136:139]
    s_add_u32 m0, s40, 1024
    ds_read_b64_tr_b16 a[178:179], v28 offset:4096
    v_cvt_pk_bf16_f32 v250, v88, v89
    v_mfma_f32_16x16x32_bf16 v[140:143], a[172:175], v[220:223], v[236:239]
    buffer_load_dwordx4 v4, s[28:31], s41 offen lds
    v_mfma_f32_16x16x32_bf16 v[140:143], a[168:171], v[188:191], v[140:143]
    v_exp_f32 v90, v90
    v_mfma_f32_16x16x32_bf16 v[140:143], a[164:167], v[156:159], v[140:143]
    ds_read_b64_tr_b16 a[180:181], v28 offset:8192
    v_mfma_f32_16x16x32_bf16 v[140:143], a[160:163], v[124:127], v[140:143]
    v_exp_f32 v91, v91
    v_mfma_f32_16x16x32_bf16 a[8:11], a[192:195], v[160:163], a[8:11]
    ds_read_b64_tr_b16 a[182:183], v28 offset:12288
    v_cvt_pk_bf16_f32 v251, v90, v91
    v_mfma_f32_16x16x32_bf16 a[8:11], a[196:199], v[192:195], a[8:11]
    v_exp_f32 v76, v76
    v_mfma_f32_16x16x32_bf16 a[40:43], a[196:199], v[196:199], a[40:43]
    v_exp_f32 v77, v77
    v_mfma_f32_16x16x32_bf16 a[40:43], a[192:195], v[164:167], a[40:43]
    ds_read_b64_tr_b16 a[184:185], v29 offset:0
    v_cvt_pk_bf16_f32 v252, v76, v77
    v_mfma_f32_16x16x32_bf16 a[72:75], a[192:195], v[168:171], a[72:75]
    v_exp_f32 v78, v78
    v_mfma_f32_16x16x32_bf16 a[72:75], a[196:199], v[200:203], a[72:75]
    s_add_u32 m0, s40, 2048
    ds_read_b64_tr_b16 a[186:187], v29 offset:4096
    v_mfma_f32_16x16x32_bf16 a[104:107], a[196:199], v[204:207], a[104:107]
    buffer_load_dwordx4 v5, s[28:31], s41 offen lds
    v_mfma_f32_16x16x32_bf16 a[104:107], a[192:195], v[172:175], a[104:107]
    v_exp_f32 v79, v79
    v_mfma_f32_16x16x32_bf16 a[12:15], a[200:203], v[160:163], a[12:15]
    ds_read_b64_tr_b16 a[188:189], v29 offset:8192
    v_cvt_pk_bf16_f32 v253, v78, v79
    v_mfma_f32_16x16x32_bf16 a[12:15], a[204:207], v[192:195], a[12:15]
    v_exp_f32 v92, v92
    v_mfma_f32_16x16x32_bf16 a[44:47], a[204:207], v[196:199], a[44:47]
    ds_read_b64_tr_b16 a[190:191], v29 offset:12288
    v_mfma_f32_16x16x32_bf16 a[44:47], a[200:203], v[164:167], a[44:47]
    v_exp_f32 v93, v93
    v_mfma_f32_16x16x32_bf16 a[76:79], a[200:203], v[168:171], a[76:79]
    s_add_u32 m0, s40, 3072
    v_cvt_pk_bf16_f32 v254, v92, v93
    v_mfma_f32_16x16x32_bf16 a[76:79], a[204:207], v[200:203], a[76:79]
    buffer_load_dwordx4 v6, s[28:31], s41 offen lds
    v_mfma_f32_16x16x32_bf16 a[108:111], a[204:207], v[204:207], a[108:111]
    v_exp_f32 v94, v94
    v_mfma_f32_16x16x32_bf16 a[108:111], a[200:203], v[172:175], a[108:111]
    v_mfma_f32_16x16x32_bf16 a[132:135], a[208:211], v[196:199], a[132:135]
    v_exp_f32 v95, v95
    v_mfma_f32_16x16x32_bf16 a[132:135], a[208:211], v[164:167], a[132:135]
    v_cvt_pk_bf16_f32 v255, v94, v95
    s_waitcnt lgkmcnt(11)
    v_mfma_f32_16x16x32_bf16 v[64:67], a[144:147], v[112:115], v[224:227]
    s_waitcnt lgkmcnt(10)
    v_exp_f32 v96, v96
    v_mfma_f32_16x16x32_bf16 v[64:67], a[148:151], v[144:147], v[64:67]
    s_waitcnt lgkmcnt(9)
    v_exp_f32 v97, v97
    v_mfma_f32_16x16x32_bf16 v[64:67], a[152:155], v[176:179], v[64:67]
    s_waitcnt lgkmcnt(8)
    ds_read_b128 a[160:163], v20 offset:36864
    v_cvt_pk_bf16_f32 v32, v96, v97
    v_mfma_f32_16x16x32_bf16 v[64:67], a[156:159], v[208:211], v[64:67]
    v_exp_f32 v98, v98
    v_mfma_f32_16x16x32_bf16 v[68:71], a[156:159], v[212:215], v[228:231]
    s_add_u32 m0, s40, 4096
    ds_read_b128 a[164:167], v21 offset:36864
    v_and_b32 v47, 63, v0
    v_mfma_f32_16x16x32_bf16 v[68:71], a[152:155], v[180:183], v[68:71]
    buffer_load_dwordx4 v7, s[28:31], s41 offen lds
    v_mfma_f32_16x16x32_bf16 v[68:71], a[148:151], v[148:151], v[68:71]
    v_exp_f32 v99, v99
    v_mfma_f32_16x16x32_bf16 v[68:71], a[144:147], v[116:119], v[68:71]
    ds_read_b128 a[168:171], v22 offset:36864
    v_cvt_pk_bf16_f32 v33, v98, v99
    v_mfma_f32_16x16x32_bf16 v[72:75], a[144:147], v[120:123], v[232:235]
    v_exp_f32 v128, v128
    v_mfma_f32_16x16x32_bf16 v[72:75], a[148:151], v[152:155], v[72:75]
    ds_read_b128 a[172:175], v23 offset:36864
    v_min_u32 v47, 4, v47
    v_mfma_f32_16x16x32_bf16 v[72:75], a[152:155], v[184:187], v[72:75]
    v_exp_f32 v129, v129
    v_mfma_f32_16x16x32_bf16 v[72:75], a[156:159], v[216:219], v[72:75]
    s_add_u32 m0, s40, 5120
    ds_read_b64_tr_b16 a[192:193], v30 offset:0
    v_cvt_pk_bf16_f32 v34, v128, v129
    v_mfma_f32_16x16x32_bf16 v[76:79], a[156:159], v[220:223], v[236:239]
    buffer_load_dwordx4 v8, s[28:31], s41 offen lds
    v_mfma_f32_16x16x32_bf16 v[76:79], a[152:155], v[188:191], v[76:79]
    v_exp_f32 v130, v130
    v_mfma_f32_16x16x32_bf16 v[76:79], a[148:151], v[156:159], v[76:79]
    ds_read_b64_tr_b16 a[194:195], v30 offset:4096
    v_cmp_gt_u32 vcc, 4, v47
    v_mfma_f32_16x16x32_bf16 v[76:79], a[144:147], v[124:127], v[76:79]
    s_waitcnt lgkmcnt(12)
    v_exp_f32 v131, v131
    v_mfma_f32_16x16x32_bf16 a[16:19], a[176:179], v[160:163], a[16:19]
    s_waitcnt lgkmcnt(10)
    ds_read_b64_tr_b16 a[196:197], v30 offset:8192
    v_cvt_pk_bf16_f32 v35, v130, v131
    v_mfma_f32_16x16x32_bf16 a[16:19], a[180:183], v[192:195], a[16:19]
    v_exp_f32 v100, v100
    v_mfma_f32_16x16x32_bf16 a[48:51], a[180:183], v[196:199], a[48:51]
    v_exp_f32 v101, v101
    v_mfma_f32_16x16x32_bf16 a[48:51], a[176:179], v[164:167], a[48:51]
    ds_read_b64_tr_b16 a[198:199], v30 offset:12288
    v_cvt_pk_bf16_f32 v36, v100, v101
    v_mfma_f32_16x16x32_bf16 a[80:83], a[176:179], v[168:171], a[80:83]
    v_exp_f32 v102, v102
    v_mfma_f32_16x16x32_bf16 a[80:83], a[180:183], v[200:203], a[80:83]
    s_add_u32 m0, s40, 6144
    ds_read_b64_tr_b16 a[200:201], v31 offset:0
    v_lshlrev_b32 v47, 3, v47
    v_mfma_f32_16x16x32_bf16 a[112:115], a[180:183], v[204:207], a[112:115]
    buffer_load_dwordx4 v9, s[28:31], s41 offen lds
    v_mfma_f32_16x16x32_bf16 a[112:115], a[176:179], v[172:175], a[112:115]
    s_waitcnt lgkmcnt(11)
    v_exp_f32 v103, v103
    v_mfma_f32_16x16x32_bf16 a[20:23], a[184:187], v[160:163], a[20:23]
    s_waitcnt lgkmcnt(9)
    ds_read_b64_tr_b16 a[202:203], v31 offset:4096
    v_cvt_pk_bf16_f32 v37, v102, v103
    v_mfma_f32_16x16x32_bf16 a[20:23], a[188:191], v[192:195], a[20:23]
    v_exp_f32 v132, v132
    v_mfma_f32_16x16x32_bf16 a[52:55], a[188:191], v[196:199], a[52:55]
    ds_read_b64_tr_b16 a[204:205], v31 offset:8192
    v_add_u32 v42, s76, v47
    v_mfma_f32_16x16x32_bf16 a[52:55], a[184:187], v[164:167], a[52:55]
    v_exp_f32 v133, v133
    v_mfma_f32_16x16x32_bf16 a[84:87], a[184:187], v[168:171], a[84:87]
    s_add_u32 m0, s40, 7168
    ds_read_b64_tr_b16 a[206:207], v31 offset:12288
    v_cvt_pk_bf16_f32 v38, v132, v133
    v_mfma_f32_16x16x32_bf16 a[84:87], a[188:191], v[200:203], a[84:87]
    buffer_load_dwordx4 v10, s[28:31], s41 offen lds
    v_mfma_f32_16x16x32_bf16 a[116:119], a[188:191], v[204:207], a[116:119]
    v_exp_f32 v134, v134
    v_mfma_f32_16x16x32_bf16 a[116:119], a[184:187], v[172:175], a[116:119]
    v_add_u32 v47, s77, v47
    v_mov_b32 v44, 0
    v_mfma_f32_16x16x32_bf16 a[136:139], a[208:211], v[168:171], a[136:139]
    v_exp_f32 v135, v135
    v_mfma_f32_16x16x32_bf16 a[136:139], a[208:211], v[200:203], a[136:139]
    s_waitcnt lgkmcnt(11)
    ds_read_b128 a[144:147], v20 offset:40960
    v_cvt_pk_bf16_f32 v39, v134, v135
    v_mfma_f32_16x16x32_bf16 v[80:83], a[160:163], v[112:115], v[224:227]
    s_waitcnt lgkmcnt(11)
    v_exp_f32 v104, v104
    v_mfma_f32_16x16x32_bf16 v[80:83], a[164:167], v[144:147], v[80:83]
    s_waitcnt lgkmcnt(10)
    v_exp_f32 v105, v105
    v_mfma_f32_16x16x32_bf16 v[80:83], a[168:171], v[176:179], v[80:83]
    s_waitcnt lgkmcnt(9)
    ds_read_b128 a[148:151], v21 offset:40960
    v_cvt_pk_bf16_f32 v48, v104, v105
    v_mfma_f32_16x16x32_bf16 v[80:83], a[172:175], v[208:211], v[80:83]
    v_exp_f32 v106, v106
    v_mfma_f32_16x16x32_bf16 v[84:87], a[172:175], v[212:215], v[228:231]
    ds_read_b128 a[152:155], v22 offset:40960
    v_cndmask_b32 v47, v47, v42, vcc
    v_mfma_f32_16x16x32_bf16 v[84:87], a[168:171], v[180:183], v[84:87]
    v_exp_f32 v107, v107
    v_mfma_f32_16x16x32_bf16 v[84:87], a[164:167], v[148:151], v[84:87]
    s_add_u32 m0, s40, 8192
    ds_read_b128 a[156:159], v23 offset:40960
    v_cvt_pk_bf16_f32 v49, v106, v107
    v_mfma_f32_16x16x32_bf16 v[84:87], a[160:163], v[116:119], v[84:87]
    buffer_load_dwordx4 v11, s[28:31], s41 offen lds
    v_mfma_f32_16x16x32_bf16 v[88:91], a[160:163], v[120:123], v[232:235]
    v_exp_f32 v136, v136
    v_mfma_f32_16x16x32_bf16 v[88:91], a[164:167], v[152:155], v[88:91]
    ds_read_b64_tr_b16 a[176:177], v24 offset:16384
    v_mfma_f32_16x16x32_bf16 v[88:91], a[168:171], v[184:187], v[88:91]
    v_exp_f32 v137, v137
    v_mfma_f32_16x16x32_bf16 v[88:91], a[172:175], v[216:219], v[88:91]
    ds_read_b64_tr_b16 a[178:179], v24 offset:20480
    v_cvt_pk_bf16_f32 v50, v136, v137
    v_mfma_f32_16x16x32_bf16 v[92:95], a[172:175], v[220:223], v[236:239]
    v_exp_f32 v138, v138
    v_mfma_f32_16x16x32_bf16 v[92:95], a[168:171], v[188:191], v[92:95]
    ds_read_b64_tr_b16 a[180:181], v24 offset:24576
    v_mfma_f32_16x16x32_bf16 v[92:95], a[164:167], v[156:159], v[92:95]
    v_exp_f32 v139, v139
    v_mfma_f32_16x16x32_bf16 v[92:95], a[160:163], v[124:127], v[92:95]
    s_waitcnt lgkmcnt(13)
    ds_read_b64_tr_b16 a[182:183], v24 offset:28672
    v_cvt_pk_bf16_f32 v51, v138, v139
    v_mfma_f32_16x16x32_bf16 a[24:27], a[192:195], v[160:163], a[24:27]
    s_waitcnt lgkmcnt(12)
    v_exp_f32 v108, v108
    v_mfma_f32_16x16x32_bf16 a[24:27], a[196:199], v[192:195], a[24:27]
    s_add_u32 m0, s83, 120832
    ds_read_b64_tr_b16 a[184:185], v25 offset:16384
    v_mfma_f32_16x16x32_bf16 a[56:59], a[196:199], v[196:199], a[56:59]
    buffer_load_dwordx4 v18, s[48:51], s85 offen offset:0 nt lds
    v_mfma_f32_16x16x32_bf16 a[56:59], a[192:195], v[164:167], a[56:59]
    v_exp_f32 v109, v109
    v_mfma_f32_16x16x32_bf16 a[88:91], a[192:195], v[168:171], a[88:91]
    ds_read_b64_tr_b16 a[186:187], v25 offset:20480
    v_cvt_pk_bf16_f32 v52, v108, v109
    v_mfma_f32_16x16x32_bf16 a[88:91], a[196:199], v[200:203], a[88:91]
    v_exp_f32 v110, v110
    v_mfma_f32_16x16x32_bf16 a[120:123], a[196:199], v[204:207], a[120:123]
    ds_read_b64_tr_b16 a[188:189], v25 offset:24576
    v_mfma_f32_16x16x32_bf16 a[120:123], a[192:195], v[172:175], a[120:123]
    s_waitcnt lgkmcnt(13)
    v_exp_f32 v111, v111
    v_mfma_f32_16x16x32_bf16 a[28:31], a[200:203], v[160:163], a[28:31]
    s_waitcnt lgkmcnt(11)
    ds_read_b64_tr_b16 a[190:191], v25 offset:28672
    v_cvt_pk_bf16_f32 v53, v110, v111
    v_mfma_f32_16x16x32_bf16 a[28:31], a[204:207], v[192:195], a[28:31]
    v_exp_f32 v140, v140
    v_mfma_f32_16x16x32_bf16 a[60:63], a[204:207], v[196:199], a[60:63]
    v_mfma_f32_16x16x32_bf16 a[60:63], a[200:203], v[164:167], a[60:63]
    buffer_load_dwordx4 v19, s[48:51], s85 offen offset:1024 nt lds
    v_mfma_f32_16x16x32_bf16 a[92:95], a[200:203], v[168:171], a[92:95]
    v_exp_f32 v141, v141
    v_mfma_f32_16x16x32_bf16 a[92:95], a[204:207], v[200:203], a[92:95]
    v_cvt_pk_bf16_f32 v54, v140, v141
    v_mfma_f32_16x16x32_bf16 a[124:127], a[204:207], v[204:207], a[124:127]
    v_exp_f32 v142, v142
    v_mfma_f32_16x16x32_bf16 a[124:127], a[200:203], v[172:175], a[124:127]
    v_mfma_f32_16x16x32_bf16 a[140:143], a[208:211], v[204:207], a[140:143]
    v_exp_f32 v143, v143
    v_mfma_f32_16x16x32_bf16 a[140:143], a[208:211], v[172:175], a[140:143]
    v_cvt_pk_bf16_f32 v55, v142, v143
    s_waitcnt lgkmcnt(11)
    v_mfma_f32_16x16x32_bf16 v[96:99], a[144:147], v[112:115], v[224:227]
    s_waitcnt lgkmcnt(10)
    v_exp_f32 v64, v64
    v_mfma_f32_16x16x32_bf16 v[96:99], a[148:151], v[144:147], v[96:99]
    s_waitcnt lgkmcnt(9)
    ds_read_b128 a[160:163], v20 offset:45056
    v_mfma_f32_16x16x32_bf16 v[96:99], a[152:155], v[176:179], v[96:99]
    s_waitcnt lgkmcnt(9)
    v_exp_f32 v65, v65
    v_mfma_f32_16x16x32_bf16 v[96:99], a[156:159], v[208:211], v[96:99]
    ds_read_b128 a[164:167], v21 offset:45056
    v_cvt_pk_bf16_f32 v160, v64, v65
    v_mfma_f32_16x16x32_bf16 v[100:103], a[156:159], v[212:215], v[228:231]
    v_exp_f32 v66, v66
    v_mfma_f32_16x16x32_bf16 v[100:103], a[152:155], v[180:183], v[100:103]
    ds_read_b128 a[168:171], v22 offset:45056
    v_mfma_f32_16x16x32_bf16 v[100:103], a[148:151], v[148:151], v[100:103]
    ds_read_b128 a[172:175], v23 offset:45056
    v_mfma_f32_16x16x32_bf16 v[100:103], a[144:147], v[116:119], v[100:103]
    v_exp_f32 v67, v67
    v_mfma_f32_16x16x32_bf16 v[104:107], a[144:147], v[120:123], v[232:235]
    ds_read_b64_tr_b16 a[192:193], v26 offset:16384
    v_cvt_pk_bf16_f32 v161, v66, v67
    v_mfma_f32_16x16x32_bf16 v[104:107], a[148:151], v[152:155], v[104:107]
    v_exp_f32 v80, v80
    v_mfma_f32_16x16x32_bf16 v[104:107], a[152:155], v[184:187], v[104:107]
    ds_read_b64_tr_b16 a[194:195], v26 offset:20480
    v_mfma_f32_16x16x32_bf16 v[104:107], a[156:159], v[216:219], v[104:107]
    buffer_load_dwordx4 v18, s[48:51], s85 offen offset:2048 nt lds
    v_mfma_f32_16x16x32_bf16 v[108:111], a[156:159], v[220:223], v[236:239]
    v_exp_f32 v81, v81
    v_mfma_f32_16x16x32_bf16 v[108:111], a[152:155], v[188:191], v[108:111]
    ds_read_b64_tr_b16 a[196:197], v26 offset:24576
    v_cvt_pk_bf16_f32 v162, v80, v81
    v_mfma_f32_16x16x32_bf16 v[108:111], a[148:151], v[156:159], v[108:111]
    ds_read_b64_tr_b16 a[198:199], v26 offset:28672
    v_mfma_f32_16x16x32_bf16 v[108:111], a[144:147], v[124:127], v[108:111]
    s_waitcnt vmcnt(14)
    v_exp_f32 v82, v82
    v_mfma_f32_16x16x32_bf16 a[224:227], a[252:255], a[212:215], a[224:227]
    ds_read_b64_tr_b16 a[200:201], v27 offset:16384
    v_mfma_f32_16x16x32_bf16 a[228:231], a[250:253], a[212:215], a[228:231]
    s_waitcnt vmcnt(13)
    v_exp_f32 v83, v83
    v_mfma_f32_16x16x32_bf16 a[232:235], a[252:255], a[216:219], a[232:235]
    ds_read_b64_tr_b16 a[202:203], v27 offset:20480
    v_cvt_pk_bf16_f32 v163, v82, v83
    v_mfma_f32_16x16x32_bf16 a[236:239], a[250:253], a[216:219], a[236:239]
    s_waitcnt vmcnt(12)
    ds_read_b64_tr_b16 a[204:205], v27 offset:24576
    v_mfma_f32_16x16x32_bf16 a[240:243], a[252:255], a[220:223], a[240:243]
    v_exp_f32 v68, v68
    v_mfma_f32_16x16x32_bf16 a[244:247], a[250:253], a[220:223], a[244:247]
    s_waitcnt lgkmcnt(13)
    ds_read_b64_tr_b16 a[206:207], v27 offset:28672
    v_mfma_f32_16x16x32_bf16 a[0:3], a[176:179], v[240:243], a[0:3]
    v_exp_f32 v69, v69
    v_mfma_f32_16x16x32_bf16 a[0:3], a[180:183], v[32:35], a[0:3]
    v_cvt_pk_bf16_f32 v164, v68, v69
    v_mfma_f32_16x16x32_bf16 a[32:35], a[180:183], v[36:39], a[32:35]
    v_exp_f32 v70, v70
    v_mfma_f32_16x16x32_bf16 a[32:35], a[176:179], v[244:247], a[32:35]
    v_mfma_f32_16x16x32_bf16 a[64:67], a[176:179], v[248:251], a[64:67]
    v_mfma_f32_16x16x32_bf16 a[64:67], a[180:183], v[48:51], a[64:67]
    v_exp_f32 v71, v71
    v_mfma_f32_16x16x32_bf16 a[96:99], a[180:183], v[52:55], a[96:99]
    v_cvt_pk_bf16_f32 v165, v70, v71
    v_mfma_f32_16x16x32_bf16 a[96:99], a[176:179], v[252:255], a[96:99]
    buffer_load_dwordx4 v19, s[48:51], s85 offen offset:3072 nt lds
    v_mfma_f32_16x16x32_bf16 a[4:7], a[184:187], v[240:243], a[4:7]
    s_waitcnt lgkmcnt(12)
    v_exp_f32 v84, v84
    v_mfma_f32_16x16x32_bf16 a[4:7], a[188:191], v[32:35], a[4:7]
    v_mfma_f32_16x16x32_bf16 a[36:39], a[188:191], v[36:39], a[36:39]
    v_exp_f32 v85, v85
    v_mfma_f32_16x16x32_bf16 a[36:39], a[184:187], v[244:247], a[36:39]
    v_cvt_pk_bf16_f32 v166, v84, v85
    v_mfma_f32_16x16x32_bf16 a[68:71], a[184:187], v[248:251], a[68:71]
    v_mfma_f32_16x16x32_bf16 a[68:71], a[188:191], v[48:51], a[68:71]
    s_add_u32 s84, s84, 16384
    v_exp_f32 v86, v86
    v_mfma_f32_16x16x32_bf16 a[100:103], a[188:191], v[52:55], a[100:103]
    s_waitcnt vmcnt(16)
    v_mfma_f32_16x16x32_bf16 a[100:103], a[184:187], v[252:255], a[100:103]
    s_barrier
    v_exp_f32 v87, v87
    v_mfma_f32_16x16x32_bf16 a[128:131], a[208:211], v[240:243], a[128:131]
    s_add_u32 s85, s85, 16384
    ds_read_b128 a[144:147], v20 offset:49152
    v_cvt_pk_bf16_f32 v167, v86, v87
    v_mfma_f32_16x16x32_bf16 a[128:131], a[208:211], v[32:35], a[128:131]
    s_waitcnt lgkmcnt(12)
    ds_read_b128 a[148:151], v21 offset:49152
    v_mfma_f32_16x16x32_bf16 v[128:131], a[160:163], v[112:115], v[224:227]
    s_waitcnt lgkmcnt(12)
    v_exp_f32 v72, v72
    v_mfma_f32_16x16x32_bf16 v[128:131], a[164:167], v[144:147], v[128:131]
    s_waitcnt lgkmcnt(11)
    v_exp_f32 v73, v73
    v_mfma_f32_16x16x32_bf16 v[128:131], a[168:171], v[176:179], v[128:131]
    s_waitcnt lgkmcnt(10)
    ds_read_b128 a[152:155], v22 offset:49152
    v_cvt_pk_bf16_f32 v168, v72, v73
    v_mfma_f32_16x16x32_bf16 v[128:131], a[172:175], v[208:211], v[128:131]
    v_exp_f32 v74, v74
    v_mfma_f32_16x16x32_bf16 v[132:135], a[172:175], v[212:215], v[228:231]
    ds_read_b128 a[156:159], v23 offset:49152
    v_mfma_f32_16x16x32_bf16 v[132:135], a[168:171], v[180:183], v[132:135]
    v_exp_f32 v75, v75
    v_mfma_f32_16x16x32_bf16 v[132:135], a[164:167], v[148:151], v[132:135]
    s_mov_b32 s88, 64512
    ds_read_b64_tr_b16 a[176:177], v28 offset:16384
    v_cvt_pk_bf16_f32 v169, v74, v75
    v_mfma_f32_16x16x32_bf16 v[132:135], a[160:163], v[116:119], v[132:135]
    buffer_load_dwordx4 a[212:215], v60, s[64:67], s88 offen sc1 nt
    v_mfma_f32_16x16x32_bf16 v[136:139], a[160:163], v[120:123], v[232:235]
    v_exp_f32 v88, v88
    v_mfma_f32_16x16x32_bf16 v[136:139], a[164:167], v[152:155], v[136:139]
    ds_read_b64_tr_b16 a[178:179], v28 offset:20480
    v_mfma_f32_16x16x32_bf16 v[136:139], a[168:171], v[184:187], v[136:139]
    v_exp_f32 v89, v89
    v_mfma_f32_16x16x32_bf16 v[136:139], a[172:175], v[216:219], v[136:139]
    ds_read_b64_tr_b16 a[180:181], v28 offset:24576
    v_cvt_pk_bf16_f32 v170, v88, v89
    v_mfma_f32_16x16x32_bf16 v[140:143], a[172:175], v[220:223], v[236:239]
    v_exp_f32 v90, v90
    v_mfma_f32_16x16x32_bf16 v[140:143], a[168:171], v[188:191], v[140:143]
    ds_read_b64_tr_b16 a[182:183], v28 offset:28672
    v_mfma_f32_16x16x32_bf16 v[140:143], a[164:167], v[156:159], v[140:143]
    v_exp_f32 v91, v91
    v_mfma_f32_16x16x32_bf16 v[140:143], a[160:163], v[124:127], v[140:143]
    s_waitcnt lgkmcnt(13)
    ds_read_b64_tr_b16 a[184:185], v29 offset:16384
    v_cvt_pk_bf16_f32 v171, v90, v91
    v_mfma_f32_16x16x32_bf16 a[8:11], a[192:195], v[240:243], a[8:11]
    s_waitcnt lgkmcnt(13)
    v_exp_f32 v76, v76
    v_mfma_f32_16x16x32_bf16 a[8:11], a[196:199], v[32:35], a[8:11]
    ds_read_b64_tr_b16 a[186:187], v29 offset:20480
    v_mfma_f32_16x16x32_bf16 a[40:43], a[196:199], v[36:39], a[40:43]
    buffer_load_dwordx4 a[216:219], v61, s[64:67], s88 offen sc1 nt
    v_mfma_f32_16x16x32_bf16 a[40:43], a[192:195], v[244:247], a[40:43]
    v_exp_f32 v77, v77
    v_mfma_f32_16x16x32_bf16 a[72:75], a[192:195], v[248:251], a[72:75]
    ds_read_b64_tr_b16 a[188:189], v29 offset:24576
    v_cvt_pk_bf16_f32 v172, v76, v77
    v_mfma_f32_16x16x32_bf16 a[72:75], a[196:199], v[48:51], a[72:75]
    v_exp_f32 v78, v78
    v_mfma_f32_16x16x32_bf16 a[104:107], a[196:199], v[52:55], a[104:107]
    ds_read_b64_tr_b16 a[190:191], v29 offset:28672
    v_mfma_f32_16x16x32_bf16 a[104:107], a[192:195], v[252:255], a[104:107]
    s_waitcnt lgkmcnt(14)
    v_exp_f32 v79, v79
    v_mfma_f32_16x16x32_bf16 a[12:15], a[200:203], v[240:243], a[12:15]
    s_waitcnt lgkmcnt(12)
    v_cvt_pk_bf16_f32 v173, v78, v79
    v_mfma_f32_16x16x32_bf16 a[12:15], a[204:207], v[32:35], a[12:15]
    v_exp_f32 v92, v92
    v_mfma_f32_16x16x32_bf16 a[44:47], a[204:207], v[36:39], a[44:47]
    v_mfma_f32_16x16x32_bf16 a[44:47], a[200:203], v[244:247], a[44:47]
    buffer_load_dwordx4 a[220:223], v62, s[64:67], s88 offen sc1 nt
    v_mfma_f32_16x16x32_bf16 a[76:79], a[200:203], v[248:251], a[76:79]
Lqad0:
    s_cbranch_execz Lqad4
    v_exp_f32 v93, v93
    v_mfma_f32_16x16x32_bf16 a[76:79], a[204:207], v[48:51], a[76:79]
    v_cvt_pk_bf16_f32 v174, v92, v93
    v_mfma_f32_16x16x32_bf16 a[108:111], a[204:207], v[52:55], a[108:111]
    v_exp_f32 v94, v94
    v_mfma_f32_16x16x32_bf16 a[108:111], a[200:203], v[252:255], a[108:111]
    v_mfma_f32_16x16x32_bf16 a[132:135], a[208:211], v[36:39], a[132:135]
    v_exp_f32 v95, v95
    v_mfma_f32_16x16x32_bf16 a[132:135], a[208:211], v[244:247], a[132:135]
    v_cvt_pk_bf16_f32 v175, v94, v95
    s_waitcnt lgkmcnt(11)
    v_mfma_f32_16x16x32_bf16 v[64:67], a[144:147], v[112:115], v[224:227]
    s_waitcnt lgkmcnt(10)
    v_exp_f32 v96, v96
    v_mfma_f32_16x16x32_bf16 v[64:67], a[148:151], v[144:147], v[64:67]
    s_waitcnt lgkmcnt(9)
    ds_read_b128 a[160:163], v20 offset:53248
    ds_read_b128 a[164:167], v21 offset:53248
    v_mfma_f32_16x16x32_bf16 v[64:67], a[152:155], v[176:179], v[64:67]
    s_waitcnt lgkmcnt(10)
    v_exp_f32 v97, v97
    v_mfma_f32_16x16x32_bf16 v[64:67], a[156:159], v[208:211], v[64:67]
    ds_read_b128 a[168:171], v22 offset:53248
    v_cvt_pk_bf16_f32 v192, v96, v97
    v_mfma_f32_16x16x32_bf16 v[68:71], a[156:159], v[212:215], v[228:231]
    v_exp_f32 v98, v98
    v_mfma_f32_16x16x32_bf16 v[68:71], a[152:155], v[180:183], v[68:71]
    ds_read_b128 a[172:175], v23 offset:53248
    v_mfma_f32_16x16x32_bf16 v[68:71], a[148:151], v[148:151], v[68:71]
    v_exp_f32 v99, v99
    v_mfma_f32_16x16x32_bf16 v[68:71], a[144:147], v[116:119], v[68:71]
    ds_read_b64_tr_b16 a[192:193], v30 offset:16384
    v_cvt_pk_bf16_f32 v193, v98, v99
    v_mfma_f32_16x16x32_bf16 v[72:75], a[144:147], v[120:123], v[232:235]
    buffer_store_dword v44, v47, s[56:59], s78 offen sc1
    v_mfma_f32_16x16x32_bf16 v[72:75], a[148:151], v[152:155], v[72:75]
    v_exp_f32 v128, v128
    v_mfma_f32_16x16x32_bf16 v[72:75], a[152:155], v[184:187], v[72:75]
    ds_read_b64_tr_b16 a[194:195], v30 offset:20480
    v_mfma_f32_16x16x32_bf16 v[72:75], a[156:159], v[216:219], v[72:75]
    v_exp_f32 v129, v129
    v_mfma_f32_16x16x32_bf16 v[76:79], a[156:159], v[220:223], v[236:239]
    ds_read_b64_tr_b16 a[196:197], v30 offset:24576
    v_cvt_pk_bf16_f32 v194, v128, v129
    v_mfma_f32_16x16x32_bf16 v[76:79], a[152:155], v[188:191], v[76:79]
    v_exp_f32 v130, v130
    v_mfma_f32_16x16x32_bf16 v[76:79], a[148:151], v[156:159], v[76:79]
    ds_read_b64_tr_b16 a[198:199], v30 offset:28672
    v_mfma_f32_16x16x32_bf16 v[76:79], a[144:147], v[124:127], v[76:79]
    s_waitcnt lgkmcnt(14)
    v_exp_f32 v131, v131
    v_mfma_f32_16x16x32_bf16 a[16:19], a[176:179], v[240:243], a[16:19]
    s_waitcnt lgkmcnt(12)
    ds_read_b64_tr_b16 a[200:201], v31 offset:16384
    v_cvt_pk_bf16_f32 v195, v130, v131
    v_mfma_f32_16x16x32_bf16 a[16:19], a[180:183], v[32:35], a[16:19]
    v_exp_f32 v100, v100
    v_mfma_f32_16x16x32_bf16 a[48:51], a[180:183], v[36:39], a[48:51]
    ds_read_b64_tr_b16 a[202:203], v31 offset:20480
    v_mfma_f32_16x16x32_bf16 a[48:51], a[176:179], v[244:247], a[48:51]
    v_exp_f32 v101, v101
    v_mfma_f32_16x16x32_bf16 a[80:83], a[176:179], v[248:251], a[80:83]
    ds_read_b64_tr_b16 a[204:205], v31 offset:24576
    v_cvt_pk_bf16_f32 v196, v100, v101
    v_mfma_f32_16x16x32_bf16 a[80:83], a[180:183], v[48:51], a[80:83]
    v_exp_f32 v102, v102
    v_mfma_f32_16x16x32_bf16 a[112:115], a[180:183], v[52:55], a[112:115]
    ds_read_b64_tr_b16 a[206:207], v31 offset:28672
    v_mfma_f32_16x16x32_bf16 a[112:115], a[176:179], v[252:255], a[112:115]
    s_waitcnt lgkmcnt(14)
    v_exp_f32 v103, v103
    v_mfma_f32_16x16x32_bf16 a[20:23], a[184:187], v[240:243], a[20:23]
    s_waitcnt lgkmcnt(12)
    s_add_u32 s79, s14, 98304
    v_cvt_pk_bf16_f32 v197, v102, v103
    v_mfma_f32_16x16x32_bf16 a[20:23], a[188:191], v[32:35], a[20:23]
    buffer_load_dword v40, v1, s[56:59], s79 offen sc1
    v_mfma_f32_16x16x32_bf16 a[52:55], a[188:191], v[36:39], a[52:55]
    v_exp_f32 v132, v132
    v_mfma_f32_16x16x32_bf16 a[52:55], a[184:187], v[244:247], a[52:55]
    v_mfma_f32_16x16x32_bf16 a[84:87], a[184:187], v[248:251], a[84:87]
    v_exp_f32 v133, v133
    v_mfma_f32_16x16x32_bf16 a[84:87], a[188:191], v[48:51], a[84:87]
    v_cvt_pk_bf16_f32 v198, v132, v133
    v_mfma_f32_16x16x32_bf16 a[116:119], a[188:191], v[52:55], a[116:119]
    s_waitcnt lgkmcnt(0)
    v_exp_f32 v134, v134
    v_mfma_f32_16x16x32_bf16 a[116:119], a[184:187], v[252:255], a[116:119]
    s_barrier
    v_mfma_f32_16x16x32_bf16 a[136:139], a[208:211], v[248:251], a[136:139]
    s_add_u32 s41, s72, 1
    v_exp_f32 v135, v135
    v_mfma_f32_16x16x32_bf16 a[136:139], a[208:211], v[48:51], a[136:139]
    s_and_b32 s41, s41, 3
    ds_read_b128 a[144:147], v20 offset:57344
    v_cvt_pk_bf16_f32 v199, v134, v135
    v_mfma_f32_16x16x32_bf16 v[80:83], a[160:163], v[112:115], v[224:227]
    s_lshl2_add_u32 s41, s41, s70
    v_exp_f32 v104, v104
    v_mfma_f32_16x16x32_bf16 v[80:83], a[164:167], v[144:147], v[80:83]
    s_mul_i32 s41, s41, 36864
    v_exp_f32 v105, v105
    v_mfma_f32_16x16x32_bf16 v[80:83], a[168:171], v[176:179], v[80:83]
    s_add_u32 s40, s81, 73728
    ds_read_b128 a[148:151], v21 offset:57344
    v_cvt_pk_bf16_f32 v200, v104, v105
    v_mfma_f32_16x16x32_bf16 v[80:83], a[172:175], v[208:211], v[80:83]
    s_cmp_eq_u32 s70, 3
    s_cselect_b32 s40, 138240, s40
    v_exp_f32 v106, v106
    v_mfma_f32_16x16x32_bf16 v[84:87], a[172:175], v[212:215], v[228:231]
    s_add_u32 m0, s40, 0
    ds_read_b128 a[152:155], v22 offset:57344
    v_mfma_f32_16x16x32_bf16 v[84:87], a[168:171], v[180:183], v[84:87]
    buffer_load_dwordx4 v3, s[28:31], s41 offen lds
    v_mfma_f32_16x16x32_bf16 v[84:87], a[164:167], v[148:151], v[84:87]
    v_exp_f32 v107, v107
    v_mfma_f32_16x16x32_bf16 v[84:87], a[160:163], v[116:119], v[84:87]
    ds_read_b128 a[156:159], v23 offset:57344
    v_cvt_pk_bf16_f32 v201, v106, v107
    v_mfma_f32_16x16x32_bf16 v[88:91], a[160:163], v[120:123], v[232:235]
    v_exp_f32 v136, v136
    v_mfma_f32_16x16x32_bf16 v[88:91], a[164:167], v[152:155], v[88:91]
    s_add_u32 m0, s40, 1024
    ds_read_b64_tr_b16 a[176:177], v24 offset:32768
    v_mfma_f32_16x16x32_bf16 v[88:91], a[168:171], v[184:187], v[88:91]
    buffer_load_dwordx4 v4, s[28:31], s41 offen lds
    v_mfma_f32_16x16x32_bf16 v[88:91], a[172:175], v[216:219], v[88:91]
    v_exp_f32 v137, v137
    v_mfma_f32_16x16x32_bf16 v[92:95], a[172:175], v[220:223], v[236:239]
    v_exp_f32 v138, v138
    v_mfma_f32_16x16x32_bf16 v[92:95], a[168:171], v[188:191], v[92:95]
    ds_read_b64_tr_b16 a[178:179], v24 offset:36864
    v_cvt_pk_bf16_f32 v202, v136, v137
    v_mfma_f32_16x16x32_bf16 v[92:95], a[164:167], v[156:159], v[92:95]
    v_exp_f32 v139, v139
    v_mfma_f32_16x16x32_bf16 v[92:95], a[160:163], v[124:127], v[92:95]
    ds_read_b64_tr_b16 a[180:181], v24 offset:40960
    v_cvt_pk_bf16_f32 v203, v138, v139
    v_mfma_f32_16x16x32_bf16 a[24:27], a[192:195], v[240:243], a[24:27]
    v_exp_f32 v108, v108
    v_mfma_f32_16x16x32_bf16 a[24:27], a[196:199], v[32:35], a[24:27]
    s_add_u32 m0, s40, 2048
    ds_read_b64_tr_b16 a[182:183], v24 offset:45056
    v_mfma_f32_16x16x32_bf16 a[56:59], a[196:199], v[36:39], a[56:59]
    buffer_load_dwordx4 v5, s[28:31], s41 offen lds
    v_mfma_f32_16x16x32_bf16 a[56:59], a[192:195], v[244:247], a[56:59]
    v_exp_f32 v109, v109
    v_mfma_f32_16x16x32_bf16 a[88:91], a[192:195], v[248:251], a[88:91]
    ds_read_b64_tr_b16 a[184:185], v25 offset:32768
    v_cvt_pk_bf16_f32 v204, v108, v109
    v_mfma_f32_16x16x32_bf16 a[88:91], a[196:199], v[48:51], a[88:91]
    v_exp_f32 v110, v110
    v_mfma_f32_16x16x32_bf16 a[120:123], a[196:199], v[52:55], a[120:123]
    v_exp_f32 v111, v111
    v_mfma_f32_16x16x32_bf16 a[120:123], a[192:195], v[252:255], a[120:123]
    s_add_u32 m0, s40, 3072
    ds_read_b64_tr_b16 a[186:187], v25 offset:36864
    v_cvt_pk_bf16_f32 v205, v110, v111
    v_mfma_f32_16x16x32_bf16 a[28:31], a[200:203], v[240:243], a[28:31]
    buffer_load_dwordx4 v6, s[28:31], s41 offen lds
    v_mfma_f32_16x16x32_bf16 a[28:31], a[204:207], v[32:35], a[28:31]
    v_exp_f32 v140, v140
    v_mfma_f32_16x16x32_bf16 a[60:63], a[204:207], v[36:39], a[60:63]
    ds_read_b64_tr_b16 a[188:189], v25 offset:40960
    v_mfma_f32_16x16x32_bf16 a[60:63], a[200:203], v[244:247], a[60:63]
    v_exp_f32 v141, v141
    v_mfma_f32_16x16x32_bf16 a[92:95], a[200:203], v[248:251], a[92:95]
    s_add_u32 m0, s40, 4096
    ds_read_b64_tr_b16 a[190:191], v25 offset:45056
    v_cvt_pk_bf16_f32 v206, v140, v141
    v_mfma_f32_16x16x32_bf16 a[92:95], a[204:207], v[48:51], a[92:95]
    buffer_load_dwordx4 v7, s[28:31], s41 offen lds
    v_mfma_f32_16x16x32_bf16 a[124:127], a[204:207], v[52:55], a[124:127]
    v_exp_f32 v142, v142
    v_mfma_f32_16x16x32_bf16 a[124:127], a[200:203], v[252:255], a[124:127]
    v_mfma_f32_16x16x32_bf16 a[140:143], a[208:211], v[52:55], a[140:143]
    v_exp_f32 v143, v143
    v_mfma_f32_16x16x32_bf16 a[140:143], a[208:211], v[252:255], a[140:143]
    v_cvt_pk_bf16_f32 v207, v142, v143
    s_waitcnt lgkmcnt(11)
    v_mfma_f32_16x16x32_bf16 v[96:99], a[144:147], v[112:115], v[224:227]
    s_waitcnt lgkmcnt(10)
    v_exp_f32 v64, v64
    v_mfma_f32_16x16x32_bf16 v[96:99], a[148:151], v[144:147], v[96:99]
    s_waitcnt lgkmcnt(9)
    v_exp_f32 v65, v65
    v_mfma_f32_16x16x32_bf16 v[96:99], a[152:155], v[176:179], v[96:99]
    s_waitcnt lgkmcnt(8)
    ds_read_b128 a[160:163], v20 offset:61440
    v_cvt_pk_bf16_f32 v240, v64, v65
    v_mfma_f32_16x16x32_bf16 v[96:99], a[156:159], v[208:211], v[96:99]
    v_exp_f32 v66, v66
    v_mfma_f32_16x16x32_bf16 v[100:103], a[156:159], v[212:215], v[228:231]
    s_add_u32 m0, s40, 5120
    ds_read_b128 a[164:167], v21 offset:61440
    ds_read_b128 a[168:171], v22 offset:61440
    v_mfma_f32_16x16x32_bf16 v[100:103], a[152:155], v[180:183], v[100:103]
    buffer_load_dwordx4 v8, s[28:31], s41 offen lds
    v_mfma_f32_16x16x32_bf16 v[100:103], a[148:151], v[148:151], v[100:103]
    v_exp_f32 v67, v67
    v_mfma_f32_16x16x32_bf16 v[100:103], a[144:147], v[116:119], v[100:103]
    ds_read_b128 a[172:175], v23 offset:61440
    v_cvt_pk_bf16_f32 v241, v66, v67
    v_mfma_f32_16x16x32_bf16 v[104:107], a[144:147], v[120:123], v[232:235]
    v_exp_f32 v80, v80
    v_mfma_f32_16x16x32_bf16 v[104:107], a[148:151], v[152:155], v[104:107]
    ds_read_b64_tr_b16 a[192:193], v26 offset:32768
    ds_read_b64_tr_b16 a[194:195], v26 offset:36864
    v_mfma_f32_16x16x32_bf16 v[104:107], a[152:155], v[184:187], v[104:107]
    v_exp_f32 v81, v81
    v_mfma_f32_16x16x32_bf16 v[104:107], a[156:159], v[216:219], v[104:107]
    s_add_u32 m0, s40, 6144
    ds_read_b64_tr_b16 a[196:197], v26 offset:40960
    v_cvt_pk_bf16_f32 v242, v80, v81
    v_mfma_f32_16x16x32_bf16 v[108:111], a[156:159], v[220:223], v[236:239]
    buffer_load_dwordx4 v9, s[28:31], s41 offen lds
    v_mfma_f32_16x16x32_bf16 v[108:111], a[152:155], v[188:191], v[108:111]
    v_exp_f32 v82, v82
    v_mfma_f32_16x16x32_bf16 v[108:111], a[148:151], v[156:159], v[108:111]
    ds_read_b64_tr_b16 a[198:199], v26 offset:45056
    ds_read_b64_tr_b16 a[200:201], v27 offset:32768
    v_mfma_f32_16x16x32_bf16 v[108:111], a[144:147], v[124:127], v[108:111]
    s_waitcnt lgkmcnt(14)
    v_exp_f32 v83, v83
    v_mfma_f32_16x16x32_bf16 a[0:3], a[176:179], v[160:163], a[0:3]
    s_waitcnt lgkmcnt(13)
    ds_read_b64_tr_b16 a[202:203], v27 offset:36864
    v_cvt_pk_bf16_f32 v243, v82, v83
    v_mfma_f32_16x16x32_bf16 a[0:3], a[180:183], v[192:195], a[0:3]
    v_exp_f32 v68, v68
    v_mfma_f32_16x16x32_bf16 a[32:35], a[180:183], v[196:199], a[32:35]
    v_exp_f32 v69, v69
    v_mfma_f32_16x16x32_bf16 a[32:35], a[176:179], v[164:167], a[32:35]
    ds_read_b64_tr_b16 a[204:205], v27 offset:40960
    v_cvt_pk_bf16_f32 v244, v68, v69
    v_mfma_f32_16x16x32_bf16 a[64:67], a[176:179], v[168:171], a[64:67]
    v_exp_f32 v70, v70
    v_mfma_f32_16x16x32_bf16 a[64:67], a[180:183], v[200:203], a[64:67]
    s_add_u32 m0, s40, 7168
    ds_read_b64_tr_b16 a[206:207], v27 offset:45056
    v_mfma_f32_16x16x32_bf16 a[96:99], a[180:183], v[204:207], a[96:99]
    buffer_load_dwordx4 v10, s[28:31], s41 offen lds
    v_mfma_f32_16x16x32_bf16 a[96:99], a[176:179], v[172:175], a[96:99]
    s_waitcnt lgkmcnt(14)
    v_exp_f32 v71, v71
    v_mfma_f32_16x16x32_bf16 a[4:7], a[184:187], v[160:163], a[4:7]
    s_waitcnt lgkmcnt(12)
    v_cvt_pk_bf16_f32 v245, v70, v71
    v_mfma_f32_16x16x32_bf16 a[4:7], a[188:191], v[192:195], a[4:7]
    v_exp_f32 v84, v84
    v_mfma_f32_16x16x32_bf16 a[36:39], a[188:191], v[196:199], a[36:39]
    v_mfma_f32_16x16x32_bf16 a[36:39], a[184:187], v[164:167], a[36:39]
    v_exp_f32 v85, v85
    v_mfma_f32_16x16x32_bf16 a[68:71], a[184:187], v[168:171], a[68:71]
    s_add_u32 m0, s40, 8192
    v_cvt_pk_bf16_f32 v246, v84, v85
    v_mfma_f32_16x16x32_bf16 a[68:71], a[188:191], v[200:203], a[68:71]
    s_add_u32 s84, s84, 16384
    buffer_load_dwordx4 v11, s[28:31], s41 offen lds
    v_mfma_f32_16x16x32_bf16 a[100:103], a[188:191], v[204:207], a[100:103]
    s_waitcnt vmcnt(14)
    s_waitcnt lgkmcnt(0)
    v_exp_f32 v86, v86
    v_mfma_f32_16x16x32_bf16 a[100:103], a[184:187], v[172:175], a[100:103]
    s_barrier
    v_mfma_f32_16x16x32_bf16 a[128:131], a[208:211], v[160:163], a[128:131]
    s_add_u32 s85, s85, 16384
    v_exp_f32 v87, v87
    v_mfma_f32_16x16x32_bf16 a[128:131], a[208:211], v[192:195], a[128:131]
    ds_read_b64_tr_b16 a[176:177], v28 offset:32768
    v_cvt_pk_bf16_f32 v247, v86, v87
    v_mfma_f32_16x16x32_bf16 v[128:131], a[160:163], v[112:115], v[224:227]
    v_exp_f32 v72, v72
    v_mfma_f32_16x16x32_bf16 v[128:131], a[164:167], v[144:147], v[128:131]
    ds_read_b64_tr_b16 a[178:179], v28 offset:36864
    v_mfma_f32_16x16x32_bf16 v[128:131], a[168:171], v[176:179], v[128:131]
    v_exp_f32 v73, v73
    v_mfma_f32_16x16x32_bf16 v[128:131], a[172:175], v[208:211], v[128:131]
    s_add_u32 s41, s72, 2
    s_and_b32 s41, s41, 3
    s_lshl2_add_u32 s41, s41, s70
    s_mul_i32 s41, s41, 36864
    s_add_u32 s40, s81, 36864
    s_add_u32 m0, s40, 0
    ds_read_b64_tr_b16 a[180:181], v28 offset:40960
    v_cvt_pk_bf16_f32 v248, v72, v73
    v_mfma_f32_16x16x32_bf16 v[132:135], a[172:175], v[212:215], v[228:231]
    buffer_load_dwordx4 v3, s[28:31], s41 offen lds
    v_mfma_f32_16x16x32_bf16 v[132:135], a[168:171], v[180:183], v[132:135]
    v_exp_f32 v74, v74
    v_mfma_f32_16x16x32_bf16 v[132:135], a[164:167], v[148:151], v[132:135]
    ds_read_b64_tr_b16 a[182:183], v28 offset:45056
    v_mfma_f32_16x16x32_bf16 v[132:135], a[160:163], v[116:119], v[132:135]
    v_exp_f32 v75, v75
    v_mfma_f32_16x16x32_bf16 v[136:139], a[160:163], v[120:123], v[232:235]
    ds_read_b64_tr_b16 a[184:185], v29 offset:32768
    v_cvt_pk_bf16_f32 v249, v74, v75
    v_mfma_f32_16x16x32_bf16 v[136:139], a[164:167], v[152:155], v[136:139]
    v_exp_f32 v88, v88
    v_mfma_f32_16x16x32_bf16 v[136:139], a[168:171], v[184:187], v[136:139]
    ds_read_b64_tr_b16 a[186:187], v29 offset:36864
    v_mfma_f32_16x16x32_bf16 v[136:139], a[172:175], v[216:219], v[136:139]
    v_exp_f32 v89, v89
    v_mfma_f32_16x16x32_bf16 v[140:143], a[172:175], v[220:223], v[236:239]
    s_add_u32 m0, s40, 1024
    ds_read_b64_tr_b16 a[188:189], v29 offset:40960
    v_cvt_pk_bf16_f32 v250, v88, v89
    v_mfma_f32_16x16x32_bf16 v[140:143], a[168:171], v[188:191], v[140:143]
    buffer_load_dwordx4 v4, s[28:31], s41 offen lds
    v_mfma_f32_16x16x32_bf16 v[140:143], a[164:167], v[156:159], v[140:143]
    ds_read_b64_tr_b16 a[190:191], v29 offset:45056
    v_mfma_f32_16x16x32_bf16 v[140:143], a[160:163], v[124:127], v[140:143]
    s_waitcnt vmcnt(15)
    v_exp_f32 v90, v90
    v_mfma_f32_16x16x32_bf16 a[224:227], a[252:255], a[212:215], a[224:227]
    v_mfma_f32_16x16x32_bf16 a[228:231], a[250:253], a[212:215], a[228:231]
    s_waitcnt vmcnt(14)
    v_exp_f32 v91, v91
    v_mfma_f32_16x16x32_bf16 a[232:235], a[252:255], a[216:219], a[232:235]
    v_cvt_pk_bf16_f32 v251, v90, v91
    v_mfma_f32_16x16x32_bf16 a[236:239], a[250:253], a[216:219], a[236:239]
    s_waitcnt vmcnt(13)
    v_exp_f32 v76, v76
    v_mfma_f32_16x16x32_bf16 a[240:243], a[252:255], a[220:223], a[240:243]
    s_add_u32 m0, s40, 2048
    v_mfma_f32_16x16x32_bf16 a[244:247], a[250:253], a[220:223], a[244:247]
    buffer_load_dwordx4 v5, s[28:31], s41 offen lds
    v_mfma_f32_16x16x32_bf16 a[8:11], a[192:195], v[160:163], a[8:11]
    v_exp_f32 v77, v77
    v_mfma_f32_16x16x32_bf16 a[8:11], a[196:199], v[192:195], a[8:11]
    v_cvt_pk_bf16_f32 v252, v76, v77
    v_mfma_f32_16x16x32_bf16 a[40:43], a[196:199], v[196:199], a[40:43]
    v_exp_f32 v78, v78
    v_mfma_f32_16x16x32_bf16 a[40:43], a[192:195], v[164:167], a[40:43]
    v_mfma_f32_16x16x32_bf16 a[72:75], a[192:195], v[168:171], a[72:75]
    s_add_u32 m0, s40, 3072
    v_mfma_f32_16x16x32_bf16 a[72:75], a[196:199], v[200:203], a[72:75]
    buffer_load_dwordx4 v6, s[28:31], s41 offen lds
    v_mfma_f32_16x16x32_bf16 a[104:107], a[196:199], v[204:207], a[104:107]
    v_exp_f32 v79, v79
    v_mfma_f32_16x16x32_bf16 a[104:107], a[192:195], v[172:175], a[104:107]
    v_cvt_pk_bf16_f32 v253, v78, v79
    v_mfma_f32_16x16x32_bf16 a[12:15], a[200:203], v[160:163], a[12:15]
    v_exp_f32 v92, v92
    v_mfma_f32_16x16x32_bf16 a[12:15], a[204:207], v[192:195], a[12:15]
    v_mfma_f32_16x16x32_bf16 a[44:47], a[204:207], v[196:199], a[44:47]
    v_exp_f32 v93, v93
    v_mfma_f32_16x16x32_bf16 a[44:47], a[200:203], v[164:167], a[44:47]
    v_cvt_pk_bf16_f32 v254, v92, v93
    v_mfma_f32_16x16x32_bf16 a[76:79], a[200:203], v[168:171], a[76:79]
    v_exp_f32 v94, v94
    v_mfma_f32_16x16x32_bf16 a[76:79], a[204:207], v[200:203], a[76:79]
    s_add_u32 m0, s40, 4096
    v_mfma_f32_16x16x32_bf16 a[108:111], a[204:207], v[204:207], a[108:111]
    buffer_load_dwordx4 v7, s[28:31], s41 offen lds
    v_mfma_f32_16x16x32_bf16 a[108:111], a[200:203], v[172:175], a[108:111]
    v_exp_f32 v95, v95
    v_mfma_f32_16x16x32_bf16 a[132:135], a[208:211], v[196:199], a[132:135]
    v_cvt_pk_bf16_f32 v255, v94, v95
    v_mfma_f32_16x16x32_bf16 a[132:135], a[208:211], v[164:167], a[132:135]
    s_waitcnt lgkmcnt(6)
    v_mfma_f32_16x16x32_bf16 a[16:19], a[176:179], v[160:163], a[16:19]
    s_waitcnt lgkmcnt(4)
    ds_read_b64_tr_b16 a[192:193], v30 offset:32768
    ds_read_b64_tr_b16 a[194:195], v30 offset:36864
    ds_read_b64_tr_b16 a[196:197], v30 offset:40960
    ds_read_b64_tr_b16 a[198:199], v30 offset:45056
    v_exp_f32 v96, v96
    v_mfma_f32_16x16x32_bf16 a[16:19], a[180:183], v[192:195], a[16:19]
    ds_read_b64_tr_b16 a[200:201], v31 offset:32768
    ds_read_b64_tr_b16 a[202:203], v31 offset:36864
    ds_read_b64_tr_b16 a[204:205], v31 offset:40960
    ds_read_b64_tr_b16 a[206:207], v31 offset:45056
    v_exp_f32 v97, v97
    v_mfma_f32_16x16x32_bf16 a[48:51], a[180:183], v[196:199], a[48:51]
    s_add_u32 m0, s40, 5120
    v_cvt_pk_bf16_f32 v32, v96, v97
    v_exp_f32 v98, v98
    v_mfma_f32_16x16x32_bf16 a[48:51], a[176:179], v[164:167], a[48:51]
    buffer_load_dwordx4 v8, s[28:31], s41 offen lds
    v_exp_f32 v99, v99
    v_mfma_f32_16x16x32_bf16 a[80:83], a[176:179], v[168:171], a[80:83]
    ds_read_b64_tr_b16 a[144:145], v28 offset:49152
    ds_read_b64_tr_b16 a[146:147], v28 offset:53248
    ds_read_b64_tr_b16 a[148:149], v28 offset:57344
    v_cvt_pk_bf16_f32 v33, v98, v99
    v_exp_f32 v128, v128
    v_mfma_f32_16x16x32_bf16 a[80:83], a[180:183], v[200:203], a[80:83]
    s_add_u32 m0, s40, 6144
    ds_read_b64_tr_b16 a[150:151], v28 offset:61440
    ds_read_b64_tr_b16 a[152:153], v29 offset:49152
    ds_read_b64_tr_b16 a[154:155], v29 offset:53248
    ds_read_b64_tr_b16 a[156:157], v29 offset:57344
    v_exp_f32 v129, v129
    v_mfma_f32_16x16x32_bf16 a[112:115], a[180:183], v[204:207], a[112:115]
    buffer_load_dwordx4 v9, s[28:31], s41 offen lds
    ds_read_b64_tr_b16 a[158:159], v29 offset:61440
    ds_read_b64_tr_b16 a[160:161], v30 offset:49152
    ds_read_b64_tr_b16 a[162:163], v30 offset:53248
    v_cvt_pk_bf16_f32 v34, v128, v129
    v_exp_f32 v130, v130
    v_mfma_f32_16x16x32_bf16 a[112:115], a[176:179], v[172:175], a[112:115]
    s_waitcnt lgkmcnt(10)
    ds_read_b64_tr_b16 a[164:165], v30 offset:57344
    ds_read_b64_tr_b16 a[166:167], v30 offset:61440
    ds_read_b64_tr_b16 a[168:169], v31 offset:49152
    ds_read_b64_tr_b16 a[170:171], v31 offset:53248
    v_exp_f32 v131, v131
    v_mfma_f32_16x16x32_bf16 a[20:23], a[184:187], v[160:163], a[20:23]
    ds_read_b64_tr_b16 a[172:173], v31 offset:57344
    ds_read_b64_tr_b16 a[174:175], v31 offset:61440
    v_cvt_pk_bf16_f32 v35, v130, v131
    v_exp_f32 v100, v100
    v_mfma_f32_16x16x32_bf16 a[20:23], a[188:191], v[192:195], a[20:23]
    s_add_u32 m0, s40, 7168
    v_exp_f32 v101, v101
    v_mfma_f32_16x16x32_bf16 a[52:55], a[188:191], v[196:199], a[52:55]
    buffer_load_dwordx4 v10, s[28:31], s41 offen lds
    v_cvt_pk_bf16_f32 v36, v100, v101
    v_exp_f32 v102, v102
    v_mfma_f32_16x16x32_bf16 a[52:55], a[184:187], v[164:167], a[52:55]
    v_exp_f32 v103, v103
    v_mfma_f32_16x16x32_bf16 a[84:87], a[184:187], v[168:171], a[84:87]
    s_add_u32 m0, s40, 8192
    v_cvt_pk_bf16_f32 v37, v102, v103
    v_exp_f32 v132, v132
    v_mfma_f32_16x16x32_bf16 a[84:87], a[188:191], v[200:203], a[84:87]
    buffer_load_dwordx4 v11, s[28:31], s41 offen lds
    v_exp_f32 v133, v133
    v_mfma_f32_16x16x32_bf16 a[116:119], a[188:191], v[204:207], a[116:119]
    v_cvt_pk_bf16_f32 v38, v132, v133
    v_exp_f32 v134, v134
    v_mfma_f32_16x16x32_bf16 a[116:119], a[184:187], v[172:175], a[116:119]
    v_exp_f32 v135, v135
    v_mfma_f32_16x16x32_bf16 a[136:139], a[208:211], v[168:171], a[136:139]
    ds_read_b64_tr_b16 a[176:177], v24 offset:49152
    ds_read_b64_tr_b16 a[178:179], v24 offset:53248
    ds_read_b64_tr_b16 a[180:181], v24 offset:57344
    v_cvt_pk_bf16_f32 v39, v134, v135
    v_mfma_f32_16x16x32_bf16 a[136:139], a[208:211], v[200:203], a[136:139]
    ds_read_b64_tr_b16 a[182:183], v24 offset:61440
    ds_read_b64_tr_b16 a[184:185], v25 offset:49152
    ds_read_b64_tr_b16 a[186:187], v25 offset:53248
    ds_read_b64_tr_b16 a[188:189], v25 offset:57344
    v_exp_f32 v104, v104
    v_mfma_f32_16x16x32_bf16 a[24:27], a[192:195], v[160:163], a[24:27]
    ds_read_b64_tr_b16 a[190:191], v25 offset:61440
    v_exp_f32 v105, v105
    v_mfma_f32_16x16x32_bf16 a[24:27], a[196:199], v[192:195], a[24:27]
    v_cvt_pk_bf16_f32 v48, v104, v105
    v_exp_f32 v106, v106
    v_mfma_f32_16x16x32_bf16 a[56:59], a[196:199], v[196:199], a[56:59]
    v_exp_f32 v107, v107
    v_mfma_f32_16x16x32_bf16 a[56:59], a[192:195], v[164:167], a[56:59]
    v_cvt_pk_bf16_f32 v49, v106, v107
    v_exp_f32 v136, v136
    v_mfma_f32_16x16x32_bf16 a[88:91], a[192:195], v[168:171], a[88:91]
    v_exp_f32 v137, v137
    v_mfma_f32_16x16x32_bf16 a[88:91], a[196:199], v[200:203], a[88:91]
    v_cvt_pk_bf16_f32 v50, v136, v137
    v_exp_f32 v138, v138
    v_mfma_f32_16x16x32_bf16 a[120:123], a[196:199], v[204:207], a[120:123]
    v_exp_f32 v139, v139
    v_mfma_f32_16x16x32_bf16 a[120:123], a[192:195], v[172:175], a[120:123]
    v_cvt_pk_bf16_f32 v51, v138, v139
    v_exp_f32 v108, v108
    v_mfma_f32_16x16x32_bf16 a[28:31], a[200:203], v[160:163], a[28:31]
    v_exp_f32 v109, v109
    v_mfma_f32_16x16x32_bf16 a[28:31], a[204:207], v[192:195], a[28:31]
    v_cvt_pk_bf16_f32 v52, v108, v109
    v_exp_f32 v110, v110
    v_mfma_f32_16x16x32_bf16 a[60:63], a[204:207], v[196:199], a[60:63]
    v_exp_f32 v111, v111
    v_mfma_f32_16x16x32_bf16 a[60:63], a[200:203], v[164:167], a[60:63]
    v_cvt_pk_bf16_f32 v53, v110, v111
    v_exp_f32 v140, v140
    v_mfma_f32_16x16x32_bf16 a[92:95], a[200:203], v[168:171], a[92:95]
    v_exp_f32 v141, v141
    v_mfma_f32_16x16x32_bf16 a[92:95], a[204:207], v[200:203], a[92:95]
    v_cvt_pk_bf16_f32 v54, v140, v141
    v_exp_f32 v142, v142
    v_mfma_f32_16x16x32_bf16 a[124:127], a[204:207], v[204:207], a[124:127]
    v_exp_f32 v143, v143
    v_mfma_f32_16x16x32_bf16 a[124:127], a[200:203], v[172:175], a[124:127]
    v_cvt_pk_bf16_f32 v55, v142, v143
    v_mfma_f32_16x16x32_bf16 a[140:143], a[208:211], v[204:207], a[140:143]
    v_mfma_f32_16x16x32_bf16 a[140:143], a[208:211], v[172:175], a[140:143]
    v_mfma_f32_16x16x32_bf16 a[128:131], a[208:211], v[240:243], a[128:131]
    s_add_u32 s41, s72, 3
    ds_read_b64_tr_b16 a[192:193], v26 offset:49152
    ds_read_b64_tr_b16 a[194:195], v26 offset:53248
    v_mfma_f32_16x16x32_bf16 a[128:131], a[208:211], v[32:35], a[128:131]
    s_and_b32 s41, s41, 3
    ds_read_b64_tr_b16 a[196:197], v26 offset:57344
    ds_read_b64_tr_b16 a[198:199], v26 offset:61440
    v_mfma_f32_16x16x32_bf16 a[132:135], a[208:211], v[36:39], a[132:135]
    s_lshl2_add_u32 s41, s41, s70
    ds_read_b64_tr_b16 a[200:201], v27 offset:49152
    ds_read_b64_tr_b16 a[202:203], v27 offset:53248
    v_mfma_f32_16x16x32_bf16 a[132:135], a[208:211], v[244:247], a[132:135]
    s_mul_i32 s41, s41, 36864
    ds_read_b64_tr_b16 a[204:205], v27 offset:57344
    ds_read_b64_tr_b16 a[206:207], v27 offset:61440
    v_mfma_f32_16x16x32_bf16 a[136:139], a[208:211], v[248:251], a[136:139]
    s_add_u32 s40, s81, 101376
    v_mfma_f32_16x16x32_bf16 a[136:139], a[208:211], v[48:51], a[136:139]
    s_cmp_eq_u32 s70, 3
    s_cselect_b32 s40, 147456, s40
    v_mfma_f32_16x16x32_bf16 a[140:143], a[208:211], v[52:55], a[140:143]
    s_mov_b32 s84, s80
    v_mfma_f32_16x16x32_bf16 a[140:143], a[208:211], v[252:255], a[140:143]
    s_waitcnt lgkmcnt(14)
    s_add_u32 s85, s84, 131072
    v_mfma_f32_16x16x32_bf16 a[0:3], a[176:179], v[240:243], a[0:3]
    s_waitcnt lgkmcnt(12)
    s_add_u32 s91, s85, 131072
    v_mfma_f32_16x16x32_bf16 a[0:3], a[180:183], v[32:35], a[0:3]
    s_add_u32 s26, s91, 131072
    v_mfma_f32_16x16x32_bf16 a[32:35], a[180:183], v[36:39], a[32:35]
    v_mfma_f32_16x16x32_bf16 a[32:35], a[176:179], v[244:247], a[32:35]
    s_waitcnt lgkmcnt(0)
    v_accvgpr_read_b32 v192, a128
    v_accvgpr_read_b32 v194, a132
    v_mfma_f32_16x16x32_bf16 a[4:7], a[184:187], v[240:243], a[4:7]
    s_barrier
    v_accvgpr_read_b32 v196, a136
    v_accvgpr_read_b32 v198, a140
    v_mfma_f32_16x16x32_bf16 a[4:7], a[188:191], v[32:35], a[4:7]
    s_add_u32 m0, s40, 0
    v_add_f32 v200, v192, v194
    v_add_f32 v201, v196, v198
    v_mfma_f32_16x16x32_bf16 a[36:39], a[188:191], v[36:39], a[36:39]
    v_mov_b32 v202, 0x4b800000
    v_add_f32 v200, v200, v201
    v_mfma_f32_16x16x32_bf16 a[36:39], a[184:187], v[244:247], a[36:39]
    v_cmp_nlt_f32 vcc, v200, v202
    v_mfma_f32_16x16x32_bf16 a[16:19], a[144:147], v[240:243], a[16:19]
    v_rcp_f32 v192, v192
    v_mfma_f32_16x16x32_bf16 a[16:19], a[148:151], v[32:35], a[16:19]
    buffer_load_dwordx4 v3, s[28:31], s41 offen lds
    v_mfma_f32_16x16x32_bf16 a[48:51], a[148:151], v[36:39], a[48:51]
    s_add_u32 m0, s40, 1024
    v_mfma_f32_16x16x32_bf16 a[48:51], a[144:147], v[244:247], a[48:51]
    s_and_saveexec_b64 s[96:97], vcc
    s_cbranch_execz Lnoflag
    ds_write_b32 v45, v202
Lnoflag:
    s_mov_b64 exec, -1
    v_mfma_f32_16x16x32_bf16 a[20:23], a[152:155], v[240:243], a[20:23]
    buffer_load_dwordx4 v4, s[28:31], s41 offen lds
    v_mfma_f32_16x16x32_bf16 a[20:23], a[156:159], v[32:35], a[20:23]
    s_add_u32 m0, s40, 2048
    v_rcp_f32 v194, v194
    v_mfma_f32_16x16x32_bf16 a[52:55], a[156:159], v[36:39], a[52:55]
    v_rcp_f32 v196, v196
    v_mfma_f32_16x16x32_bf16 a[52:55], a[152:155], v[244:247], a[52:55]
    buffer_load_dwordx4 v5, s[28:31], s41 offen lds
    v_mfma_f32_16x16x32_bf16 a[24:27], a[160:163], v[240:243], a[24:27]
    s_add_u32 m0, s40, 3072
    v_rcp_f32 v198, v198
    v_mfma_f32_16x16x32_bf16 a[24:27], a[164:167], v[32:35], a[24:27]
    s_waitcnt vmcnt(3)
    v_accvgpr_read_b32 v160, a0
    s_waitcnt lgkmcnt(0)
    v_mfma_f32_16x16x32_bf16 a[56:59], a[164:167], v[36:39], a[56:59]
    s_barrier
    ds_read_b32 v200, v45
    v_accvgpr_read_b32 v161, a1
    v_mfma_f32_16x16x32_bf16 a[56:59], a[160:163], v[244:247], a[56:59]
    buffer_load_dwordx4 v6, s[28:31], s41 offen lds
    v_mfma_f32_16x16x32_bf16 a[28:31], a[168:171], v[240:243], a[28:31]
    s_add_u32 m0, s40, 4096
    v_accvgpr_read_b32 v162, a2
    v_accvgpr_read_b32 v163, a3
    v_mfma_f32_16x16x32_bf16 a[28:31], a[172:175], v[32:35], a[28:31]
    v_accvgpr_read_b32 v164, a4
    v_accvgpr_read_b32 v165, a5
    v_mfma_f32_16x16x32_bf16 a[60:63], a[172:175], v[36:39], a[60:63]
    v_accvgpr_read_b32 v166, a6
    v_accvgpr_read_b32 v167, a7
    v_mfma_f32_16x16x32_bf16 a[60:63], a[168:171], v[244:247], a[60:63]
    buffer_load_dwordx4 v7, s[28:31], s41 offen lds
    v_mfma_f32_16x16x32_bf16 a[8:11], a[192:195], v[240:243], a[8:11]
    s_add_u32 m0, s40, 5120
    v_mul_f32 v160, v160, v192
    v_mul_f32 v161, v161, v192
    v_mfma_f32_16x16x32_bf16 a[8:11], a[196:199], v[32:35], a[8:11]
    v_mul_f32 v162, v162, v192
    v_mul_f32 v163, v163, v192
    v_mfma_f32_16x16x32_bf16 a[40:43], a[196:199], v[36:39], a[40:43]
    v_mul_f32 v164, v164, v192
    v_mul_f32 v165, v165, v192
    v_mfma_f32_16x16x32_bf16 a[40:43], a[192:195], v[244:247], a[40:43]
    v_mul_f32 v166, v166, v192
    v_mul_f32 v167, v167, v192
    v_mfma_f32_16x16x32_bf16 a[12:15], a[200:203], v[240:243], a[12:15]
Lqad1:
    s_cbranch_execz Lqad5
    buffer_load_dwordx4 v8, s[28:31], s41 offen lds
    v_mfma_f32_16x16x32_bf16 a[12:15], a[204:207], v[32:35], a[12:15]
    s_add_u32 m0, s40, 6144
    v_cvt_pk_bf16_f32 v64, v160, v161
    v_cvt_pk_bf16_f32 v65, v162, v163
    v_mfma_f32_16x16x32_bf16 a[44:47], a[204:207], v[36:39], a[44:47]
    v_cvt_pk_bf16_f32 v66, v164, v165
    v_cvt_pk_bf16_f32 v67, v166, v167
    v_mfma_f32_16x16x32_bf16 a[44:47], a[200:203], v[244:247], a[44:47]
    v_accvgpr_read_b32 v168, a32
    v_accvgpr_read_b32 v169, a33
    v_mfma_f32_16x16x32_bf16 a[64:67], a[176:179], v[248:251], a[64:67]
    v_accvgpr_read_b32 v170, a34
    v_accvgpr_read_b32 v171, a35
    v_mfma_f32_16x16x32_bf16 a[64:67], a[180:183], v[48:51], a[64:67]
    buffer_load_dwordx4 v9, s[28:31], s41 offen lds
    v_mfma_f32_16x16x32_bf16 a[96:99], a[180:183], v[52:55], a[96:99]
    s_add_u32 m0, s40, 7168
    v_accvgpr_read_b32 v172, a36
    v_accvgpr_read_b32 v173, a37
    v_mfma_f32_16x16x32_bf16 a[96:99], a[176:179], v[252:255], a[96:99]
    v_accvgpr_read_b32 v174, a38
    v_accvgpr_read_b32 v175, a39
    v_mfma_f32_16x16x32_bf16 a[68:71], a[184:187], v[248:251], a[68:71]
    v_mul_f32 v168, v168, v194
    v_mul_f32 v169, v169, v194
    v_mfma_f32_16x16x32_bf16 a[68:71], a[188:191], v[48:51], a[68:71]
    v_mul_f32 v170, v170, v194
    v_mul_f32 v171, v171, v194
    v_mfma_f32_16x16x32_bf16 a[100:103], a[188:191], v[52:55], a[100:103]
    buffer_load_dwordx4 v10, s[28:31], s41 offen lds
    v_mfma_f32_16x16x32_bf16 a[100:103], a[184:187], v[252:255], a[100:103]
    s_add_u32 m0, s40, 8192
    v_mul_f32 v172, v172, v194
    v_mul_f32 v173, v173, v194
    v_mfma_f32_16x16x32_bf16 a[80:83], a[144:147], v[248:251], a[80:83]
    v_mul_f32 v174, v174, v194
    v_mul_f32 v175, v175, v194
    v_mfma_f32_16x16x32_bf16 a[80:83], a[148:151], v[48:51], a[80:83]
    v_cvt_pk_bf16_f32 v68, v168, v169
    v_cvt_pk_bf16_f32 v69, v170, v171
    v_mfma_f32_16x16x32_bf16 a[112:115], a[148:151], v[52:55], a[112:115]
    v_cvt_pk_bf16_f32 v70, v172, v173
    v_cvt_pk_bf16_f32 v71, v174, v175
    v_mfma_f32_16x16x32_bf16 a[112:115], a[144:147], v[252:255], a[112:115]
    buffer_load_dwordx4 v11, s[28:31], s41 offen lds
    v_mfma_f32_16x16x32_bf16 a[84:87], a[152:155], v[248:251], a[84:87]
    v_accvgpr_read_b32 v160, a16
    v_accvgpr_read_b32 v161, a17
    v_mfma_f32_16x16x32_bf16 a[84:87], a[156:159], v[48:51], a[84:87]
    v_accvgpr_read_b32 v162, a18
    v_accvgpr_read_b32 v163, a19
    v_mfma_f32_16x16x32_bf16 a[116:119], a[156:159], v[52:55], a[116:119]
    v_accvgpr_read_b32 v164, a20
    v_accvgpr_read_b32 v165, a21
    v_mfma_f32_16x16x32_bf16 a[116:119], a[152:155], v[252:255], a[116:119]
    v_accvgpr_read_b32 v166, a22
    v_accvgpr_read_b32 v167, a23
    v_mfma_f32_16x16x32_bf16 a[88:91], a[160:163], v[248:251], a[88:91]
    buffer_store_dwordx4 v[64:67], v2, s[52:55], s84 offen offset:0 nt
    v_mfma_f32_16x16x32_bf16 a[88:91], a[164:167], v[48:51], a[88:91]
    v_mul_f32 v160, v160, v192
    v_mul_f32 v161, v161, v192
    v_mfma_f32_16x16x32_bf16 a[120:123], a[164:167], v[52:55], a[120:123]
    v_mul_f32 v162, v162, v192
    v_mul_f32 v163, v163, v192
    v_mfma_f32_16x16x32_bf16 a[120:123], a[160:163], v[252:255], a[120:123]
    v_mul_f32 v164, v164, v192
    v_mul_f32 v165, v165, v192
    v_mfma_f32_16x16x32_bf16 a[92:95], a[168:171], v[248:251], a[92:95]
    v_mul_f32 v166, v166, v192
    v_mul_f32 v167, v167, v192
    v_mfma_f32_16x16x32_bf16 a[92:95], a[172:175], v[48:51], a[92:95]
    v_cvt_pk_bf16_f32 v96, v160, v161
    v_cvt_pk_bf16_f32 v97, v162, v163
    v_mfma_f32_16x16x32_bf16 a[124:127], a[172:175], v[52:55], a[124:127]
    v_cvt_pk_bf16_f32 v98, v164, v165
    v_cvt_pk_bf16_f32 v99, v166, v167
    v_mfma_f32_16x16x32_bf16 a[124:127], a[168:171], v[252:255], a[124:127]
    v_accvgpr_read_b32 v168, a48
    v_accvgpr_read_b32 v169, a49
    v_mfma_f32_16x16x32_bf16 a[72:75], a[192:195], v[248:251], a[72:75]
    v_accvgpr_read_b32 v170, a50
    v_accvgpr_read_b32 v171, a51
    v_mfma_f32_16x16x32_bf16 a[72:75], a[196:199], v[48:51], a[72:75]
    v_accvgpr_read_b32 v172, a52
    v_accvgpr_read_b32 v173, a53
    v_mfma_f32_16x16x32_bf16 a[104:107], a[196:199], v[52:55], a[104:107]
    buffer_store_dwordx4 v[68:71], v2, s[52:55], s84 offen offset:1024 nt
    v_mfma_f32_16x16x32_bf16 a[104:107], a[192:195], v[252:255], a[104:107]
    v_accvgpr_read_b32 v174, a54
    v_accvgpr_read_b32 v175, a55
    v_mfma_f32_16x16x32_bf16 a[76:79], a[200:203], v[248:251], a[76:79]
    v_mul_f32 v168, v168, v194
    v_mul_f32 v169, v169, v194
    v_mfma_f32_16x16x32_bf16 a[76:79], a[204:207], v[48:51], a[76:79]
    v_mul_f32 v170, v170, v194
    v_mul_f32 v171, v171, v194
    v_mfma_f32_16x16x32_bf16 a[108:111], a[204:207], v[52:55], a[108:111]
    v_mul_f32 v172, v172, v194
    v_mul_f32 v173, v173, v194
    v_mfma_f32_16x16x32_bf16 a[108:111], a[200:203], v[252:255], a[108:111]
    s_waitcnt lgkmcnt(0)
    v_mul_f32 v174, v174, v194
    v_mul_f32 v175, v175, v194
    v_cvt_pk_bf16_f32 v100, v168, v169
    v_cvt_pk_bf16_f32 v101, v170, v171
    v_cvt_pk_bf16_f32 v102, v172, v173
    v_cvt_pk_bf16_f32 v103, v174, v175
    s_nop 2
    buffer_store_dwordx4 v[96:99], v2, s[52:55], s91 offen offset:0 nt
    v_accvgpr_read_b32 v160, a24
    v_accvgpr_read_b32 v161, a25
    v_accvgpr_read_b32 v162, a26
    v_accvgpr_read_b32 v163, a27
    v_accvgpr_read_b32 v164, a28
    v_accvgpr_read_b32 v165, a29
    v_accvgpr_read_b32 v166, a30
    v_accvgpr_read_b32 v167, a31
    v_pk_mul_f32 v[160:161], v[160:161], v[192:193] op_sel:[0,0] op_sel_hi:[1,0]
    v_pk_mul_f32 v[162:163], v[162:163], v[192:193] op_sel:[0,0] op_sel_hi:[1,0]
    v_pk_mul_f32 v[164:165], v[164:165], v[192:193] op_sel:[0,0] op_sel_hi:[1,0]
    v_pk_mul_f32 v[166:167], v[166:167], v[192:193] op_sel:[0,0] op_sel_hi:[1,0]
    v_cvt_pk_bf16_f32 v128, v160, v161
    v_cvt_pk_bf16_f32 v129, v162, v163
    v_cvt_pk_bf16_f32 v130, v164, v165
    v_cvt_pk_bf16_f32 v131, v166, v167
    v_readfirstlane_b32 s89, v200
    s_nop 1
    s_andn2_b32 s89, s89, s87
    s_cbranch_scc1 Lfallback
    v_accvgpr_read_b32 v168, a56
    v_accvgpr_read_b32 v169, a57
    v_accvgpr_read_b32 v170, a58
    v_accvgpr_read_b32 v171, a59
    v_accvgpr_read_b32 v172, a60
    v_accvgpr_read_b32 v173, a61
    v_accvgpr_read_b32 v174, a62
    v_accvgpr_read_b32 v175, a63
    v_pk_mul_f32 v[168:169], v[168:169], v[194:195] op_sel:[0,0] op_sel_hi:[1,0]
    v_pk_mul_f32 v[170:171], v[170:171], v[194:195] op_sel:[0,0] op_sel_hi:[1,0]
    v_pk_mul_f32 v[172:173], v[172:173], v[194:195] op_sel:[0,0] op_sel_hi:[1,0]
    v_pk_mul_f32 v[174:175], v[174:175], v[194:195] op_sel:[0,0] op_sel_hi:[1,0]
    v_cvt_pk_bf16_f32 v132, v168, v169
    v_cvt_pk_bf16_f32 v133, v170, v171
    v_cvt_pk_bf16_f32 v134, v172, v173
    v_cvt_pk_bf16_f32 v135, v174, v175
    buffer_store_dwordx4 v[100:103], v2, s[52:55], s91 offen offset:1024 nt
    v_accvgpr_read_b32 v160, a8
    v_accvgpr_read_b32 v161, a9
    v_accvgpr_read_b32 v162, a10
    v_accvgpr_read_b32 v163, a11
    v_accvgpr_read_b32 v164, a12
    v_accvgpr_read_b32 v165, a13
    v_accvgpr_read_b32 v166, a14
    v_accvgpr_read_b32 v167, a15
    v_pk_mul_f32 v[160:161], v[160:161], v[192:193] op_sel:[0,0] op_sel_hi:[1,0]
    v_pk_mul_f32 v[162:163], v[162:163], v[192:193] op_sel:[0,0] op_sel_hi:[1,0]
    v_pk_mul_f32 v[164:165], v[164:165], v[192:193] op_sel:[0,0] op_sel_hi:[1,0]
    v_pk_mul_f32 v[166:167], v[166:167], v[192:193] op_sel:[0,0] op_sel_hi:[1,0]
    v_cvt_pk_bf16_f32 v80, v160, v161
    v_cvt_pk_bf16_f32 v81, v162, v163
    v_cvt_pk_bf16_f32 v82, v164, v165
    v_cvt_pk_bf16_f32 v83, v166, v167
    v_accvgpr_read_b32 v168, a40
    v_accvgpr_read_b32 v169, a41
    v_accvgpr_read_b32 v170, a42
    v_accvgpr_read_b32 v171, a43
    v_accvgpr_read_b32 v172, a44
    v_accvgpr_read_b32 v173, a45
    v_accvgpr_read_b32 v174, a46
    v_accvgpr_read_b32 v175, a47
    v_pk_mul_f32 v[168:169], v[168:169], v[194:195] op_sel:[0,0] op_sel_hi:[1,0]
    v_pk_mul_f32 v[170:171], v[170:171], v[194:195] op_sel:[0,0] op_sel_hi:[1,0]
    v_pk_mul_f32 v[172:173], v[172:173], v[194:195] op_sel:[0,0] op_sel_hi:[1,0]
    v_pk_mul_f32 v[174:175], v[174:175], v[194:195] op_sel:[0,0] op_sel_hi:[1,0]
    v_cvt_pk_bf16_f32 v84, v168, v169
    v_cvt_pk_bf16_f32 v85, v170, v171
    v_cvt_pk_bf16_f32 v86, v172, v173
    v_cvt_pk_bf16_f32 v87, v174, v175
    buffer_store_dwordx4 v[128:131], v2, s[52:55], s26 offen offset:0 nt
    v_accvgpr_read_b32 v160, a64
    v_accvgpr_read_b32 v161, a65
    v_accvgpr_read_b32 v162, a66
    v_accvgpr_read_b32 v163, a67
    v_accvgpr_read_b32 v164, a68
    v_accvgpr_read_b32 v165, a69
    v_accvgpr_read_b32 v166, a70
    v_accvgpr_read_b32 v167, a71
    v_pk_mul_f32 v[160:161], v[160:161], v[196:197] op_sel:[0,0] op_sel_hi:[1,0]
    v_pk_mul_f32 v[162:163], v[162:163], v[196:197] op_sel:[0,0] op_sel_hi:[1,0]
    v_pk_mul_f32 v[164:165], v[164:165], v[196:197] op_sel:[0,0] op_sel_hi:[1,0]
    v_pk_mul_f32 v[166:167], v[166:167], v[196:197] op_sel:[0,0] op_sel_hi:[1,0]
    v_cvt_pk_bf16_f32 v72, v160, v161
    v_cvt_pk_bf16_f32 v73, v162, v163
    v_cvt_pk_bf16_f32 v74, v164, v165
    v_cvt_pk_bf16_f32 v75, v166, v167
    v_accvgpr_read_b32 v168, a96
    v_accvgpr_read_b32 v169, a97
    v_accvgpr_read_b32 v170, a98
    v_accvgpr_read_b32 v171, a99
    v_accvgpr_read_b32 v172, a100
    v_accvgpr_read_b32 v173, a101
    v_accvgpr_read_b32 v174, a102
    v_accvgpr_read_b32 v175, a103
    v_pk_mul_f32 v[168:169], v[168:169], v[198:199] op_sel:[0,0] op_sel_hi:[1,0]
    v_pk_mul_f32 v[170:171], v[170:171], v[198:199] op_sel:[0,0] op_sel_hi:[1,0]
    v_pk_mul_f32 v[172:173], v[172:173], v[198:199] op_sel:[0,0] op_sel_hi:[1,0]
    v_pk_mul_f32 v[174:175], v[174:175], v[198:199] op_sel:[0,0] op_sel_hi:[1,0]
    v_cvt_pk_bf16_f32 v76, v168, v169
    v_cvt_pk_bf16_f32 v77, v170, v171
    v_cvt_pk_bf16_f32 v78, v172, v173
    v_cvt_pk_bf16_f32 v79, v174, v175
    v_accvgpr_read_b32 v160, a80
    v_accvgpr_read_b32 v161, a81
    v_accvgpr_read_b32 v162, a82
    v_accvgpr_read_b32 v163, a83
    v_accvgpr_read_b32 v164, a84
    v_accvgpr_read_b32 v165, a85
    v_accvgpr_read_b32 v166, a86
    v_accvgpr_read_b32 v167, a87
    v_pk_mul_f32 v[160:161], v[160:161], v[196:197] op_sel:[0,0] op_sel_hi:[1,0]
    v_pk_mul_f32 v[162:163], v[162:163], v[196:197] op_sel:[0,0] op_sel_hi:[1,0]
    v_pk_mul_f32 v[164:165], v[164:165], v[196:197] op_sel:[0,0] op_sel_hi:[1,0]
    v_pk_mul_f32 v[166:167], v[166:167], v[196:197] op_sel:[0,0] op_sel_hi:[1,0]
    v_cvt_pk_bf16_f32 v104, v160, v161
    v_cvt_pk_bf16_f32 v105, v162, v163
    v_cvt_pk_bf16_f32 v106, v164, v165
    v_cvt_pk_bf16_f32 v107, v166, v167
    buffer_store_dwordx4 v[132:135], v2, s[52:55], s26 offen offset:1024 nt
    v_accvgpr_read_b32 v168, a112
    v_accvgpr_read_b32 v169, a113
    v_accvgpr_read_b32 v170, a114
    v_accvgpr_read_b32 v171, a115
    v_accvgpr_read_b32 v172, a116
    v_accvgpr_read_b32 v173, a117
    v_accvgpr_read_b32 v174, a118
    v_accvgpr_read_b32 v175, a119
    v_pk_mul_f32 v[168:169], v[168:169], v[198:199] op_sel:[0,0] op_sel_hi:[1,0]
    v_pk_mul_f32 v[170:171], v[170:171], v[198:199] op_sel:[0,0] op_sel_hi:[1,0]
    v_pk_mul_f32 v[172:173], v[172:173], v[198:199] op_sel:[0,0] op_sel_hi:[1,0]
    v_pk_mul_f32 v[174:175], v[174:175], v[198:199] op_sel:[0,0] op_sel_hi:[1,0]
    v_cvt_pk_bf16_f32 v108, v168, v169
    v_cvt_pk_bf16_f32 v109, v170, v171
    v_cvt_pk_bf16_f32 v110, v172, v173
    v_cvt_pk_bf16_f32 v111, v174, v175
    v_accvgpr_read_b32 v160, a88
    v_accvgpr_read_b32 v161, a89
    v_accvgpr_read_b32 v162, a90
    v_accvgpr_read_b32 v163, a91
    v_accvgpr_read_b32 v164, a92
    v_accvgpr_read_b32 v165, a93
    v_accvgpr_read_b32 v166, a94
    v_accvgpr_read_b32 v167, a95
    v_pk_mul_f32 v[160:161], v[160:161], v[196:197] op_sel:[0,0] op_sel_hi:[1,0]
    v_pk_mul_f32 v[162:163], v[162:163], v[196:197] op_sel:[0,0] op_sel_hi:[1,0]
    v_pk_mul_f32 v[164:165], v[164:165], v[196:197] op_sel:[0,0] op_sel_hi:[1,0]
    v_pk_mul_f32 v[166:167], v[166:167], v[196:197] op_sel:[0,0] op_sel_hi:[1,0]
    v_cvt_pk_bf16_f32 v136, v160, v161
    v_cvt_pk_bf16_f32 v137, v162, v163
    v_cvt_pk_bf16_f32 v138, v164, v165
    v_cvt_pk_bf16_f32 v139, v166, v167
    buffer_store_dwordx4 v[80:83], v2, s[52:55], s85 offen offset:0 nt
    v_accvgpr_read_b32 v168, a120
    v_accvgpr_read_b32 v169, a121
    v_accvgpr_read_b32 v170, a122
    v_accvgpr_read_b32 v171, a123
    v_accvgpr_read_b32 v172, a124
    v_accvgpr_read_b32 v173, a125
    v_accvgpr_read_b32 v174, a126
    v_accvgpr_read_b32 v175, a127
    v_pk_mul_f32 v[168:169], v[168:169], v[198:199] op_sel:[0,0] op_sel_hi:[1,0]
    v_pk_mul_f32 v[170:171], v[170:171], v[198:199] op_sel:[0,0] op_sel_hi:[1,0]
    v_pk_mul_f32 v[172:173], v[172:173], v[198:199] op_sel:[0,0] op_sel_hi:[1,0]
    v_pk_mul_f32 v[174:175], v[174:175], v[198:199] op_sel:[0,0] op_sel_hi:[1,0]
    v_cvt_pk_bf16_f32 v140, v168, v169
    v_cvt_pk_bf16_f32 v141, v170, v171
    v_cvt_pk_bf16_f32 v142, v172, v173
    v_cvt_pk_bf16_f32 v143, v174, v175
    v_accvgpr_read_b32 v160, a72
    v_accvgpr_read_b32 v161, a73
    v_accvgpr_read_b32 v162, a74
    v_accvgpr_read_b32 v163, a75
    v_accvgpr_read_b32 v164, a76
    v_accvgpr_read_b32 v165, a77
    v_accvgpr_read_b32 v166, a78
    v_accvgpr_read_b32 v167, a79
    v_pk_mul_f32 v[160:161], v[160:161], v[196:197] op_sel:[0,0] op_sel_hi:[1,0]
    v_pk_mul_f32 v[162:163], v[162:163], v[196:197] op_sel:[0,0] op_sel_hi:[1,0]
    v_pk_mul_f32 v[164:165], v[164:165], v[196:197] op_sel:[0,0] op_sel_hi:[1,0]
    v_pk_mul_f32 v[166:167], v[166:167], v[196:197] op_sel:[0,0] op_sel_hi:[1,0]
    v_cvt_pk_bf16_f32 v88, v160, v161
    v_cvt_pk_bf16_f32 v89, v162, v163
    v_cvt_pk_bf16_f32 v90, v164, v165
    v_cvt_pk_bf16_f32 v91, v166, v167
    v_accvgpr_read_b32 v168, a104
    v_accvgpr_read_b32 v169, a105
    v_accvgpr_read_b32 v170, a106
    v_accvgpr_read_b32 v171, a107
    v_accvgpr_read_b32 v172, a108
    v_accvgpr_read_b32 v173, a109
    v_accvgpr_read_b32 v174, a110
    v_accvgpr_read_b32 v175, a111
    v_pk_mul_f32 v[168:169], v[168:169], v[198:199] op_sel:[0,0] op_sel_hi:[1,0]
    v_pk_mul_f32 v[170:171], v[170:171], v[198:199] op_sel:[0,0] op_sel_hi:[1,0]
    v_pk_mul_f32 v[172:173], v[172:173], v[198:199] op_sel:[0,0] op_sel_hi:[1,0]
    v_pk_mul_f32 v[174:175], v[174:175], v[198:199] op_sel:[0,0] op_sel_hi:[1,0]
    v_cvt_pk_bf16_f32 v92, v168, v169
    v_cvt_pk_bf16_f32 v93, v170, v171
    v_cvt_pk_bf16_f32 v94, v172, v173
    v_cvt_pk_bf16_f32 v95, v174, v175
    buffer_store_dwordx4 v[84:87], v2, s[52:55], s85 offen offset:1024 nt
    v_mov_b32 v4, v196
    v_mov_b32 v5, v198
    v_mov_b32 v15, s22
    v_and_b32 v59, 0x0fffffff, v59
    v_and_b32 v246, 8, v0
    s_cmp_lt_u32 s70, 2
    s_cselect_b32 s89, 3, 2
    v_lshl_add_u32 v246, v246, s89, v46
    ds_read_b64_tr_b16 v[16:17], v56 offset:0
    ds_read_b64_tr_b16 v[18:19], v56 offset:4608
    ds_read_b64_tr_b16 v[20:21], v56 offset:18432
    ds_read_b64_tr_b16 v[22:23], v56 offset:23040
    ds_read_b64_tr_b16 v[24:25], v56 offset:32
    ds_read_b64_tr_b16 v[26:27], v56 offset:4640
    ds_read_b64_tr_b16 v[28:29], v56 offset:18464
    ds_read_b64_tr_b16 v[30:31], v56 offset:23072
    s_waitcnt lgkmcnt(6)
    v_mfma_f32_16x16x32_bf16 v[112:115], v[16:19], v[64:67], 0
    s_waitcnt lgkmcnt(4)
    s_lshl2_add_u32 s73, s72, s14
    ds_read_b64_tr_b16 v[32:33], v56 offset:64
    ds_read_b64_tr_b16 v[34:35], v56 offset:4672
    v_mfma_f32_16x16x32_bf16 v[112:115], v[20:23], v[96:99], v[112:115]
    s_add_u32 s75, s73, 98304
    ds_read_b64_tr_b16 v[36:37], v56 offset:18496
    ds_read_b64_tr_b16 v[38:39], v56 offset:23104
    v_mfma_f32_16x16x32_bf16 v[116:119], v[20:23], v[100:103], 0
    s_cmp_eq_u32 s27, 0
    s_cselect_b32 s79, s79, s14
    ds_read_b64_tr_b16 v[40:41], v56 offset:96
    v_mfma_f32_16x16x32_bf16 v[116:119], v[16:19], v[68:71], v[116:119]
    s_cmp_eq_u32 s27, 0
    s_cselect_b32 s73, 1879048192, s73
    ds_read_b64_tr_b16 v[42:43], v56 offset:4704
    v_mfma_f32_16x16x32_bf16 v[120:123], v[16:19], v[72:75], 0
    buffer_store_dwordx4 v[72:75], v2, s[52:55], s84 offen offset:2048 nt
    v_mfma_f32_16x16x32_bf16 v[120:123], v[20:23], v[104:107], v[120:123]
    ds_read_b64_tr_b16 v[44:45], v56 offset:18528
    ds_read_b64_tr_b16 v[46:47], v56 offset:23136
    v_mfma_f32_16x16x32_bf16 v[124:127], v[20:23], v[108:111], 0
    ds_read_b64_tr_b16 v[48:49], v56 offset:128
    ds_read_b64_tr_b16 v[50:51], v56 offset:4736
    v_mfma_f32_16x16x32_bf16 v[124:127], v[16:19], v[76:79], v[124:127]
    s_waitcnt lgkmcnt(12)
    ds_read_b64_tr_b16 v[52:53], v56 offset:18560
    ds_read_b64_tr_b16 v[54:55], v56 offset:23168
    v_mfma_f32_16x16x32_bf16 v[144:147], v[24:27], v[64:67], 0
    s_waitcnt lgkmcnt(12)
    ds_read_b64_tr_b16 v[16:17], v56 offset:160
    ds_read_b64_tr_b16 v[18:19], v56 offset:4768
    v_mfma_f32_16x16x32_bf16 v[144:147], v[28:31], v[96:99], v[144:147]
    ds_read_b64_tr_b16 v[20:21], v56 offset:18592
    ds_read_b64_tr_b16 v[22:23], v56 offset:23200
    v_mfma_f32_16x16x32_bf16 v[148:151], v[28:31], v[100:103], 0
    v_mfma_f32_16x16x32_bf16 v[148:151], v[24:27], v[68:71], v[148:151]
    v_mfma_f32_16x16x32_bf16 v[152:155], v[24:27], v[72:75], 0
    buffer_store_dwordx4 v[76:79], v2, s[52:55], s84 offen offset:3072 nt
    v_mfma_f32_16x16x32_bf16 v[152:155], v[28:31], v[104:107], v[152:155]
    v_mfma_f32_16x16x32_bf16 v[156:159], v[28:31], v[108:111], 0
    v_mfma_f32_16x16x32_bf16 v[156:159], v[24:27], v[76:79], v[156:159]
    s_waitcnt lgkmcnt(14)
    v_mfma_f32_16x16x32_bf16 a[176:179], v[32:35], v[64:67], 0
    s_waitcnt lgkmcnt(12)
    ds_read_b64_tr_b16 v[24:25], v56 offset:192
    ds_read_b64_tr_b16 v[26:27], v56 offset:4800
    v_mfma_f32_16x16x32_bf16 a[176:179], v[36:39], v[96:99], a[176:179]
    ds_read_b64_tr_b16 v[28:29], v56 offset:18624
    ds_read_b64_tr_b16 v[30:31], v56 offset:23232
    v_mfma_f32_16x16x32_bf16 a[180:183], v[36:39], v[100:103], 0
    v_mfma_f32_16x16x32_bf16 a[180:183], v[32:35], v[68:71], a[180:183]
    v_mfma_f32_16x16x32_bf16 a[184:187], v[32:35], v[72:75], 0
    v_mfma_f32_16x16x32_bf16 a[184:187], v[36:39], v[104:107], a[184:187]
    v_mfma_f32_16x16x32_bf16 a[188:191], v[36:39], v[108:111], 0
    buffer_store_dwordx4 v[104:107], v2, s[52:55], s91 offen offset:2048 nt
    v_mfma_f32_16x16x32_bf16 a[188:191], v[32:35], v[76:79], a[188:191]
    s_waitcnt lgkmcnt(14)
    v_mfma_f32_16x16x32_bf16 v[176:179], v[40:43], v[64:67], 0
    s_waitcnt lgkmcnt(12)
    ds_read_b64_tr_b16 v[32:33], v56 offset:224
    ds_read_b64_tr_b16 v[34:35], v56 offset:4832
    v_mfma_f32_16x16x32_bf16 v[176:179], v[44:47], v[96:99], v[176:179]
    ds_read_b64_tr_b16 v[36:37], v56 offset:18656
    ds_read_b64_tr_b16 v[38:39], v56 offset:23264
    v_mfma_f32_16x16x32_bf16 v[180:183], v[44:47], v[100:103], 0
    v_mfma_f32_16x16x32_bf16 v[180:183], v[40:43], v[68:71], v[180:183]
    v_mfma_f32_16x16x32_bf16 v[184:187], v[40:43], v[72:75], 0
    v_mfma_f32_16x16x32_bf16 v[184:187], v[44:47], v[104:107], v[184:187]
    s_waitcnt vmcnt(3)
    v_mfma_f32_16x16x32_bf16 v[188:191], v[44:47], v[108:111], 0
    s_barrier
    s_cmp_lg_u32 s27, 0
    s_cbranch_scc1 Lrel_oa
Lrel2_oa:
    v_mfma_f32_16x16x32_bf16 v[188:191], v[40:43], v[76:79], v[188:191]
    s_waitcnt lgkmcnt(14)
    buffer_store_dword v15, v63, s[56:59], s75 offen offset:16
    v_mfma_f32_16x16x32_bf16 v[208:211], v[48:51], v[64:67], 0
    s_waitcnt lgkmcnt(12)
    ds_read_b64_tr_b16 v[40:41], v56 offset:256
    ds_read_b64_tr_b16 v[42:43], v56 offset:4864
    v_mfma_f32_16x16x32_bf16 v[208:211], v[52:55], v[96:99], v[208:211]
    buffer_store_dword v15, v63, s[56:59], s73 offen offset:16 sc1
    v_mfma_f32_16x16x32_bf16 v[212:215], v[52:55], v[100:103], 0
    ds_read_b64_tr_b16 v[44:45], v56 offset:18688
    ds_read_b64_tr_b16 v[46:47], v56 offset:23296
    v_mfma_f32_16x16x32_bf16 v[212:215], v[48:51], v[68:71], v[212:215]
    buffer_store_dwordx4 v[108:111], v2, s[52:55], s91 offen offset:3072 nt
    v_mfma_f32_16x16x32_bf16 v[216:219], v[48:51], v[72:75], 0
    v_mfma_f32_16x16x32_bf16 v[216:219], v[52:55], v[104:107], v[216:219]
    v_mfma_f32_16x16x32_bf16 v[220:223], v[52:55], v[108:111], 0
    v_mfma_f32_16x16x32_bf16 v[220:223], v[48:51], v[76:79], v[220:223]
    s_waitcnt lgkmcnt(14)
    v_mfma_f32_16x16x32_bf16 a[192:195], v[16:19], v[64:67], 0
    s_waitcnt lgkmcnt(12)
    ds_read_b64_tr_b16 v[48:49], v56 offset:27648
    ds_read_b64_tr_b16 v[50:51], v56 offset:32256
    v_mfma_f32_16x16x32_bf16 a[192:195], v[20:23], v[96:99], a[192:195]
    ds_read_b64_tr_b16 v[52:53], v56 offset:9216
    ds_read_b64_tr_b16 v[54:55], v56 offset:13824
    v_mfma_f32_16x16x32_bf16 a[196:199], v[20:23], v[100:103], 0
    v_mfma_f32_16x16x32_bf16 a[196:199], v[16:19], v[68:71], a[196:199]
    v_mfma_f32_16x16x32_bf16 a[200:203], v[16:19], v[72:75], 0
    buffer_store_dwordx4 v[136:139], v2, s[52:55], s26 offen offset:2048 nt
    v_mfma_f32_16x16x32_bf16 a[200:203], v[20:23], v[104:107], a[200:203]
    v_mfma_f32_16x16x32_bf16 a[204:207], v[20:23], v[108:111], 0
    v_mfma_f32_16x16x32_bf16 a[204:207], v[16:19], v[76:79], a[204:207]
    s_waitcnt lgkmcnt(14)
    v_mfma_f32_16x16x32_bf16 v[160:163], v[24:27], v[64:67], 0
    s_waitcnt lgkmcnt(12)
    ds_read_b64_tr_b16 v[16:17], v56 offset:27680
    ds_read_b64_tr_b16 v[18:19], v56 offset:32288
    v_mfma_f32_16x16x32_bf16 v[160:163], v[28:31], v[96:99], v[160:163]
    ds_read_b64_tr_b16 v[20:21], v56 offset:9248
    ds_read_b64_tr_b16 v[22:23], v56 offset:13856
    v_mfma_f32_16x16x32_bf16 v[164:167], v[28:31], v[100:103], 0
    v_mfma_f32_16x16x32_bf16 v[164:167], v[24:27], v[68:71], v[164:167]
    v_mfma_f32_16x16x32_bf16 v[168:171], v[24:27], v[72:75], 0
    v_mfma_f32_16x16x32_bf16 v[168:171], v[28:31], v[104:107], v[168:171]
    v_mfma_f32_16x16x32_bf16 v[172:175], v[28:31], v[108:111], 0
    buffer_store_dwordx4 v[140:143], v2, s[52:55], s26 offen offset:3072 nt
    v_mfma_f32_16x16x32_bf16 v[172:175], v[24:27], v[76:79], v[172:175]
    s_waitcnt lgkmcnt(14)
    v_mfma_f32_16x16x32_bf16 v[192:195], v[32:35], v[64:67], 0
    s_waitcnt lgkmcnt(12)
    buffer_load_dword v14, v1, s[56:59], s79 offen offset:16 sc1
    v_mfma_f32_16x16x32_bf16 v[192:195], v[36:39], v[96:99], v[192:195]
    ds_read_b64_tr_b16 v[24:25], v56 offset:27712
    ds_read_b64_tr_b16 v[26:27], v56 offset:32320
    v_mfma_f32_16x16x32_bf16 v[196:199], v[36:39], v[100:103], 0
    ds_read_b64_tr_b16 v[28:29], v56 offset:9280
    ds_read_b64_tr_b16 v[30:31], v56 offset:13888
    v_mfma_f32_16x16x32_bf16 v[196:199], v[32:35], v[68:71], v[196:199]
    v_mfma_f32_16x16x32_bf16 v[200:203], v[32:35], v[72:75], 0
    v_mfma_f32_16x16x32_bf16 v[200:203], v[36:39], v[104:107], v[200:203]
    v_mfma_f32_16x16x32_bf16 v[204:207], v[36:39], v[108:111], 0
    v_mfma_f32_16x16x32_bf16 v[204:207], v[32:35], v[76:79], v[204:207]
    s_waitcnt lgkmcnt(14)
    v_mfma_f32_16x16x32_bf16 v[224:227], v[40:43], v[64:67], 0
    s_waitcnt lgkmcnt(12)
    ds_read_b64_tr_b16 v[32:33], v56 offset:27744
    ds_read_b64_tr_b16 v[34:35], v56 offset:32352
    v_mfma_f32_16x16x32_bf16 v[224:227], v[44:47], v[96:99], v[224:227]
    buffer_store_dwordx4 v[88:91], v2, s[52:55], s85 offen offset:2048 nt
    v_mfma_f32_16x16x32_bf16 v[228:231], v[44:47], v[100:103], 0
    ds_read_b64_tr_b16 v[36:37], v56 offset:9312
    ds_read_b64_tr_b16 v[38:39], v56 offset:13920
    v_mfma_f32_16x16x32_bf16 v[228:231], v[40:43], v[68:71], v[228:231]
    v_mfma_f32_16x16x32_bf16 v[232:235], v[40:43], v[72:75], 0
    v_mfma_f32_16x16x32_bf16 v[232:235], v[44:47], v[104:107], v[232:235]
    v_mfma_f32_16x16x32_bf16 v[236:239], v[44:47], v[108:111], 0
    v_mfma_f32_16x16x32_bf16 v[236:239], v[40:43], v[76:79], v[236:239]
    s_waitcnt lgkmcnt(14)
    v_mfma_f32_16x16x32_bf16 v[112:115], v[48:51], v[128:131], v[112:115]
    s_waitcnt lgkmcnt(12)
    ds_read_b64_tr_b16 v[40:41], v56 offset:27776
    ds_read_b64_tr_b16 v[42:43], v56 offset:32384
    v_mfma_f32_16x16x32_bf16 v[112:115], v[52:55], v[80:83], v[112:115]
    ds_read_b64_tr_b16 v[44:45], v56 offset:9344
    ds_read_b64_tr_b16 v[46:47], v56 offset:13952
    v_mfma_f32_16x16x32_bf16 v[116:119], v[52:55], v[84:87], v[116:119]
    v_mfma_f32_16x16x32_bf16 v[116:119], v[48:51], v[132:135], v[116:119]
    buffer_store_dwordx4 v[92:95], v2, s[52:55], s85 offen offset:3072 nt
    v_mfma_f32_16x16x32_bf16 v[120:123], v[48:51], v[136:139], v[120:123]
    s_add_u32 s42, s72, 1
    v_mfma_f32_16x16x32_bf16 v[120:123], v[52:55], v[88:91], v[120:123]
    s_and_b32 s42, s42, 3
    v_mfma_f32_16x16x32_bf16 v[124:127], v[52:55], v[92:95], v[124:127]
    s_mul_i32 s42, s42, 9
    v_mfma_f32_16x16x32_bf16 v[124:127], v[48:51], v[140:143], v[124:127]
    s_waitcnt lgkmcnt(14)
    s_add_u32 s42, s42, 1
    v_mfma_f32_16x16x32_bf16 v[144:147], v[16:19], v[128:131], v[144:147]
    s_waitcnt lgkmcnt(12)
    s_lshr_b32 s42, s42, 1
    ds_read_b64_tr_b16 v[48:49], v56 offset:27808
    ds_read_b64_tr_b16 v[50:51], v56 offset:32416
    v_mfma_f32_16x16x32_bf16 v[144:147], v[20:23], v[80:83], v[144:147]
    s_add_u32 s42, s42, s3
    ds_read_b64_tr_b16 v[52:53], v56 offset:9376
    ds_read_b64_tr_b16 v[54:55], v56 offset:13984
    v_mfma_f32_16x16x32_bf16 v[148:151], v[20:23], v[84:87], v[148:151]
    s_lshl_b32 s42, s42, 17
    v_accvgpr_read_b32 v240, a250
    v_accvgpr_read_b32 v241, a251
    v_mfma_f32_16x16x32_bf16 v[148:151], v[16:19], v[132:135], v[148:151]
    v_accvgpr_read_b32 v242, a252
    v_accvgpr_read_b32 v243, a253
    v_mfma_f32_16x16x32_bf16 v[152:155], v[16:19], v[136:139], v[152:155]
    s_waitcnt vmcnt(2)
    v_cmp_ne_u32 vcc, s22, v14
    s_nop 0
    s_or_b32 s43, vcc_lo, s27
    s_cbranch_scc1 Lspin_oa
Lret_oa:
    v_mfma_f32_16x16x32_bf16 v[152:155], v[20:23], v[88:91], v[152:155]
    buffer_load_dwordx4 a[0:3], v2, s[52:55], s42 offen offset:0 sc1
    v_mfma_f32_16x16x32_bf16 v[156:159], v[20:23], v[92:95], v[156:159]
    v_accvgpr_read_b32 v244, a254
    v_accvgpr_read_b32 v245, a255
    v_mfma_f32_16x16x32_bf16 v[156:159], v[16:19], v[140:143], v[156:159]
    s_waitcnt lgkmcnt(14)
    v_mfma_f32_16x16x32_bf16 a[176:179], v[24:27], v[128:131], a[176:179]
    s_waitcnt lgkmcnt(12)
    ds_read_b64_tr_b16 v[16:17], v56 offset:27840
    ds_read_b64_tr_b16 v[18:19], v56 offset:32448
    v_mfma_f32_16x16x32_bf16 a[176:179], v[28:31], v[80:83], a[176:179]
    ds_read_b64_tr_b16 v[20:21], v56 offset:9408
    ds_read_b64_tr_b16 v[22:23], v56 offset:14016
    v_mfma_f32_16x16x32_bf16 a[180:183], v[28:31], v[84:87], a[180:183]
    buffer_load_dwordx4 a[4:7], v2, s[52:55], s42 offen offset:1024 sc1
    v_mfma_f32_16x16x32_bf16 a[180:183], v[24:27], v[132:135], a[180:183]
    s_add_u32 s42, s42, 131072
    v_mfma_f32_16x16x32_bf16 a[184:187], v[24:27], v[136:139], a[184:187]
    v_mfma_f32_16x16x32_bf16 a[184:187], v[28:31], v[88:91], a[184:187]
    v_mfma_f32_16x16x32_bf16 a[188:191], v[28:31], v[92:95], a[188:191]
    buffer_load_dwordx4 a[8:11], v2, s[52:55], s42 offen offset:0 sc1
    v_mfma_f32_16x16x32_bf16 a[188:191], v[24:27], v[140:143], a[188:191]
    s_waitcnt lgkmcnt(14)
    v_mfma_f32_16x16x32_bf16 v[176:179], v[32:35], v[128:131], v[176:179]
    s_waitcnt lgkmcnt(12)
    ds_read_b64_tr_b16 v[24:25], v56 offset:27872
    ds_read_b64_tr_b16 v[26:27], v56 offset:32480
    v_mfma_f32_16x16x32_bf16 v[176:179], v[36:39], v[80:83], v[176:179]
Lqad2:
    s_cbranch_execz Lwalk2_done
    ds_read_b64_tr_b16 v[28:29], v56 offset:9440
    ds_read_b64_tr_b16 v[30:31], v56 offset:14048
    v_mfma_f32_16x16x32_bf16 v[180:183], v[36:39], v[84:87], v[180:183]
    v_mfma_f32_16x16x32_bf16 v[180:183], v[32:35], v[132:135], v[180:183]
    buffer_load_dwordx4 a[12:15], v2, s[52:55], s42 offen offset:1024 sc1
    v_mfma_f32_16x16x32_bf16 v[184:187], v[32:35], v[136:139], v[184:187]
    s_add_u32 s42, s42, 131072
    v_mfma_f32_16x16x32_bf16 v[184:187], v[36:39], v[88:91], v[184:187]
    v_mfma_f32_16x16x32_bf16 v[188:191], v[36:39], v[92:95], v[188:191]
    v_mfma_f32_16x16x32_bf16 v[188:191], v[32:35], v[140:143], v[188:191]
    s_waitcnt lgkmcnt(14)
    buffer_load_dwordx4 a[16:19], v2, s[52:55], s42 offen offset:0 sc1
    v_mfma_f32_16x16x32_bf16 v[208:211], v[40:43], v[128:131], v[208:211]
    s_waitcnt lgkmcnt(12)
    ds_read_b64_tr_b16 v[32:33], v56 offset:27904
    ds_read_b64_tr_b16 v[34:35], v56 offset:32512
    v_mfma_f32_16x16x32_bf16 v[208:211], v[44:47], v[80:83], v[208:211]
    ds_read_b64_tr_b16 v[36:37], v56 offset:9472
    ds_read_b64_tr_b16 v[38:39], v56 offset:14080
    v_mfma_f32_16x16x32_bf16 v[212:215], v[44:47], v[84:87], v[212:215]
    v_mfma_f32_16x16x32_bf16 v[212:215], v[40:43], v[132:135], v[212:215]
    s_waitcnt vmcnt(5)
    v_mfma_f32_16x16x32_bf16 v[216:219], v[40:43], v[136:139], v[216:219]
    s_barrier
    s_cmp_lg_u32 s27, 0
    s_cbranch_scc1 Lrel_ob
Lrel2_ob:
    v_mfma_f32_16x16x32_bf16 v[216:219], v[44:47], v[88:91], v[216:219]
    buffer_store_dword v15, v63, s[56:59], s75 offen offset:48
    v_mfma_f32_16x16x32_bf16 v[220:223], v[44:47], v[92:95], v[220:223]
    s_lshr_b32 s91, s71, 1
    v_mfma_f32_16x16x32_bf16 v[220:223], v[40:43], v[140:143], v[220:223]
    s_waitcnt lgkmcnt(14)
    s_lshl2_add_u32 s91, s69, s91
    buffer_store_dword v15, v63, s[56:59], s73 offen offset:48 sc1
    v_mfma_f32_16x16x32_bf16 a[192:195], v[48:51], v[128:131], a[192:195]
    s_waitcnt lgkmcnt(12)
    s_mul_i32 s91, s91, 73728
    ds_read_b64_tr_b16 v[40:41], v57 offset:18432
    ds_read_b64_tr_b16 v[42:43], v57 offset:23040
    v_mfma_f32_16x16x32_bf16 a[192:195], v[52:55], v[80:83], a[192:195]
    s_mul_i32 s26, s72, 288
    buffer_load_dwordx4 a[20:23], v2, s[52:55], s42 offen offset:1024 sc1
    v_mfma_f32_16x16x32_bf16 a[196:199], v[52:55], v[84:87], a[196:199]
    s_add_u32 s42, s42, 131072
    ds_read_b64_tr_b16 v[44:45], v57 offset:27648
    ds_read_b64_tr_b16 v[46:47], v57 offset:32256
    v_mfma_f32_16x16x32_bf16 a[196:199], v[48:51], v[132:135], a[196:199]
    s_add_u32 s91, s91, s26
    buffer_load_dwordx4 a[24:27], v2, s[52:55], s42 offen offset:0 sc1
    v_mfma_f32_16x16x32_bf16 a[200:203], v[48:51], v[136:139], a[200:203]
    s_and_b32 s80, s71, 1
    v_mfma_f32_16x16x32_bf16 a[200:203], v[52:55], v[88:91], a[200:203]
    s_mul_i32 s26, s80, 36864
    v_mfma_f32_16x16x32_bf16 a[204:207], v[52:55], v[92:95], a[204:207]
    s_add_u32 s26, s26, s91
    buffer_load_dwordx4 a[28:31], v2, s[52:55], s42 offen offset:1024 sc1
    v_mfma_f32_16x16x32_bf16 a[204:207], v[48:51], v[140:143], a[204:207]
    s_waitcnt lgkmcnt(14)
    s_add_u32 s42, s72, 2
    v_mfma_f32_16x16x32_bf16 v[160:163], v[16:19], v[128:131], v[160:163]
    s_waitcnt lgkmcnt(12)
    s_and_b32 s42, s42, 3
    ds_read_b64_tr_b16 v[48:49], v57 offset:18464
    ds_read_b64_tr_b16 v[50:51], v57 offset:23072
    v_mfma_f32_16x16x32_bf16 v[160:163], v[20:23], v[80:83], v[160:163]
    s_mul_i32 s42, s42, 9
    ds_read_b64_tr_b16 v[52:53], v57 offset:27680
    ds_read_b64_tr_b16 v[54:55], v57 offset:32288
    v_mfma_f32_16x16x32_bf16 v[164:167], v[20:23], v[84:87], v[164:167]
    s_add_u32 s42, s42, 1
    v_mfma_f32_16x16x32_bf16 v[164:167], v[16:19], v[132:135], v[164:167]
    s_lshr_b32 s42, s42, 1
    v_mfma_f32_16x16x32_bf16 v[168:171], v[16:19], v[136:139], v[168:171]
    s_add_u32 s42, s42, s3
    v_mfma_f32_16x16x32_bf16 v[168:171], v[20:23], v[88:91], v[168:171]
    s_lshl_b32 s42, s42, 17
    buffer_load_dwordx4 a[32:35], v2, s[52:55], s42 offen offset:0 sc1
    v_mfma_f32_16x16x32_bf16 v[172:175], v[20:23], v[92:95], v[172:175]
    s_add_u32 s26, s26, 128
    v_mfma_f32_16x16x32_bf16 v[172:175], v[16:19], v[140:143], v[172:175]
    s_waitcnt lgkmcnt(14)
    buffer_load_dwordx4 a[36:39], v2, s[52:55], s42 offen offset:1024 sc1
    v_mfma_f32_16x16x32_bf16 v[192:195], v[24:27], v[128:131], v[192:195]
    s_waitcnt lgkmcnt(12)
    s_add_u32 s42, s42, 131072
    ds_read_b64_tr_b16 v[16:17], v57 offset:18496
    ds_read_b64_tr_b16 v[18:19], v57 offset:23104
    v_mfma_f32_16x16x32_bf16 v[192:195], v[28:31], v[80:83], v[192:195]
    ds_read_b64_tr_b16 v[20:21], v57 offset:27712
    ds_read_b64_tr_b16 v[22:23], v57 offset:32320
    v_mfma_f32_16x16x32_bf16 v[196:199], v[28:31], v[84:87], v[196:199]
    s_cmp_eq_u32 s70, 0
    s_cselect_b32 s26, s26, 1879048192
    v_mfma_f32_16x16x32_bf16 v[196:199], v[24:27], v[132:135], v[196:199]
    s_mul_i32 s80, s80, 5
    v_mfma_f32_16x16x32_bf16 v[200:203], v[24:27], v[136:139], v[200:203]
    s_add_u32 s80, s80, s70
    buffer_load_dwordx4 a[40:43], v2, s[52:55], s42 offen offset:0 sc1
    v_mfma_f32_16x16x32_bf16 v[200:203], v[28:31], v[88:91], v[200:203]
    s_lshl_b32 s80, s80, 5
    v_mfma_f32_16x16x32_bf16 v[204:207], v[28:31], v[92:95], v[204:207]
    s_add_u32 s91, s91, s80
    v_mfma_f32_16x16x32_bf16 v[204:207], v[24:27], v[140:143], v[204:207]
    s_waitcnt lgkmcnt(14)
    s_mov_b32 s86, 18432
    v_mfma_f32_16x16x32_bf16 v[224:227], v[32:35], v[128:131], v[224:227]
    s_waitcnt lgkmcnt(12)
    s_lshl2_add_u32 s74, s71, s15
    buffer_load_dwordx4 a[44:47], v2, s[52:55], s42 offen offset:1024 sc1
    v_mfma_f32_16x16x32_bf16 v[224:227], v[36:39], v[80:83], v[224:227]
    s_add_u32 s42, s42, 131072
    ds_read_b64_tr_b16 v[24:25], v57 offset:18528
    ds_read_b64_tr_b16 v[26:27], v57 offset:23136
    v_mfma_f32_16x16x32_bf16 v[228:231], v[36:39], v[84:87], v[228:231]
    s_lshl_b32 s87, 0x101, s71
    ds_read_b64_tr_b16 v[28:29], v57 offset:27744
    ds_read_b64_tr_b16 v[30:31], v57 offset:32352
    v_mfma_f32_16x16x32_bf16 v[228:231], v[32:35], v[132:135], v[228:231]
    s_lshl_b32 s78, s70, 1
    v_mfma_f32_16x16x32_bf16 v[232:235], v[32:35], v[136:139], v[232:235]
    buffer_load_dword v14, v1, s[56:59], s79 offen offset:48 sc1
    v_mfma_f32_16x16x32_bf16 v[232:235], v[36:39], v[88:91], v[232:235]
    s_cmp_eq_u32 s78, s71
    s_cselect_b32 s76, 1879048192, 0
    v_mfma_f32_16x16x32_bf16 v[236:239], v[36:39], v[92:95], v[236:239]
    s_add_u32 s78, s78, 1
    buffer_load_dwordx4 a[48:51], v2, s[52:55], s42 offen offset:0 sc1
    v_mfma_f32_16x16x32_bf16 v[236:239], v[32:35], v[140:143], v[236:239]
    s_waitcnt vmcnt(15) lgkmcnt(14)
    s_cmp_eq_u32 s78, s71
    s_cselect_b32 s77, 1879048192, 0
    v_and_b32 v11, 15, v0
    v_mfma_f32_16x16x32_bf16 v[112:115], v[40:43], a[0:3], v[112:115]
    s_waitcnt vmcnt(13) lgkmcnt(12)
    ds_read_b64_tr_b16 v[32:33], v57 offset:18560
    ds_read_b64_tr_b16 v[34:35], v57 offset:23168
    v_mfma_f32_16x16x32_bf16 v[112:115], v[44:47], a[8:11], v[112:115]
    s_waitcnt vmcnt(12)
    ds_read_b64_tr_b16 v[36:37], v57 offset:27776
    ds_read_b64_tr_b16 v[38:39], v57 offset:32384
    v_mfma_f32_16x16x32_bf16 v[116:119], v[44:47], a[12:15], v[116:119]
    buffer_load_dwordx4 a[52:55], v2, s[52:55], s42 offen offset:1024 sc1
    v_mfma_f32_16x16x32_bf16 v[116:119], v[40:43], a[4:7], v[116:119]
    s_waitcnt lgkmcnt(14)
    s_add_u32 s42, s42, 131072
    v_mul_u32_u24 v11, 1152, v11
    v_bfe_u32 v10, v0, 4, 2
    v_mfma_f32_16x16x32_bf16 v[144:147], v[48:51], a[0:3], v[144:147]
    s_waitcnt lgkmcnt(12)
    ds_read_b64_tr_b16 v[40:41], v57 offset:18592
    ds_read_b64_tr_b16 v[42:43], v57 offset:23200
    v_mfma_f32_16x16x32_bf16 v[144:147], v[52:55], a[8:11], v[144:147]
    ds_read_b64_tr_b16 v[44:45], v57 offset:27808
    ds_read_b64_tr_b16 v[46:47], v57 offset:32416
    v_mfma_f32_16x16x32_bf16 v[148:151], v[52:55], a[12:15], v[148:151]
    buffer_load_dwordx4 a[56:59], v2, s[52:55], s42 offen offset:0 sc1
    v_mfma_f32_16x16x32_bf16 v[148:151], v[48:51], a[4:7], v[148:151]
    s_waitcnt lgkmcnt(14)
    v_lshl_add_u32 v11, v10, 3, v11
    v_add_u32 v9, s91, v11
    v_mfma_f32_16x16x32_bf16 a[176:179], v[16:19], a[0:3], a[176:179]
    s_waitcnt lgkmcnt(12)
    ds_read_b64_tr_b16 v[48:49], v57 offset:18624
    ds_read_b64_tr_b16 v[50:51], v57 offset:23232
    v_mfma_f32_16x16x32_bf16 a[176:179], v[20:23], a[8:11], a[176:179]
    ds_read_b64_tr_b16 v[52:53], v57 offset:27840
    ds_read_b64_tr_b16 v[54:55], v57 offset:32448
    v_mfma_f32_16x16x32_bf16 a[180:183], v[20:23], a[12:15], a[180:183]
    v_add_u32 v10, 36864, v9
    v_add_u32 v11, s26, v11
    v_mfma_f32_16x16x32_bf16 a[180:183], v[16:19], a[4:7], a[180:183]
    s_waitcnt lgkmcnt(14)
    buffer_load_dwordx4 a[60:63], v2, s[52:55], s42 offen offset:1024 sc1
    v_mfma_f32_16x16x32_bf16 v[176:179], v[24:27], a[0:3], v[176:179]
    s_waitcnt lgkmcnt(12)
    s_add_u32 s42, s72, 3
    ds_read_b64_tr_b16 v[16:17], v57 offset:18656
    ds_read_b64_tr_b16 v[18:19], v57 offset:23264
    v_mfma_f32_16x16x32_bf16 v[176:179], v[28:31], a[8:11], v[176:179]
    s_and_b32 s42, s42, 3
    ds_read_b64_tr_b16 v[20:21], v57 offset:27872
    ds_read_b64_tr_b16 v[22:23], v57 offset:32480
    v_mfma_f32_16x16x32_bf16 v[180:183], v[28:31], a[12:15], v[180:183]
    s_mul_i32 s42, s42, 9
    v_mfma_f32_16x16x32_bf16 v[180:183], v[24:27], a[4:7], v[180:183]
    s_waitcnt lgkmcnt(14)
    s_add_u32 s42, s42, 1
    v_mfma_f32_16x16x32_bf16 v[208:211], v[32:35], a[0:3], v[208:211]
    s_waitcnt lgkmcnt(12)
    s_lshr_b32 s42, s42, 1
    ds_read_b64_tr_b16 v[24:25], v57 offset:18688
    ds_read_b64_tr_b16 v[26:27], v57 offset:23296
    v_mfma_f32_16x16x32_bf16 v[208:211], v[36:39], a[8:11], v[208:211]
    s_add_u32 s42, s42, s3
    ds_read_b64_tr_b16 v[28:29], v57 offset:27904
    ds_read_b64_tr_b16 v[30:31], v57 offset:32512
    v_mfma_f32_16x16x32_bf16 v[212:215], v[36:39], a[12:15], v[212:215]
    s_lshl_b32 s42, s42, 17
    buffer_load_dwordx4 a[64:67], v2, s[52:55], s42 offen offset:0 sc1
    v_mfma_f32_16x16x32_bf16 v[212:215], v[32:35], a[4:7], v[212:215]
    s_waitcnt lgkmcnt(14)
    v_mfma_f32_16x16x32_bf16 a[192:195], v[40:43], a[0:3], a[192:195]
    s_waitcnt lgkmcnt(12)
    buffer_load_dwordx4 a[68:71], v2, s[52:55], s42 offen offset:1024 sc1
    v_mfma_f32_16x16x32_bf16 a[192:195], v[44:47], a[8:11], a[192:195]
    s_add_u32 s42, s42, 131072
    ds_read_b64_tr_b16 v[32:33], v57 offset:36864
    ds_read_b64_tr_b16 v[34:35], v57 offset:41472
    v_mfma_f32_16x16x32_bf16 a[196:199], v[44:47], a[12:15], a[196:199]
    ds_read_b64_tr_b16 v[36:37], v58 offset:27648
    ds_read_b64_tr_b16 v[38:39], v58 offset:32256
    v_mfma_f32_16x16x32_bf16 a[196:199], v[40:43], a[4:7], a[196:199]
    s_waitcnt lgkmcnt(14)
    v_mfma_f32_16x16x32_bf16 v[160:163], v[48:51], a[0:3], v[160:163]
    s_waitcnt lgkmcnt(12)
    buffer_load_dwordx4 a[72:75], v2, s[52:55], s42 offen offset:0 sc1
    v_mfma_f32_16x16x32_bf16 v[160:163], v[52:55], a[8:11], v[160:163]
    ds_read_b64_tr_b16 v[40:41], v57 offset:36896
    ds_read_b64_tr_b16 v[42:43], v57 offset:41504
    v_mfma_f32_16x16x32_bf16 v[164:167], v[52:55], a[12:15], v[164:167]
    ds_read_b64_tr_b16 v[44:45], v58 offset:27680
    ds_read_b64_tr_b16 v[46:47], v58 offset:32288
    v_mfma_f32_16x16x32_bf16 v[164:167], v[48:51], a[4:7], v[164:167]
    s_waitcnt lgkmcnt(14)
    v_mfma_f32_16x16x32_bf16 v[192:195], v[16:19], a[0:3], v[192:195]
    s_waitcnt lgkmcnt(12)
    buffer_load_dwordx4 a[76:79], v2, s[52:55], s42 offen offset:1024 sc1
    v_mfma_f32_16x16x32_bf16 v[192:195], v[20:23], a[8:11], v[192:195]
    s_add_u32 s42, s42, 131072
    ds_read_b64_tr_b16 v[48:49], v57 offset:36928
    ds_read_b64_tr_b16 v[50:51], v57 offset:41536
    v_mfma_f32_16x16x32_bf16 v[196:199], v[20:23], a[12:15], v[196:199]
    ds_read_b64_tr_b16 v[52:53], v58 offset:27712
    ds_read_b64_tr_b16 v[54:55], v58 offset:32320
    v_mfma_f32_16x16x32_bf16 v[196:199], v[16:19], a[4:7], v[196:199]
    s_waitcnt lgkmcnt(14)
    v_mfma_f32_16x16x32_bf16 v[224:227], v[24:27], a[0:3], v[224:227]
    s_waitcnt lgkmcnt(12)
    ds_read_b64_tr_b16 v[16:17], v57 offset:36960
    ds_read_b64_tr_b16 v[18:19], v57 offset:41568
    v_mfma_f32_16x16x32_bf16 v[224:227], v[28:31], a[8:11], v[224:227]
    buffer_load_dwordx4 a[80:83], v2, s[52:55], s42 offen offset:0 sc1
    v_mfma_f32_16x16x32_bf16 v[228:231], v[28:31], a[12:15], v[228:231]
    s_waitcnt vmcnt(9)
    v_cmp_ne_u32 vcc, s22, v14
    s_nop 0
    s_or_b32 s43, vcc_lo, s27
    s_cbranch_scc1 Lspin_ob
Lret_ob:
    v_mfma_f32_16x16x32_bf16 v[228:231], v[24:27], a[4:7], v[228:231]
    s_waitcnt lgkmcnt(12)
    ds_read_b64_tr_b16 v[20:21], v58 offset:27744
    ds_read_b64_tr_b16 v[22:23], v58 offset:32352
    v_mfma_f32_16x16x32_bf16 v[112:115], v[32:35], a[16:19], v[112:115]
    s_waitcnt lgkmcnt(12)
    ds_read_b64_tr_b16 v[24:25], v57 offset:36992
    ds_read_b64_tr_b16 v[26:27], v57 offset:41600
    v_mfma_f32_16x16x32_bf16 v[112:115], v[36:39], a[24:27], v[112:115]
    buffer_load_dwordx4 a[84:87], v2, s[52:55], s42 offen offset:1024 sc1
    v_mfma_f32_16x16x32_bf16 v[116:119], v[36:39], a[28:31], v[116:119]
    s_add_u32 s42, s42, 131072
    ds_read_b64_tr_b16 v[28:29], v58 offset:27776
    ds_read_b64_tr_b16 v[30:31], v58 offset:32384
    v_mfma_f32_16x16x32_bf16 v[116:119], v[32:35], a[20:23], v[116:119]
    s_waitcnt lgkmcnt(14)
    v_mfma_f32_16x16x32_bf16 v[144:147], v[40:43], a[16:19], v[144:147]
    s_waitcnt lgkmcnt(12)
    ds_read_b64_tr_b16 v[32:33], v57 offset:37024
    ds_read_b64_tr_b16 v[34:35], v57 offset:41632
    v_mfma_f32_16x16x32_bf16 v[144:147], v[44:47], a[24:27], v[144:147]
    buffer_load_dwordx4 a[88:91], v2, s[52:55], s42 offen offset:0 sc1
    v_mfma_f32_16x16x32_bf16 v[148:151], v[44:47], a[28:31], v[148:151]
    ds_read_b64_tr_b16 v[36:37], v58 offset:27808
    ds_read_b64_tr_b16 v[38:39], v58 offset:32416
    v_mfma_f32_16x16x32_bf16 v[148:151], v[40:43], a[20:23], v[148:151]
    s_waitcnt lgkmcnt(14)
    v_mfma_f32_16x16x32_bf16 a[176:179], v[48:51], a[16:19], a[176:179]
    s_waitcnt lgkmcnt(12)
    ds_read_b64_tr_b16 v[40:41], v57 offset:37056
    ds_read_b64_tr_b16 v[42:43], v57 offset:41664
    v_mfma_f32_16x16x32_bf16 a[176:179], v[52:55], a[24:27], a[176:179]
    ds_read_b64_tr_b16 v[44:45], v58 offset:27840
    ds_read_b64_tr_b16 v[46:47], v58 offset:32448
    v_mfma_f32_16x16x32_bf16 a[180:183], v[52:55], a[28:31], a[180:183]
    buffer_load_dwordx4 a[92:95], v2, s[52:55], s42 offen offset:1024 sc1
    v_mfma_f32_16x16x32_bf16 a[180:183], v[48:51], a[20:23], a[180:183]
    s_waitcnt lgkmcnt(14)
    s_add_u32 s42, s72, 1
    v_mfma_f32_16x16x32_bf16 v[176:179], v[16:19], a[16:19], v[176:179]
    s_waitcnt lgkmcnt(12)
    s_and_b32 s42, s42, 3
    ds_read_b64_tr_b16 v[48:49], v57 offset:37088
    ds_read_b64_tr_b16 v[50:51], v57 offset:41696
    v_mfma_f32_16x16x32_bf16 v[176:179], v[20:23], a[24:27], v[176:179]
    s_mul_i32 s42, s42, 9
    ds_read_b64_tr_b16 v[52:53], v58 offset:27872
    ds_read_b64_tr_b16 v[54:55], v58 offset:32480
    v_mfma_f32_16x16x32_bf16 v[180:183], v[20:23], a[28:31], v[180:183]
    s_add_u32 s42, s42, 1
    v_mfma_f32_16x16x32_bf16 v[180:183], v[16:19], a[20:23], v[180:183]
    s_waitcnt lgkmcnt(14)
    s_lshr_b32 s42, s42, 1
    v_mfma_f32_16x16x32_bf16 v[208:211], v[24:27], a[16:19], v[208:211]
    s_waitcnt lgkmcnt(12)
    s_add_u32 s42, s42, s3
    ds_read_b64_tr_b16 v[16:17], v57 offset:37120
    ds_read_b64_tr_b16 v[18:19], v57 offset:41728
    v_mfma_f32_16x16x32_bf16 v[208:211], v[28:31], a[24:27], v[208:211]
    s_lshl_b32 s42, s42, 17
    buffer_load_dwordx4 a[96:99], v2, s[52:55], s42 offen offset:2048 sc1
    v_mfma_f32_16x16x32_bf16 v[212:215], v[28:31], a[28:31], v[212:215]
    ds_read_b64_tr_b16 v[20:21], v58 offset:27904
    ds_read_b64_tr_b16 v[22:23], v58 offset:32512
    v_mfma_f32_16x16x32_bf16 v[212:215], v[24:27], a[20:23], v[212:215]
    s_waitcnt lgkmcnt(14)
    buffer_load_dwordx4 a[100:103], v2, s[52:55], s42 offen offset:3072 sc1
    v_mfma_f32_16x16x32_bf16 a[192:195], v[32:35], a[16:19], a[192:195]
    s_waitcnt lgkmcnt(12)
    s_add_u32 s42, s42, 131072
    ds_read_b64_tr_b16 v[24:25], v56 offset:36864
    ds_read_b64_tr_b16 v[26:27], v56 offset:41472
    v_mfma_f32_16x16x32_bf16 a[192:195], v[36:39], a[24:27], a[192:195]
    ds_read_b64_tr_b16 v[28:29], v56 offset:46080
    ds_read_b64_tr_b16 v[30:31], v56 offset:50688
    v_mfma_f32_16x16x32_bf16 a[196:199], v[36:39], a[28:31], a[196:199]
    v_mfma_f32_16x16x32_bf16 a[196:199], v[32:35], a[20:23], a[196:199]
    s_waitcnt lgkmcnt(14)
    buffer_load_dwordx4 a[104:107], v2, s[52:55], s42 offen offset:2048 sc1
    v_mfma_f32_16x16x32_bf16 v[160:163], v[40:43], a[16:19], v[160:163]
    s_waitcnt lgkmcnt(12)
    ds_read_b64_tr_b16 v[32:33], v57 offset:0
    ds_read_b64_tr_b16 v[34:35], v57 offset:4608
    v_mfma_f32_16x16x32_bf16 v[160:163], v[44:47], a[24:27], v[160:163]
    ds_read_b64_tr_b16 v[36:37], v57 offset:9216
    ds_read_b64_tr_b16 v[38:39], v57 offset:13824
    v_mfma_f32_16x16x32_bf16 v[164:167], v[44:47], a[28:31], v[164:167]
    v_mfma_f32_16x16x32_bf16 v[164:167], v[40:43], a[20:23], v[164:167]
    s_waitcnt lgkmcnt(14)
    buffer_load_dwordx4 a[108:111], v2, s[52:55], s42 offen offset:3072 sc1
    v_mfma_f32_16x16x32_bf16 v[192:195], v[48:51], a[16:19], v[192:195]
    s_waitcnt lgkmcnt(12)
    s_add_u32 s42, s42, 131072
    ds_read_b64_tr_b16 v[40:41], v56 offset:36896
    ds_read_b64_tr_b16 v[42:43], v56 offset:41504
    v_mfma_f32_16x16x32_bf16 v[192:195], v[52:55], a[24:27], v[192:195]
    ds_read_b64_tr_b16 v[44:45], v56 offset:46112
    ds_read_b64_tr_b16 v[46:47], v56 offset:50720
    v_mfma_f32_16x16x32_bf16 v[196:199], v[52:55], a[28:31], v[196:199]
    v_mfma_f32_16x16x32_bf16 v[196:199], v[48:51], a[20:23], v[196:199]
    s_waitcnt lgkmcnt(14)
    v_mfma_f32_16x16x32_bf16 v[224:227], v[16:19], a[16:19], v[224:227]
    s_waitcnt lgkmcnt(12)
    buffer_load_dwordx4 a[112:115], v2, s[52:55], s42 offen offset:2048 sc1
    v_mfma_f32_16x16x32_bf16 v[224:227], v[20:23], a[24:27], v[224:227]
    ds_read_b64_tr_b16 v[48:49], v57 offset:46080
    ds_read_b64_tr_b16 v[50:51], v57 offset:50688
    v_mfma_f32_16x16x32_bf16 v[228:231], v[20:23], a[28:31], v[228:231]
    ds_read_b64_tr_b16 v[52:53], v58 offset:0
    ds_read_b64_tr_b16 v[54:55], v58 offset:4608
    v_mfma_f32_16x16x32_bf16 v[228:231], v[16:19], a[20:23], v[228:231]
    s_waitcnt lgkmcnt(14)
    v_mfma_f32_16x16x32_bf16 v[112:115], v[24:27], a[32:35], v[112:115]
    s_waitcnt lgkmcnt(12)
    buffer_load_dwordx4 a[116:119], v2, s[52:55], s42 offen offset:3072 sc1
    v_mfma_f32_16x16x32_bf16 v[112:115], v[28:31], a[40:43], v[112:115]
    s_add_u32 s42, s42, 131072
    ds_read_b64_tr_b16 v[16:17], v57 offset:32
    ds_read_b64_tr_b16 v[18:19], v57 offset:4640
    v_mfma_f32_16x16x32_bf16 v[116:119], v[28:31], a[44:47], v[116:119]
    ds_read_b64_tr_b16 v[20:21], v57 offset:9248
    ds_read_b64_tr_b16 v[22:23], v57 offset:13856
    v_mfma_f32_16x16x32_bf16 v[116:119], v[24:27], a[36:39], v[116:119]
    s_waitcnt vmcnt(17) lgkmcnt(14)
    v_mfma_f32_16x16x32_bf16 v[112:115], v[32:35], a[48:51], v[112:115]
    s_waitcnt vmcnt(15) lgkmcnt(12)
    ds_read_b64_tr_b16 v[24:25], v58 offset:9216
    ds_read_b64_tr_b16 v[26:27], v58 offset:13824
    v_mfma_f32_16x16x32_bf16 v[112:115], v[36:39], a[56:59], v[112:115]
    s_waitcnt vmcnt(14)
    buffer_load_dwordx4 a[120:123], v2, s[52:55], s42 offen offset:2048 sc1
    v_mfma_f32_16x16x32_bf16 v[116:119], v[36:39], a[60:63], v[116:119]
    ds_read_b64_tr_b16 v[28:29], v58 offset:36864
    ds_read_b64_tr_b16 v[30:31], v58 offset:41472
    v_mfma_f32_16x16x32_bf16 v[116:119], v[32:35], a[52:55], v[116:119]
    s_waitcnt lgkmcnt(14)
    v_mfma_f32_16x16x32_bf16 v[144:147], v[40:43], a[32:35], v[144:147]
    s_waitcnt lgkmcnt(12)
    ds_read_b64_tr_b16 v[32:33], v56 offset:36928
    ds_read_b64_tr_b16 v[34:35], v56 offset:41536
    v_mfma_f32_16x16x32_bf16 v[144:147], v[44:47], a[40:43], v[144:147]
    buffer_load_dwordx4 a[124:127], v2, s[52:55], s42 offen offset:3072 sc1
    v_mfma_f32_16x16x32_bf16 v[148:151], v[44:47], a[44:47], v[148:151]
    s_add_u32 s42, s72, 2
    ds_read_b64_tr_b16 v[36:37], v56 offset:46144
    ds_read_b64_tr_b16 v[38:39], v56 offset:50752
    v_mfma_f32_16x16x32_bf16 v[148:151], v[40:43], a[36:39], v[148:151]
    s_waitcnt vmcnt(15) lgkmcnt(14)
    s_and_b32 s42, s42, 3
    v_mfma_f32_16x16x32_bf16 v[112:115], v[48:51], a[64:67], v[112:115]
    s_waitcnt vmcnt(13) lgkmcnt(12)
    s_mul_i32 s42, s42, 9
    ds_read_b64_tr_b16 v[40:41], v57 offset:46112
    ds_read_b64_tr_b16 v[42:43], v57 offset:50720
    v_mfma_f32_16x16x32_bf16 v[112:115], v[52:55], a[72:75], v[112:115]
    s_waitcnt vmcnt(12)
    s_add_u32 s42, s42, 1
    ds_read_b64_tr_b16 v[44:45], v58 offset:32
    ds_read_b64_tr_b16 v[46:47], v58 offset:4640
    v_mfma_f32_16x16x32_bf16 v[116:119], v[52:55], a[76:79], v[116:119]
    s_lshr_b32 s42, s42, 1
    v_mfma_f32_16x16x32_bf16 v[116:119], v[48:51], a[68:71], v[116:119]
    s_waitcnt lgkmcnt(14)
    s_add_u32 s42, s42, s3
    v_mfma_f32_16x16x32_bf16 v[144:147], v[16:19], a[48:51], v[144:147]
    s_waitcnt lgkmcnt(12)
    s_lshl_b32 s42, s42, 17
    buffer_load_dwordx4 a[128:131], v2, s[52:55], s42 offen offset:2048 sc1
    v_mfma_f32_16x16x32_bf16 v[144:147], v[20:23], a[56:59], v[144:147]
    ds_read_b64_tr_b16 v[48:49], v57 offset:64
    ds_read_b64_tr_b16 v[50:51], v57 offset:4672
    v_mfma_f32_16x16x32_bf16 v[148:151], v[20:23], a[60:63], v[148:151]
    buffer_load_dwordx4 a[132:135], v2, s[52:55], s42 offen offset:3072 sc1
    v_mfma_f32_16x16x32_bf16 v[148:151], v[16:19], a[52:55], v[148:151]
    s_waitcnt vmcnt(13) lgkmcnt(12)
    s_add_u32 s42, s42, 131072
    ds_read_b64_tr_b16 v[52:53], v57 offset:9280
    ds_read_b64_tr_b16 v[54:55], v57 offset:13888
    v_mfma_f32_16x16x32_bf16 v[112:115], v[24:27], a[80:83], v[112:115]
    s_waitcnt vmcnt(11) lgkmcnt(12)
    ds_read_b64_tr_b16 v[16:17], v58 offset:9248
    ds_read_b64_tr_b16 v[18:19], v58 offset:13856
    v_mfma_f32_16x16x32_bf16 v[112:115], v[28:31], a[88:91], v[112:115]
    s_waitcnt vmcnt(10)
    ds_read_b64_tr_b16 v[20:21], v58 offset:36896
    ds_read_b64_tr_b16 v[22:23], v58 offset:41504
    v_mfma_f32_16x16x32_bf16 v[116:119], v[28:31], a[92:95], v[116:119]
    buffer_load_dwordx4 a[136:139], v2, s[52:55], s42 offen offset:2048 sc1
    v_mfma_f32_16x16x32_bf16 v[116:119], v[24:27], a[84:87], v[116:119]
    s_waitcnt lgkmcnt(14)
    v_mfma_f32_16x16x32_bf16 a[176:179], v[32:35], a[32:35], a[176:179]
    s_waitcnt lgkmcnt(12)
    ds_read_b64_tr_b16 v[24:25], v56 offset:36960
    ds_read_b64_tr_b16 v[26:27], v56 offset:41568
    v_mfma_f32_16x16x32_bf16 a[176:179], v[36:39], a[40:43], a[176:179]
    ds_read_b64_tr_b16 v[28:29], v56 offset:46176
    ds_read_b64_tr_b16 v[30:31], v56 offset:50784
    v_mfma_f32_16x16x32_bf16 a[180:183], v[36:39], a[44:47], a[180:183]
    v_mfma_f32_16x16x32_bf16 a[180:183], v[32:35], a[36:39], a[180:183]
    s_waitcnt lgkmcnt(14)
    buffer_load_dwordx4 a[140:143], v2, s[52:55], s42 offen offset:3072 sc1
    v_mfma_f32_16x16x32_bf16 v[144:147], v[40:43], a[64:67], v[144:147]
    s_waitcnt lgkmcnt(12)
    s_add_u32 s42, s42, 131072
    ds_read_b64_tr_b16 v[32:33], v57 offset:46144
    ds_read_b64_tr_b16 v[34:35], v57 offset:50752
    v_mfma_f32_16x16x32_bf16 v[144:147], v[44:47], a[72:75], v[144:147]
    ds_read_b64_tr_b16 v[36:37], v58 offset:64
    ds_read_b64_tr_b16 v[38:39], v58 offset:4672
    v_mfma_f32_16x16x32_bf16 v[148:151], v[44:47], a[76:79], v[148:151]
    v_cvt_pk_bf16_f32 v112, v112, v113
    v_cvt_pk_bf16_f32 v113, v114, v115
    v_mfma_f32_16x16x32_bf16 v[148:151], v[40:43], a[68:71], v[148:151]
    s_waitcnt lgkmcnt(14)
    buffer_load_dwordx4 a[144:147], v2, s[52:55], s42 offen offset:2048 sc1
    v_mfma_f32_16x16x32_bf16 a[176:179], v[48:51], a[48:51], a[176:179]
    s_waitcnt lgkmcnt(12)
    ds_read_b64_tr_b16 v[40:41], v57 offset:96
    ds_read_b64_tr_b16 v[42:43], v57 offset:4704
    v_mfma_f32_16x16x32_bf16 a[176:179], v[52:55], a[56:59], a[176:179]
    ds_read_b64_tr_b16 v[44:45], v57 offset:9312
    ds_read_b64_tr_b16 v[46:47], v57 offset:13920
    v_mfma_f32_16x16x32_bf16 a[180:183], v[52:55], a[60:63], a[180:183]
    v_cvt_pk_bf16_f32 v114, v116, v117
    v_cvt_pk_bf16_f32 v115, v118, v119
    v_mfma_f32_16x16x32_bf16 a[180:183], v[48:51], a[52:55], a[180:183]
    s_waitcnt lgkmcnt(14)
    buffer_load_dwordx4 a[148:151], v2, s[52:55], s42 offen offset:3072 sc1
    v_mfma_f32_16x16x32_bf16 v[144:147], v[16:19], a[80:83], v[144:147]
    s_waitcnt lgkmcnt(12)
    s_add_u32 s42, s42, 131072
    ds_read_b64_tr_b16 v[48:49], v58 offset:9280
    ds_read_b64_tr_b16 v[50:51], v58 offset:13888
    v_mfma_f32_16x16x32_bf16 v[144:147], v[20:23], a[88:91], v[144:147]
    ds_read_b64_tr_b16 v[52:53], v58 offset:36928
    ds_read_b64_tr_b16 v[54:55], v58 offset:41536
    v_mfma_f32_16x16x32_bf16 v[148:151], v[20:23], a[92:95], v[148:151]
    v_mfma_f32_16x16x32_bf16 v[148:151], v[16:19], a[84:87], v[148:151]
    s_waitcnt lgkmcnt(14)
    v_mfma_f32_16x16x32_bf16 v[176:179], v[24:27], a[32:35], v[176:179]
    s_waitcnt lgkmcnt(12)
    buffer_load_dwordx4 a[152:155], v2, s[52:55], s42 offen offset:2048 sc1
    v_mfma_f32_16x16x32_bf16 v[176:179], v[28:31], a[40:43], v[176:179]
    ds_read_b64_tr_b16 v[16:17], v56 offset:36992
    ds_read_b64_tr_b16 v[18:19], v56 offset:41600
    v_mfma_f32_16x16x32_bf16 v[180:183], v[28:31], a[44:47], v[180:183]
    ds_read_b64_tr_b16 v[20:21], v56 offset:46208
    ds_read_b64_tr_b16 v[22:23], v56 offset:50816
    v_mfma_f32_16x16x32_bf16 v[180:183], v[24:27], a[36:39], v[180:183]
    s_waitcnt lgkmcnt(14)
    v_mfma_f32_16x16x32_bf16 a[176:179], v[32:35], a[64:67], a[176:179]
    s_waitcnt lgkmcnt(12)
    buffer_load_dwordx4 a[156:159], v2, s[52:55], s42 offen offset:3072 sc1
    v_mfma_f32_16x16x32_bf16 a[176:179], v[36:39], a[72:75], a[176:179]
    s_add_u32 s42, s72, 3
    ds_read_b64_tr_b16 v[24:25], v57 offset:46176
    ds_read_b64_tr_b16 v[26:27], v57 offset:50784
    v_mfma_f32_16x16x32_bf16 a[180:183], v[36:39], a[76:79], a[180:183]
    s_and_b32 s42, s42, 3
    ds_read_b64_tr_b16 v[28:29], v58 offset:96
    ds_read_b64_tr_b16 v[30:31], v58 offset:4704
    v_mfma_f32_16x16x32_bf16 a[180:183], v[32:35], a[68:71], a[180:183]
    s_waitcnt lgkmcnt(14)
    s_mul_i32 s42, s42, 9
    v_cvt_pk_bf16_f32 v144, v144, v145
    v_cvt_pk_bf16_f32 v145, v146, v147
    v_mfma_f32_16x16x32_bf16 v[176:179], v[40:43], a[48:51], v[176:179]
    s_waitcnt lgkmcnt(12)
    s_add_u32 s42, s42, 1
    ds_read_b64_tr_b16 v[32:33], v57 offset:128
    ds_read_b64_tr_b16 v[34:35], v57 offset:4736
    v_mfma_f32_16x16x32_bf16 v[176:179], v[44:47], a[56:59], v[176:179]
    s_lshr_b32 s42, s42, 1
    ds_read_b64_tr_b16 v[36:37], v57 offset:9344
    ds_read_b64_tr_b16 v[38:39], v57 offset:13952
    v_mfma_f32_16x16x32_bf16 v[180:183], v[44:47], a[60:63], v[180:183]
    s_add_u32 s42, s42, s3
    v_cvt_pk_bf16_f32 v146, v148, v149
    v_cvt_pk_bf16_f32 v147, v150, v151
    v_mfma_f32_16x16x32_bf16 v[180:183], v[40:43], a[52:55], v[180:183]
    s_waitcnt lgkmcnt(14)
    s_lshl_b32 s42, s42, 17
    buffer_load_dwordx4 a[160:163], v2, s[52:55], s42 offen offset:2048 sc1
    v_mfma_f32_16x16x32_bf16 a[176:179], v[48:51], a[80:83], a[176:179]
    s_waitcnt lgkmcnt(12)
    ds_read_b64_tr_b16 v[40:41], v58 offset:9312
    ds_read_b64_tr_b16 v[42:43], v58 offset:13920
    v_mfma_f32_16x16x32_bf16 a[176:179], v[52:55], a[88:91], a[176:179]
    buffer_load_dwordx4 a[164:167], v2, s[52:55], s42 offen offset:3072 sc1
    v_mfma_f32_16x16x32_bf16 a[180:183], v[52:55], a[92:95], a[180:183]
    s_add_u32 s42, s42, 131072
    ds_read_b64_tr_b16 v[44:45], v58 offset:36960
    ds_read_b64_tr_b16 v[46:47], v58 offset:41568
    v_mfma_f32_16x16x32_bf16 a[180:183], v[48:51], a[84:87], a[180:183]
    s_waitcnt lgkmcnt(14)
    v_mfma_f32_16x16x32_bf16 v[208:211], v[16:19], a[32:35], v[208:211]
    s_waitcnt lgkmcnt(12)
    ds_read_b64_tr_b16 v[48:49], v56 offset:37024
    ds_read_b64_tr_b16 v[50:51], v56 offset:41632
    v_mfma_f32_16x16x32_bf16 v[208:211], v[20:23], a[40:43], v[208:211]
    buffer_load_dwordx4 a[168:171], v2, s[52:55], s42 offen offset:2048 sc1
    v_mfma_f32_16x16x32_bf16 v[212:215], v[20:23], a[44:47], v[212:215]
    ds_read_b64_tr_b16 v[52:53], v56 offset:46240
    ds_read_b64_tr_b16 v[54:55], v56 offset:50848
    v_mfma_f32_16x16x32_bf16 v[212:215], v[16:19], a[36:39], v[212:215]
    s_waitcnt lgkmcnt(14)
    v_mfma_f32_16x16x32_bf16 v[176:179], v[24:27], a[64:67], v[176:179]
    s_waitcnt lgkmcnt(12)
    ds_read_b64_tr_b16 v[16:17], v57 offset:46208
    ds_read_b64_tr_b16 v[18:19], v57 offset:50816
    v_mfma_f32_16x16x32_bf16 v[176:179], v[28:31], a[72:75], v[176:179]
    ds_read_b64_tr_b16 v[20:21], v58 offset:128
    ds_read_b64_tr_b16 v[22:23], v58 offset:4736
    v_mfma_f32_16x16x32_bf16 v[180:183], v[28:31], a[76:79], v[180:183]
    buffer_load_dwordx4 a[172:175], v2, s[52:55], s42 offen offset:3072 sc1
    v_mfma_f32_16x16x32_bf16 v[180:183], v[24:27], a[68:71], v[180:183]
    s_waitcnt lgkmcnt(14)
    s_add_u32 s42, s42, 131072
    v_accvgpr_read_b32 v84, a180
    v_accvgpr_read_b32 v85, a181
    v_mfma_f32_16x16x32_bf16 v[208:211], v[32:35], a[48:51], v[208:211]
    s_waitcnt lgkmcnt(12)
    ds_read_b64_tr_b16 v[24:25], v57 offset:160
    ds_read_b64_tr_b16 v[26:27], v57 offset:4768
    v_mfma_f32_16x16x32_bf16 v[208:211], v[36:39], a[56:59], v[208:211]
    ds_read_b64_tr_b16 v[28:29], v57 offset:9376
    ds_read_b64_tr_b16 v[30:31], v57 offset:13984
    v_mfma_f32_16x16x32_bf16 v[212:215], v[36:39], a[60:63], v[212:215]
    buffer_load_dwordx4 v[128:131], v2, s[52:55], s42 offen offset:2048 sc1
    v_mfma_f32_16x16x32_bf16 v[212:215], v[32:35], a[52:55], v[212:215]
    s_waitcnt lgkmcnt(14)
    v_accvgpr_read_b32 v86, a182
    v_accvgpr_read_b32 v87, a183
    v_mfma_f32_16x16x32_bf16 v[176:179], v[40:43], a[80:83], v[176:179]
    s_waitcnt lgkmcnt(12)
    ds_read_b64_tr_b16 v[32:33], v58 offset:9344
    ds_read_b64_tr_b16 v[34:35], v58 offset:13952
    v_mfma_f32_16x16x32_bf16 v[176:179], v[44:47], a[88:91], v[176:179]
Lqad3:
    s_cbranch_execz Lwalk2_done
    ds_read_b64_tr_b16 v[36:37], v58 offset:36992
    ds_read_b64_tr_b16 v[38:39], v58 offset:41600
    v_mfma_f32_16x16x32_bf16 v[180:183], v[44:47], a[92:95], v[180:183]
    buffer_load_dwordx4 v[132:135], v2, s[52:55], s42 offen offset:3072 sc1
    v_mfma_f32_16x16x32_bf16 v[180:183], v[40:43], a[84:87], v[180:183]
    s_waitcnt lgkmcnt(14)
    s_add_u32 s42, s42, 131072
    v_accvgpr_read_b32 v80, a176
    v_accvgpr_read_b32 v81, a177
    v_mfma_f32_16x16x32_bf16 a[192:195], v[48:51], a[32:35], a[192:195]
    s_waitcnt lgkmcnt(12)
    ds_read_b64_tr_b16 v[40:41], v56 offset:37056
    ds_read_b64_tr_b16 v[42:43], v56 offset:41664
    v_mfma_f32_16x16x32_bf16 a[192:195], v[52:55], a[40:43], a[192:195]
    ds_read_b64_tr_b16 v[44:45], v56 offset:46272
    ds_read_b64_tr_b16 v[46:47], v56 offset:50880
    v_mfma_f32_16x16x32_bf16 a[196:199], v[52:55], a[44:47], a[196:199]
    v_accvgpr_read_b32 v82, a178
    v_accvgpr_read_b32 v83, a179
    v_mfma_f32_16x16x32_bf16 a[196:199], v[48:51], a[36:39], a[196:199]
    s_waitcnt lgkmcnt(14)
    buffer_load_dwordx4 v[136:139], v2, s[52:55], s42 offen offset:2048 sc1
    v_mfma_f32_16x16x32_bf16 v[208:211], v[16:19], a[64:67], v[208:211]
    s_waitcnt lgkmcnt(12)
    v_cvt_pk_bf16_f32 v80, v80, v81
    v_cvt_pk_bf16_f32 v81, v82, v83
    v_mfma_f32_16x16x32_bf16 v[208:211], v[20:23], a[72:75], v[208:211]
    v_cvt_pk_bf16_f32 v82, v84, v85
    v_cvt_pk_bf16_f32 v83, v86, v87
    v_mfma_f32_16x16x32_bf16 v[212:215], v[20:23], a[76:79], v[212:215]
    ds_read_b64_tr_b16 v[48:49], v57 offset:46240
    ds_read_b64_tr_b16 v[50:51], v57 offset:50848
    v_mfma_f32_16x16x32_bf16 v[212:215], v[16:19], a[68:71], v[212:215]
    s_waitcnt lgkmcnt(12)
    buffer_load_dwordx4 v[140:143], v2, s[52:55], s42 offen offset:3072 sc1
    v_mfma_f32_16x16x32_bf16 a[192:195], v[24:27], a[48:51], a[192:195]
    s_waitcnt lgkmcnt(10)
    s_or_b32 s90, s76, 18874368
    ds_read_b64_tr_b16 v[52:53], v58 offset:160
    ds_read_b64_tr_b16 v[54:55], v58 offset:4768
    v_mfma_f32_16x16x32_bf16 a[192:195], v[28:31], a[56:59], a[192:195]
    ds_read_b64_tr_b16 v[16:17], v57 offset:192
    ds_read_b64_tr_b16 v[18:19], v57 offset:4800
    v_mfma_f32_16x16x32_bf16 a[196:199], v[28:31], a[60:63], a[196:199]
    ds_read_b64_tr_b16 v[20:21], v57 offset:9408
    ds_read_b64_tr_b16 v[22:23], v57 offset:14016
    v_mfma_f32_16x16x32_bf16 a[196:199], v[24:27], a[52:55], a[196:199]
    s_waitcnt lgkmcnt(14)
    v_cvt_pk_bf16_f32 v176, v176, v177
    v_cvt_pk_bf16_f32 v177, v178, v179
    v_mfma_f32_16x16x32_bf16 v[208:211], v[32:35], a[80:83], v[208:211]
    s_waitcnt lgkmcnt(12)
    buffer_store_dwordx4 v[112:115], v59, s[64:67], s90 offen offset:0 sc1
    v_mfma_f32_16x16x32_bf16 v[208:211], v[36:39], a[88:91], v[208:211]
    s_or_b32 s90, s76, 18874368
    ds_read_b64_tr_b16 v[24:25], v58 offset:9376
    ds_read_b64_tr_b16 v[26:27], v58 offset:13984
    v_mfma_f32_16x16x32_bf16 v[212:215], v[36:39], a[92:95], v[212:215]
    ds_read_b64_tr_b16 v[28:29], v58 offset:37024
    ds_read_b64_tr_b16 v[30:31], v58 offset:41632
    v_mfma_f32_16x16x32_bf16 v[212:215], v[32:35], a[84:87], v[212:215]
    s_waitcnt lgkmcnt(14)
    v_cvt_pk_bf16_f32 v178, v180, v181
    v_cvt_pk_bf16_f32 v179, v182, v183
    v_mfma_f32_16x16x32_bf16 v[160:163], v[40:43], a[32:35], v[160:163]
    s_waitcnt lgkmcnt(12)
    ds_read_b64_tr_b16 v[32:33], v56 offset:37088
    ds_read_b64_tr_b16 v[34:35], v56 offset:41696
    v_mfma_f32_16x16x32_bf16 v[160:163], v[44:47], a[40:43], v[160:163]
    ds_read_b64_tr_b16 v[36:37], v56 offset:46304
    ds_read_b64_tr_b16 v[38:39], v56 offset:50912
    v_mfma_f32_16x16x32_bf16 v[164:167], v[44:47], a[44:47], v[164:167]
    v_mfma_f32_16x16x32_bf16 v[164:167], v[40:43], a[36:39], v[164:167]
    s_waitcnt lgkmcnt(14)
    v_mfma_f32_16x16x32_bf16 a[192:195], v[48:51], a[64:67], a[192:195]
    s_waitcnt lgkmcnt(12)
    ds_read_b64_tr_b16 v[40:41], v57 offset:46272
    ds_read_b64_tr_b16 v[42:43], v57 offset:50880
    v_mfma_f32_16x16x32_bf16 a[192:195], v[52:55], a[72:75], a[192:195]
    ds_read_b64_tr_b16 v[44:45], v58 offset:192
    ds_read_b64_tr_b16 v[46:47], v58 offset:4800
    v_mfma_f32_16x16x32_bf16 a[196:199], v[52:55], a[76:79], a[196:199]
    v_cvt_pk_bf16_f32 v208, v208, v209
    v_cvt_pk_bf16_f32 v209, v210, v211
    v_mfma_f32_16x16x32_bf16 a[196:199], v[48:51], a[68:71], a[196:199]
    s_waitcnt lgkmcnt(14)
    v_cvt_pk_bf16_f32 v210, v212, v213
    v_cvt_pk_bf16_f32 v211, v214, v215
    v_mfma_f32_16x16x32_bf16 v[160:163], v[16:19], a[48:51], v[160:163]
    s_waitcnt lgkmcnt(12)
    ds_read_b64_tr_b16 v[48:49], v57 offset:224
    ds_read_b64_tr_b16 v[50:51], v57 offset:4832
    v_mfma_f32_16x16x32_bf16 v[160:163], v[20:23], a[56:59], v[160:163]
    ds_read_b64_tr_b16 v[52:53], v57 offset:9440
    ds_read_b64_tr_b16 v[54:55], v57 offset:14048
    v_mfma_f32_16x16x32_bf16 v[164:167], v[20:23], a[60:63], v[164:167]
    buffer_store_dwordx4 v[144:147], v59, s[64:67], s90 offen offset:1024 sc1
    v_mfma_f32_16x16x32_bf16 v[164:167], v[16:19], a[52:55], v[164:167]
    s_waitcnt lgkmcnt(14)
    s_or_b32 s90, s76, 18874368
    v_mfma_f32_16x16x32_bf16 a[192:195], v[24:27], a[80:83], a[192:195]
    s_waitcnt lgkmcnt(12)
    ds_read_b64_tr_b16 v[16:17], v58 offset:9408
    ds_read_b64_tr_b16 v[18:19], v58 offset:14016
    v_mfma_f32_16x16x32_bf16 a[192:195], v[28:31], a[88:91], a[192:195]
    ds_read_b64_tr_b16 v[20:21], v58 offset:37056
    ds_read_b64_tr_b16 v[22:23], v58 offset:41664
    v_mfma_f32_16x16x32_bf16 a[196:199], v[28:31], a[92:95], a[196:199]
    v_mfma_f32_16x16x32_bf16 a[196:199], v[24:27], a[84:87], a[196:199]
    s_waitcnt lgkmcnt(14)
    v_mfma_f32_16x16x32_bf16 v[192:195], v[32:35], a[32:35], v[192:195]
    s_waitcnt lgkmcnt(12)
    ds_read_b64_tr_b16 v[24:25], v56 offset:37120
    ds_read_b64_tr_b16 v[26:27], v56 offset:41728
    v_mfma_f32_16x16x32_bf16 v[192:195], v[36:39], a[40:43], v[192:195]
    ds_read_b64_tr_b16 v[28:29], v56 offset:46336
    ds_read_b64_tr_b16 v[30:31], v56 offset:50944
    v_mfma_f32_16x16x32_bf16 v[196:199], v[36:39], a[44:47], v[196:199]
    v_mfma_f32_16x16x32_bf16 v[196:199], v[32:35], a[36:39], v[196:199]
    s_waitcnt lgkmcnt(14)
    v_mfma_f32_16x16x32_bf16 v[160:163], v[40:43], a[64:67], v[160:163]
    s_waitcnt lgkmcnt(12)
    ds_read_b64_tr_b16 v[32:33], v57 offset:46304
    ds_read_b64_tr_b16 v[34:35], v57 offset:50912
    v_mfma_f32_16x16x32_bf16 v[160:163], v[44:47], a[72:75], v[160:163]
    ds_read_b64_tr_b16 v[36:37], v58 offset:224
    ds_read_b64_tr_b16 v[38:39], v58 offset:4832
    v_mfma_f32_16x16x32_bf16 v[164:167], v[44:47], a[76:79], v[164:167]
    v_accvgpr_read_b32 v100, a196
    v_accvgpr_read_b32 v101, a197
    v_mfma_f32_16x16x32_bf16 v[164:167], v[40:43], a[68:71], v[164:167]
    s_waitcnt lgkmcnt(14)
    v_accvgpr_read_b32 v102, a198
    v_accvgpr_read_b32 v103, a199
    v_mfma_f32_16x16x32_bf16 v[192:195], v[48:51], a[48:51], v[192:195]
    s_waitcnt lgkmcnt(12)
    buffer_store_dwordx4 v[80:83], v59, s[64:67], s90 offen offset:2048 sc1
    v_mfma_f32_16x16x32_bf16 v[192:195], v[52:55], a[56:59], v[192:195]
    s_or_b32 s90, s76, 18874368
    ds_read_b64_tr_b16 v[40:41], v57 offset:256
    ds_read_b64_tr_b16 v[42:43], v57 offset:4864
    v_mfma_f32_16x16x32_bf16 v[196:199], v[52:55], a[60:63], v[196:199]
    ds_read_b64_tr_b16 v[44:45], v57 offset:9472
    ds_read_b64_tr_b16 v[46:47], v57 offset:14080
    v_mfma_f32_16x16x32_bf16 v[196:199], v[48:51], a[52:55], v[196:199]
    s_waitcnt lgkmcnt(14)
    v_accvgpr_read_b32 v96, a192
    v_accvgpr_read_b32 v97, a193
    v_mfma_f32_16x16x32_bf16 v[160:163], v[16:19], a[80:83], v[160:163]
    s_waitcnt lgkmcnt(12)
    ds_read_b64_tr_b16 v[48:49], v58 offset:9440
    ds_read_b64_tr_b16 v[50:51], v58 offset:14048
    v_mfma_f32_16x16x32_bf16 v[160:163], v[20:23], a[88:91], v[160:163]
    ds_read_b64_tr_b16 v[52:53], v58 offset:37088
    ds_read_b64_tr_b16 v[54:55], v58 offset:41696
    v_mfma_f32_16x16x32_bf16 v[164:167], v[20:23], a[92:95], v[164:167]
    v_accvgpr_read_b32 v98, a194
    v_accvgpr_read_b32 v99, a195
    v_mfma_f32_16x16x32_bf16 v[164:167], v[16:19], a[84:87], v[164:167]
    s_waitcnt lgkmcnt(14)
    v_cvt_pk_bf16_f32 v96, v96, v97
    v_cvt_pk_bf16_f32 v97, v98, v99
    v_mfma_f32_16x16x32_bf16 v[224:227], v[24:27], a[32:35], v[224:227]
    s_waitcnt lgkmcnt(12)
    ds_read_b64_tr_b16 v[16:17], v57 offset:46336
    ds_read_b64_tr_b16 v[18:19], v57 offset:50944
    v_mfma_f32_16x16x32_bf16 v[224:227], v[28:31], a[40:43], v[224:227]
    ds_read_b64_tr_b16 v[20:21], v58 offset:256
    ds_read_b64_tr_b16 v[22:23], v58 offset:4864
    v_mfma_f32_16x16x32_bf16 v[228:231], v[28:31], a[44:47], v[228:231]
    v_cvt_pk_bf16_f32 v98, v100, v101
    v_cvt_pk_bf16_f32 v99, v102, v103
    v_mfma_f32_16x16x32_bf16 v[228:231], v[24:27], a[36:39], v[228:231]
    s_waitcnt lgkmcnt(14)
    v_mfma_f32_16x16x32_bf16 v[192:195], v[32:35], a[64:67], v[192:195]
    s_waitcnt lgkmcnt(12)
    ds_read_b64_tr_b16 v[24:25], v58 offset:9472
    ds_read_b64_tr_b16 v[26:27], v58 offset:14080
    v_mfma_f32_16x16x32_bf16 v[192:195], v[36:39], a[72:75], v[192:195]
    ds_read_b64_tr_b16 v[28:29], v58 offset:37120
    ds_read_b64_tr_b16 v[30:31], v58 offset:41728
    v_mfma_f32_16x16x32_bf16 v[196:199], v[36:39], a[76:79], v[196:199]
    buffer_store_dwordx4 v[176:179], v59, s[64:67], s90 offen offset:3072 sc1
    v_mfma_f32_16x16x32_bf16 v[196:199], v[32:35], a[68:71], v[196:199]
    s_waitcnt lgkmcnt(14)
    s_or_b32 s90, s76, 18882560
    v_cvt_pk_bf16_f32 v160, v160, v161
    v_cvt_pk_bf16_f32 v161, v162, v163
    v_mfma_f32_16x16x32_bf16 v[224:227], v[40:43], a[48:51], v[224:227]
    s_waitcnt lgkmcnt(12)
    ds_read_b64_tr_b16 v[32:33], v57 offset:18560
    ds_read_b64_tr_b16 v[34:35], v57 offset:23168
    v_mfma_f32_16x16x32_bf16 v[224:227], v[44:47], a[56:59], v[224:227]
    ds_read_b64_tr_b16 v[36:37], v57 offset:27776
    ds_read_b64_tr_b16 v[38:39], v57 offset:32384
    v_mfma_f32_16x16x32_bf16 v[228:231], v[44:47], a[60:63], v[228:231]
    v_cvt_pk_bf16_f32 v162, v164, v165
    v_cvt_pk_bf16_f32 v163, v166, v167
    v_mfma_f32_16x16x32_bf16 v[228:231], v[40:43], a[52:55], v[228:231]
    s_waitcnt lgkmcnt(14)
    v_mfma_f32_16x16x32_bf16 v[192:195], v[48:51], a[80:83], v[192:195]
    s_waitcnt lgkmcnt(12)
    ds_read_b64_tr_b16 v[40:41], v57 offset:36992
    ds_read_b64_tr_b16 v[42:43], v57 offset:41600
    v_mfma_f32_16x16x32_bf16 v[192:195], v[52:55], a[88:91], v[192:195]
    ds_read_b64_tr_b16 v[44:45], v58 offset:27776
    ds_read_b64_tr_b16 v[46:47], v58 offset:32384
    v_mfma_f32_16x16x32_bf16 v[196:199], v[52:55], a[92:95], v[196:199]
    v_mfma_f32_16x16x32_bf16 v[196:199], v[48:51], a[84:87], v[196:199]
    s_waitcnt lgkmcnt(14)
    v_mfma_f32_16x16x32_bf16 v[224:227], v[16:19], a[64:67], v[224:227]
    s_waitcnt lgkmcnt(12)
    ds_read_b64_tr_b16 v[48:49], v56 offset:36992
    ds_read_b64_tr_b16 v[50:51], v56 offset:41600
    v_mfma_f32_16x16x32_bf16 v[224:227], v[20:23], a[72:75], v[224:227]
    ds_read_b64_tr_b16 v[52:53], v56 offset:46208
    ds_read_b64_tr_b16 v[54:55], v56 offset:50816
    v_mfma_f32_16x16x32_bf16 v[228:231], v[20:23], a[76:79], v[228:231]
    v_mfma_f32_16x16x32_bf16 v[228:231], v[16:19], a[68:71], v[228:231]
    s_waitcnt lgkmcnt(14)
    v_mfma_f32_16x16x32_bf16 v[224:227], v[24:27], a[80:83], v[224:227]
    s_waitcnt lgkmcnt(12)
    buffer_store_dwordx4 v[208:211], v59, s[64:67], s90 offen offset:0 sc1
    v_mfma_f32_16x16x32_bf16 v[224:227], v[28:31], a[88:91], v[224:227]
    s_or_b32 s90, s77, 18948096
    ds_read_b64_tr_b16 v[16:17], v57 offset:128
    ds_read_b64_tr_b16 v[18:19], v57 offset:4736
    v_mfma_f32_16x16x32_bf16 v[228:231], v[28:31], a[92:95], v[228:231]
    ds_read_b64_tr_b16 v[20:21], v57 offset:9344
    ds_read_b64_tr_b16 v[22:23], v57 offset:13952
    v_mfma_f32_16x16x32_bf16 v[228:231], v[24:27], a[84:87], v[228:231]
    s_waitcnt vmcnt(28) lgkmcnt(14)
    v_cvt_pk_bf16_f32 v192, v192, v193
    v_cvt_pk_bf16_f32 v193, v194, v195
    v_mfma_f32_16x16x32_bf16 v[216:219], v[32:35], a[96:99], v[216:219]
    s_waitcnt vmcnt(26) lgkmcnt(12)
    ds_read_b64_tr_b16 v[24:25], v57 offset:46208
    ds_read_b64_tr_b16 v[26:27], v57 offset:50816
    v_mfma_f32_16x16x32_bf16 v[216:219], v[36:39], a[104:107], v[216:219]
    s_waitcnt vmcnt(25)
    ds_read_b64_tr_b16 v[28:29], v58 offset:128
    ds_read_b64_tr_b16 v[30:31], v58 offset:4736
    v_mfma_f32_16x16x32_bf16 v[220:223], v[36:39], a[108:111], v[220:223]
    v_cvt_pk_bf16_f32 v194, v196, v197
    v_cvt_pk_bf16_f32 v195, v198, v199
    v_mfma_f32_16x16x32_bf16 v[220:223], v[32:35], a[100:103], v[220:223]
    s_waitcnt vmcnt(24) lgkmcnt(14)
    v_mfma_f32_16x16x32_bf16 v[216:219], v[40:43], a[112:115], v[216:219]
    s_waitcnt vmcnt(22) lgkmcnt(12)
    ds_read_b64_tr_b16 v[32:33], v58 offset:9344
    ds_read_b64_tr_b16 v[34:35], v58 offset:13952
    v_mfma_f32_16x16x32_bf16 v[216:219], v[44:47], a[120:123], v[216:219]
    s_waitcnt vmcnt(21)
    ds_read_b64_tr_b16 v[36:37], v58 offset:36992
    ds_read_b64_tr_b16 v[38:39], v58 offset:41600
    v_mfma_f32_16x16x32_bf16 v[220:223], v[44:47], a[124:127], v[220:223]
    v_cvt_pk_bf16_f32 v224, v224, v225
    v_cvt_pk_bf16_f32 v225, v226, v227
    v_mfma_f32_16x16x32_bf16 v[220:223], v[40:43], a[116:119], v[220:223]
    s_waitcnt vmcnt(20) lgkmcnt(14)
    v_cvt_pk_bf16_f32 v226, v228, v229
    v_cvt_pk_bf16_f32 v227, v230, v231
    v_mfma_f32_16x16x32_bf16 v[216:219], v[48:51], a[128:131], v[216:219]
    s_waitcnt vmcnt(18) lgkmcnt(12)
    ds_read_b64_tr_b16 v[40:41], v57 offset:18432
    ds_read_b64_tr_b16 v[42:43], v57 offset:23040
    v_mfma_f32_16x16x32_bf16 v[216:219], v[52:55], a[136:139], v[216:219]
    s_waitcnt vmcnt(17)
    ds_read_b64_tr_b16 v[44:45], v57 offset:27648
    ds_read_b64_tr_b16 v[46:47], v57 offset:32256
    v_mfma_f32_16x16x32_bf16 v[220:223], v[52:55], a[140:143], v[220:223]
    buffer_store_dwordx4 v[96:99], v59, s[64:67], s90 offen offset:0 sc1
    v_mfma_f32_16x16x32_bf16 v[220:223], v[48:51], a[132:135], v[220:223]
    s_waitcnt vmcnt(17) lgkmcnt(14)
    s_or_b32 s90, s77, 18948096
    v_mfma_f32_16x16x32_bf16 v[216:219], v[16:19], a[144:147], v[216:219]
    s_waitcnt vmcnt(15) lgkmcnt(12)
    ds_read_b64_tr_b16 v[48:49], v57 offset:36864
    ds_read_b64_tr_b16 v[50:51], v57 offset:41472
    v_mfma_f32_16x16x32_bf16 v[216:219], v[20:23], a[152:155], v[216:219]
    s_waitcnt vmcnt(14)
    ds_read_b64_tr_b16 v[52:53], v58 offset:27648
    ds_read_b64_tr_b16 v[54:55], v58 offset:32256
    v_mfma_f32_16x16x32_bf16 v[220:223], v[20:23], a[156:159], v[220:223]
    v_mfma_f32_16x16x32_bf16 v[220:223], v[16:19], a[148:151], v[220:223]
    s_waitcnt vmcnt(13) lgkmcnt(14)
    v_mfma_f32_16x16x32_bf16 v[216:219], v[24:27], a[160:163], v[216:219]
    s_waitcnt vmcnt(11) lgkmcnt(12)
    ds_read_b64_tr_b16 v[16:17], v56 offset:36864
    ds_read_b64_tr_b16 v[18:19], v56 offset:41472
    v_mfma_f32_16x16x32_bf16 v[216:219], v[28:31], a[168:171], v[216:219]
    s_waitcnt vmcnt(10)
    ds_read_b64_tr_b16 v[20:21], v56 offset:46080
    ds_read_b64_tr_b16 v[22:23], v56 offset:50688
    v_mfma_f32_16x16x32_bf16 v[220:223], v[28:31], a[172:175], v[220:223]
    v_mfma_f32_16x16x32_bf16 v[220:223], v[24:27], a[164:167], v[220:223]
    s_waitcnt vmcnt(9) lgkmcnt(14)
    v_mfma_f32_16x16x32_bf16 v[216:219], v[32:35], v[128:131], v[216:219]
    s_waitcnt vmcnt(7) lgkmcnt(12)
    ds_read_b64_tr_b16 v[24:25], v57 offset:0
    ds_read_b64_tr_b16 v[26:27], v57 offset:4608
    v_mfma_f32_16x16x32_bf16 v[216:219], v[36:39], v[136:139], v[216:219]
    s_waitcnt vmcnt(6)
    ds_read_b64_tr_b16 v[28:29], v57 offset:9216
    ds_read_b64_tr_b16 v[30:31], v57 offset:13824
    v_mfma_f32_16x16x32_bf16 v[220:223], v[36:39], v[140:143], v[220:223]
    v_mfma_f32_16x16x32_bf16 v[220:223], v[32:35], v[132:135], v[220:223]
    s_waitcnt lgkmcnt(14)
    v_mfma_f32_16x16x32_bf16 v[120:123], v[40:43], a[96:99], v[120:123]
    s_waitcnt lgkmcnt(12)
    buffer_store_dwordx4 v[160:163], v59, s[64:67], s90 offen offset:1024 sc1
    v_mfma_f32_16x16x32_bf16 v[120:123], v[44:47], a[104:107], v[120:123]
    s_or_b32 s90, s77, 18948096
    ds_read_b64_tr_b16 v[32:33], v57 offset:46080
    ds_read_b64_tr_b16 v[34:35], v57 offset:50688
    v_mfma_f32_16x16x32_bf16 v[124:127], v[44:47], a[108:111], v[124:127]
    ds_read_b64_tr_b16 v[36:37], v58 offset:0
    ds_read_b64_tr_b16 v[38:39], v58 offset:4608
    v_mfma_f32_16x16x32_bf16 v[124:127], v[40:43], a[100:103], v[124:127]
    s_waitcnt lgkmcnt(14)
    v_mfma_f32_16x16x32_bf16 v[120:123], v[48:51], a[112:115], v[120:123]
    s_waitcnt lgkmcnt(12)
    ds_read_b64_tr_b16 v[40:41], v58 offset:9216
    ds_read_b64_tr_b16 v[42:43], v58 offset:13824
    v_mfma_f32_16x16x32_bf16 v[120:123], v[52:55], a[120:123], v[120:123]
    ds_read_b64_tr_b16 v[44:45], v58 offset:36864
    ds_read_b64_tr_b16 v[46:47], v58 offset:41472
    v_mfma_f32_16x16x32_bf16 v[124:127], v[52:55], a[124:127], v[124:127]
    v_cvt_pk_bf16_f32 v216, v216, v217
    v_cvt_pk_bf16_f32 v217, v218, v219
    v_mfma_f32_16x16x32_bf16 v[124:127], v[48:51], a[116:119], v[124:127]
    s_waitcnt lgkmcnt(14)
    v_cvt_pk_bf16_f32 v218, v220, v221
    v_cvt_pk_bf16_f32 v219, v222, v223
    v_mfma_f32_16x16x32_bf16 v[120:123], v[16:19], a[128:131], v[120:123]
    s_waitcnt lgkmcnt(12)
    ds_read_b64_tr_b16 v[48:49], v57 offset:18592
    ds_read_b64_tr_b16 v[50:51], v57 offset:23200
    v_mfma_f32_16x16x32_bf16 v[120:123], v[20:23], a[136:139], v[120:123]
    ds_read_b64_tr_b16 v[52:53], v57 offset:27808
    ds_read_b64_tr_b16 v[54:55], v57 offset:32416
    v_mfma_f32_16x16x32_bf16 v[124:127], v[20:23], a[140:143], v[124:127]
    v_mfma_f32_16x16x32_bf16 v[124:127], v[16:19], a[132:135], v[124:127]
    s_waitcnt lgkmcnt(14)
    v_mfma_f32_16x16x32_bf16 v[120:123], v[24:27], a[144:147], v[120:123]
    s_waitcnt lgkmcnt(12)
    ds_read_b64_tr_b16 v[16:17], v57 offset:37024
    ds_read_b64_tr_b16 v[18:19], v57 offset:41632
    v_mfma_f32_16x16x32_bf16 v[120:123], v[28:31], a[152:155], v[120:123]
    ds_read_b64_tr_b16 v[20:21], v58 offset:27808
    ds_read_b64_tr_b16 v[22:23], v58 offset:32416
    v_mfma_f32_16x16x32_bf16 v[124:127], v[28:31], a[156:159], v[124:127]
    buffer_store_dwordx4 v[192:195], v59, s[64:67], s90 offen offset:2048 sc1
    v_mfma_f32_16x16x32_bf16 v[124:127], v[24:27], a[148:151], v[124:127]
    s_waitcnt lgkmcnt(14)
    s_or_b32 s90, s77, 18948096
    v_mfma_f32_16x16x32_bf16 v[120:123], v[32:35], a[160:163], v[120:123]
    s_waitcnt lgkmcnt(12)
    ds_read_b64_tr_b16 v[24:25], v56 offset:37024
    ds_read_b64_tr_b16 v[26:27], v56 offset:41632
    v_mfma_f32_16x16x32_bf16 v[120:123], v[36:39], a[168:171], v[120:123]
    ds_read_b64_tr_b16 v[28:29], v56 offset:46240
    ds_read_b64_tr_b16 v[30:31], v56 offset:50848
    v_mfma_f32_16x16x32_bf16 v[124:127], v[36:39], a[172:175], v[124:127]
    v_mfma_f32_16x16x32_bf16 v[124:127], v[32:35], a[164:167], v[124:127]
    s_waitcnt lgkmcnt(14)
    v_mfma_f32_16x16x32_bf16 v[120:123], v[40:43], v[128:131], v[120:123]
    s_waitcnt lgkmcnt(12)
    ds_read_b64_tr_b16 v[32:33], v57 offset:160
    ds_read_b64_tr_b16 v[34:35], v57 offset:4768
    v_mfma_f32_16x16x32_bf16 v[120:123], v[44:47], v[136:139], v[120:123]
    ds_read_b64_tr_b16 v[36:37], v57 offset:9376
    ds_read_b64_tr_b16 v[38:39], v57 offset:13984
    v_mfma_f32_16x16x32_bf16 v[124:127], v[44:47], v[140:143], v[124:127]
    v_mfma_f32_16x16x32_bf16 v[124:127], v[40:43], v[132:135], v[124:127]
    s_waitcnt lgkmcnt(14)
    v_mfma_f32_16x16x32_bf16 a[200:203], v[48:51], a[96:99], a[200:203]
    s_waitcnt lgkmcnt(12)
    ds_read_b64_tr_b16 v[40:41], v57 offset:46240
    ds_read_b64_tr_b16 v[42:43], v57 offset:50848
    v_mfma_f32_16x16x32_bf16 a[200:203], v[52:55], a[104:107], a[200:203]
    ds_read_b64_tr_b16 v[44:45], v58 offset:160
    ds_read_b64_tr_b16 v[46:47], v58 offset:4768
    v_mfma_f32_16x16x32_bf16 a[204:207], v[52:55], a[108:111], a[204:207]
    v_mfma_f32_16x16x32_bf16 a[204:207], v[48:51], a[100:103], a[204:207]
    s_waitcnt lgkmcnt(14)
    v_mfma_f32_16x16x32_bf16 a[200:203], v[16:19], a[112:115], a[200:203]
    s_waitcnt lgkmcnt(12)
    buffer_store_dwordx4 v[224:227], v59, s[64:67], s90 offen offset:3072 sc1
    v_mfma_f32_16x16x32_bf16 a[200:203], v[20:23], a[120:123], a[200:203]
    s_or_b32 s90, s77, 18956288
    ds_read_b64_tr_b16 v[48:49], v58 offset:9376
    ds_read_b64_tr_b16 v[50:51], v58 offset:13984
    v_mfma_f32_16x16x32_bf16 a[204:207], v[20:23], a[124:127], a[204:207]
    ds_read_b64_tr_b16 v[52:53], v58 offset:37024
    ds_read_b64_tr_b16 v[54:55], v58 offset:41632
    v_mfma_f32_16x16x32_bf16 a[204:207], v[16:19], a[116:119], a[204:207]
    s_waitcnt lgkmcnt(14)
    v_cvt_pk_bf16_f32 v120, v120, v121
    v_cvt_pk_bf16_f32 v121, v122, v123
    v_mfma_f32_16x16x32_bf16 a[200:203], v[24:27], a[128:131], a[200:203]
    s_waitcnt lgkmcnt(12)
    ds_read_b64_tr_b16 v[16:17], v57 offset:18464
    ds_read_b64_tr_b16 v[18:19], v57 offset:23072
    v_mfma_f32_16x16x32_bf16 a[200:203], v[28:31], a[136:139], a[200:203]
    ds_read_b64_tr_b16 v[20:21], v57 offset:27680
    ds_read_b64_tr_b16 v[22:23], v57 offset:32288
    v_mfma_f32_16x16x32_bf16 a[204:207], v[28:31], a[140:143], a[204:207]
    v_cvt_pk_bf16_f32 v122, v124, v125
    v_cvt_pk_bf16_f32 v123, v126, v127
    v_mfma_f32_16x16x32_bf16 a[204:207], v[24:27], a[132:135], a[204:207]
    s_waitcnt lgkmcnt(14)
    v_mfma_f32_16x16x32_bf16 a[200:203], v[32:35], a[144:147], a[200:203]
    s_waitcnt lgkmcnt(12)
    ds_read_b64_tr_b16 v[24:25], v57 offset:36896
    ds_read_b64_tr_b16 v[26:27], v57 offset:41504
    v_mfma_f32_16x16x32_bf16 a[200:203], v[36:39], a[152:155], a[200:203]
    ds_read_b64_tr_b16 v[28:29], v58 offset:27680
    ds_read_b64_tr_b16 v[30:31], v58 offset:32288
    v_mfma_f32_16x16x32_bf16 a[204:207], v[36:39], a[156:159], a[204:207]
    v_mfma_f32_16x16x32_bf16 a[204:207], v[32:35], a[148:151], a[204:207]
    s_waitcnt lgkmcnt(14)
    v_mfma_f32_16x16x32_bf16 a[200:203], v[40:43], a[160:163], a[200:203]
    s_waitcnt lgkmcnt(12)
    ds_read_b64_tr_b16 v[32:33], v56 offset:36896
    ds_read_b64_tr_b16 v[34:35], v56 offset:41504
    v_mfma_f32_16x16x32_bf16 a[200:203], v[44:47], a[168:171], a[200:203]
    ds_read_b64_tr_b16 v[36:37], v56 offset:46112
    ds_read_b64_tr_b16 v[38:39], v56 offset:50720
    v_mfma_f32_16x16x32_bf16 a[204:207], v[44:47], a[172:175], a[204:207]
    buffer_store_dwordx4 v[216:219], v59, s[64:67], s90 offen offset:0 sc1
    v_mfma_f32_16x16x32_bf16 a[204:207], v[40:43], a[164:167], a[204:207]
    s_waitcnt lgkmcnt(14)
    s_or_b32 s90, s76, 18878464
    v_mfma_f32_16x16x32_bf16 a[200:203], v[48:51], v[128:131], a[200:203]
    s_waitcnt lgkmcnt(12)
    ds_read_b64_tr_b16 v[40:41], v57 offset:32
    ds_read_b64_tr_b16 v[42:43], v57 offset:4640
    v_mfma_f32_16x16x32_bf16 a[200:203], v[52:55], v[136:139], a[200:203]
    ds_read_b64_tr_b16 v[44:45], v57 offset:9248
    ds_read_b64_tr_b16 v[46:47], v57 offset:13856
    v_mfma_f32_16x16x32_bf16 a[204:207], v[52:55], v[140:143], a[204:207]
    v_mfma_f32_16x16x32_bf16 a[204:207], v[48:51], v[132:135], a[204:207]
    s_waitcnt lgkmcnt(14)
    v_mfma_f32_16x16x32_bf16 v[152:155], v[16:19], a[96:99], v[152:155]
    s_waitcnt lgkmcnt(12)
    ds_read_b64_tr_b16 v[48:49], v57 offset:46112
    ds_read_b64_tr_b16 v[50:51], v57 offset:50720
    v_mfma_f32_16x16x32_bf16 v[152:155], v[20:23], a[104:107], v[152:155]
    ds_read_b64_tr_b16 v[52:53], v58 offset:32
    ds_read_b64_tr_b16 v[54:55], v58 offset:4640
    v_mfma_f32_16x16x32_bf16 v[156:159], v[20:23], a[108:111], v[156:159]
    v_mfma_f32_16x16x32_bf16 v[156:159], v[16:19], a[100:103], v[156:159]
    s_waitcnt lgkmcnt(14)
    v_mfma_f32_16x16x32_bf16 v[152:155], v[24:27], a[112:115], v[152:155]
    s_waitcnt lgkmcnt(12)
    ds_read_b64_tr_b16 v[16:17], v58 offset:9248
    ds_read_b64_tr_b16 v[18:19], v58 offset:13856
    v_mfma_f32_16x16x32_bf16 v[152:155], v[28:31], a[120:123], v[152:155]
    ds_read_b64_tr_b16 v[20:21], v58 offset:36896
    ds_read_b64_tr_b16 v[22:23], v58 offset:41504
    v_mfma_f32_16x16x32_bf16 v[156:159], v[28:31], a[124:127], v[156:159]
    v_accvgpr_read_b32 v108, a204
    v_accvgpr_read_b32 v109, a205
    v_mfma_f32_16x16x32_bf16 v[156:159], v[24:27], a[116:119], v[156:159]
    s_waitcnt lgkmcnt(14)
    v_accvgpr_read_b32 v110, a206
    v_accvgpr_read_b32 v111, a207
    v_mfma_f32_16x16x32_bf16 v[152:155], v[32:35], a[128:131], v[152:155]
    s_waitcnt lgkmcnt(12)
    buffer_store_dwordx4 v[120:123], v59, s[64:67], s90 offen offset:0 sc1
    v_mfma_f32_16x16x32_bf16 v[152:155], v[36:39], a[136:139], v[152:155]
    ds_read_b64_tr_b16 v[24:25], v57 offset:18624
    ds_read_b64_tr_b16 v[26:27], v57 offset:23232
    v_mfma_f32_16x16x32_bf16 v[156:159], v[36:39], a[140:143], v[156:159]
    ds_read_b64_tr_b16 v[28:29], v57 offset:27840
    ds_read_b64_tr_b16 v[30:31], v57 offset:32448
    v_mfma_f32_16x16x32_bf16 v[156:159], v[32:35], a[132:135], v[156:159]
    s_waitcnt lgkmcnt(14)
    v_accvgpr_read_b32 v104, a200
    v_accvgpr_read_b32 v105, a201
    v_mfma_f32_16x16x32_bf16 v[152:155], v[40:43], a[144:147], v[152:155]
    s_waitcnt lgkmcnt(12)
    ds_read_b64_tr_b16 v[32:33], v57 offset:37056
    ds_read_b64_tr_b16 v[34:35], v57 offset:41664
    v_mfma_f32_16x16x32_bf16 v[152:155], v[44:47], a[152:155], v[152:155]
    ds_read_b64_tr_b16 v[36:37], v58 offset:27840
    ds_read_b64_tr_b16 v[38:39], v58 offset:32448
    v_mfma_f32_16x16x32_bf16 v[156:159], v[44:47], a[156:159], v[156:159]
    v_accvgpr_read_b32 v106, a202
    v_accvgpr_read_b32 v107, a203
    v_mfma_f32_16x16x32_bf16 v[156:159], v[40:43], a[148:151], v[156:159]
    s_waitcnt lgkmcnt(14)
    v_cvt_pk_bf16_f32 v104, v104, v105
    v_cvt_pk_bf16_f32 v105, v106, v107
    v_mfma_f32_16x16x32_bf16 v[152:155], v[48:51], a[160:163], v[152:155]
    s_waitcnt lgkmcnt(12)
    ds_read_b64_tr_b16 v[40:41], v56 offset:37056
    ds_read_b64_tr_b16 v[42:43], v56 offset:41664
    v_mfma_f32_16x16x32_bf16 v[152:155], v[52:55], a[168:171], v[152:155]
    ds_read_b64_tr_b16 v[44:45], v56 offset:46272
    ds_read_b64_tr_b16 v[46:47], v56 offset:50880
    v_mfma_f32_16x16x32_bf16 v[156:159], v[52:55], a[172:175], v[156:159]
    v_cvt_pk_bf16_f32 v106, v108, v109
    v_cvt_pk_bf16_f32 v107, v110, v111
    v_mfma_f32_16x16x32_bf16 v[156:159], v[48:51], a[164:167], v[156:159]
    s_waitcnt lgkmcnt(14)
    s_or_b32 s90, s77, 18952192
    v_mfma_f32_16x16x32_bf16 v[152:155], v[16:19], v[128:131], v[152:155]
    s_waitcnt lgkmcnt(12)
    ds_read_b64_tr_b16 v[48:49], v57 offset:192
    ds_read_b64_tr_b16 v[50:51], v57 offset:4800
    v_mfma_f32_16x16x32_bf16 v[152:155], v[20:23], v[136:139], v[152:155]
    ds_read_b64_tr_b16 v[52:53], v57 offset:9408
    ds_read_b64_tr_b16 v[54:55], v57 offset:14016
    v_mfma_f32_16x16x32_bf16 v[156:159], v[20:23], v[140:143], v[156:159]
    buffer_store_dwordx4 v[104:107], v59, s[64:67], s90 offen offset:0 sc1
    v_mfma_f32_16x16x32_bf16 v[156:159], v[16:19], v[132:135], v[156:159]
    s_waitcnt lgkmcnt(14)
    v_mfma_f32_16x16x32_bf16 v[168:171], v[24:27], a[96:99], v[168:171]
    s_waitcnt lgkmcnt(12)
    ds_read_b64_tr_b16 v[16:17], v57 offset:46272
    ds_read_b64_tr_b16 v[18:19], v57 offset:50880
    v_mfma_f32_16x16x32_bf16 v[168:171], v[28:31], a[104:107], v[168:171]
    ds_read_b64_tr_b16 v[20:21], v58 offset:192
    ds_read_b64_tr_b16 v[22:23], v58 offset:4800
    v_mfma_f32_16x16x32_bf16 v[172:175], v[28:31], a[108:111], v[172:175]
    v_mfma_f32_16x16x32_bf16 v[172:175], v[24:27], a[100:103], v[172:175]
    s_waitcnt lgkmcnt(14)
    v_mfma_f32_16x16x32_bf16 v[168:171], v[32:35], a[112:115], v[168:171]
    s_waitcnt lgkmcnt(12)
    ds_read_b64_tr_b16 v[24:25], v58 offset:9408
    ds_read_b64_tr_b16 v[26:27], v58 offset:14016
    v_mfma_f32_16x16x32_bf16 v[168:171], v[36:39], a[120:123], v[168:171]
    ds_read_b64_tr_b16 v[28:29], v58 offset:37056
    ds_read_b64_tr_b16 v[30:31], v58 offset:41664
    v_mfma_f32_16x16x32_bf16 v[172:175], v[36:39], a[124:127], v[172:175]
    v_cvt_pk_bf16_f32 v152, v152, v153
    v_cvt_pk_bf16_f32 v153, v154, v155
    v_mfma_f32_16x16x32_bf16 v[172:175], v[32:35], a[116:119], v[172:175]
    s_waitcnt lgkmcnt(14)
    v_cvt_pk_bf16_f32 v154, v156, v157
    v_cvt_pk_bf16_f32 v155, v158, v159
    v_mfma_f32_16x16x32_bf16 v[168:171], v[40:43], a[128:131], v[168:171]
    s_waitcnt vmcnt(2) lgkmcnt(12)
    ds_read_b64_tr_b16 v[32:33], v57 offset:18496
    ds_read_b64_tr_b16 v[34:35], v57 offset:23104
    v_mfma_f32_16x16x32_bf16 v[168:171], v[44:47], a[136:139], v[168:171]
    s_barrier
    ds_read_b64_tr_b16 v[36:37], v57 offset:27712
    ds_read_b64_tr_b16 v[38:39], v57 offset:32320
    v_mfma_f32_16x16x32_bf16 v[172:175], v[44:47], a[140:143], v[172:175]
    s_or_b32 s90, s76, 18878464
    buffer_store_dword v15, v63, s[56:59], s74 offen offset:32 sc1
    v_mfma_f32_16x16x32_bf16 v[172:175], v[40:43], a[132:135], v[172:175]
    s_waitcnt lgkmcnt(14)
    v_mfma_f32_16x16x32_bf16 v[168:171], v[48:51], a[144:147], v[168:171]
    s_waitcnt lgkmcnt(12)
    ds_read_b64_tr_b16 v[40:41], v57 offset:36928
    ds_read_b64_tr_b16 v[42:43], v57 offset:41536
    v_mfma_f32_16x16x32_bf16 v[168:171], v[52:55], a[152:155], v[168:171]
Lqad4:
    s_cbranch_execz Lwalk2_done
    buffer_store_dwordx4 v[152:155], v59, s[64:67], s90 offen offset:1024 sc1
    v_mfma_f32_16x16x32_bf16 v[172:175], v[52:55], a[156:159], v[172:175]
    ds_read_b64_tr_b16 v[44:45], v58 offset:27712
    ds_read_b64_tr_b16 v[46:47], v58 offset:32320
    v_mfma_f32_16x16x32_bf16 v[172:175], v[48:51], a[148:151], v[172:175]
    s_waitcnt lgkmcnt(14)
    v_mfma_f32_16x16x32_bf16 v[168:171], v[16:19], a[160:163], v[168:171]
    s_waitcnt lgkmcnt(12)
    ds_read_b64_tr_b16 v[48:49], v56 offset:36928
    ds_read_b64_tr_b16 v[50:51], v56 offset:41536
    v_mfma_f32_16x16x32_bf16 v[168:171], v[20:23], a[168:171], v[168:171]
    ds_read_b64_tr_b16 v[52:53], v56 offset:46144
    ds_read_b64_tr_b16 v[54:55], v56 offset:50752
    v_mfma_f32_16x16x32_bf16 v[172:175], v[20:23], a[172:175], v[172:175]
    v_mfma_f32_16x16x32_bf16 v[172:175], v[16:19], a[164:167], v[172:175]
    s_waitcnt lgkmcnt(14)
    v_mfma_f32_16x16x32_bf16 v[168:171], v[24:27], v[128:131], v[168:171]
    s_waitcnt lgkmcnt(12)
    ds_read_b64_tr_b16 v[16:17], v57 offset:64
    ds_read_b64_tr_b16 v[18:19], v57 offset:4672
    v_mfma_f32_16x16x32_bf16 v[168:171], v[28:31], v[136:139], v[168:171]
    ds_read_b64_tr_b16 v[20:21], v57 offset:9280
    ds_read_b64_tr_b16 v[22:23], v57 offset:13888
    v_mfma_f32_16x16x32_bf16 v[172:175], v[28:31], v[140:143], v[172:175]
    v_mfma_f32_16x16x32_bf16 v[172:175], v[24:27], v[132:135], v[172:175]
    s_waitcnt lgkmcnt(14)
    v_mfma_f32_16x16x32_bf16 a[184:187], v[32:35], a[96:99], a[184:187]
    s_waitcnt lgkmcnt(12)
    ds_read_b64_tr_b16 v[24:25], v57 offset:46144
    ds_read_b64_tr_b16 v[26:27], v57 offset:50752
    v_mfma_f32_16x16x32_bf16 a[184:187], v[36:39], a[104:107], a[184:187]
    ds_read_b64_tr_b16 v[28:29], v58 offset:64
    ds_read_b64_tr_b16 v[30:31], v58 offset:4672
    v_mfma_f32_16x16x32_bf16 a[188:191], v[36:39], a[108:111], a[188:191]
    v_mfma_f32_16x16x32_bf16 a[188:191], v[32:35], a[100:103], a[188:191]
    s_waitcnt lgkmcnt(14)
    v_mfma_f32_16x16x32_bf16 a[184:187], v[40:43], a[112:115], a[184:187]
    s_waitcnt lgkmcnt(12)
    ds_read_b64_tr_b16 v[32:33], v58 offset:9280
    ds_read_b64_tr_b16 v[34:35], v58 offset:13888
    v_mfma_f32_16x16x32_bf16 a[184:187], v[44:47], a[120:123], a[184:187]
    ds_read_b64_tr_b16 v[36:37], v58 offset:36928
    ds_read_b64_tr_b16 v[38:39], v58 offset:41536
    v_mfma_f32_16x16x32_bf16 a[188:191], v[44:47], a[124:127], a[188:191]
    v_cvt_pk_bf16_f32 v168, v168, v169
    v_cvt_pk_bf16_f32 v169, v170, v171
    v_mfma_f32_16x16x32_bf16 a[188:191], v[40:43], a[116:119], a[188:191]
    s_waitcnt lgkmcnt(14)
    v_cvt_pk_bf16_f32 v170, v172, v173
    v_cvt_pk_bf16_f32 v171, v174, v175
    v_mfma_f32_16x16x32_bf16 a[184:187], v[48:51], a[128:131], a[184:187]
    s_waitcnt lgkmcnt(12)
    s_or_b32 s90, s77, 18952192
    buffer_store_dwordx4 v[168:171], v59, s[64:67], s90 offen offset:1024 sc1
    v_mfma_f32_16x16x32_bf16 a[184:187], v[52:55], a[136:139], a[184:187]
    ds_read_b64_tr_b16 v[40:41], v57 offset:18656
    ds_read_b64_tr_b16 v[42:43], v57 offset:23264
    v_mfma_f32_16x16x32_bf16 a[188:191], v[52:55], a[140:143], a[188:191]
    ds_read_b64_tr_b16 v[44:45], v57 offset:27872
    ds_read_b64_tr_b16 v[46:47], v57 offset:32480
    v_mfma_f32_16x16x32_bf16 a[188:191], v[48:51], a[132:135], a[188:191]
    s_waitcnt lgkmcnt(14)
    v_mfma_f32_16x16x32_bf16 a[184:187], v[16:19], a[144:147], a[184:187]
    s_waitcnt lgkmcnt(12)
    ds_read_b64_tr_b16 v[48:49], v57 offset:37088
    ds_read_b64_tr_b16 v[50:51], v57 offset:41696
    v_mfma_f32_16x16x32_bf16 a[184:187], v[20:23], a[152:155], a[184:187]
    ds_read_b64_tr_b16 v[52:53], v58 offset:27872
    ds_read_b64_tr_b16 v[54:55], v58 offset:32480
    v_mfma_f32_16x16x32_bf16 a[188:191], v[20:23], a[156:159], a[188:191]
    v_mfma_f32_16x16x32_bf16 a[188:191], v[16:19], a[148:151], a[188:191]
    s_waitcnt lgkmcnt(14)
    v_mfma_f32_16x16x32_bf16 a[184:187], v[24:27], a[160:163], a[184:187]
    s_waitcnt lgkmcnt(12)
    ds_read_b64_tr_b16 v[16:17], v56 offset:37088
    ds_read_b64_tr_b16 v[18:19], v56 offset:41696
    v_mfma_f32_16x16x32_bf16 a[184:187], v[28:31], a[168:171], a[184:187]
    ds_read_b64_tr_b16 v[20:21], v56 offset:46304
    ds_read_b64_tr_b16 v[22:23], v56 offset:50912
    v_mfma_f32_16x16x32_bf16 a[188:191], v[28:31], a[172:175], a[188:191]
    v_mfma_f32_16x16x32_bf16 a[188:191], v[24:27], a[164:167], a[188:191]
    s_waitcnt lgkmcnt(14)
    v_mfma_f32_16x16x32_bf16 a[184:187], v[32:35], v[128:131], a[184:187]
    s_waitcnt lgkmcnt(12)
    ds_read_b64_tr_b16 v[24:25], v57 offset:224
    ds_read_b64_tr_b16 v[26:27], v57 offset:4832
    v_mfma_f32_16x16x32_bf16 a[184:187], v[36:39], v[136:139], a[184:187]
    ds_read_b64_tr_b16 v[28:29], v57 offset:9440
    ds_read_b64_tr_b16 v[30:31], v57 offset:14048
    v_mfma_f32_16x16x32_bf16 a[188:191], v[36:39], v[140:143], a[188:191]
    v_mfma_f32_16x16x32_bf16 a[188:191], v[32:35], v[132:135], a[188:191]
    s_waitcnt lgkmcnt(14)
    v_mfma_f32_16x16x32_bf16 v[200:203], v[40:43], a[96:99], v[200:203]
    s_waitcnt lgkmcnt(12)
    ds_read_b64_tr_b16 v[32:33], v57 offset:46304
    ds_read_b64_tr_b16 v[34:35], v57 offset:50912
    v_mfma_f32_16x16x32_bf16 v[200:203], v[44:47], a[104:107], v[200:203]
    ds_read_b64_tr_b16 v[36:37], v58 offset:224
    ds_read_b64_tr_b16 v[38:39], v58 offset:4832
    v_mfma_f32_16x16x32_bf16 v[204:207], v[44:47], a[108:111], v[204:207]
    v_mfma_f32_16x16x32_bf16 v[204:207], v[40:43], a[100:103], v[204:207]
    s_waitcnt lgkmcnt(14)
    v_mfma_f32_16x16x32_bf16 v[200:203], v[48:51], a[112:115], v[200:203]
    s_waitcnt lgkmcnt(12)
    ds_read_b64_tr_b16 v[40:41], v58 offset:9440
    ds_read_b64_tr_b16 v[42:43], v58 offset:14048
    v_mfma_f32_16x16x32_bf16 v[200:203], v[52:55], a[120:123], v[200:203]
    ds_read_b64_tr_b16 v[44:45], v58 offset:37088
    ds_read_b64_tr_b16 v[46:47], v58 offset:41696
    v_mfma_f32_16x16x32_bf16 v[204:207], v[52:55], a[124:127], v[204:207]
    v_accvgpr_read_b32 v92, a188
    v_accvgpr_read_b32 v93, a189
    v_mfma_f32_16x16x32_bf16 v[204:207], v[48:51], a[116:119], v[204:207]
    s_waitcnt lgkmcnt(14)
    v_accvgpr_read_b32 v94, a190
    v_accvgpr_read_b32 v95, a191
    v_mfma_f32_16x16x32_bf16 v[200:203], v[16:19], a[128:131], v[200:203]
    s_waitcnt lgkmcnt(12)
    buffer_load_dword v14, v246, s[56:59], s15 offen offset:32 sc1
    v_mfma_f32_16x16x32_bf16 v[200:203], v[20:23], a[136:139], v[200:203]
    ds_read_b64_tr_b16 v[48:49], v57 offset:18528
    ds_read_b64_tr_b16 v[50:51], v57 offset:23136
    v_mfma_f32_16x16x32_bf16 v[204:207], v[20:23], a[140:143], v[204:207]
    ds_read_b64_tr_b16 v[52:53], v57 offset:27744
    ds_read_b64_tr_b16 v[54:55], v57 offset:32352
    v_mfma_f32_16x16x32_bf16 v[204:207], v[16:19], a[132:135], v[204:207]
    s_waitcnt lgkmcnt(14)
    v_accvgpr_read_b32 v88, a184
    v_accvgpr_read_b32 v89, a185
    v_mfma_f32_16x16x32_bf16 v[200:203], v[24:27], a[144:147], v[200:203]
    s_waitcnt lgkmcnt(12)
    ds_read_b64_tr_b16 v[16:17], v57 offset:36960
    ds_read_b64_tr_b16 v[18:19], v57 offset:41568
    v_mfma_f32_16x16x32_bf16 v[200:203], v[28:31], a[152:155], v[200:203]
    ds_read_b64_tr_b16 v[20:21], v58 offset:27744
    ds_read_b64_tr_b16 v[22:23], v58 offset:32352
    v_mfma_f32_16x16x32_bf16 v[204:207], v[28:31], a[156:159], v[204:207]
    v_accvgpr_read_b32 v90, a186
    v_accvgpr_read_b32 v91, a187
    v_mfma_f32_16x16x32_bf16 v[204:207], v[24:27], a[148:151], v[204:207]
    s_waitcnt lgkmcnt(14)
    v_cvt_pk_bf16_f32 v88, v88, v89
    v_cvt_pk_bf16_f32 v89, v90, v91
    v_mfma_f32_16x16x32_bf16 v[200:203], v[32:35], a[160:163], v[200:203]
    s_waitcnt lgkmcnt(12)
    ds_read_b64_tr_b16 v[24:25], v56 offset:36960
    ds_read_b64_tr_b16 v[26:27], v56 offset:41568
    v_mfma_f32_16x16x32_bf16 v[200:203], v[36:39], a[168:171], v[200:203]
    ds_read_b64_tr_b16 v[28:29], v56 offset:46176
    ds_read_b64_tr_b16 v[30:31], v56 offset:50784
    v_mfma_f32_16x16x32_bf16 v[204:207], v[36:39], a[172:175], v[204:207]
    v_cvt_pk_bf16_f32 v90, v92, v93
    v_cvt_pk_bf16_f32 v91, v94, v95
    v_mfma_f32_16x16x32_bf16 v[204:207], v[32:35], a[164:167], v[204:207]
    s_waitcnt lgkmcnt(14)
    s_or_b32 s90, s76, 18878464
    buffer_store_dwordx4 v[88:91], v59, s[64:67], s90 offen offset:2048 sc1
    v_mfma_f32_16x16x32_bf16 v[200:203], v[40:43], v[128:131], v[200:203]
    s_waitcnt lgkmcnt(12)
    ds_read_b64_tr_b16 v[32:33], v57 offset:96
    ds_read_b64_tr_b16 v[34:35], v57 offset:4704
    v_mfma_f32_16x16x32_bf16 v[200:203], v[44:47], v[136:139], v[200:203]
    ds_read_b64_tr_b16 v[36:37], v57 offset:9312
    ds_read_b64_tr_b16 v[38:39], v57 offset:13920
    v_mfma_f32_16x16x32_bf16 v[204:207], v[44:47], v[140:143], v[204:207]
    v_mfma_f32_16x16x32_bf16 v[204:207], v[40:43], v[132:135], v[204:207]
    s_waitcnt lgkmcnt(14)
    v_mfma_f32_16x16x32_bf16 v[184:187], v[48:51], a[96:99], v[184:187]
    s_waitcnt lgkmcnt(12)
    ds_read_b64_tr_b16 v[40:41], v57 offset:46176
    ds_read_b64_tr_b16 v[42:43], v57 offset:50784
    v_mfma_f32_16x16x32_bf16 v[184:187], v[52:55], a[104:107], v[184:187]
    ds_read_b64_tr_b16 v[44:45], v58 offset:96
    ds_read_b64_tr_b16 v[46:47], v58 offset:4704
    v_mfma_f32_16x16x32_bf16 v[188:191], v[52:55], a[108:111], v[188:191]
    v_mfma_f32_16x16x32_bf16 v[188:191], v[48:51], a[100:103], v[188:191]
    s_waitcnt lgkmcnt(14)
    v_mfma_f32_16x16x32_bf16 v[184:187], v[16:19], a[112:115], v[184:187]
    s_waitcnt lgkmcnt(12)
    ds_read_b64_tr_b16 v[48:49], v58 offset:9312
    ds_read_b64_tr_b16 v[50:51], v58 offset:13920
    v_mfma_f32_16x16x32_bf16 v[184:187], v[20:23], a[120:123], v[184:187]
    ds_read_b64_tr_b16 v[52:53], v58 offset:36960
    ds_read_b64_tr_b16 v[54:55], v58 offset:41568
    v_mfma_f32_16x16x32_bf16 v[188:191], v[20:23], a[124:127], v[188:191]
    v_cvt_pk_bf16_f32 v200, v200, v201
    v_cvt_pk_bf16_f32 v201, v202, v203
    v_mfma_f32_16x16x32_bf16 v[188:191], v[16:19], a[116:119], v[188:191]
    s_waitcnt lgkmcnt(14)
    v_cvt_pk_bf16_f32 v202, v204, v205
    v_cvt_pk_bf16_f32 v203, v206, v207
    v_mfma_f32_16x16x32_bf16 v[184:187], v[24:27], a[128:131], v[184:187]
    s_waitcnt lgkmcnt(12)
    s_or_b32 s90, s77, 18952192
    buffer_store_dwordx4 v[200:203], v59, s[64:67], s90 offen offset:2048 sc1
    v_mfma_f32_16x16x32_bf16 v[184:187], v[28:31], a[136:139], v[184:187]
    ds_read_b64_tr_b16 v[16:17], v57 offset:18688
    ds_read_b64_tr_b16 v[18:19], v57 offset:23296
    v_mfma_f32_16x16x32_bf16 v[188:191], v[28:31], a[140:143], v[188:191]
    ds_read_b64_tr_b16 v[20:21], v57 offset:27904
    ds_read_b64_tr_b16 v[22:23], v57 offset:32512
    v_mfma_f32_16x16x32_bf16 v[188:191], v[24:27], a[132:135], v[188:191]
    s_waitcnt lgkmcnt(14)
    v_mfma_f32_16x16x32_bf16 v[184:187], v[32:35], a[144:147], v[184:187]
    s_waitcnt lgkmcnt(12)
    ds_read_b64_tr_b16 v[24:25], v57 offset:37120
    ds_read_b64_tr_b16 v[26:27], v57 offset:41728
    v_mfma_f32_16x16x32_bf16 v[184:187], v[36:39], a[152:155], v[184:187]
    ds_read_b64_tr_b16 v[28:29], v58 offset:27904
    ds_read_b64_tr_b16 v[30:31], v58 offset:32512
    v_mfma_f32_16x16x32_bf16 v[188:191], v[36:39], a[156:159], v[188:191]
    v_mfma_f32_16x16x32_bf16 v[188:191], v[32:35], a[148:151], v[188:191]
    s_waitcnt lgkmcnt(14)
    v_mfma_f32_16x16x32_bf16 v[184:187], v[40:43], a[160:163], v[184:187]
    s_waitcnt lgkmcnt(12)
    ds_read_b64_tr_b16 v[32:33], v56 offset:37120
    ds_read_b64_tr_b16 v[34:35], v56 offset:41728
    v_mfma_f32_16x16x32_bf16 v[184:187], v[44:47], a[168:171], v[184:187]
    ds_read_b64_tr_b16 v[36:37], v56 offset:46336
    ds_read_b64_tr_b16 v[38:39], v56 offset:50944
    v_mfma_f32_16x16x32_bf16 v[188:191], v[44:47], a[172:175], v[188:191]
    v_mfma_f32_16x16x32_bf16 v[188:191], v[40:43], a[164:167], v[188:191]
    s_waitcnt lgkmcnt(14)
    v_mfma_f32_16x16x32_bf16 v[184:187], v[48:51], v[128:131], v[184:187]
    s_waitcnt lgkmcnt(12)
    ds_read_b64_tr_b16 v[40:41], v57 offset:256
    ds_read_b64_tr_b16 v[42:43], v57 offset:4864
    v_mfma_f32_16x16x32_bf16 v[184:187], v[52:55], v[136:139], v[184:187]
    s_waitcnt vmcnt(3)
    ds_read_b64_tr_b16 v[44:45], v57 offset:9472
    ds_read_b64_tr_b16 v[46:47], v57 offset:14080
    v_mfma_f32_16x16x32_bf16 v[188:191], v[52:55], v[140:143], v[188:191]
    s_barrier
    v_mfma_f32_16x16x32_bf16 v[188:191], v[48:51], v[132:135], v[188:191]
    s_waitcnt lgkmcnt(14)
    buffer_store_dword v15, v63, s[56:59], s74 offen offset:96 sc1
    v_mfma_f32_16x16x32_bf16 v[232:235], v[16:19], a[96:99], v[232:235]
    s_waitcnt lgkmcnt(12)
    ds_read_b64_tr_b16 v[48:49], v57 offset:46336
    ds_read_b64_tr_b16 v[50:51], v57 offset:50944
    v_mfma_f32_16x16x32_bf16 v[232:235], v[20:23], a[104:107], v[232:235]
    ds_read_b64_tr_b16 v[52:53], v58 offset:256
    ds_read_b64_tr_b16 v[54:55], v58 offset:4864
    v_mfma_f32_16x16x32_bf16 v[236:239], v[20:23], a[108:111], v[236:239]
    v_mfma_f32_16x16x32_bf16 v[236:239], v[16:19], a[100:103], v[236:239]
    s_waitcnt lgkmcnt(14)
    v_mfma_f32_16x16x32_bf16 v[232:235], v[24:27], a[112:115], v[232:235]
    s_waitcnt lgkmcnt(12)
    ds_read_b64_tr_b16 v[16:17], v58 offset:9472
    ds_read_b64_tr_b16 v[18:19], v58 offset:14080
    v_mfma_f32_16x16x32_bf16 v[232:235], v[28:31], a[120:123], v[232:235]
    ds_read_b64_tr_b16 v[20:21], v58 offset:37120
    ds_read_b64_tr_b16 v[22:23], v58 offset:41728
    v_mfma_f32_16x16x32_bf16 v[236:239], v[28:31], a[124:127], v[236:239]
    v_cvt_pk_bf16_f32 v184, v184, v185
    v_cvt_pk_bf16_f32 v185, v186, v187
    v_mfma_f32_16x16x32_bf16 v[236:239], v[24:27], a[116:119], v[236:239]
    s_waitcnt lgkmcnt(14)
    v_cvt_pk_bf16_f32 v186, v188, v189
    v_cvt_pk_bf16_f32 v187, v190, v191
    v_mfma_f32_16x16x32_bf16 v[232:235], v[32:35], a[128:131], v[232:235]
    s_waitcnt lgkmcnt(12)
    s_or_b32 s90, s76, 18878464
    buffer_store_dwordx4 v[184:187], v59, s[64:67], s90 offen offset:3072 sc1
    v_mfma_f32_16x16x32_bf16 v[232:235], v[36:39], a[136:139], v[232:235]
    v_mfma_f32_16x16x32_bf16 v[236:239], v[36:39], a[140:143], v[236:239]
    v_mfma_f32_16x16x32_bf16 v[236:239], v[32:35], a[132:135], v[236:239]
    s_waitcnt lgkmcnt(10)
    v_mfma_f32_16x16x32_bf16 v[232:235], v[40:43], a[144:147], v[232:235]
    s_waitcnt lgkmcnt(8)
    v_mfma_f32_16x16x32_bf16 v[232:235], v[44:47], a[152:155], v[232:235]
    v_mfma_f32_16x16x32_bf16 v[236:239], v[44:47], a[156:159], v[236:239]
    v_mfma_f32_16x16x32_bf16 v[236:239], v[40:43], a[148:151], v[236:239]
    s_waitcnt lgkmcnt(6)
    v_mfma_f32_16x16x32_bf16 v[232:235], v[48:51], a[160:163], v[232:235]
    s_waitcnt lgkmcnt(4)
    v_mfma_f32_16x16x32_bf16 v[232:235], v[52:55], a[168:171], v[232:235]
    v_mfma_f32_16x16x32_bf16 v[236:239], v[52:55], a[172:175], v[236:239]
    v_mfma_f32_16x16x32_bf16 v[236:239], v[48:51], a[164:167], v[236:239]
    s_waitcnt lgkmcnt(2)
    v_mfma_f32_16x16x32_bf16 v[232:235], v[16:19], v[128:131], v[232:235]
    s_waitcnt lgkmcnt(0)
    v_mfma_f32_16x16x32_bf16 v[232:235], v[20:23], v[136:139], v[232:235]
    v_mfma_f32_16x16x32_bf16 v[236:239], v[20:23], v[140:143], v[236:239]
    s_waitcnt vmcnt(4)
    v_cmp_eq_u32 vcc, s22, v14
    s_nop 0
    s_andn2_b32 s84, vcc_lo, s87
    s_and_b32 s84, s84, 0xff
    v_mfma_f32_16x16x32_bf16 v[236:239], v[16:19], v[132:135], v[236:239]
    s_nop 7
    v_cvt_pk_bf16_f32 v232, v232, v233
    v_cvt_pk_bf16_f32 v233, v234, v235
    v_cvt_pk_bf16_f32 v234, v236, v237
    v_cvt_pk_bf16_f32 v235, v238, v239
    s_or_b32 s90, s77, 18952192
    buffer_store_dwordx4 v[232:235], v59, s[64:67], s90 offen offset:3072 sc1
    buffer_load_dword v14, v246, s[56:59], s15 offen offset:32 sc1
    s_mov_b32 s43, 1048576
    s_mov_b32 s88, 18874368
    s_bitcmp1_b32 s84, 0
    s_cselect_b32 s88, s88, 1879048192
    buffer_load_dwordx4 a[0:3], v60, s[64:67], s88 offen sc1 nt
    buffer_load_dwordx4 a[36:39], v62, s[64:67], s88 offen sc1 nt
    s_mov_b32 s88, 18883584
    s_bitcmp1_b32 s84, 1
    s_cselect_b32 s88, s88, 1879048192
    buffer_load_dwordx4 a[4:7], v60, s[64:67], s88 offen sc1 nt
    buffer_load_dwordx4 a[44:47], v62, s[64:67], s88 offen sc1 nt
    s_mov_b32 s88, 18892800
    s_bitcmp1_b32 s84, 2
    s_cselect_b32 s88, s88, 1879048192
    buffer_load_dwordx4 a[8:11], v60, s[64:67], s88 offen sc1 nt
    buffer_load_dwordx4 a[52:55], v62, s[64:67], s88 offen sc1 nt
    s_mov_b32 s88, 18902016
    s_bitcmp1_b32 s84, 3
    s_cselect_b32 s88, s88, 1879048192
    buffer_load_dwordx4 a[12:15], v60, s[64:67], s88 offen sc1 nt
    buffer_load_dwordx4 a[60:63], v62, s[64:67], s88 offen sc1 nt
    s_mov_b32 s88, 18911232
    s_bitcmp1_b32 s84, 4
    s_cselect_b32 s88, s88, 1879048192
    buffer_load_dwordx4 a[16:19], v60, s[64:67], s88 offen sc1 nt
    buffer_load_dwordx4 a[68:71], v62, s[64:67], s88 offen sc1 nt
    s_mov_b32 s88, 18920448
    s_bitcmp1_b32 s84, 5
    s_cselect_b32 s88, s88, 1879048192
    buffer_load_dwordx4 a[20:23], v60, s[64:67], s88 offen sc1 nt
    buffer_load_dwordx4 a[76:79], v62, s[64:67], s88 offen sc1 nt
    s_mov_b32 s88, 18929664
    s_bitcmp1_b32 s84, 6
    s_cselect_b32 s88, s88, 1879048192
    buffer_load_dwordx4 a[24:27], v60, s[64:67], s88 offen sc1 nt
    buffer_load_dwordx4 a[84:87], v62, s[64:67], s88 offen sc1 nt
    s_mov_b32 s88, 18938880
    s_bitcmp1_b32 s84, 7
    s_cselect_b32 s88, s88, 1879048192
    buffer_load_dwordx4 a[28:31], v60, s[64:67], s88 offen sc1 nt
    buffer_load_dwordx4 a[92:95], v62, s[64:67], s88 offen sc1 nt
    s_mov_b32 s26, 1
    s_lshl_b32 s90, s69, 7
    s_add_u32 s90, s90, 12288
    s_cmp_eq_u32 s68, 0
    s_cselect_b32 s90, s90, 1879048192
    s_or_b32 s84, s84, s87
    v_and_b32 v7, 63, v0
    v_lshlrev_b32 v7, 4, v7
    v_add_u32 v7, 129024, v7
    v_lshlrev_b32 v8, 4, v0
    v_add_u32 v8, 129024, v8
    s_cmp_eq_u32 s76, 0
    s_cbranch_scc1 Lown0
    ds_write_b128 v7, v[112:115] offset:0
    ds_write_b128 v7, v[144:147] offset:1024
    ds_write_b128 v7, v[80:83] offset:2048
    ds_write_b128 v7, v[176:179] offset:3072
    ds_write_b128 v7, v[120:123] offset:4096
    ds_write_b128 v7, v[152:155] offset:5120
    ds_write_b128 v7, v[88:91] offset:6144
    ds_write_b128 v7, v[184:187] offset:7168
    ds_write_b128 v7, v[208:211] offset:8192
Lown0:
    s_cmp_eq_u32 s77, 0
    s_cbranch_scc1 Lown1
    ds_write_b128 v7, v[96:99] offset:0
    ds_write_b128 v7, v[160:163] offset:1024
    ds_write_b128 v7, v[192:195] offset:2048
    ds_write_b128 v7, v[224:227] offset:3072
    ds_write_b128 v7, v[104:107] offset:4096
    ds_write_b128 v7, v[168:171] offset:5120
    ds_write_b128 v7, v[200:203] offset:6144
    ds_write_b128 v7, v[232:235] offset:7168
    ds_write_b128 v7, v[216:219] offset:8192
Lown1:
    s_waitcnt lgkmcnt(0)
    s_waitcnt vmcnt(16)
    s_barrier
    buffer_store_dword v15, v63, s[56:59], s74 offen offset:64 sc1
    buffer_store_dword v15, v63, s[56:59], s90 offen sc1
    buffer_load_dwordx2 v[64:65], v9, s[32:35], 0 offen
    buffer_load_dwordx2 v[66:67], v9, s[32:35], s86 offen
    buffer_load_dwordx2 v[68:69], v10, s[32:35], 0 offen
    buffer_load_dwordx2 v[70:71], v10, s[32:35], s86 offen
    buffer_load_dwordx2 v[72:73], v11, s[32:35], 0 offen
    buffer_load_dwordx2 v[74:75], v11, s[32:35], s86 offen
Lfin_loop:
    v_cmp_eq_u32 vcc, s22, v14
    s_nop 0
    s_or_b32 s85, vcc_lo, s87
    s_and_b32 s85, s85, 0xffff
    s_andn2_b32 s85, s85, s84
    s_or_b32 s84, s84, s85
    s_bitcmp1_b32 s85, 0
    s_cbranch_scc0 Lfin_a0
    s_mov_b32 s88, 18874368
    buffer_load_dwordx4 a[0:3], v60, s[64:67], s88 offen sc1 nt
    buffer_load_dwordx4 a[36:39], v62, s[64:67], s88 offen sc1 nt
Lfin_a0:
    s_bitcmp1_b32 s85, 1
    s_cbranch_scc0 Lfin_a1
    s_mov_b32 s88, 18883584
    buffer_load_dwordx4 a[4:7], v60, s[64:67], s88 offen sc1 nt
    buffer_load_dwordx4 a[44:47], v62, s[64:67], s88 offen sc1 nt
Lfin_a1:
    s_bitcmp1_b32 s85, 2
    s_cbranch_scc0 Lfin_a2
    s_mov_b32 s88, 18892800
    buffer_load_dwordx4 a[8:11], v60, s[64:67], s88 offen sc1 nt
    buffer_load_dwordx4 a[52:55], v62, s[64:67], s88 offen sc1 nt
Lfin_a2:
    s_bitcmp1_b32 s85, 3
    s_cbranch_scc0 Lfin_a3
    s_mov_b32 s88, 18902016
    buffer_load_dwordx4 a[12:15], v60, s[64:67], s88 offen sc1 nt
    buffer_load_dwordx4 a[60:63], v62, s[64:67], s88 offen sc1 nt
Lfin_a3:
    s_bitcmp1_b32 s85, 4
    s_cbranch_scc0 Lfin_a4
    s_mov_b32 s88, 18911232
    buffer_load_dwordx4 a[16:19], v60, s[64:67], s88 offen sc1 nt
    buffer_load_dwordx4 a[68:71], v62, s[64:67], s88 offen sc1 nt
Lfin_a4:
    s_bitcmp1_b32 s85, 5
    s_cbranch_scc0 Lfin_a5
    s_mov_b32 s88, 18920448
    buffer_load_dwordx4 a[20:23], v60, s[64:67], s88 offen sc1 nt
    buffer_load_dwordx4 a[76:79], v62, s[64:67], s88 offen sc1 nt
Lfin_a5:
    s_bitcmp1_b32 s85, 6
    s_cbranch_scc0 Lfin_a6
    s_mov_b32 s88, 18929664
    buffer_load_dwordx4 a[24:27], v60, s[64:67], s88 offen sc1 nt
    buffer_load_dwordx4 a[84:87], v62, s[64:67], s88 offen sc1 nt
Lfin_a6:
    s_bitcmp1_b32 s85, 7
    s_cbranch_scc0 Lfin_a7
    s_mov_b32 s88, 18938880
    buffer_load_dwordx4 a[28:31], v60, s[64:67], s88 offen sc1 nt
    buffer_load_dwordx4 a[92:95], v62, s[64:67], s88 offen sc1 nt
Lfin_a7:
    s_bitcmp1_b32 s85, 8
    s_cbranch_scc0 Lfin_b0
    s_mov_b32 s88, 18874368
    buffer_load_dwordx4 a[32:35], v61, s[64:67], s88 offen sc1 nt
Lfin_b0:
    s_bitcmp1_b32 s85, 9
    s_cbranch_scc0 Lfin_b1
    s_mov_b32 s88, 18883584
    buffer_load_dwordx4 a[40:43], v61, s[64:67], s88 offen sc1 nt
Lfin_b1:
    s_bitcmp1_b32 s85, 10
    s_cbranch_scc0 Lfin_b2
    s_mov_b32 s88, 18892800
    buffer_load_dwordx4 a[48:51], v61, s[64:67], s88 offen sc1 nt
Lfin_b2:
    s_bitcmp1_b32 s85, 11
    s_cbranch_scc0 Lfin_b3
    s_mov_b32 s88, 18902016
    buffer_load_dwordx4 a[56:59], v61, s[64:67], s88 offen sc1 nt
Lfin_b3:
    s_bitcmp1_b32 s85, 12
    s_cbranch_scc0 Lfin_b4
    s_mov_b32 s88, 18911232
    buffer_load_dwordx4 a[64:67], v61, s[64:67], s88 offen sc1 nt
Lfin_b4:
    s_bitcmp1_b32 s85, 13
    s_cbranch_scc0 Lfin_b5
    s_mov_b32 s88, 18920448
    buffer_load_dwordx4 a[72:75], v61, s[64:67], s88 offen sc1 nt
Lfin_b5:
    s_bitcmp1_b32 s85, 14
    s_cbranch_scc0 Lfin_b6
    s_mov_b32 s88, 18929664
    buffer_load_dwordx4 a[80:83], v61, s[64:67], s88 offen sc1 nt
Lfin_b6:
    s_bitcmp1_b32 s85, 15
    s_cbranch_scc0 Lfin_b7
    s_mov_b32 s88, 18938880
    buffer_load_dwordx4 a[88:91], v61, s[64:67], s88 offen sc1 nt
Lfin_b7:
    s_cmp_eq_u32 s26, 0
    s_cbranch_scc1 Lfin_c
    s_mov_b32 s26, 0
    v_accvgpr_read_b32 v176, a224
    v_accvgpr_read_b32 v177, a225
    v_accvgpr_read_b32 v178, a226
    v_accvgpr_read_b32 v179, a227
    v_accvgpr_read_b32 v180, a228
    v_accvgpr_read_b32 v181, a229
    v_accvgpr_read_b32 v182, a230
    v_accvgpr_read_b32 v183, a231
    v_accvgpr_read_b32 v184, a232
    v_accvgpr_read_b32 v185, a233
    v_accvgpr_read_b32 v186, a234
    v_accvgpr_read_b32 v187, a235
    v_accvgpr_read_b32 v188, a236
    v_accvgpr_read_b32 v189, a237
    v_accvgpr_read_b32 v190, a238
    v_accvgpr_read_b32 v191, a239
    v_accvgpr_read_b32 v192, a240
    v_accvgpr_read_b32 v193, a241
    v_accvgpr_read_b32 v194, a242
    v_accvgpr_read_b32 v195, a243
    v_accvgpr_read_b32 v196, a244
    v_accvgpr_read_b32 v197, a245
    v_accvgpr_read_b32 v198, a246
    v_accvgpr_read_b32 v199, a247
    v_mul_f32 v176, 1090187827, v176
    v_mul_f32 v208, 0xbfb8aa3b, v176
    v_mul_f32 v177, 1090187827, v177
    v_mul_f32 v209, 0xbfb8aa3b, v177
    v_mul_f32 v178, 1090187827, v178
    v_mul_f32 v210, 0xbfb8aa3b, v178
    v_mul_f32 v179, 1090187827, v179
    v_mul_f32 v211, 0xbfb8aa3b, v179
    v_mul_f32 v180, 1090187827, v180
    v_mul_f32 v212, 0xbfb8aa3b, v180
    v_mul_f32 v181, 1090187827, v181
    v_mul_f32 v213, 0xbfb8aa3b, v181
    v_mul_f32 v182, 1090187827, v182
    v_mul_f32 v214, 0xbfb8aa3b, v182
    v_mul_f32 v183, 1090187827, v183
    v_mul_f32 v215, 0xbfb8aa3b, v183
    v_mul_f32 v184, 1090187827, v184
    v_mul_f32 v216, 0xbfb8aa3b, v184
    v_mul_f32 v185, 1090187827, v185
    v_mul_f32 v217, 0xbfb8aa3b, v185
    v_mul_f32 v186, 1090187827, v186
    v_mul_f32 v218, 0xbfb8aa3b, v186
    v_mul_f32 v187, 1090187827, v187
    v_mul_f32 v219, 0xbfb8aa3b, v187
    v_mul_f32 v188, 1090187827, v188
    v_mul_f32 v220, 0xbfb8aa3b, v188
    v_mul_f32 v189, 1090187827, v189
    v_mul_f32 v221, 0xbfb8aa3b, v189
    v_mul_f32 v190, 1090187827, v190
    v_mul_f32 v222, 0xbfb8aa3b, v190
    v_mul_f32 v191, 1090187827, v191
    v_mul_f32 v223, 0xbfb8aa3b, v191
    v_mul_f32 v192, 1090187827, v192
    v_mul_f32 v224, 0xbfb8aa3b, v192
    v_mul_f32 v193, 1090187827, v193
    v_mul_f32 v225, 0xbfb8aa3b, v193
    v_mul_f32 v194, 1090187827, v194
    v_mul_f32 v226, 0xbfb8aa3b, v194
    v_mul_f32 v195, 1090187827, v195
    v_mul_f32 v227, 0xbfb8aa3b, v195
    v_mul_f32 v196, 1090187827, v196
    v_mul_f32 v228, 0xbfb8aa3b, v196
    v_mul_f32 v197, 1090187827, v197
    v_mul_f32 v229, 0xbfb8aa3b, v197
    v_mul_f32 v198, 1090187827, v198
    v_mul_f32 v230, 0xbfb8aa3b, v198
    v_mul_f32 v199, 1090187827, v199
    v_mul_f32 v231, 0xbfb8aa3b, v199
    v_exp_f32 v208, v208
    v_exp_f32 v209, v209
    v_exp_f32 v210, v210
    v_exp_f32 v211, v211
    v_exp_f32 v212, v212
    v_exp_f32 v213, v213
    v_exp_f32 v214, v214
    v_exp_f32 v215, v215
    v_exp_f32 v216, v216
    v_exp_f32 v217, v217
    v_exp_f32 v218, v218
    v_exp_f32 v219, v219
    v_exp_f32 v220, v220
    v_exp_f32 v221, v221
    v_exp_f32 v222, v222
    v_exp_f32 v223, v223
    v_exp_f32 v224, v224
    v_exp_f32 v225, v225
    v_exp_f32 v226, v226
    v_exp_f32 v227, v227
    v_exp_f32 v228, v228
    v_exp_f32 v229, v229
    v_exp_f32 v230, v230
    v_exp_f32 v231, v231
    v_add_f32 v208, 1.0, v208
    v_add_f32 v209, 1.0, v209
    v_add_f32 v210, 1.0, v210
    v_add_f32 v211, 1.0, v211
    v_add_f32 v212, 1.0, v212
    v_add_f32 v213, 1.0, v213
    v_add_f32 v214, 1.0, v214
    v_add_f32 v215, 1.0, v215
    v_add_f32 v216, 1.0, v216
    v_add_f32 v217, 1.0, v217
    v_add_f32 v218, 1.0, v218
    v_add_f32 v219, 1.0, v219
    v_add_f32 v220, 1.0, v220
    v_add_f32 v221, 1.0, v221
    v_add_f32 v222, 1.0, v222
    v_add_f32 v223, 1.0, v223
    v_add_f32 v224, 1.0, v224
    v_add_f32 v225, 1.0, v225
    v_add_f32 v226, 1.0, v226
    v_add_f32 v227, 1.0, v227
    v_add_f32 v228, 1.0, v228
    v_add_f32 v229, 1.0, v229
    v_add_f32 v230, 1.0, v230
    v_add_f32 v231, 1.0, v231
    v_rcp_f32 v208, v208
    v_rcp_f32 v209, v209
    v_rcp_f32 v210, v210
    v_rcp_f32 v211, v211
    v_rcp_f32 v212, v212
    v_rcp_f32 v213, v213
    v_rcp_f32 v214, v214
    v_rcp_f32 v215, v215
    v_rcp_f32 v216, v216
    v_rcp_f32 v217, v217
    v_rcp_f32 v218, v218
    v_rcp_f32 v219, v219
    v_rcp_f32 v220, v220
    v_rcp_f32 v221, v221
    v_rcp_f32 v222, v222
    v_rcp_f32 v223, v223
    v_rcp_f32 v224, v224
    v_rcp_f32 v225, v225
    v_rcp_f32 v226, v226
    v_rcp_f32 v227, v227
    v_rcp_f32 v228, v228
    v_rcp_f32 v229, v229
    v_rcp_f32 v230, v230
    v_rcp_f32 v231, v231
    v_mul_f32 v176, v176, v208
    v_mul_f32 v177, v177, v209
    v_mul_f32 v178, v178, v210
    v_mul_f32 v179, v179, v211
    v_mul_f32 v180, v180, v212
    v_mul_f32 v181, v181, v213
Lqad5:
    s_cbranch_execz Lwalk2_done
    v_mul_f32 v182, v182, v214
    v_mul_f32 v183, v183, v215
    v_mul_f32 v184, v184, v216
    v_mul_f32 v185, v185, v217
    v_mul_f32 v186, v186, v218
    v_mul_f32 v187, v187, v219
    v_mul_f32 v188, v188, v220
    v_mul_f32 v189, v189, v221
    v_mul_f32 v190, v190, v222
    v_mul_f32 v191, v191, v223
    v_mul_f32 v192, v192, v224
    v_mul_f32 v193, v193, v225
    v_mul_f32 v194, v194, v226
    v_mul_f32 v195, v195, v227
    v_mul_f32 v196, v196, v228
    v_mul_f32 v197, v197, v229
    v_mul_f32 v198, v198, v230
    v_mul_f32 v199, v199, v231
Lfin_c:
    s_cmp_eq_u32 s84, 0xffff
    s_cbranch_scc1 Lfin_go
    s_sub_u32 s43, s43, 1
    s_cbranch_scc1 Lfin_go
    buffer_load_dword v14, v246, s[56:59], s15 offen offset:32 sc1
    s_waitcnt vmcnt(0)
    s_branch Lfin_loop
Lfin_go:
    s_lshr_b32 s85, s85, 8
    s_bcnt1_i32_b32 s85, s85
    s_waitcnt vmcnt(8)
    s_cmp_eq_u32 s85, 8
    s_cbranch_scc1 Lfin_h
    s_waitcnt vmcnt(7)
    s_cmp_eq_u32 s85, 7
    s_cbranch_scc1 Lfin_h
    s_waitcnt vmcnt(6)
    s_cmp_eq_u32 s85, 6
    s_cbranch_scc1 Lfin_h
    s_waitcnt vmcnt(5)
    s_cmp_eq_u32 s85, 5
    s_cbranch_scc1 Lfin_h
    s_waitcnt vmcnt(4)
    s_cmp_eq_u32 s85, 4
    s_cbranch_scc1 Lfin_h
    s_waitcnt vmcnt(3)
    s_cmp_eq_u32 s85, 3
    s_cbranch_scc1 Lfin_h
    s_waitcnt vmcnt(2)
    s_cmp_eq_u32 s85, 2
    s_cbranch_scc1 Lfin_h
    s_waitcnt vmcnt(1)
    s_cmp_eq_u32 s85, 1
    s_cbranch_scc1 Lfin_h
    s_waitcnt vmcnt(0)
Lfin_h:
    s_cmp_lg_u32 s71, 0
    s_cbranch_scc1 Lown_r0
    ds_read_b128 a[0:3], v8
    ds_read_b128 a[36:39], v7 offset:8192
    ds_read_b128 a[32:35], v8 offset:4096
Lown_r0:
    s_cmp_lg_u32 s71, 1
    s_cbranch_scc1 Lown_r1
    ds_read_b128 a[4:7], v8
    ds_read_b128 a[44:47], v7 offset:8192
    ds_read_b128 a[40:43], v8 offset:4096
Lown_r1:
    s_cmp_lg_u32 s71, 2
    s_cbranch_scc1 Lown_r2
    ds_read_b128 a[8:11], v8
    ds_read_b128 a[52:55], v7 offset:8192
    ds_read_b128 a[48:51], v8 offset:4096
Lown_r2:
    s_cmp_lg_u32 s71, 3
    s_cbranch_scc1 Lown_r3
    ds_read_b128 a[12:15], v8
    ds_read_b128 a[60:63], v7 offset:8192
    ds_read_b128 a[56:59], v8 offset:4096
Lown_r3:
    s_cmp_lg_u32 s71, 4
    s_cbranch_scc1 Lown_r4
    ds_read_b128 a[16:19], v8
    ds_read_b128 a[68:71], v7 offset:8192
    ds_read_b128 a[64:67], v8 offset:4096
Lown_r4:
    s_cmp_lg_u32 s71, 5
    s_cbranch_scc1 Lown_r5
    ds_read_b128 a[20:23], v8
    ds_read_b128 a[76:79], v7 offset:8192
    ds_read_b128 a[72:75], v8 offset:4096
Lown_r5:
    s_cmp_lg_u32 s71, 6
    s_cbranch_scc1 Lown_r6
    ds_read_b128 a[24:27], v8
    ds_read_b128 a[84:87], v7 offset:8192
    ds_read_b128 a[80:83], v8 offset:4096
Lown_r6:
    s_cmp_lg_u32 s71, 7
    s_cbranch_scc1 Lown_r7
    ds_read_b128 a[28:31], v8
    ds_read_b128 a[92:95], v7 offset:8192
    ds_read_b128 a[88:91], v8 offset:4096
Lown_r7:
    s_waitcnt lgkmcnt(0)
    v_mfma_f32_16x16x32_bf16 v[144:147], v[242:245], a[0:3], 0
    v_lshlrev_b32 v112, 16, v64
    v_and_b32 v113, 0xffff0000, v64
    v_mfma_f32_16x16x32_bf16 v[148:151], v[240:243], a[0:3], 0
    v_lshlrev_b32 v114, 16, v65
    v_and_b32 v115, 0xffff0000, v65
    v_mfma_f32_16x16x32_bf16 v[144:147], v[242:245], a[4:7], v[144:147]
    v_lshlrev_b32 v116, 16, v66
    v_and_b32 v117, 0xffff0000, v66
    v_mfma_f32_16x16x32_bf16 v[148:151], v[240:243], a[4:7], v[148:151]
    v_lshlrev_b32 v118, 16, v67
    v_and_b32 v119, 0xffff0000, v67
    v_mfma_f32_16x16x32_bf16 v[144:147], v[242:245], a[8:11], v[144:147]
    v_lshlrev_b32 v120, 16, v68
    v_and_b32 v121, 0xffff0000, v68
    v_mfma_f32_16x16x32_bf16 v[148:151], v[240:243], a[8:11], v[148:151]
    v_lshlrev_b32 v122, 16, v69
    v_and_b32 v123, 0xffff0000, v69
    v_mfma_f32_16x16x32_bf16 v[144:147], v[242:245], a[12:15], v[144:147]
    v_lshlrev_b32 v124, 16, v70
    v_and_b32 v125, 0xffff0000, v70
    v_mfma_f32_16x16x32_bf16 v[148:151], v[240:243], a[12:15], v[148:151]
    v_lshlrev_b32 v126, 16, v71
    v_and_b32 v127, 0xffff0000, v71
    v_mfma_f32_16x16x32_bf16 v[144:147], v[242:245], a[16:19], v[144:147]
    v_lshlrev_b32 v128, 16, v72
    v_and_b32 v129, 0xffff0000, v72
    v_mfma_f32_16x16x32_bf16 v[148:151], v[240:243], a[16:19], v[148:151]
    v_lshlrev_b32 v130, 16, v73
    v_and_b32 v131, 0xffff0000, v73
    v_mfma_f32_16x16x32_bf16 v[144:147], v[242:245], a[20:23], v[144:147]
    v_lshlrev_b32 v132, 16, v74
    v_and_b32 v133, 0xffff0000, v74
    v_mfma_f32_16x16x32_bf16 v[148:151], v[240:243], a[20:23], v[148:151]
    v_lshlrev_b32 v134, 16, v75
    v_and_b32 v135, 0xffff0000, v75
    v_mfma_f32_16x16x32_bf16 v[144:147], v[242:245], a[24:27], v[144:147]
    v_mfma_f32_16x16x32_bf16 v[148:151], v[240:243], a[24:27], v[148:151]
    v_mfma_f32_16x16x32_bf16 v[144:147], v[242:245], a[28:31], v[144:147]
    v_mfma_f32_16x16x32_bf16 v[148:151], v[240:243], a[28:31], v[148:151]
    v_mfma_f32_16x16x32_bf16 v[160:163], v[242:245], a[36:39], 0
    v_mfma_f32_16x16x32_bf16 v[164:167], v[240:243], a[36:39], 0
    v_mfma_f32_16x16x32_bf16 v[160:163], v[242:245], a[44:47], v[160:163]
    v_mfma_f32_16x16x32_bf16 v[164:167], v[240:243], a[44:47], v[164:167]
    v_mfma_f32_16x16x32_bf16 v[160:163], v[242:245], a[52:55], v[160:163]
    v_mfma_f32_16x16x32_bf16 v[164:167], v[240:243], a[52:55], v[164:167]
    v_mfma_f32_16x16x32_bf16 v[160:163], v[242:245], a[60:63], v[160:163]
    v_mfma_f32_16x16x32_bf16 v[164:167], v[240:243], a[60:63], v[164:167]
    v_fmac_f32 v112, v144, v176
    v_fmac_f32 v113, v145, v177
    v_mfma_f32_16x16x32_bf16 v[160:163], v[242:245], a[68:71], v[160:163]
    v_fmac_f32 v114, v146, v178
    v_fmac_f32 v115, v147, v179
    v_mfma_f32_16x16x32_bf16 v[164:167], v[240:243], a[68:71], v[164:167]
    v_cvt_pk_bf16_f32 v112, v112, v113
    v_cvt_pk_bf16_f32 v113, v114, v115
    v_mfma_f32_16x16x32_bf16 v[160:163], v[242:245], a[76:79], v[160:163]
    buffer_store_dwordx2 v[112:113], v9, s[36:39], 0 offen nt
    v_mfma_f32_16x16x32_bf16 v[164:167], v[240:243], a[76:79], v[164:167]
    v_fmac_f32 v116, v148, v180
    v_fmac_f32 v117, v149, v181
    v_mfma_f32_16x16x32_bf16 v[160:163], v[242:245], a[84:87], v[160:163]
    v_fmac_f32 v118, v150, v182
    v_fmac_f32 v119, v151, v183
    v_mfma_f32_16x16x32_bf16 v[164:167], v[240:243], a[84:87], v[164:167]
    v_cvt_pk_bf16_f32 v116, v116, v117
    v_cvt_pk_bf16_f32 v117, v118, v119
    v_mfma_f32_16x16x32_bf16 v[160:163], v[242:245], a[92:95], v[160:163]
    buffer_store_dwordx2 v[116:117], v9, s[36:39], s86 offen nt
    v_mfma_f32_16x16x32_bf16 v[164:167], v[240:243], a[92:95], v[164:167]
    s_nop 7
    v_fmac_f32 v128, v160, v192
    v_fmac_f32 v129, v161, v193
    v_fmac_f32 v130, v162, v194
    v_fmac_f32 v131, v163, v195
    v_cvt_pk_bf16_f32 v128, v128, v129
    v_cvt_pk_bf16_f32 v129, v130, v131
    buffer_store_dwordx2 v[128:129], v11, s[36:39], 0 offen nt
    v_fmac_f32 v132, v164, v196
    v_fmac_f32 v133, v165, v197
    v_fmac_f32 v134, v166, v198
    v_fmac_f32 v135, v167, v199
    v_cvt_pk_bf16_f32 v132, v132, v133
    v_cvt_pk_bf16_f32 v133, v134, v135
    buffer_store_dwordx2 v[132:133], v11, s[36:39], s86 offen nt
    s_waitcnt vmcnt(4)
    v_mfma_f32_16x16x32_bf16 v[152:155], v[242:245], a[32:35], 0
    v_mfma_f32_16x16x32_bf16 v[156:159], v[240:243], a[32:35], 0
    v_mfma_f32_16x16x32_bf16 v[152:155], v[242:245], a[40:43], v[152:155]
    v_mfma_f32_16x16x32_bf16 v[156:159], v[240:243], a[40:43], v[156:159]
    v_mfma_f32_16x16x32_bf16 v[152:155], v[242:245], a[48:51], v[152:155]
    v_mfma_f32_16x16x32_bf16 v[156:159], v[240:243], a[48:51], v[156:159]
    v_mfma_f32_16x16x32_bf16 v[152:155], v[242:245], a[56:59], v[152:155]
    v_mfma_f32_16x16x32_bf16 v[156:159], v[240:243], a[56:59], v[156:159]
    v_mfma_f32_16x16x32_bf16 v[152:155], v[242:245], a[64:67], v[152:155]
    v_mfma_f32_16x16x32_bf16 v[156:159], v[240:243], a[64:67], v[156:159]
    v_mfma_f32_16x16x32_bf16 v[152:155], v[242:245], a[72:75], v[152:155]
    v_mfma_f32_16x16x32_bf16 v[156:159], v[240:243], a[72:75], v[156:159]
    v_mfma_f32_16x16x32_bf16 v[152:155], v[242:245], a[80:83], v[152:155]
    v_mfma_f32_16x16x32_bf16 v[156:159], v[240:243], a[80:83], v[156:159]
    v_mfma_f32_16x16x32_bf16 v[152:155], v[242:245], a[88:91], v[152:155]
    v_mfma_f32_16x16x32_bf16 v[156:159], v[240:243], a[88:91], v[156:159]
    s_nop 7
    v_fmac_f32 v120, v152, v184
    v_fmac_f32 v121, v153, v185
    v_fmac_f32 v122, v154, v186
    v_fmac_f32 v123, v155, v187
    v_cvt_pk_bf16_f32 v120, v120, v121
    v_cvt_pk_bf16_f32 v121, v122, v123
    buffer_store_dwordx2 v[120:121], v10, s[36:39], 0 offen nt
    v_fmac_f32 v124, v156, v188
    v_fmac_f32 v125, v157, v189
    v_fmac_f32 v126, v158, v190
    v_fmac_f32 v127, v159, v191
    v_cvt_pk_bf16_f32 v124, v124, v125
    v_cvt_pk_bf16_f32 v125, v126, v127
    buffer_store_dwordx2 v[124:125], v10, s[36:39], s86 offen nt
Lend:
    s_endpgm
Lfallback:
    s_mov_b32 s87, -1
    s_mov_b32 s84, 0
    v_or_b32 v59, 1879048192, v59
    v_mov_b32 v32, 0xff800000
    v_mov_b32 v33, 0xff800000
    v_mov_b32 v34, 0xff800000
    v_mov_b32 v35, 0xff800000
    s_waitcnt vmcnt(0)
Lfb_loop:
    s_barrier
    s_add_u32 m0, s83, 4096
    s_nop 0
    buffer_load_dwordx4 v14, s[44:47], s84 offen offset:0 lds
    s_nop 0
    buffer_load_dwordx4 v15, s[44:47], s84 offen offset:1024 lds
    s_nop 0
    buffer_load_dwordx4 v16, s[44:47], s84 offen offset:2048 lds
    s_nop 0
    buffer_load_dwordx4 v17, s[44:47], s84 offen offset:3072 lds
    s_waitcnt vmcnt(0)
    s_barrier
    ds_read_b128 a[144:147], v20 offset:0
    ds_read_b128 a[148:151], v21 offset:0
    ds_read_b128 a[152:155], v22 offset:0
    ds_read_b128 a[156:159], v23 offset:0
    ds_read_b128 a[160:163], v20 offset:4096
    ds_read_b128 a[164:167], v21 offset:4096
    ds_read_b128 a[168:171], v22 offset:4096
    ds_read_b128 a[172:175], v23 offset:4096
    s_waitcnt lgkmcnt(0)
    v_mfma_f32_16x16x32_bf16 v[64:67], a[144:147], v[112:115], 0
    v_mfma_f32_16x16x32_bf16 v[64:67], a[148:151], v[144:147], v[64:67]
    v_mfma_f32_16x16x32_bf16 v[64:67], a[152:155], v[176:179], v[64:67]
    v_mfma_f32_16x16x32_bf16 v[64:67], a[156:159], v[208:211], v[64:67]
    v_mfma_f32_16x16x32_bf16 v[68:71], a[156:159], v[212:215], 0
    v_mfma_f32_16x16x32_bf16 v[68:71], a[152:155], v[180:183], v[68:71]
    v_mfma_f32_16x16x32_bf16 v[68:71], a[148:151], v[148:151], v[68:71]
    v_mfma_f32_16x16x32_bf16 v[68:71], a[144:147], v[116:119], v[68:71]
    v_mfma_f32_16x16x32_bf16 v[72:75], a[144:147], v[120:123], 0
    v_mfma_f32_16x16x32_bf16 v[72:75], a[148:151], v[152:155], v[72:75]
    v_mfma_f32_16x16x32_bf16 v[72:75], a[152:155], v[184:187], v[72:75]
    v_mfma_f32_16x16x32_bf16 v[72:75], a[156:159], v[216:219], v[72:75]
    v_mfma_f32_16x16x32_bf16 v[76:79], a[156:159], v[220:223], 0
    v_mfma_f32_16x16x32_bf16 v[76:79], a[152:155], v[188:191], v[76:79]
    v_mfma_f32_16x16x32_bf16 v[76:79], a[148:151], v[156:159], v[76:79]
    v_mfma_f32_16x16x32_bf16 v[76:79], a[144:147], v[124:127], v[76:79]
    v_mfma_f32_16x16x32_bf16 v[80:83], a[160:163], v[112:115], 0
    v_mfma_f32_16x16x32_bf16 v[80:83], a[164:167], v[144:147], v[80:83]
    v_mfma_f32_16x16x32_bf16 v[80:83], a[168:171], v[176:179], v[80:83]
    v_mfma_f32_16x16x32_bf16 v[80:83], a[172:175], v[208:211], v[80:83]
    v_mfma_f32_16x16x32_bf16 v[84:87], a[172:175], v[212:215], 0
    v_mfma_f32_16x16x32_bf16 v[84:87], a[168:171], v[180:183], v[84:87]
    v_mfma_f32_16x16x32_bf16 v[84:87], a[164:167], v[148:151], v[84:87]
    v_mfma_f32_16x16x32_bf16 v[84:87], a[160:163], v[116:119], v[84:87]
    v_mfma_f32_16x16x32_bf16 v[88:91], a[160:163], v[120:123], 0
    v_mfma_f32_16x16x32_bf16 v[88:91], a[164:167], v[152:155], v[88:91]
    v_mfma_f32_16x16x32_bf16 v[88:91], a[168:171], v[184:187], v[88:91]
    v_mfma_f32_16x16x32_bf16 v[88:91], a[172:175], v[216:219], v[88:91]
    v_mfma_f32_16x16x32_bf16 v[92:95], a[172:175], v[220:223], 0
    v_mfma_f32_16x16x32_bf16 v[92:95], a[168:171], v[188:191], v[92:95]
    v_mfma_f32_16x16x32_bf16 v[92:95], a[164:167], v[156:159], v[92:95]
    v_mfma_f32_16x16x32_bf16 v[92:95], a[160:163], v[124:127], v[92:95]
    s_nop 7
    v_max3_f32 v32, v64, v65, v32
    v_max3_f32 v32, v66, v67, v32
    v_max3_f32 v32, v80, v81, v32
    v_max3_f32 v32, v82, v83, v32
    v_max3_f32 v33, v68, v69, v33
    v_max3_f32 v33, v70, v71, v33
    v_max3_f32 v33, v84, v85, v33
    v_max3_f32 v33, v86, v87, v33
    v_max3_f32 v34, v72, v73, v34
    v_max3_f32 v34, v74, v75, v34
    v_max3_f32 v34, v88, v89, v34
    v_max3_f32 v34, v90, v91, v34
    v_max3_f32 v35, v76, v77, v35
    v_max3_f32 v35, v78, v79, v35
    v_max3_f32 v35, v92, v93, v35
    v_max3_f32 v35, v94, v95, v35
    ds_read_b128 a[144:147], v20 offset:8192
    ds_read_b128 a[148:151], v21 offset:8192
    ds_read_b128 a[152:155], v22 offset:8192
    ds_read_b128 a[156:159], v23 offset:8192
    ds_read_b128 a[160:163], v20 offset:12288
    ds_read_b128 a[164:167], v21 offset:12288
    ds_read_b128 a[168:171], v22 offset:12288
    ds_read_b128 a[172:175], v23 offset:12288
    s_waitcnt lgkmcnt(0)
    v_mfma_f32_16x16x32_bf16 v[64:67], a[144:147], v[112:115], 0
    v_mfma_f32_16x16x32_bf16 v[64:67], a[148:151], v[144:147], v[64:67]
    v_mfma_f32_16x16x32_bf16 v[64:67], a[152:155], v[176:179], v[64:67]
    v_mfma_f32_16x16x32_bf16 v[64:67], a[156:159], v[208:211], v[64:67]
    v_mfma_f32_16x16x32_bf16 v[68:71], a[156:159], v[212:215], 0
    v_mfma_f32_16x16x32_bf16 v[68:71], a[152:155], v[180:183], v[68:71]
    v_mfma_f32_16x16x32_bf16 v[68:71], a[148:151], v[148:151], v[68:71]
    v_mfma_f32_16x16x32_bf16 v[68:71], a[144:147], v[116:119], v[68:71]
    v_mfma_f32_16x16x32_bf16 v[72:75], a[144:147], v[120:123], 0
    v_mfma_f32_16x16x32_bf16 v[72:75], a[148:151], v[152:155], v[72:75]
    v_mfma_f32_16x16x32_bf16 v[72:75], a[152:155], v[184:187], v[72:75]
    v_mfma_f32_16x16x32_bf16 v[72:75], a[156:159], v[216:219], v[72:75]
    v_mfma_f32_16x16x32_bf16 v[76:79], a[156:159], v[220:223], 0
    v_mfma_f32_16x16x32_bf16 v[76:79], a[152:155], v[188:191], v[76:79]
    v_mfma_f32_16x16x32_bf16 v[76:79], a[148:151], v[156:159], v[76:79]
    v_mfma_f32_16x16x32_bf16 v[76:79], a[144:147], v[124:127], v[76:79]
    v_mfma_f32_16x16x32_bf16 v[80:83], a[160:163], v[112:115], 0
    v_mfma_f32_16x16x32_bf16 v[80:83], a[164:167], v[144:147], v[80:83]
    v_mfma_f32_16x16x32_bf16 v[80:83], a[168:171], v[176:179], v[80:83]
    v_mfma_f32_16x16x32_bf16 v[80:83], a[172:175], v[208:211], v[80:83]
    v_mfma_f32_16x16x32_bf16 v[84:87], a[172:175], v[212:215], 0
    v_mfma_f32_16x16x32_bf16 v[84:87], a[168:171], v[180:183], v[84:87]
    v_mfma_f32_16x16x32_bf16 v[84:87], a[164:167], v[148:151], v[84:87]
    v_mfma_f32_16x16x32_bf16 v[84:87], a[160:163], v[116:119], v[84:87]
    v_mfma_f32_16x16x32_bf16 v[88:91], a[160:163], v[120:123], 0
    v_mfma_f32_16x16x32_bf16 v[88:91], a[164:167], v[152:155], v[88:91]
    v_mfma_f32_16x16x32_bf16 v[88:91], a[168:171], v[184:187], v[88:91]
    v_mfma_f32_16x16x32_bf16 v[88:91], a[172:175], v[216:219], v[88:91]
    v_mfma_f32_16x16x32_bf16 v[92:95], a[172:175], v[220:223], 0
    v_mfma_f32_16x16x32_bf16 v[92:95], a[168:171], v[188:191], v[92:95]
    v_mfma_f32_16x16x32_bf16 v[92:95], a[164:167], v[156:159], v[92:95]
    v_mfma_f32_16x16x32_bf16 v[92:95], a[160:163], v[124:127], v[92:95]
    s_nop 7
    v_max3_f32 v32, v64, v65, v32
    v_max3_f32 v32, v66, v67, v32
    v_max3_f32 v32, v80, v81, v32
    v_max3_f32 v32, v82, v83, v32
    v_max3_f32 v33, v68, v69, v33
    v_max3_f32 v33, v70, v71, v33
    v_max3_f32 v33, v84, v85, v33
    v_max3_f32 v33, v86, v87, v33
    v_max3_f32 v34, v72, v73, v34
    v_max3_f32 v34, v74, v75, v34
    v_max3_f32 v34, v88, v89, v34
    v_max3_f32 v34, v90, v91, v34
    v_max3_f32 v35, v76, v77, v35
    v_max3_f32 v35, v78, v79, v35
    v_max3_f32 v35, v92, v93, v35
    v_max3_f32 v35, v94, v95, v35
    s_add_u32 s84, s84, 16384
    s_cmp_lt_u32 s84, 524288
    s_cbranch_scc1 Lfb_loop
    s_barrier
    s_mov_b32 s84, 0
    s_add_u32 m0, s83, 4096
    s_nop 0
    buffer_load_dwordx4 v14, s[44:47], s84 offen offset:0 lds
    s_nop 0
    buffer_load_dwordx4 v15, s[44:47], s84 offen offset:1024 lds
    s_nop 0
    buffer_load_dwordx4 v16, s[44:47], s84 offen offset:2048 lds
    s_nop 0
    buffer_load_dwordx4 v17, s[44:47], s84 offen offset:3072 lds
    s_mov_b32 s84, 16384
    s_add_u32 m0, s83, 20480
    s_nop 0
    buffer_load_dwordx4 v14, s[44:47], s84 offen offset:0 lds
    s_nop 0
    buffer_load_dwordx4 v15, s[44:47], s84 offen offset:1024 lds
    s_nop 0
    buffer_load_dwordx4 v16, s[44:47], s84 offen offset:2048 lds
    s_nop 0
    buffer_load_dwordx4 v17, s[44:47], s84 offen offset:3072 lds
    s_mov_b32 s84, 0
    s_add_u32 m0, s83, 71680
    s_nop 0
    buffer_load_dwordx4 v18, s[48:51], s84 offen offset:0 lds
    s_nop 0
    buffer_load_dwordx4 v19, s[48:51], s84 offen offset:1024 lds
    s_nop 0
    buffer_load_dwordx4 v18, s[48:51], s84 offen offset:2048 lds
    s_nop 0
    buffer_load_dwordx4 v19, s[48:51], s84 offen offset:3072 lds
    s_waitcnt vmcnt(0)
    s_branch Latt
Lspin_ln:
    s_mov_b32 s27, 1048576
Lspin2_ln:
    buffer_load_dword v25, v24, s[56:59], s86 offen offset:0 sc1
    s_waitcnt vmcnt(0)
    v_cmp_ne_u32 vcc, s22, v25
    s_sub_u32 s27, s27, 1
    s_cbranch_scc1 Lret_ln
    s_cbranch_vccz Lret_ln
    s_sleep 1
    s_branch Lspin2_ln
Lspin_ha:
    s_mov_b32 s43, 1048576
Lspin2_ha:
    buffer_load_dword v21, v1, s[56:59], s79 offen offset:0 sc1
    s_waitcnt vmcnt(0)
    v_cmp_ne_u32 vcc, s22, v21
    s_sub_u32 s43, s43, 1
    s_cbranch_scc1 Lret_ha
    s_cbranch_vccz Lret_ha
    s_sleep 1
    s_branch Lspin2_ha
Lspin_hb:
    s_mov_b32 s43, 1048576
Lspin2_hb:
    buffer_load_dword v21, v1, s[56:59], s79 offen offset:64 sc1
    s_waitcnt vmcnt(0)
    v_cmp_ne_u32 vcc, s22, v21
    s_sub_u32 s43, s43, 1
    s_cbranch_scc1 Lret_hb
    s_cbranch_vccz Lret_hb
    s_sleep 1
    s_branch Lspin2_hb
Lspin_hp:
    s_mov_b32 s43, 1048576
Lspin2_hp:
    buffer_load_dword v61, v1, s[56:59], s89 offen offset:64 sc1
    s_waitcnt vmcnt(0)
    v_cmp_ne_u32 vcc, s22, v61
    s_sub_u32 s43, s43, 1
    s_cbranch_scc1 Lret_hp
    s_cbranch_vccz Lret_hp
    s_sleep 1
    s_branch Lspin2_hp
Lspin_g:
    s_mov_b32 s43, 1048576
Lspin2_g:
    buffer_load_dword v44, v47, s[56:59], 0 offen offset:0 sc1
    s_waitcnt vmcnt(0)
    v_cmp_ne_u32 vcc, s22, v44
    s_sub_u32 s43, s43, 1
    s_cbranch_scc1 Lret_g
    s_cbranch_vccz Lret_g
    s_sleep 1
    s_branch Lspin2_g
Lrel_oa:
    buffer_wbl2 sc1
    s_waitcnt vmcnt(0)
    s_branch Lrel2_oa
Lspin_oa:
    s_mov_b32 s43, 1048576
Lspin2_oa:
    buffer_load_dword v14, v1, s[56:59], s79 offen offset:16 sc1
    s_waitcnt vmcnt(0)
    v_cmp_ne_u32 vcc, s22, v14
    s_sub_u32 s43, s43, 1
    s_cbranch_scc1 Lacq_oa
    s_cbranch_vccz Lacq_oa
    s_sleep 1
    s_branch Lspin2_oa
Lacq_oa:
    s_cmp_eq_u32 s27, 0
    s_cbranch_scc1 Lret_oa
    buffer_inv sc1
    s_waitcnt vmcnt(0)
    s_branch Lret_oa
Lrel_ob:
    buffer_wbl2 sc1
    s_waitcnt vmcnt(0)
    s_branch Lrel2_ob
Lspin_ob:
    s_mov_b32 s43, 1048576
Lspin2_ob:
    buffer_load_dword v14, v1, s[56:59], s79 offen offset:48 sc1
    s_waitcnt vmcnt(0)
    v_cmp_ne_u32 vcc, s22, v14
    s_sub_u32 s43, s43, 1
    s_cbranch_scc1 Lacq_ob
    s_cbranch_vccz Lacq_ob
    s_sleep 1
    s_branch Lspin2_ob
Lacq_ob:
    s_cmp_eq_u32 s27, 0
    s_cbranch_scc1 Lret_ob
    buffer_inv sc1
    s_waitcnt vmcnt(0)
    s_branch Lret_ob
Lcode_end:
.section .rodata,"a"
.p2align 6
.amdhsa_kernel recurrent_scan__mha_block_cached__dense_activation_relu__prompt_kernel
      .amdhsa_next_free_vgpr 512
      .amdhsa_next_free_sgpr 102
      .amdhsa_accum_offset 256
      .amdhsa_group_segment_fixed_size 0
      .amdhsa_kernarg_size 88
      .amdhsa_user_sgpr_count 2
      .amdhsa_user_sgpr_kernarg_segment_ptr 1
      .amdhsa_system_sgpr_workgroup_id_x 1
.end_amdhsa_kernel
```
